```python
import torch

def _softmax(x, axis=-1):
    return torch.softmax(x, dim=axis)
def _gelu(x):
    return torch.nn.functional.gelu(x, approximate="tanh")
def _silu(x):
    return torch.nn.functional.silu(x)
def _sigmoid(x):
    return torch.sigmoid(x)
def _layernorm(x, axis=-1, eps=1e-5):
    m = x.mean(dim=axis, keepdim=True)
    v = x.var(dim=axis, keepdim=True, unbiased=False)
    return (x - m) / torch.sqrt(v + eps)
def _scatter_add(tgt, idx, src, axis=0):
    return tgt.clone().index_add_(axis, idx, src)
def _segment_sum(src, seg, n):
    out = torch.zeros((n,) + src.shape[1:], dtype=src.dtype)
    return out.index_add_(0, seg, src)
def _pad(x, pw):
    flat = tuple(v for pair in reversed(pw) for v in pair)
    return torch.nn.functional.pad(x, flat)

kernel_name = 'gated_mix__ssm_conv_s5__glu_gated_reglu__prompt'

def setup_inputs():

    _w = (lambda a: (lambda t: t.to(torch.bfloat16) if t.is_floating_point() else t)(torch.as_tensor(a)))
    def _A_setup():
        B, S, D = 1, 2048, 576
        P = D
        Lambda_re = -0.5 * (lambda _x: torch.exp(torch.as_tensor(_x)))((lambda *s: torch.randn(*s, dtype=torch.bfloat16) * 0.2)(P))
        Lambda_im = (lambda *s: torch.randn(*s, dtype=torch.bfloat16) * 0.4)(P) * 1.0
        B_re = (lambda *s: torch.randn(*s, dtype=torch.bfloat16) * 0.2)(P, D) * (D ** -0.5)
        B_im = (lambda *s: torch.randn(*s, dtype=torch.bfloat16) * 0.2)(P, D) * (D ** -0.5)
        C_re = (lambda *s: torch.randn(*s, dtype=torch.bfloat16) * 0.2)(D, P) * (P ** -0.5)
        C_im = (lambda *s: torch.randn(*s, dtype=torch.bfloat16) * 0.2)(D, P) * (P ** -0.5)
        log_dt = (lambda *s: torch.randn(*s, dtype=torch.bfloat16) * 0.2)(P) * 0.3 - 2.0
        Dskip = (lambda *s: torch.randn(*s, dtype=torch.bfloat16) * 0.05)(D)
        return {
            "x": _w((lambda *s: torch.randn(*s, dtype=torch.bfloat16) * 0.05)(B, S, D)),
            "Lambda_re": _w(Lambda_re),
            "Lambda_im": _w(Lambda_im),
            "B_re": _w(B_re),
            "B_im": _w(B_im),
            "C_re": _w(C_re),
            "C_im": _w(C_im),
            "log_dt": _w(log_dt),
            "Dskip": _w(Dskip),
        }
    _A_in = _A_setup()

    def _B_setup():
        B, S, D, F = 1, 2048, 576, 4608
        return {
            "x": _w((lambda *s: torch.randn(*s, dtype=torch.bfloat16) * 0.05)(B, S, D)),
            "W_gate": _w((lambda *s: torch.randn(*s, dtype=torch.bfloat16) * 0.8)(D, F) * (2.0 / D) ** 0.5),
            "W_up": _w((lambda *s: torch.randn(*s, dtype=torch.bfloat16) * 0.8)(D, F) * (2.0 / D) ** 0.5),
            "W_down": _w((lambda *s: torch.randn(*s, dtype=torch.bfloat16) * 0.8)(F, D) * (1.0 / F) ** 0.5),
        }
    _B_in = _B_setup()

    return {
        "A_x": _A_in["x"],
        "A_Lambda_re": _A_in["Lambda_re"],
        "A_Lambda_im": _A_in["Lambda_im"],
        "A_B_re": _A_in["B_re"],
        "A_B_im": _A_in["B_im"],
        "A_C_re": _A_in["C_re"],
        "A_C_im": _A_in["C_im"],
        "A_log_dt": _A_in["log_dt"],
        "A_Dskip": _A_in["Dskip"],
        "B_x": _B_in["x"],
        "B_W_gate": _B_in["W_gate"],
        "B_W_up": _B_in["W_up"],
        "B_W_down": _B_in["W_down"],
        "gate_w": _w((lambda *s: torch.randn(*s, dtype=torch.bfloat16) * 0.05)(576) * 16.0),
    }

def reference(A_x, A_Lambda_re, A_Lambda_im, A_B_re, A_B_im, A_C_re, A_C_im, A_log_dt, A_Dskip, B_x, B_W_gate, B_W_up, B_W_down, gate_w):
    def _A_ref(x, Lambda_re, Lambda_im, B_re, B_im, C_re, C_im, log_dt, Dskip):
        Bsz, L, H = x.shape
        Lam = Lambda_re + 1j * Lambda_im
        Bmat = B_re + 1j * B_im
        Cmat = C_re + 1j * C_im
        dt = torch.exp(log_dt)
        Lam_bar = torch.exp(dt * Lam)
        B_bar = ((Lam_bar - 1.0) / Lam)[:, None] * Bmat
        Bu = torch.einsum("bld,pd->blp", x + 0j, B_bar)
        h = torch.zeros_like(Bu[:, 0, :])
        hs = []
        for t in range(L):
            h = Lam_bar[None, :] * h + Bu[:, t, :]
            hs.append(h)
        hseq = torch.stack(hs, 1)
        y = 2.0 * torch.einsum("blp,dp->bld", hseq, Cmat).real + x * Dskip[None, None, :]
        return y

    def _B_ref(x, W_gate, W_up, W_down):
        gate = torch.einsum("bsd,df->bsf", x, W_gate)
        up = torch.einsum("bsd,df->bsf", x, W_up)
        gate = gate * (lambda x, dt: x.to(dt))(gate > 0, gate.dtype)
        h = gate * up
        return torch.einsum("bsf,fd->bsd", h, W_down)

    x = A_x
    g = _sigmoid((x * gate_w).sum(-1, keepdims=True))
    a = _A_ref(x, A_Lambda_re, A_Lambda_im, A_B_re, A_B_im, A_C_re, A_C_im, A_log_dt, A_Dskip)
    b = _B_ref(x, B_W_gate, B_W_up, B_W_down)
    return g * a + (1 - g) * b
```

```asm
; @launch grid=(256,1,1) block=(256,1,1) lds=163840
.amdgcn_target "amdgcn-amd-amdhsa--gfx950"
.text
.macro MF a, b, c, d
  v_mfma_f32_16x16x32_bf16 \a, \b, \c, \d
.endm
.macro TR a, b, c:vararg
  ds_read_b64_tr_b16 \a, \b \c
.endm
.macro BL4 a:vararg
  buffer_load_dwordx4 \a
.endm
.p2align 8
KERNEL_BEGIN:
K1_TB_MAIN:
  s_add_u32 m0, s37, 16384
  s_add_u32 s89, s42, 0
  BL4 v8, s[8:11], s89 offen lds
  s_add_u32 m0, s38, 24576
  s_nop 0
  BL4 v9, s[12:15], s60 offen lds
  s_add_u32 m0, s37, 20480
  s_add_u32 s89, s43, 0
  BL4 v8, s[8:11], s89 offen lds
  s_add_u32 m0, s38, 25600
  s_nop 0
  BL4 v27, s[12:15], s60 offen lds
  s_add_u32 s90, s60, 0
  s_add_u32 m0, s91, 8192
  s_nop 0
  BL4 v30, s[4:7], s90 offen lds
  s_add_u32 m0, s91, 9216
  s_nop 0
  BL4 v31, s[4:7], s90 offen lds
  s_add_u32 s90, s60, 4608
  s_add_u32 m0, s91, 10240
  s_nop 0
  BL4 v30, s[4:7], s90 offen lds
  s_add_u32 m0, s91, 11264
  s_nop 0
  BL4 v31, s[4:7], s90 offen lds
  s_add_u32 s90, s60, 9216
  s_add_u32 m0, s91, 12288
  s_nop 0
  BL4 v30, s[4:7], s90 offen lds
  s_add_u32 m0, s91, 13312
  s_nop 0
  BL4 v31, s[4:7], s90 offen lds
  s_and_b32 s17, s17, 65535
  s_mov_b32 s18, 67108864
  s_mov_b32 s19, 131072
  s_and_b32 s21, s21, 65535
  s_mov_b32 s22, 256
  s_mov_b32 s23, 131072
  s_and_b32 s25, s25, 65535
  s_mov_b32 s26, 1152
  s_mov_b32 s27, 131072
  s_lshl_b32 s80, s33, 4
  s_lshl_b32 s81, s32, 2
  s_add_u32 s80, s80, s81
  s_mul_i32 s80, s80, 185344
  v_lshlrev_b32 v10, 4, v1
  v_add_u32 v10, s80, v10
  s_add_u32 s80, s39, 0
  s_lshl_b32 s80, s80, 5
  v_and_b32 v242, 15, v1
  v_lshlrev_b32 v242, 1, v242
  v_add_u32 v242, s80, v242
  s_mov_b32 s28, s92
  s_and_b32 s29, s93, 65535
  s_mov_b32 s30, 1152
  s_mov_b32 s31, 131072
  buffer_load_ushort v234, v242, s[28:31], 0 offen
  s_mov_b32 s28, s94
  s_and_b32 s29, s95, 65535
  s_mov_b32 s30, 1152
  s_mov_b32 s31, 131072
  buffer_load_ushort v235, v242, s[28:31], 0 offen
  s_mov_b32 s28, s96
  s_and_b32 s29, s97, 65535
  s_mov_b32 s30, 1152
  s_mov_b32 s31, 131072
  buffer_load_ushort v236, v242, s[28:31], 0 offen
  s_add_u32 s80, s39, 1
  s_lshl_b32 s80, s80, 5
  v_and_b32 v242, 15, v1
  v_lshlrev_b32 v242, 1, v242
  v_add_u32 v242, s80, v242
  s_mov_b32 s28, s92
  s_and_b32 s29, s93, 65535
  s_mov_b32 s30, 1152
  s_mov_b32 s31, 131072
  buffer_load_ushort v237, v242, s[28:31], 0 offen
  s_mov_b32 s28, s94
  s_and_b32 s29, s95, 65535
  s_mov_b32 s30, 1152
  s_mov_b32 s31, 131072
  buffer_load_ushort v238, v242, s[28:31], 0 offen
  s_mov_b32 s28, s96
  s_and_b32 s29, s97, 65535
  s_mov_b32 s30, 1152
  s_mov_b32 s31, 131072
  buffer_load_ushort v239, v242, s[28:31], 0 offen
  v_lshrrev_b32 v26, 4, v1
  v_and_b32 v255, 15, v1
  s_lshl_b32 s80, s32, 7
  s_add_u32 s80, s80, 141312
  v_lshlrev_b32 v240, 3, v255
  v_add_u32 v12, 141312, v240
  v_add_u32 v240, s80, v240
  v_lshlrev_b32 v241, 3, v1
  v_add_u32 v241, 142336, v241
  v_cmp_eq_u32 vcc, 3, v26
  s_nop 1
  v_cndmask_b32 v11, v241, v240, vcc
  s_mul_i32 s80, s32, 4608
  s_add_u32 s80, s80, 122880
  v_mul_u32_u24 v240, 144, v255
  v_lshlrev_b32 v241, 5, v26
  v_add_u32 v240, v240, v241
  v_add_u32 v13, s80, v240
  v_lshlrev_b32 v240, 2, v26
  v_lshrrev_b32 v241, 2, v255
  v_add_u32 v240, v240, v241
  v_mul_u32_u24 v240, 144, v240
  v_and_b32 v241, 3, v255
  v_lshlrev_b32 v241, 5, v241
  v_add_u32 v240, v240, v241
  v_add_u32 v14, s80, v240
  s_lshl_b32 s80, s39, 10
  s_add_u32 s80, s80, 32571392
  v_lshlrev_b32 v240, 3, v255
  v_add_u32 v15, s80, v240
  s_lshl_b32 s80, s33, 7
  s_cmp_eq_u32 s32, 0
  s_cselect_b32 s80, s80, 1073741824
  v_add_u32 v22, s80, v15
  v_add_u32 v240, 48, v1
  v_and_b32 v240, 63, v240
  v_lshlrev_b32 v16, 2, v240
  v_add_u32 v240, 32, v1
  v_and_b32 v240, 63, v240
  v_lshlrev_b32 v17, 2, v240
  v_cmp_le_u32 vcc, 1, v26
  v_mov_b32 v240, 0
  v_mov_b32 v241, 1.0
  v_cndmask_b32 v18, v240, v241, vcc
  v_cmp_le_u32 vcc, 2, v26
  s_nop 1
  v_cndmask_b32 v19, v240, v241, vcc
  v_lshlrev_b32 v240, 4, v26
  v_cvt_f32_u32 v20, v240
  s_lshl_b32 s80, s32, 6
  v_add_u32 v240, s80, v240
  v_cvt_f32_u32 v21, v240
  s_cmp_eq_u32 s32, 1
  s_cselect_b32 s76, 0x3f800000, 0
  s_cmp_eq_u32 s32, 2
  s_cselect_b32 s77, 0x3f800000, 0
  s_cmp_eq_u32 s32, 3
  s_cselect_b32 s78, 0x3f800000, 0
  s_mul_i32 s80, s34, 5
  s_add_u32 s80, s80, s35
  s_lshl_b32 s80, s80, 7
  s_add_u32 s80, s80, 32638976
  v_lshlrev_b32 v240, 2, v1
  v_add_u32 v240, s80, v240
  v_mov_b32 v241, 1073741824
  s_cmp_eq_u32 s32, 0
  s_cselect_b32 s81, s33, 0
  v_cmp_gt_u32 vcc, s81, v1
  s_nop 1
  v_cndmask_b32 v24, v241, v240, vcc
  s_lshl_b32 s81, s33, 2
  s_add_u32 s80, s80, s81
  s_cmp_eq_u32 s32, 0
  s_cselect_b32 s80, s80, 1073741824
  v_mov_b32 v240, s80
  v_cmp_eq_u32 vcc, 0, v1
  s_nop 1
  v_cndmask_b32 v23, v241, v240, vcc
  s_cmp_eq_u32 s32, 0
  s_cselect_b32 s81, s33, 0
  s_lshl_b32 s86, 1, s81
  s_sub_u32 s86, s86, 1
  s_cmp_eq_u32 s32, 0
  s_cselect_b32 s3, 1024, 0
  s_add_u32 s3, s3, 142336
  s_cmp_eq_u32 s32, 0
  s_cselect_b32 s80, 0, 1073741824
  v_add_u32 v15, s80, v15
  s_lshl_b32 s80, s2, 3
  s_lshl_b32 s81, s32, 1
  s_add_u32 s80, s80, s81
  v_lshrrev_b32 v25, 5, v1
  v_add_u32 v25, s80, v25
  v_and_b32 v26, 31, v1
  v_lshlrev_b32 v26, 2, v26
  s_mov_b32 s83, 1152
  v_mul_lo_u32 v255, v25, s83
  v_add_u32 v255, v255, v26
  buffer_load_dword v208, v255, s[4:7], 0 offen
  buffer_load_dword v217, v26, s[24:27], 0 offen
  buffer_load_dword v209, v255, s[4:7], 0 offen offset:128
  buffer_load_dword v218, v26, s[24:27], 0 offen offset:128
  buffer_load_dword v210, v255, s[4:7], 0 offen offset:256
  buffer_load_dword v219, v26, s[24:27], 0 offen offset:256
  buffer_load_dword v211, v255, s[4:7], 0 offen offset:384
  buffer_load_dword v220, v26, s[24:27], 0 offen offset:384
  buffer_load_dword v212, v255, s[4:7], 0 offen offset:512
  buffer_load_dword v221, v26, s[24:27], 0 offen offset:512
  buffer_load_dword v213, v255, s[4:7], 0 offen offset:640
  buffer_load_dword v222, v26, s[24:27], 0 offen offset:640
  buffer_load_dword v214, v255, s[4:7], 0 offen offset:768
  buffer_load_dword v223, v26, s[24:27], 0 offen offset:768
  buffer_load_dword v215, v255, s[4:7], 0 offen offset:896
  buffer_load_dword v224, v26, s[24:27], 0 offen offset:896
  buffer_load_dword v216, v255, s[4:7], 0 offen offset:1024
  buffer_load_dword v225, v26, s[24:27], 0 offen offset:1024
  s_mul_i32 s80, s33, 72
  s_lshr_b32 s81, s32, 1
  s_mul_i32 s81, s81, 36
  s_add_u32 s80, s80, s81
  v_add_u32 v248, s80, v1
  s_mov_b32 s81, 9216
  v_mul_lo_u32 v248, v248, s81
  s_lshl_b32 s80, s35, 2
  s_mul_i32 s81, s35, 5
  s_sub_u32 s81, s81, 4
  s_cmp_lt_u32 s35, 4
  s_cselect_b32 s80, s80, s81
  s_mul_i32 s81, s34, 36
  s_add_u32 s80, s80, s81
  s_lshl_b32 s80, s80, 6
  v_add_u32 v248, s80, v248
  v_mov_b32 v232, 1073741824
  v_cmp_gt_u32 vcc, 36, v1
  s_nop 1
  v_cndmask_b32 v248, v232, v248, vcc
  s_waitcnt vmcnt(45)
  ds_read_b128 a[0:3], v252
  ds_read_b128 a[16:19], v253
  s_add_u32 s90, s60, 13824
  s_add_u32 m0, s91, 14336
  s_nop 0
  BL4 v30, s[4:7], s90 offen lds
  s_add_u32 m0, s91, 15360
  s_nop 0
  BL4 v31, s[4:7], s90 offen lds
  s_waitcnt vmcnt(45)
  ds_read_b128 a[4:7], v252 offset:2048
  ds_read_b128 a[20:23], v253 offset:2048
  s_add_u32 s90, s62, 0
  s_add_u32 m0, s91, 0
  s_nop 0
  s_waitcnt lgkmcnt(2)
  BL4 v30, s[4:7], s90 offen lds
  s_add_u32 m0, s91, 1024
  s_nop 0
  BL4 v31, s[4:7], s90 offen lds
  s_waitcnt vmcnt(45)
  ds_read_b128 a[8:11], v252 offset:4096
  ds_read_b128 a[24:27], v253 offset:4096
  s_add_u32 s90, s62, 4608
  s_add_u32 m0, s91, 2048
  s_nop 0
  s_waitcnt lgkmcnt(2)
  BL4 v30, s[4:7], s90 offen lds
  s_add_u32 m0, s91, 3072
  s_nop 0
  BL4 v31, s[4:7], s90 offen lds
  s_waitcnt vmcnt(45)
  ds_read_b128 a[12:15], v252 offset:6144
  ds_read_b128 a[28:31], v253 offset:6144
  s_add_u32 s90, s62, 9216
  s_add_u32 m0, s91, 4096
  s_nop 0
  s_waitcnt lgkmcnt(2)
  BL4 v30, s[4:7], s90 offen lds
  s_add_u32 m0, s91, 5120
  s_nop 0
  BL4 v31, s[4:7], s90 offen lds
  s_waitcnt vmcnt(43)
  s_barrier
  TR v[160:161], v2
  TR v[162:163], v2 offset:256
  TR v[164:165], v2 offset:2048
  TR v[166:167], v2 offset:2304
  TR v[168:169], v4
  TR v[170:171], v4 offset:256
  s_waitcnt lgkmcnt(4)
  MF v[96:99], v[160:163], a[0:3], 0
  TR v[172:173], v4 offset:2048
  MF v[100:103], v[160:163], a[4:7], 0
  TR v[174:175], v4 offset:2304
  MF v[104:107], v[160:163], a[8:11], 0
  s_add_u32 m0, s37, 32768
  s_add_u32 s89, s44, 0
  BL4 v8, s[8:11], s89 offen lds
  MF v[108:111], v[160:163], a[12:15], 0
  s_add_u32 m0, s38, 40960
  s_nop 0
  BL4 v9, s[12:15], s62 offen lds
  s_waitcnt lgkmcnt(4)
  MF v[112:115], v[164:167], a[0:3], 0
  ds_read_b128 v[160:163], v6 offset:8192
  MF v[116:119], v[164:167], a[4:7], 0
  s_cmp_eq_u32 s2, 0
  s_cbranch_scc0 ZSKIP2
  v_mov_b32 v244, 0
  v_mov_b32 v245, 0
  v_mov_b32 v246, 0
  v_mov_b32 v247, 0
  v_lshlrev_b32 v243, 4, v1
  s_add_u32 s80, s32, 0
  s_lshl_b32 s81, s80, 10
  s_add_u32 s81, s81, 32636928
  s_cmp_lt_u32 s80, 14
  s_cselect_b32 s81, s81, 1073741824
  buffer_store_dwordx4 v[244:247], v243, s[16:19], s81 offen sc1
  s_add_u32 s80, s32, 4
  s_lshl_b32 s81, s80, 10
  s_add_u32 s81, s81, 32636928
  s_cmp_lt_u32 s80, 14
  s_cselect_b32 s81, s81, 1073741824
  buffer_store_dwordx4 v[244:247], v243, s[16:19], s81 offen sc1
  s_add_u32 s80, s32, 8
  s_lshl_b32 s81, s80, 10
  s_add_u32 s81, s81, 32636928
  s_cmp_lt_u32 s80, 14
  s_cselect_b32 s81, s81, 1073741824
  buffer_store_dwordx4 v[244:247], v243, s[16:19], s81 offen sc1
  s_add_u32 s80, s32, 12
  s_lshl_b32 s81, s80, 10
  s_add_u32 s81, s81, 32636928
  s_cmp_lt_u32 s80, 14
  s_cselect_b32 s81, s81, 1073741824
  buffer_store_dwordx4 v[244:247], v243, s[16:19], s81 offen sc1
  s_waitcnt vmcnt(0)
ZSKIP2:
  MF v[120:123], v[164:167], a[8:11], 0
  s_waitcnt vmcnt(38)
  ds_read_b128 a[32:35], v252 offset:8192
  MF v[124:127], v[164:167], a[12:15], 0
  ds_read_b128 a[48:51], v253 offset:8192
  s_waitcnt lgkmcnt(5)
  MF v[128:131], v[168:171], a[0:3], 0
  ds_read_b128 v[164:167], v6 offset:10240
  MF v[132:135], v[168:171], a[4:7], 0
  MF v[136:139], v[168:171], a[8:11], 0
  s_add_u32 s90, s62, 13824
  s_add_u32 m0, s91, 6144
  s_nop 0
  BL4 v30, s[4:7], s90 offen lds
  MF v[140:143], v[168:171], a[12:15], 0
  s_add_u32 m0, s91, 7168
  s_nop 0
  BL4 v31, s[4:7], s90 offen lds
  s_waitcnt lgkmcnt(4)
  MF v[144:147], v[172:175], a[0:3], 0
  ds_read_b128 v[168:171], v6 offset:12288
  MF v[148:151], v[172:175], a[4:7], 0
  MF v[152:155], v[172:175], a[8:11], 0
  s_waitcnt vmcnt(38)
  ds_read_b128 a[36:39], v252 offset:10240
  MF v[156:159], v[172:175], a[12:15], 0
  ds_read_b128 a[52:55], v253 offset:10240
  s_add_u32 s90, s64, 0
  s_add_u32 m0, s91, 8192
  s_nop 0
  s_waitcnt lgkmcnt(4)
  BL4 v30, s[4:7], s90 offen lds
  s_add_u32 m0, s91, 9216
  s_nop 0
  BL4 v31, s[4:7], s90 offen lds
  MF v[32:35], a[0:3], v[160:163], 0
  ds_read_b128 v[172:175], v6 offset:14336
  MF v[36:39], a[4:7], v[160:163], 0
  MF v[40:43], a[8:11], v[160:163], 0
  s_add_u32 m0, s37, 36864
  s_add_u32 s89, s45, 0
  BL4 v8, s[8:11], s89 offen lds
  MF v[44:47], a[12:15], v[160:163], 0
  s_add_u32 m0, s38, 41984
  s_nop 0
  BL4 v27, s[12:15], s62 offen lds
  s_waitcnt lgkmcnt(4)
  MF v[48:51], a[0:3], v[164:167], 0
  TR v[160:161], v2 offset:4096
  MF v[52:55], a[4:7], v[164:167], 0
  TR v[162:163], v2 offset:4352
  MF v[56:59], a[8:11], v[164:167], 0
  MF v[60:63], a[12:15], v[164:167], 0
  s_waitcnt lgkmcnt(5)
  MF v[64:67], a[0:3], v[168:171], 0
  TR v[164:165], v2 offset:6144
  MF v[68:71], a[4:7], v[168:171], 0
  TR v[166:167], v2 offset:6400
  MF v[72:75], a[8:11], v[168:171], 0
  MF v[76:79], a[12:15], v[168:171], 0
  s_waitcnt lgkmcnt(4)
  MF v[80:83], a[0:3], v[172:175], 0
  TR v[168:169], v4 offset:4096
  MF v[84:87], a[4:7], v[172:175], 0
  TR v[170:171], v4 offset:4352
  MF v[88:91], a[8:11], v[172:175], 0
  MF v[92:95], a[12:15], v[172:175], 0
  s_waitcnt lgkmcnt(4)
  MF v[96:99], v[160:163], a[16:19], v[96:99]
  TR v[172:173], v4 offset:6144
  MF v[100:103], v[160:163], a[20:23], v[100:103]
  TR v[174:175], v4 offset:6400
  MF v[104:107], v[160:163], a[24:27], v[104:107]
  s_add_u32 m0, s37, 49152
  s_add_u32 s89, s46, 0
  BL4 v8, s[8:11], s89 offen lds
  MF v[108:111], v[160:163], a[28:31], v[108:111]
  s_add_u32 m0, s38, 57344
  s_nop 0
  BL4 v9, s[12:15], s64 offen lds
  s_waitcnt lgkmcnt(4)
  MF v[112:115], v[164:167], a[16:19], v[112:115]
  ds_read_b128 v[160:163], v7 offset:8192
  MF v[116:119], v[164:167], a[20:23], v[116:119]
  MF v[120:123], v[164:167], a[24:27], v[120:123]
  s_waitcnt vmcnt(42)
  ds_read_b128 a[40:43], v252 offset:12288
  MF v[124:127], v[164:167], a[28:31], v[124:127]
  ds_read_b128 a[56:59], v253 offset:12288
  s_waitcnt lgkmcnt(5)
  MF v[128:131], v[168:171], a[16:19], v[128:131]
  ds_read_b128 v[164:167], v7 offset:10240
  s_mov_b32 s84, 64
  MF v[132:135], v[168:171], a[20:23], v[132:135]
  buffer_load_dword v233, v248, s[8:11], s84 offen
  MF v[136:139], v[168:171], a[24:27], v[136:139]
  s_add_u32 s90, s64, 4608
  s_add_u32 m0, s91, 10240
  s_nop 0
  BL4 v30, s[4:7], s90 offen lds
  MF v[140:143], v[168:171], a[28:31], v[140:143]
  s_add_u32 m0, s91, 11264
  s_nop 0
  BL4 v31, s[4:7], s90 offen lds
  s_waitcnt lgkmcnt(4)
  MF v[144:147], v[172:175], a[16:19], v[144:147]
  ds_read_b128 v[168:171], v7 offset:12288
  MF v[148:151], v[172:175], a[20:23], v[148:151]
  MF v[152:155], v[172:175], a[24:27], v[152:155]
  s_waitcnt vmcnt(19)
  ds_read_b128 a[44:47], v252 offset:14336
  MF v[156:159], v[172:175], a[28:31], v[156:159]
  ds_read_b128 a[60:63], v253 offset:14336
  s_add_u32 s90, s64, 9216
  s_add_u32 m0, s91, 12288
  s_nop 0
  s_waitcnt lgkmcnt(4)
  BL4 v30, s[4:7], s90 offen lds
  s_add_u32 m0, s91, 13312
  s_nop 0
  BL4 v31, s[4:7], s90 offen lds
  MF v[32:35], a[16:19], v[160:163], v[32:35]
  ds_read_b128 v[172:175], v7 offset:14336
  MF v[36:39], a[20:23], v[160:163], v[36:39]
  MF v[40:43], a[24:27], v[160:163], v[40:43]
  s_add_u32 m0, s37, 53248
  s_add_u32 s89, s47, 0
  BL4 v8, s[8:11], s89 offen lds
  MF v[44:47], a[28:31], v[160:163], v[44:47]
  s_add_u32 m0, s38, 58368
  s_nop 0
  BL4 v27, s[12:15], s64 offen lds
  s_waitcnt lgkmcnt(4)
  MF v[48:51], a[16:19], v[164:167], v[48:51]
  s_barrier
  TR v[160:161], v2 offset:16384
  MF v[52:55], a[20:23], v[164:167], v[52:55]
  TR v[162:163], v2 offset:16640
  MF v[56:59], a[24:27], v[164:167], v[56:59]
  MF v[60:63], a[28:31], v[164:167], v[60:63]
  s_waitcnt lgkmcnt(5)
  MF v[64:67], a[16:19], v[168:171], v[64:67]
  TR v[164:165], v2 offset:18432
  MF v[68:71], a[20:23], v[168:171], v[68:71]
  TR v[166:167], v2 offset:18688
  MF v[72:75], a[24:27], v[168:171], v[72:75]
  MF v[76:79], a[28:31], v[168:171], v[76:79]
  s_waitcnt lgkmcnt(4)
  MF v[80:83], a[16:19], v[172:175], v[80:83]
  TR v[168:169], v4 offset:16384
  MF v[84:87], a[20:23], v[172:175], v[84:87]
  TR v[170:171], v4 offset:16640
  MF v[88:91], a[24:27], v[172:175], v[88:91]
  MF v[92:95], a[28:31], v[172:175], v[92:95]
  s_waitcnt lgkmcnt(4)
  MF v[96:99], v[160:163], a[32:35], v[96:99]
  TR v[172:173], v4 offset:18432
  MF v[100:103], v[160:163], a[36:39], v[100:103]
  TR v[174:175], v4 offset:18688
  MF v[104:107], v[160:163], a[40:43], v[104:107]
  s_add_u32 m0, s37, 65536
  s_add_u32 s89, s48, 0
  BL4 v8, s[8:11], s89 offen lds
  MF v[108:111], v[160:163], a[44:47], v[108:111]
  s_add_u32 m0, s38, 73728
  s_nop 0
  BL4 v9, s[12:15], s66 offen lds
  s_waitcnt lgkmcnt(4)
  MF v[112:115], v[164:167], a[32:35], v[112:115]
  ds_read_b128 v[160:163], v6 offset:24576
  MF v[116:119], v[164:167], a[36:39], v[116:119]
  MF v[120:123], v[164:167], a[40:43], v[120:123]
  s_waitcnt vmcnt(23)
  ds_read_b128 a[64:67], v252
  MF v[124:127], v[164:167], a[44:47], v[124:127]
  ds_read_b128 a[80:83], v253
  s_waitcnt lgkmcnt(5)
  MF v[128:131], v[168:171], a[32:35], v[128:131]
  ds_read_b128 v[164:167], v6 offset:26624
  MF v[132:135], v[168:171], a[36:39], v[132:135]
  MF v[136:139], v[168:171], a[40:43], v[136:139]
  s_add_u32 s90, s64, 13824
  s_add_u32 m0, s91, 14336
  s_nop 0
  BL4 v30, s[4:7], s90 offen lds
  MF v[140:143], v[168:171], a[44:47], v[140:143]
  s_add_u32 m0, s91, 15360
  s_nop 0
  BL4 v31, s[4:7], s90 offen lds
  s_waitcnt lgkmcnt(4)
  MF v[144:147], v[172:175], a[32:35], v[144:147]
  ds_read_b128 v[168:171], v6 offset:28672
  MF v[148:151], v[172:175], a[36:39], v[148:151]
  MF v[152:155], v[172:175], a[40:43], v[152:155]
  s_waitcnt vmcnt(23)
  ds_read_b128 a[68:71], v252 offset:2048
  MF v[156:159], v[172:175], a[44:47], v[156:159]
  ds_read_b128 a[84:87], v253 offset:2048
  s_add_u32 s90, s66, 0
  s_add_u32 m0, s91, 0
  s_nop 0
  s_waitcnt lgkmcnt(4)
  BL4 v30, s[4:7], s90 offen lds
  s_add_u32 m0, s91, 1024
  s_nop 0
  BL4 v31, s[4:7], s90 offen lds
  MF v[32:35], a[32:35], v[160:163], v[32:35]
  ds_read_b128 v[172:175], v6 offset:30720
  MF v[36:39], a[36:39], v[160:163], v[36:39]
  MF v[40:43], a[40:43], v[160:163], v[40:43]
  s_add_u32 m0, s37, 69632
  s_add_u32 s89, s49, 0
  BL4 v8, s[8:11], s89 offen lds
  MF v[44:47], a[44:47], v[160:163], v[44:47]
  s_add_u32 m0, s38, 74752
  s_nop 0
  BL4 v27, s[12:15], s66 offen lds
  s_waitcnt lgkmcnt(4)
  MF v[48:51], a[32:35], v[164:167], v[48:51]
  TR v[160:161], v2 offset:20480
  MF v[52:55], a[36:39], v[164:167], v[52:55]
  TR v[162:163], v2 offset:20736
  MF v[56:59], a[40:43], v[164:167], v[56:59]
  MF v[60:63], a[44:47], v[164:167], v[60:63]
  s_waitcnt lgkmcnt(5)
  MF v[64:67], a[32:35], v[168:171], v[64:67]
  TR v[164:165], v2 offset:22528
  MF v[68:71], a[36:39], v[168:171], v[68:71]
  TR v[166:167], v2 offset:22784
  MF v[72:75], a[40:43], v[168:171], v[72:75]
  MF v[76:79], a[44:47], v[168:171], v[76:79]
  s_waitcnt lgkmcnt(4)
  MF v[80:83], a[32:35], v[172:175], v[80:83]
  TR v[168:169], v4 offset:20480
  MF v[84:87], a[36:39], v[172:175], v[84:87]
  TR v[170:171], v4 offset:20736
  MF v[88:91], a[40:43], v[172:175], v[88:91]
  MF v[92:95], a[44:47], v[172:175], v[92:95]
  s_waitcnt lgkmcnt(4)
  MF v[96:99], v[160:163], a[48:51], v[96:99]
  TR v[172:173], v4 offset:22528
  MF v[100:103], v[160:163], a[52:55], v[100:103]
  TR v[174:175], v4 offset:22784
  MF v[104:107], v[160:163], a[56:59], v[104:107]
  s_add_u32 m0, s37, 81920
  s_add_u32 s89, s50, 0
  BL4 v8, s[8:11], s89 offen lds
  MF v[108:111], v[160:163], a[60:63], v[108:111]
  s_waitcnt vmcnt(26)
  ds_read_b128 a[72:75], v252 offset:4096
  s_waitcnt lgkmcnt(5)
  MF v[112:115], v[164:167], a[48:51], v[112:115]
  ds_read_b128 v[160:163], v7 offset:24576
  MF v[116:119], v[164:167], a[52:55], v[116:119]
  MF v[120:123], v[164:167], a[56:59], v[120:123]
  ds_read_b128 a[88:91], v253 offset:4096
  MF v[124:127], v[164:167], a[60:63], v[124:127]
  s_add_u32 s90, s66, 4608
  s_add_u32 m0, s91, 2048
  s_nop 0
  BL4 v30, s[4:7], s90 offen lds
  s_waitcnt lgkmcnt(5)
  MF v[128:131], v[168:171], a[48:51], v[128:131]
  ds_read_b128 v[164:167], v7 offset:26624
  MF v[132:135], v[168:171], a[52:55], v[132:135]
  MF v[136:139], v[168:171], a[56:59], v[136:139]
  s_add_u32 m0, s91, 3072
  s_nop 0
  BL4 v31, s[4:7], s90 offen lds
  MF v[140:143], v[168:171], a[60:63], v[140:143]
  s_waitcnt vmcnt(24)
  ds_read_b128 a[76:79], v252 offset:6144
  s_waitcnt lgkmcnt(5)
  MF v[144:147], v[172:175], a[48:51], v[144:147]
  ds_read_b128 v[168:171], v7 offset:28672
  MF v[148:151], v[172:175], a[52:55], v[148:151]
  MF v[152:155], v[172:175], a[56:59], v[152:155]
  ds_read_b128 a[92:95], v253 offset:6144
  MF v[156:159], v[172:175], a[60:63], v[156:159]
  s_add_u32 s90, s66, 9216
  s_add_u32 m0, s91, 4096
  s_nop 0
  s_waitcnt lgkmcnt(4)
  BL4 v30, s[4:7], s90 offen lds
  s_add_u32 m0, s91, 5120
  s_nop 0
  BL4 v31, s[4:7], s90 offen lds
  MF v[32:35], a[48:51], v[160:163], v[32:35]
  ds_read_b128 v[172:175], v7 offset:30720
  MF v[36:39], a[52:55], v[160:163], v[36:39]
  MF v[40:43], a[56:59], v[160:163], v[40:43]
  s_add_u32 m0, s38, 90112
  s_nop 0
  BL4 v9, s[12:15], s68 offen lds
  MF v[44:47], a[60:63], v[160:163], v[44:47]
  s_waitcnt lgkmcnt(4)
  MF v[48:51], a[48:51], v[164:167], v[48:51]
  s_waitcnt vmcnt(23)
  s_barrier
  TR v[160:161], v2 offset:32768
  MF v[52:55], a[52:55], v[164:167], v[52:55]
  TR v[162:163], v2 offset:33024
  MF v[56:59], a[56:59], v[164:167], v[56:59]
  MF v[60:63], a[60:63], v[164:167], v[60:63]
  s_waitcnt lgkmcnt(4)
  MF v[64:67], a[48:51], v[168:171], v[64:67]
  TR v[164:165], v2 offset:34816
  MF v[68:71], a[52:55], v[168:171], v[68:71]
  TR v[166:167], v2 offset:35072
  MF v[72:75], a[56:59], v[168:171], v[72:75]
  MF v[76:79], a[60:63], v[168:171], v[76:79]
  s_waitcnt lgkmcnt(4)
  MF v[80:83], a[48:51], v[172:175], v[80:83]
  TR v[168:169], v4 offset:32768
  MF v[84:87], a[52:55], v[172:175], v[84:87]
  TR v[170:171], v4 offset:33024
  MF v[88:91], a[56:59], v[172:175], v[88:91]
  MF v[92:95], a[60:63], v[172:175], v[92:95]
  s_waitcnt lgkmcnt(4)
  MF v[96:99], v[160:163], a[64:67], v[96:99]
  TR v[172:173], v4 offset:34816
  MF v[100:103], v[160:163], a[68:71], v[100:103]
  TR v[174:175], v4 offset:35072
  MF v[104:107], v[160:163], a[72:75], v[104:107]
  s_add_u32 m0, s37, 86016
  s_add_u32 s89, s51, 0
  BL4 v8, s[8:11], s89 offen lds
  MF v[108:111], v[160:163], a[76:79], v[108:111]
  s_add_u32 m0, s38, 91136
  s_nop 0
  BL4 v27, s[12:15], s68 offen lds
  s_waitcnt lgkmcnt(4)
  MF v[112:115], v[164:167], a[64:67], v[112:115]
  ds_read_b128 v[160:163], v6 offset:40960
  MF v[116:119], v[164:167], a[68:71], v[116:119]
  MF v[120:123], v[164:167], a[72:75], v[120:123]
  ds_read_b128 a[96:99], v252 offset:8192
  MF v[124:127], v[164:167], a[76:79], v[124:127]
  ds_read_b128 a[112:115], v253 offset:8192
  s_waitcnt lgkmcnt(5)
  MF v[128:131], v[168:171], a[64:67], v[128:131]
  ds_read_b128 v[164:167], v6 offset:43008
  MF v[132:135], v[168:171], a[68:71], v[132:135]
  MF v[136:139], v[168:171], a[72:75], v[136:139]
  s_add_u32 s90, s66, 13824
  s_add_u32 m0, s91, 6144
  s_nop 0
  BL4 v30, s[4:7], s90 offen lds
  MF v[140:143], v[168:171], a[76:79], v[140:143]
  s_add_u32 m0, s91, 7168
  s_nop 0
  BL4 v31, s[4:7], s90 offen lds
  s_waitcnt lgkmcnt(4)
  MF v[144:147], v[172:175], a[64:67], v[144:147]
  ds_read_b128 v[168:171], v6 offset:45056
  s_or_b32 s80, s2, s32
  MF v[148:151], v[172:175], a[68:71], v[148:151]
  s_cmp_eq_u32 s80, 0
  s_cselect_b32 s80, 0, 1073741824
  v_mov_b32 v229, s80
  MF v[152:155], v[172:175], a[72:75], v[152:155]
  s_waitcnt vmcnt(22)
  ds_read_b128 a[100:103], v252 offset:10240
  MF v[156:159], v[172:175], a[76:79], v[156:159]
  ds_read_b128 a[116:119], v253 offset:10240
  s_add_u32 s90, s68, 0
  s_add_u32 m0, s91, 8192
  s_nop 0
  s_waitcnt lgkmcnt(4)
  BL4 v30, s[4:7], s90 offen lds
  s_add_u32 m0, s91, 9216
  s_nop 0
  BL4 v31, s[4:7], s90 offen lds
  MF v[32:35], a[64:67], v[160:163], v[32:35]
  ds_read_b128 v[172:175], v6 offset:47104
  v_mov_b32 v230, 1073741824
  MF v[36:39], a[68:71], v[160:163], v[36:39]
  v_cmp_eq_u32 vcc, 0, v1
  s_nop 1
  v_cndmask_b32 v229, v230, v229, vcc
  MF v[40:43], a[72:75], v[160:163], v[40:43]
  s_add_u32 m0, s37, 0
  s_add_u32 s89, s52, 0
  BL4 v8, s[8:11], s89 offen lds
  MF v[44:47], a[76:79], v[160:163], v[44:47]
  v_mov_b32 v230, 1
  s_waitcnt lgkmcnt(4)
  MF v[48:51], a[64:67], v[164:167], v[48:51]
  TR v[160:161], v2 offset:36864
  MF v[52:55], a[68:71], v[164:167], v[52:55]
  TR v[162:163], v2 offset:37120
  MF v[56:59], a[72:75], v[164:167], v[56:59]
  buffer_store_dword v230, v229, s[20:23], 0 offen sc1
  MF v[60:63], a[76:79], v[164:167], v[60:63]
  v_mov_b32 v226, 0
  s_waitcnt lgkmcnt(5)
  MF v[64:67], a[64:67], v[168:171], v[64:67]
  TR v[164:165], v2 offset:38912
  v_mov_b32 v227, 0
  MF v[68:71], a[68:71], v[168:171], v[68:71]
  TR v[166:167], v2 offset:39168
  v_lshlrev_b32 v228, 16, v208
  MF v[72:75], a[72:75], v[168:171], v[72:75]
  v_and_b32 v229, 0xffff0000, v208
  v_lshlrev_b32 v230, 16, v217
  MF v[76:79], a[76:79], v[168:171], v[76:79]
  v_and_b32 v231, 0xffff0000, v217
  s_waitcnt lgkmcnt(4)
  MF v[80:83], a[64:67], v[172:175], v[80:83]
  TR v[168:169], v4 offset:36864
  v_mul_f32 v228, v228, v230
  MF v[84:87], a[68:71], v[172:175], v[84:87]
  TR v[170:171], v4 offset:37120
  v_mul_f32 v229, v229, v231
  MF v[88:91], a[72:75], v[172:175], v[88:91]
  v_cvt_pk_bf16_f32 v228, v228, v229
  v_lshlrev_b32 v230, 16, v228
  MF v[92:95], a[76:79], v[172:175], v[92:95]
  v_and_b32 v231, 0xffff0000, v228
  s_waitcnt lgkmcnt(4)
  MF v[96:99], v[160:163], a[80:83], v[96:99]
  TR v[172:173], v4 offset:38912
  v_add_f32 v226, v226, v230
  MF v[100:103], v[160:163], a[84:87], v[100:103]
  TR v[174:175], v4 offset:39168
  v_add_f32 v227, v227, v231
  MF v[104:107], v[160:163], a[88:91], v[104:107]
  s_add_u32 m0, s38, 8192
  s_nop 0
  BL4 v9, s[12:15], s70 offen lds
  MF v[108:111], v[160:163], a[92:95], v[108:111]
  s_waitcnt vmcnt(25)
  ds_read_b128 a[104:107], v252 offset:12288
  s_waitcnt lgkmcnt(5)
  MF v[112:115], v[164:167], a[80:83], v[112:115]
  ds_read_b128 v[160:163], v7 offset:40960
  v_lshlrev_b32 v228, 16, v209
  MF v[116:119], v[164:167], a[84:87], v[116:119]
  v_and_b32 v229, 0xffff0000, v209
  v_lshlrev_b32 v230, 16, v218
  MF v[120:123], v[164:167], a[88:91], v[120:123]
  ds_read_b128 a[120:123], v253 offset:12288
  MF v[124:127], v[164:167], a[92:95], v[124:127]
  s_add_u32 s90, s68, 4608
  s_add_u32 m0, s91, 10240
  s_nop 0
  BL4 v30, s[4:7], s90 offen lds
  s_waitcnt lgkmcnt(5)
  MF v[128:131], v[168:171], a[80:83], v[128:131]
  ds_read_b128 v[164:167], v7 offset:43008
  v_and_b32 v231, 0xffff0000, v218
  MF v[132:135], v[168:171], a[84:87], v[132:135]
  v_mul_f32 v228, v228, v230
  v_mul_f32 v229, v229, v231
  MF v[136:139], v[168:171], a[88:91], v[136:139]
  s_add_u32 m0, s91, 11264
  s_nop 0
  BL4 v31, s[4:7], s90 offen lds
  MF v[140:143], v[168:171], a[92:95], v[140:143]
  s_waitcnt vmcnt(21)
  ds_read_b128 a[108:111], v252 offset:14336
  s_waitcnt lgkmcnt(5)
  MF v[144:147], v[172:175], a[80:83], v[144:147]
  ds_read_b128 v[168:171], v7 offset:45056
  v_cvt_pk_bf16_f32 v228, v228, v229
  MF v[148:151], v[172:175], a[84:87], v[148:151]
  v_lshlrev_b32 v230, 16, v228
  v_and_b32 v231, 0xffff0000, v228
  MF v[152:155], v[172:175], a[88:91], v[152:155]
  ds_read_b128 a[124:127], v253 offset:14336
  MF v[156:159], v[172:175], a[92:95], v[156:159]
  s_add_u32 s90, s68, 9216
  s_add_u32 m0, s91, 12288
  s_nop 0
  s_waitcnt lgkmcnt(4)
  BL4 v30, s[4:7], s90 offen lds
  s_add_u32 m0, s91, 13312
  s_nop 0
  BL4 v31, s[4:7], s90 offen lds
  MF v[32:35], a[80:83], v[160:163], v[32:35]
  ds_read_b128 v[172:175], v7 offset:47104
  v_add_f32 v226, v226, v230
  MF v[36:39], a[84:87], v[160:163], v[36:39]
  v_add_f32 v227, v227, v231
  v_lshlrev_b32 v228, 16, v210
  MF v[40:43], a[88:91], v[160:163], v[40:43]
  s_add_u32 m0, s37, 4096
  s_add_u32 s89, s53, 0
  BL4 v8, s[8:11], s89 offen lds
  MF v[44:47], a[92:95], v[160:163], v[44:47]
  v_and_b32 v229, 0xffff0000, v210
  s_waitcnt lgkmcnt(4)
  MF v[48:51], a[80:83], v[164:167], v[48:51]
  s_barrier
  TR v[160:161], v2 offset:49152
  v_lshlrev_b32 v230, 16, v219
  MF v[52:55], a[84:87], v[164:167], v[52:55]
  TR v[162:163], v2 offset:49408
  v_and_b32 v231, 0xffff0000, v219
  MF v[56:59], a[88:91], v[164:167], v[56:59]
  v_mul_f32 v228, v228, v230
  v_mul_f32 v229, v229, v231
  MF v[60:63], a[92:95], v[164:167], v[60:63]
  v_cvt_pk_bf16_f32 v228, v228, v229
  s_waitcnt lgkmcnt(4)
  MF v[64:67], a[80:83], v[168:171], v[64:67]
  TR v[164:165], v2 offset:51200
  v_lshlrev_b32 v230, 16, v228
  MF v[68:71], a[84:87], v[168:171], v[68:71]
  TR v[166:167], v2 offset:51456
  v_and_b32 v231, 0xffff0000, v228
  MF v[72:75], a[88:91], v[168:171], v[72:75]
  v_add_f32 v226, v226, v230
  v_add_f32 v227, v227, v231
  MF v[76:79], a[92:95], v[168:171], v[76:79]
  v_lshlrev_b32 v228, 16, v211
  s_waitcnt lgkmcnt(4)
  MF v[80:83], a[80:83], v[172:175], v[80:83]
  TR v[168:169], v4 offset:49152
  v_and_b32 v229, 0xffff0000, v211
  MF v[84:87], a[84:87], v[172:175], v[84:87]
  TR v[170:171], v4 offset:49408
  v_lshlrev_b32 v230, 16, v220
  MF v[88:91], a[88:91], v[172:175], v[88:91]
  v_and_b32 v231, 0xffff0000, v220
  v_mul_f32 v228, v228, v230
  MF v[92:95], a[92:95], v[172:175], v[92:95]
  v_mul_f32 v229, v229, v231
  s_waitcnt lgkmcnt(4)
  MF v[96:99], v[160:163], a[96:99], v[96:99]
  TR v[172:173], v4 offset:51200
  v_cvt_pk_bf16_f32 v228, v228, v229
  MF v[100:103], v[160:163], a[100:103], v[100:103]
  TR v[174:175], v4 offset:51456
  v_lshlrev_b32 v230, 16, v228
  MF v[104:107], v[160:163], a[104:107], v[104:107]
  s_add_u32 m0, s38, 9216
  s_nop 0
  BL4 v27, s[12:15], s70 offen lds
  MF v[108:111], v[160:163], a[108:111], v[108:111]
  s_waitcnt vmcnt(23)
  ds_read_b128 a[128:131], v252
  s_waitcnt lgkmcnt(5)
  MF v[112:115], v[164:167], a[96:99], v[112:115]
  ds_read_b128 v[160:163], v6 offset:57344
  v_and_b32 v231, 0xffff0000, v228
  MF v[116:119], v[164:167], a[100:103], v[116:119]
  v_add_f32 v226, v226, v230
  v_add_f32 v227, v227, v231
  MF v[120:123], v[164:167], a[104:107], v[120:123]
  ds_read_b128 a[144:147], v253
  MF v[124:127], v[164:167], a[108:111], v[124:127]
  s_add_u32 s90, s68, 13824
  s_add_u32 m0, s91, 14336
  s_nop 0
  BL4 v30, s[4:7], s90 offen lds
  s_waitcnt lgkmcnt(5)
  MF v[128:131], v[168:171], a[96:99], v[128:131]
  ds_read_b128 v[164:167], v6 offset:59392
  v_lshlrev_b32 v228, 16, v212
  MF v[132:135], v[168:171], a[100:103], v[132:135]
  v_and_b32 v229, 0xffff0000, v212
  v_lshlrev_b32 v230, 16, v221
  MF v[136:139], v[168:171], a[104:107], v[136:139]
  s_add_u32 m0, s91, 15360
  s_nop 0
  BL4 v31, s[4:7], s90 offen lds
  MF v[140:143], v[168:171], a[108:111], v[140:143]
  s_waitcnt vmcnt(20)
  ds_read_b128 a[132:135], v252 offset:2048
  s_waitcnt lgkmcnt(5)
  MF v[144:147], v[172:175], a[96:99], v[144:147]
  ds_read_b128 v[168:171], v28
  v_and_b32 v231, 0xffff0000, v221
  MF v[148:151], v[172:175], a[100:103], v[148:151]
  v_mul_f32 v228, v228, v230
  v_mul_f32 v229, v229, v231
  MF v[152:155], v[172:175], a[104:107], v[152:155]
  ds_read_b128 a[148:151], v253 offset:2048
  MF v[156:159], v[172:175], a[108:111], v[156:159]
  s_add_u32 s90, s70, 0
  s_add_u32 m0, s91, 0
  s_nop 0
  s_waitcnt lgkmcnt(4)
  BL4 v30, s[4:7], s90 offen lds
  s_add_u32 m0, s91, 1024
  s_nop 0
  BL4 v31, s[4:7], s90 offen lds
  MF v[32:35], a[96:99], v[160:163], v[32:35]
  ds_read_b128 v[172:175], v28 offset:2048
  v_cvt_pk_bf16_f32 v228, v228, v229
  MF v[36:39], a[100:103], v[160:163], v[36:39]
  v_lshlrev_b32 v230, 16, v228
  v_and_b32 v231, 0xffff0000, v228
  MF v[40:43], a[104:107], v[160:163], v[40:43]
  v_add_f32 v226, v226, v230
  v_add_f32 v227, v227, v231
  MF v[44:47], a[108:111], v[160:163], v[44:47]
  v_lshlrev_b32 v228, 16, v213
  s_waitcnt lgkmcnt(4)
  MF v[48:51], a[96:99], v[164:167], v[48:51]
  TR v[160:161], v2 offset:53248
  v_and_b32 v229, 0xffff0000, v213
  MF v[52:55], a[100:103], v[164:167], v[52:55]
  TR v[162:163], v2 offset:53504
  v_lshlrev_b32 v230, 16, v222
  MF v[56:59], a[104:107], v[164:167], v[56:59]
  v_and_b32 v231, 0xffff0000, v222
  v_mul_f32 v228, v228, v230
  MF v[60:63], a[108:111], v[164:167], v[60:63]
  v_mul_f32 v229, v229, v231
  s_waitcnt lgkmcnt(4)
  MF v[64:67], a[96:99], v[168:171], v[64:67]
  TR v[164:165], v2 offset:55296
  v_cvt_pk_bf16_f32 v228, v228, v229
  MF v[68:71], a[100:103], v[168:171], v[68:71]
  TR v[166:167], v2 offset:55552
  v_lshlrev_b32 v230, 16, v228
  MF v[72:75], a[104:107], v[168:171], v[72:75]
  v_and_b32 v231, 0xffff0000, v228
  v_add_f32 v226, v226, v230
  MF v[76:79], a[108:111], v[168:171], v[76:79]
  v_add_f32 v227, v227, v231
  s_waitcnt lgkmcnt(4)
  MF v[80:83], a[96:99], v[172:175], v[80:83]
  TR v[168:169], v4 offset:53248
  v_lshlrev_b32 v228, 16, v214
  MF v[84:87], a[100:103], v[172:175], v[84:87]
  TR v[170:171], v4 offset:53504
  v_and_b32 v229, 0xffff0000, v214
  MF v[88:91], a[104:107], v[172:175], v[88:91]
  v_lshlrev_b32 v230, 16, v223
  v_and_b32 v231, 0xffff0000, v223
  MF v[92:95], a[108:111], v[172:175], v[92:95]
  v_mul_f32 v228, v228, v230
  s_waitcnt lgkmcnt(4)
  MF v[96:99], v[160:163], a[112:115], v[96:99]
  TR v[172:173], v4 offset:55296
  v_mul_f32 v229, v229, v231
  MF v[100:103], v[160:163], a[116:119], v[100:103]
  TR v[174:175], v4 offset:55552
  v_cvt_pk_bf16_f32 v228, v228, v229
  MF v[104:107], v[160:163], a[120:123], v[104:107]
  s_waitcnt vmcnt(20)
  ds_read_b128 a[136:139], v252 offset:4096
  MF v[108:111], v[160:163], a[124:127], v[108:111]
  ds_read_b128 a[152:155], v253 offset:4096
  s_waitcnt lgkmcnt(6)
  MF v[112:115], v[164:167], a[112:115], v[112:115]
  ds_read_b128 v[160:163], v7 offset:57344
  v_lshlrev_b32 v230, 16, v228
  MF v[116:119], v[164:167], a[116:119], v[116:119]
  v_and_b32 v231, 0xffff0000, v228
  v_add_f32 v226, v226, v230
  MF v[120:123], v[164:167], a[120:123], v[120:123]
  s_add_u32 s90, s70, 4608
  s_add_u32 m0, s91, 2048
  s_nop 0
  BL4 v30, s[4:7], s90 offen lds
  MF v[124:127], v[164:167], a[124:127], v[124:127]
  s_add_u32 m0, s91, 3072
  s_nop 0
  BL4 v31, s[4:7], s90 offen lds
  s_waitcnt lgkmcnt(5)
  MF v[128:131], v[168:171], a[112:115], v[128:131]
  ds_read_b128 v[164:167], v7 offset:59392
  v_add_f32 v227, v227, v231
  MF v[132:135], v[168:171], a[116:119], v[132:135]
  v_lshlrev_b32 v228, 16, v215
  v_and_b32 v229, 0xffff0000, v215
  MF v[136:139], v[168:171], a[120:123], v[136:139]
  s_waitcnt vmcnt(17)
  ds_read_b128 a[140:143], v252 offset:6144
  MF v[140:143], v[168:171], a[124:127], v[140:143]
  ds_read_b128 a[156:159], v253 offset:6144
  s_waitcnt lgkmcnt(6)
  MF v[144:147], v[172:175], a[112:115], v[144:147]
  ds_read_b128 v[168:171], v29
  v_lshlrev_b32 v230, 16, v224
  MF v[148:151], v[172:175], a[116:119], v[148:151]
  v_and_b32 v231, 0xffff0000, v224
  v_mul_f32 v228, v228, v230
  MF v[152:155], v[172:175], a[120:123], v[152:155]
  s_add_u32 s90, s70, 9216
  s_add_u32 m0, s91, 4096
  s_nop 0
  s_waitcnt lgkmcnt(5)
  BL4 v30, s[4:7], s90 offen lds
  MF v[156:159], v[172:175], a[124:127], v[156:159]
  s_add_u32 m0, s91, 5120
  s_nop 0
  BL4 v31, s[4:7], s90 offen lds
  s_waitcnt lgkmcnt(4)
  MF v[32:35], a[112:115], v[160:163], v[32:35]
  ds_read_b128 v[172:175], v29 offset:2048
  v_mul_f32 v229, v229, v231
  MF v[36:39], a[116:119], v[160:163], v[36:39]
  v_cvt_pk_bf16_f32 v228, v228, v229
  v_lshlrev_b32 v230, 16, v228
  MF v[40:43], a[120:123], v[160:163], v[40:43]
  v_and_b32 v231, 0xffff0000, v228
  v_add_f32 v226, v226, v230
  MF v[44:47], a[124:127], v[160:163], v[44:47]
  v_add_f32 v227, v227, v231
  s_waitcnt lgkmcnt(4)
  MF v[48:51], a[112:115], v[164:167], v[48:51]
  s_barrier
  TR v[160:161], v3 offset:4096
  v_lshlrev_b32 v228, 16, v216
  MF v[52:55], a[116:119], v[164:167], v[52:55]
  TR v[162:163], v3 offset:4352
  v_and_b32 v229, 0xffff0000, v216
  MF v[56:59], a[120:123], v[164:167], v[56:59]
  v_lshlrev_b32 v230, 16, v225
  v_and_b32 v231, 0xffff0000, v225
  MF v[60:63], a[124:127], v[164:167], v[60:63]
  v_mul_f32 v228, v228, v230
  s_waitcnt lgkmcnt(3)
  MF v[64:67], a[112:115], v[168:171], v[64:67]
  TR v[164:165], v3 offset:6144
  v_mul_f32 v229, v229, v231
  MF v[68:71], a[116:119], v[168:171], v[68:71]
  TR v[166:167], v3 offset:6400
  v_cvt_pk_bf16_f32 v228, v228, v229
  MF v[72:75], a[120:123], v[168:171], v[72:75]
  v_lshlrev_b32 v230, 16, v228
  v_and_b32 v231, 0xffff0000, v228
  MF v[76:79], a[124:127], v[168:171], v[76:79]
  v_add_f32 v226, v226, v230
  s_waitcnt lgkmcnt(4)
  MF v[80:83], a[112:115], v[172:175], v[80:83]
  TR v[168:169], v5 offset:4096
  v_add_f32 v227, v227, v231
  MF v[84:87], a[116:119], v[172:175], v[84:87]
  TR v[170:171], v5 offset:4352
  v_add_f32 v226, v226, v227
  MF v[88:91], a[120:123], v[172:175], v[88:91]
  s_nop 0
  v_add_f32_dpp v226, v226, v226 row_shr:1 row_mask:0xf bank_mask:0xf bound_ctrl:1
  s_nop 1
  v_add_f32_dpp v226, v226, v226 row_shr:2 row_mask:0xf bank_mask:0xf bound_ctrl:1
  MF v[92:95], a[124:127], v[172:175], v[92:95]
  s_nop 0
  v_add_f32_dpp v226, v226, v226 row_shr:4 row_mask:0xf bank_mask:0xf bound_ctrl:1
  s_waitcnt lgkmcnt(4)
  MF v[96:99], v[160:163], a[128:131], v[96:99]
  TR v[172:173], v5 offset:6144
  v_add_f32_dpp v226, v226, v226 row_shr:8 row_mask:0xf bank_mask:0xf bound_ctrl:1
  MF v[100:103], v[160:163], a[132:135], v[100:103]
  TR v[174:175], v5 offset:6400
  v_add_f32_dpp v226, v226, v226 row_bcast:15 row_mask:0xa bank_mask:0xf
  MF v[104:107], v[160:163], a[136:139], v[104:107]
  s_add_u32 m0, s37, 16384
  s_add_u32 s89, s54, 0
  BL4 v8, s[8:11], s89 offen lds
  MF v[108:111], v[160:163], a[140:143], v[108:111]
  s_add_u32 m0, s38, 32768
  s_nop 0
  BL4 v9, s[12:15], s72 offen lds
  s_waitcnt lgkmcnt(4)
  MF v[112:115], v[164:167], a[128:131], v[112:115]
  ds_read_b128 v[160:163], v28 offset:12288
  v_cvt_pk_bf16_f32 v226, v226, v226
  MF v[116:119], v[164:167], a[132:135], v[116:119]
  v_lshlrev_b32 v226, 16, v226
  v_mul_f32 v226, 0xbfb8aa3b, v226
  MF v[120:123], v[164:167], a[136:139], v[120:123]
  s_waitcnt vmcnt(19)
  ds_read_b128 a[160:163], v252 offset:8192
  MF v[124:127], v[164:167], a[140:143], v[124:127]
  ds_read_b128 a[176:179], v253 offset:8192
  s_waitcnt lgkmcnt(5)
  MF v[128:131], v[168:171], a[128:131], v[128:131]
  ds_read_b128 v[164:167], v28 offset:14336
  v_exp_f32 v226, v226
  MF v[132:135], v[168:171], a[132:135], v[132:135]
  v_add_f32 v226, 1.0, v226
  v_rcp_f32 v226, v226
  MF v[136:139], v[168:171], a[136:139], v[136:139]
  s_add_u32 s90, s70, 13824
  s_add_u32 m0, s91, 6144
  s_nop 0
  BL4 v30, s[4:7], s90 offen lds
  MF v[140:143], v[168:171], a[140:143], v[140:143]
  s_add_u32 m0, s91, 7168
  s_nop 0
  BL4 v31, s[4:7], s90 offen lds
  s_waitcnt lgkmcnt(4)
  MF v[144:147], v[172:175], a[128:131], v[144:147]
  ds_read_b128 v[168:171], v28 offset:16384
  v_cvt_pk_bf16_f32 v226, v226, v226
  MF v[148:151], v[172:175], a[132:135], v[148:151]
  v_lshlrev_b32 v226, 16, v226
  v_lshlrev_b32 v228, 2, v25
  MF v[152:155], v[172:175], a[136:139], v[152:155]
  s_waitcnt vmcnt(16)
  ds_read_b128 a[164:167], v252 offset:10240
  MF v[156:159], v[172:175], a[140:143], v[156:159]
  ds_read_b128 a[180:183], v253 offset:10240
  s_add_u32 s90, s72, 0
  s_add_u32 m0, s91, 8192
  s_nop 0
  s_waitcnt lgkmcnt(4)
  BL4 v30, s[4:7], s90 offen lds
  s_add_u32 m0, s91, 9216
  s_nop 0
  BL4 v31, s[4:7], s90 offen lds
  MF v[32:35], a[128:131], v[160:163], v[32:35]
  ds_read_b128 v[172:175], v28 offset:18432
  v_add_u32 v228, 32505856, v228
  MF v[36:39], a[132:135], v[160:163], v[36:39]
  v_and_b32 v229, 31, v1
  MF v[40:43], a[136:139], v[160:163], v[40:43]
  s_add_u32 m0, s37, 20480
  s_add_u32 s89, s55, 0
  BL4 v8, s[8:11], s89 offen lds
  MF v[44:47], a[140:143], v[160:163], v[44:47]
  s_add_u32 m0, s38, 33792
  s_nop 0
  BL4 v27, s[12:15], s72 offen lds
  s_waitcnt lgkmcnt(4)
  MF v[48:51], a[128:131], v[164:167], v[48:51]
  TR v[160:161], v3 offset:8192
  MF v[52:55], a[132:135], v[164:167], v[52:55]
  TR v[162:163], v3 offset:8448
  MF v[56:59], a[136:139], v[164:167], v[56:59]
  v_cmp_eq_u32 vcc, 31, v229
  v_mov_b32 v229, 1073741824
  s_nop 0
  v_cndmask_b32 v228, v229, v228, vcc
  MF v[60:63], a[140:143], v[164:167], v[60:63]
  s_waitcnt lgkmcnt(5)
  MF v[64:67], a[128:131], v[168:171], v[64:67]
  TR v[164:165], v3 offset:10240
  MF v[68:71], a[132:135], v[168:171], v[68:71]
  TR v[166:167], v3 offset:10496
  MF v[72:75], a[136:139], v[168:171], v[72:75]
  buffer_store_dword v226, v228, s[16:19], 0 offen sc1
  MF v[76:79], a[140:143], v[168:171], v[76:79]
  v_lshlrev_b32 v234, 16, v234
  s_waitcnt lgkmcnt(4)
  MF v[80:83], a[128:131], v[172:175], v[80:83]
  TR v[168:169], v5 offset:8192
  v_lshlrev_b32 v235, 16, v235
  MF v[84:87], a[132:135], v[172:175], v[84:87]
  TR v[170:171], v5 offset:8448
  v_lshlrev_b32 v236, 16, v236
  MF v[88:91], a[136:139], v[172:175], v[88:91]
  v_mul_f32 v236, 0x3fb8aa3b, v236
  v_exp_f32 v236, v236
  MF v[92:95], a[140:143], v[172:175], v[92:95]
  v_cvt_pk_bf16_f32 v236, v236, v236
  s_waitcnt lgkmcnt(4)
  MF v[96:99], v[160:163], a[144:147], v[96:99]
  TR v[172:173], v5 offset:10240
  v_lshlrev_b32 v236, 16, v236
  MF v[100:103], v[160:163], a[148:151], v[100:103]
  TR v[174:175], v5 offset:10496
  v_mul_f32 v234, v236, v234
  MF v[104:107], v[160:163], a[152:155], v[104:107]
  s_add_u32 m0, s37, 24576
  s_add_u32 s89, s56, 0
  BL4 v8, s[8:11], s89 offen lds
  MF v[108:111], v[160:163], a[156:159], v[108:111]
  s_add_u32 m0, s38, 40960
  s_nop 0
  BL4 v9, s[12:15], s74 offen lds
  s_waitcnt lgkmcnt(4)
  MF v[112:115], v[164:167], a[144:147], v[112:115]
  ds_read_b128 v[160:163], v29 offset:12288
  v_mul_f32 v235, v236, v235
  MF v[116:119], v[164:167], a[148:151], v[116:119]
  v_mul_f32 v208, 0x3fb8aa3b, v234
  v_mul_f32 v209, 0x3e22f983, v235
  MF v[120:123], v[164:167], a[152:155], v[120:123]
  s_waitcnt vmcnt(21)
  ds_read_b128 a[168:171], v252 offset:12288
  MF v[124:127], v[164:167], a[156:159], v[124:127]
  ds_read_b128 a[184:187], v253 offset:12288
  s_waitcnt lgkmcnt(5)
  MF v[128:131], v[168:171], a[144:147], v[128:131]
  ds_read_b128 v[164:167], v29 offset:14336
  v_exp_f32 v210, v208
  MF v[132:135], v[168:171], a[148:151], v[132:135]
  v_fract_f32 v241, v209
  v_cos_f32 v240, v241
  MF v[136:139], v[168:171], a[152:155], v[136:139]
  s_add_u32 s90, s72, 4608
  s_add_u32 m0, s91, 10240
  s_nop 0
  BL4 v30, s[4:7], s90 offen lds
  MF v[140:143], v[168:171], a[156:159], v[140:143]
  s_add_u32 m0, s91, 11264
  s_nop 0
  BL4 v31, s[4:7], s90 offen lds
  s_waitcnt lgkmcnt(4)
  MF v[144:147], v[172:175], a[144:147], v[144:147]
  ds_read_b128 v[168:171], v29 offset:16384
  v_sin_f32 v241, v241
  MF v[148:151], v[172:175], a[148:151], v[148:151]
  v_mul_f32 v211, v210, v241
  v_mul_f32 v210, v210, v240
  MF v[152:155], v[172:175], a[152:155], v[152:155]
  s_waitcnt vmcnt(19)
  ds_read_b128 a[172:175], v252 offset:14336
  MF v[156:159], v[172:175], a[156:159], v[156:159]
  ds_read_b128 a[188:191], v253 offset:14336
  s_add_u32 s90, s72, 9216
  s_add_u32 m0, s91, 12288
  s_nop 0
  s_waitcnt lgkmcnt(4)
  BL4 v30, s[4:7], s90 offen lds
  s_add_u32 m0, s91, 13312
  s_nop 0
  BL4 v31, s[4:7], s90 offen lds
  MF v[32:35], a[144:147], v[160:163], v[32:35]
  ds_read_b128 v[172:175], v29 offset:18432
  v_mul_f32 v240, 0x41800000, v208
  MF v[36:39], a[148:151], v[160:163], v[36:39]
  v_mul_f32 v241, 0x41800000, v209
  v_exp_f32 v214, v240
  MF v[40:43], a[152:155], v[160:163], v[40:43]
  s_add_u32 m0, s37, 28672
  s_add_u32 s89, s57, 0
  BL4 v8, s[8:11], s89 offen lds
  MF v[44:47], a[156:159], v[160:163], v[44:47]
  s_add_u32 m0, s38, 41984
  s_nop 0
  BL4 v27, s[12:15], s74 offen lds
  s_waitcnt lgkmcnt(4)
  MF v[48:51], a[144:147], v[164:167], v[48:51]
  s_barrier
  TR v[160:161], v3 offset:20480
  v_fract_f32 v241, v241
  MF v[52:55], a[148:151], v[164:167], v[52:55]
  TR v[162:163], v3 offset:20736
  v_mul_f32 v214, v214, v18
  MF v[56:59], a[152:155], v[164:167], v[56:59]
  v_cos_f32 v240, v241
  v_sin_f32 v241, v241
  MF v[60:63], a[156:159], v[164:167], v[60:63]
  v_mul_f32 v215, v214, v241
  s_waitcnt lgkmcnt(5)
  MF v[64:67], a[144:147], v[168:171], v[64:67]
  TR v[164:165], v3 offset:22528
  v_mul_f32 v214, v214, v240
  MF v[68:71], a[148:151], v[168:171], v[68:71]
  TR v[166:167], v3 offset:22784
  v_lshlrev_b32 v237, 16, v237
  MF v[72:75], a[152:155], v[168:171], v[72:75]
  v_lshlrev_b32 v238, 16, v238
  v_lshlrev_b32 v239, 16, v239
  MF v[76:79], a[156:159], v[168:171], v[76:79]
  v_mul_f32 v239, 0x3fb8aa3b, v239
  s_waitcnt lgkmcnt(4)
  MF v[80:83], a[144:147], v[172:175], v[80:83]
  TR v[168:169], v5 offset:20480
  v_exp_f32 v239, v239
  MF v[84:87], a[148:151], v[172:175], v[84:87]
  TR v[170:171], v5 offset:20736
  v_cvt_pk_bf16_f32 v239, v239, v239
  MF v[88:91], a[152:155], v[172:175], v[88:91]
  v_lshlrev_b32 v239, 16, v239
  v_mul_f32 v237, v239, v237
  MF v[92:95], a[156:159], v[172:175], v[92:95]
  v_mul_f32 v238, v239, v238
  s_waitcnt lgkmcnt(4)
  MF v[96:99], v[160:163], a[160:163], v[96:99]
  TR v[172:173], v5 offset:22528
  v_mul_f32 v216, 0x3fb8aa3b, v237
  MF v[100:103], v[160:163], a[164:167], v[100:103]
  TR v[174:175], v5 offset:22784
  v_mul_f32 v217, 0x3e22f983, v238
  MF v[104:107], v[160:163], a[168:171], v[104:107]
  s_waitcnt vmcnt(21)
  ds_read_b128 a[192:195], v252
  MF v[108:111], v[160:163], a[172:175], v[108:111]
  ds_read_b128 a[208:211], v253
  s_waitcnt lgkmcnt(6)
  MF v[112:115], v[164:167], a[160:163], v[112:115]
  ds_read_b128 v[160:163], v28 offset:28672
  v_exp_f32 v218, v216
  MF v[116:119], v[164:167], a[164:167], v[116:119]
  v_fract_f32 v241, v217
  v_cos_f32 v240, v241
  MF v[120:123], v[164:167], a[168:171], v[120:123]
  s_add_u32 s90, s72, 13824
  s_add_u32 m0, s91, 14336
  s_nop 0
  BL4 v30, s[4:7], s90 offen lds
  MF v[124:127], v[164:167], a[172:175], v[124:127]
  s_add_u32 m0, s91, 15360
  s_nop 0
  BL4 v31, s[4:7], s90 offen lds
  s_waitcnt lgkmcnt(5)
  MF v[128:131], v[168:171], a[160:163], v[128:131]
  ds_read_b128 v[164:167], v28 offset:30720
  v_sin_f32 v241, v241
  MF v[132:135], v[168:171], a[164:167], v[132:135]
  v_mul_f32 v219, v218, v241
  v_mul_f32 v218, v218, v240
  MF v[136:139], v[168:171], a[168:171], v[136:139]
  s_waitcnt vmcnt(21)
  ds_read_b128 a[196:199], v252 offset:2048
  MF v[140:143], v[168:171], a[172:175], v[140:143]
  ds_read_b128 a[212:215], v253 offset:2048
  s_waitcnt lgkmcnt(6)
  MF v[144:147], v[172:175], a[160:163], v[144:147]
  ds_read_b128 v[168:171], v28 offset:32768
  v_mul_f32 v240, 0x41800000, v216
  MF v[148:151], v[172:175], a[164:167], v[148:151]
  v_mul_f32 v241, 0x41800000, v217
  v_exp_f32 v222, v240
  MF v[152:155], v[172:175], a[168:171], v[152:155]
  s_add_u32 s90, s74, 0
  s_add_u32 m0, s91, 0
  s_nop 0
  s_waitcnt lgkmcnt(5)
  BL4 v30, s[4:7], s90 offen lds
  MF v[156:159], v[172:175], a[172:175], v[156:159]
  s_add_u32 m0, s91, 1024
  s_nop 0
  BL4 v31, s[4:7], s90 offen lds
  s_waitcnt lgkmcnt(4)
  MF v[32:35], a[160:163], v[160:163], v[32:35]
  ds_read_b128 v[172:175], v28 offset:34816
  v_fract_f32 v241, v241
  MF v[36:39], a[164:167], v[160:163], v[36:39]
  v_mul_f32 v222, v222, v18
  v_cos_f32 v240, v241
  MF v[40:43], a[168:171], v[160:163], v[40:43]
  v_sin_f32 v241, v241
  s_nop 0
  v_mul_f32 v223, v222, v241
  MF v[44:47], a[172:175], v[160:163], v[44:47]
  v_mul_f32 v222, v222, v240
  s_waitcnt lgkmcnt(4)
  MF v[48:51], a[160:163], v[164:167], v[48:51]
  TR v[160:161], v3 offset:24576
  s_mov_b32 s84, 128
  MF v[52:55], a[164:167], v[164:167], v[52:55]
  TR v[162:163], v3 offset:24832
  MF v[56:59], a[168:171], v[164:167], v[56:59]
  buffer_load_dword v233, v248, s[8:11], s84 offen
  MF v[60:63], a[172:175], v[164:167], v[60:63]
  s_cmp_eq_u32 s32, 0
  s_cselect_b32 s80, 0, 1073741824
  s_waitcnt lgkmcnt(3)
  MF v[64:67], a[160:163], v[168:171], v[64:67]
  TR v[164:165], v3 offset:26624
  v_mov_b32 v247, s80
  MF v[68:71], a[164:167], v[168:171], v[68:71]
  TR v[166:167], v3 offset:26880
  MF v[72:75], a[168:171], v[168:171], v[72:75]
  buffer_load_dword v245, v247, s[20:23], 0 offen sc1
  MF v[76:79], a[172:175], v[168:171], v[76:79]
  s_waitcnt lgkmcnt(4)
  MF v[80:83], a[160:163], v[172:175], v[80:83]
  TR v[168:169], v5 offset:24576
  MF v[84:87], a[164:167], v[172:175], v[84:87]
  TR v[170:171], v5 offset:24832
  MF v[88:91], a[168:171], v[172:175], v[88:91]
  MF v[92:95], a[172:175], v[172:175], v[92:95]
  s_waitcnt lgkmcnt(4)
  MF v[96:99], v[160:163], a[176:179], v[96:99]
  TR v[172:173], v5 offset:26624
  MF v[100:103], v[160:163], a[180:183], v[100:103]
  TR v[174:175], v5 offset:26880
  MF v[104:107], v[160:163], a[184:187], v[104:107]
  s_waitcnt vmcnt(23)
  ds_read_b128 a[200:203], v252 offset:4096
  MF v[108:111], v[160:163], a[188:191], v[108:111]
  ds_read_b128 a[216:219], v253 offset:4096
  s_waitcnt lgkmcnt(6)
  MF v[112:115], v[164:167], a[176:179], v[112:115]
  ds_read_b128 v[160:163], v29 offset:28672
  MF v[116:119], v[164:167], a[180:183], v[116:119]
  MF v[120:123], v[164:167], a[184:187], v[120:123]
  s_add_u32 s90, s74, 4608
  s_add_u32 m0, s91, 2048
  s_nop 0
  BL4 v30, s[4:7], s90 offen lds
  MF v[124:127], v[164:167], a[188:191], v[124:127]
  s_add_u32 m0, s91, 3072
  s_nop 0
  BL4 v31, s[4:7], s90 offen lds
  s_waitcnt lgkmcnt(5)
  MF v[128:131], v[168:171], a[176:179], v[128:131]
  ds_read_b128 v[164:167], v29 offset:30720
  MF v[132:135], v[168:171], a[180:183], v[132:135]
  MF v[136:139], v[168:171], a[184:187], v[136:139]
  s_waitcnt vmcnt(21)
  ds_read_b128 a[204:207], v252 offset:6144
  MF v[140:143], v[168:171], a[188:191], v[140:143]
  ds_read_b128 a[220:223], v253 offset:6144
  s_waitcnt lgkmcnt(6)
  MF v[144:147], v[172:175], a[176:179], v[144:147]
  ds_read_b128 v[168:171], v29 offset:32768
  MF v[148:151], v[172:175], a[180:183], v[148:151]
  MF v[152:155], v[172:175], a[184:187], v[152:155]
  s_add_u32 s90, s74, 9216
  s_add_u32 m0, s91, 4096
  s_nop 0
  s_waitcnt lgkmcnt(5)
  BL4 v30, s[4:7], s90 offen lds
  MF v[156:159], v[172:175], a[188:191], v[156:159]
  s_add_u32 m0, s91, 5120
  s_nop 0
  BL4 v31, s[4:7], s90 offen lds
  s_waitcnt lgkmcnt(4)
  MF v[32:35], a[176:179], v[160:163], v[32:35]
  ds_read_b128 v[172:175], v29 offset:34816
  MF v[36:39], a[180:183], v[160:163], v[36:39]
  MF v[40:43], a[184:187], v[160:163], v[40:43]
  MF v[44:47], a[188:191], v[160:163], v[44:47]
  s_waitcnt lgkmcnt(4)
  MF v[48:51], a[176:179], v[164:167], v[48:51]
  s_barrier
  TR v[160:161], v2
  MF v[52:55], a[180:183], v[164:167], v[52:55]
  TR v[162:163], v2 offset:256
  MF v[56:59], a[184:187], v[164:167], v[56:59]
  MF v[60:63], a[188:191], v[164:167], v[60:63]
  s_waitcnt lgkmcnt(3)
  MF v[64:67], a[176:179], v[168:171], v[64:67]
  TR v[164:165], v2 offset:2048
  MF v[68:71], a[180:183], v[168:171], v[68:71]
  TR v[166:167], v2 offset:2304
  MF v[72:75], a[184:187], v[168:171], v[72:75]
  MF v[76:79], a[188:191], v[168:171], v[76:79]
  s_waitcnt lgkmcnt(4)
  MF v[80:83], a[176:179], v[172:175], v[80:83]
  TR v[168:169], v4
  MF v[84:87], a[180:183], v[172:175], v[84:87]
  TR v[170:171], v4 offset:256
  MF v[88:91], a[184:187], v[172:175], v[88:91]
  MF v[92:95], a[188:191], v[172:175], v[92:95]
  s_waitcnt lgkmcnt(4)
  MF v[96:99], v[160:163], a[192:195], v[96:99]
  TR v[172:173], v4 offset:2048
  MF v[100:103], v[160:163], a[196:199], v[100:103]
  TR v[174:175], v4 offset:2304
  MF v[104:107], v[160:163], a[200:203], v[104:107]
  s_add_u32 m0, s37, 49152
  s_add_u32 s89, s40, 64
  BL4 v8, s[8:11], s89 offen lds
  MF v[108:111], v[160:163], a[204:207], v[108:111]
  s_add_u32 m0, s37, 53248
  s_add_u32 s89, s41, 64
  BL4 v8, s[8:11], s89 offen lds
  s_waitcnt lgkmcnt(4)
  MF v[112:115], v[164:167], a[192:195], v[112:115]
  ds_read_b128 v[160:163], v6 offset:8192
  MF v[116:119], v[164:167], a[196:199], v[116:119]
  MF v[120:123], v[164:167], a[200:203], v[120:123]
  s_waitcnt vmcnt(23)
  ds_read_b128 a[224:227], v252 offset:8192
  MF v[124:127], v[164:167], a[204:207], v[124:127]
  ds_read_b128 a[240:243], v253 offset:8192
  s_waitcnt lgkmcnt(5)
  MF v[128:131], v[168:171], a[192:195], v[128:131]
  ds_read_b128 v[164:167], v6 offset:10240
  MF v[132:135], v[168:171], a[196:199], v[132:135]
  MF v[136:139], v[168:171], a[200:203], v[136:139]
  s_add_u32 s90, s74, 13824
  s_add_u32 m0, s91, 6144
  s_nop 0
  BL4 v30, s[4:7], s90 offen lds
  MF v[140:143], v[168:171], a[204:207], v[140:143]
  s_add_u32 m0, s91, 7168
  s_nop 0
  BL4 v31, s[4:7], s90 offen lds
  s_waitcnt lgkmcnt(4)
  MF v[144:147], v[172:175], a[192:195], v[144:147]
  ds_read_b128 v[168:171], v6 offset:12288
  MF v[148:151], v[172:175], a[196:199], v[148:151]
  MF v[152:155], v[172:175], a[200:203], v[152:155]
  s_waitcnt vmcnt(18)
  ds_read_b128 a[228:231], v252 offset:10240
  MF v[156:159], v[172:175], a[204:207], v[156:159]
  ds_read_b128 a[244:247], v253 offset:10240
  s_waitcnt lgkmcnt(6)
  MF v[32:35], a[192:195], v[160:163], v[32:35]
  ds_read_b128 v[172:175], v6 offset:14336
  MF v[36:39], a[196:199], v[160:163], v[36:39]
  MF v[40:43], a[200:203], v[160:163], v[40:43]
  s_add_u32 m0, s37, 57344
  s_add_u32 s89, s42, 64
  BL4 v8, s[8:11], s89 offen lds
  MF v[44:47], a[204:207], v[160:163], v[44:47]
  s_add_u32 m0, s37, 61440
  s_add_u32 s89, s43, 64
  BL4 v8, s[8:11], s89 offen lds
  s_waitcnt lgkmcnt(4)
  MF v[48:51], a[192:195], v[164:167], v[48:51]
  TR v[160:161], v2 offset:4096
  MF v[52:55], a[196:199], v[164:167], v[52:55]
  TR v[162:163], v2 offset:4352
  MF v[56:59], a[200:203], v[164:167], v[56:59]
  MF v[60:63], a[204:207], v[164:167], v[60:63]
  s_waitcnt lgkmcnt(5)
  MF v[64:67], a[192:195], v[168:171], v[64:67]
  TR v[164:165], v2 offset:6144
  MF v[68:71], a[196:199], v[168:171], v[68:71]
  TR v[166:167], v2 offset:6400
  MF v[72:75], a[200:203], v[168:171], v[72:75]
  MF v[76:79], a[204:207], v[168:171], v[76:79]
  s_waitcnt lgkmcnt(4)
  MF v[80:83], a[192:195], v[172:175], v[80:83]
  TR v[168:169], v4 offset:4096
  MF v[84:87], a[196:199], v[172:175], v[84:87]
  TR v[170:171], v4 offset:4352
  MF v[88:91], a[200:203], v[172:175], v[88:91]
  MF v[92:95], a[204:207], v[172:175], v[92:95]
  s_waitcnt lgkmcnt(4)
  MF v[96:99], v[160:163], a[208:211], v[96:99]
  TR v[172:173], v4 offset:6144
  MF v[100:103], v[160:163], a[212:215], v[100:103]
  TR v[174:175], v4 offset:6400
  MF v[104:107], v[160:163], a[216:219], v[104:107]
  s_add_u32 m0, s37, 65536
  s_add_u32 s89, s44, 64
  BL4 v8, s[8:11], s89 offen lds
  MF v[108:111], v[160:163], a[220:223], v[108:111]
  s_add_u32 m0, s37, 69632
  s_add_u32 s89, s45, 64
  BL4 v8, s[8:11], s89 offen lds
  s_waitcnt lgkmcnt(4)
  MF v[112:115], v[164:167], a[208:211], v[112:115]
  ds_read_b128 v[160:163], v7 offset:8192
  MF v[116:119], v[164:167], a[212:215], v[116:119]
  MF v[120:123], v[164:167], a[216:219], v[120:123]
  s_waitcnt vmcnt(20)
  ds_read_b128 a[232:235], v252 offset:12288
  MF v[124:127], v[164:167], a[220:223], v[124:127]
  ds_read_b128 a[248:251], v253 offset:12288
  s_waitcnt lgkmcnt(5)
  MF v[128:131], v[168:171], a[208:211], v[128:131]
  ds_read_b128 v[164:167], v7 offset:10240
  MF v[132:135], v[168:171], a[212:215], v[132:135]
  MF v[136:139], v[168:171], a[216:219], v[136:139]
  s_waitcnt vmcnt(16)
  ds_read_b128 a[236:239], v252 offset:14336
  MF v[140:143], v[168:171], a[220:223], v[140:143]
  ds_read_b128 a[252:255], v253 offset:14336
  s_waitcnt lgkmcnt(6)
  MF v[144:147], v[172:175], a[208:211], v[144:147]
  ds_read_b128 v[168:171], v7 offset:12288
  MF v[148:151], v[172:175], a[212:215], v[148:151]
  MF v[152:155], v[172:175], a[216:219], v[152:155]
  MF v[156:159], v[172:175], a[220:223], v[156:159]
  s_waitcnt lgkmcnt(6)
  MF v[32:35], a[208:211], v[160:163], v[32:35]
  ds_read_b128 v[172:175], v7 offset:14336
  MF v[36:39], a[212:215], v[160:163], v[36:39]
  MF v[40:43], a[216:219], v[160:163], v[40:43]
  MF v[44:47], a[220:223], v[160:163], v[44:47]
  s_waitcnt lgkmcnt(4)
  MF v[48:51], a[208:211], v[164:167], v[48:51]
  s_barrier
  TR v[160:161], v2 offset:16384
  MF v[52:55], a[212:215], v[164:167], v[52:55]
  TR v[162:163], v2 offset:16640
  MF v[56:59], a[216:219], v[164:167], v[56:59]
  MF v[60:63], a[220:223], v[164:167], v[60:63]
  s_waitcnt lgkmcnt(3)
  MF v[64:67], a[208:211], v[168:171], v[64:67]
  TR v[164:165], v2 offset:18432
  MF v[68:71], a[212:215], v[168:171], v[68:71]
  TR v[166:167], v2 offset:18688
  MF v[72:75], a[216:219], v[168:171], v[72:75]
  MF v[76:79], a[220:223], v[168:171], v[76:79]
  s_waitcnt lgkmcnt(4)
  MF v[80:83], a[208:211], v[172:175], v[80:83]
  TR v[168:169], v2 offset:20480
  MF v[84:87], a[212:215], v[172:175], v[84:87]
  TR v[170:171], v2 offset:20736
  MF v[88:91], a[216:219], v[172:175], v[88:91]
  s_mov_b32 s84, 192
  MF v[92:95], a[220:223], v[172:175], v[92:95]
  s_waitcnt lgkmcnt(4)
  MF v[96:99], v[160:163], a[224:227], v[96:99]
  TR v[172:173], v2 offset:22528
  MF v[100:103], v[160:163], a[228:231], v[100:103]
  TR v[174:175], v2 offset:22784
  MF v[104:107], v[160:163], a[232:235], v[104:107]
  s_add_u32 m0, s37, 73728
  s_add_u32 s89, s46, 64
  BL4 v8, s[8:11], s89 offen lds
  MF v[108:111], v[160:163], a[236:239], v[108:111]
  s_add_u32 m0, s37, 77824
  s_add_u32 s89, s47, 64
  BL4 v8, s[8:11], s89 offen lds
  s_waitcnt lgkmcnt(4)
  MF v[112:115], v[164:167], a[224:227], v[112:115]
  TR v[160:161], v2 offset:24576
  MF v[116:119], v[164:167], a[228:231], v[116:119]
  TR v[162:163], v2 offset:24832
  MF v[120:123], v[164:167], a[232:235], v[120:123]
  s_waitcnt vmcnt(16)
  ds_read_b128 v[176:179], v252
  MF v[124:127], v[164:167], a[236:239], v[124:127]
  ds_read_b128 v[192:195], v253
  s_waitcnt vmcnt(12)
  ds_read_b128 v[180:183], v252 offset:2048
  ds_read_b128 v[196:199], v253 offset:2048
  s_waitcnt lgkmcnt(8)
  MF v[96:99], v[168:171], a[240:243], v[96:99]
  TR v[164:165], v2 offset:26624
  MF v[100:103], v[168:171], a[244:247], v[100:103]
  TR v[166:167], v2 offset:26880
  MF v[104:107], v[168:171], a[248:251], v[104:107]
  s_add_u32 m0, s37, 81920
  s_add_u32 s89, s48, 64
  BL4 v8, s[8:11], s89 offen lds
  MF v[108:111], v[168:171], a[252:255], v[108:111]
  s_add_u32 m0, s37, 86016
  s_add_u32 s89, s49, 64
  BL4 v8, s[8:11], s89 offen lds
  s_waitcnt lgkmcnt(8)
  MF v[112:115], v[172:175], a[240:243], v[112:115]
  TR v[168:169], v2 offset:28672
  MF v[116:119], v[172:175], a[244:247], v[116:119]
  TR v[170:171], v2 offset:28928
  MF v[120:123], v[172:175], a[248:251], v[120:123]
  s_waitcnt vmcnt(12)
  ds_read_b128 v[184:187], v252 offset:4096
  MF v[124:127], v[172:175], a[252:255], v[124:127]
  ds_read_b128 v[200:203], v253 offset:4096
  s_waitcnt vmcnt(8)
  ds_read_b128 v[188:191], v252 offset:6144
  ds_read_b128 v[204:207], v253 offset:6144
  s_waitcnt lgkmcnt(11)
  MF v[96:99], v[160:163], v[176:179], v[96:99]
  TR v[172:173], v2 offset:30720
  s_waitcnt lgkmcnt(10)
  MF v[100:103], v[160:163], v[180:183], v[100:103]
  TR v[174:175], v2 offset:30976
  s_waitcnt lgkmcnt(5)
  MF v[104:107], v[160:163], v[184:187], v[104:107]
  s_add_u32 m0, s37, 90112
  s_add_u32 s89, s50, 64
  BL4 v8, s[8:11], s89 offen lds
  s_waitcnt lgkmcnt(3)
  MF v[108:111], v[160:163], v[188:191], v[108:111]
  s_add_u32 m0, s37, 94208
  s_add_u32 s89, s51, 64
  BL4 v8, s[8:11], s89 offen lds
  MF v[112:115], v[164:167], v[176:179], v[112:115]
  TR v[160:161], v4 offset:16384
  MF v[116:119], v[164:167], v[180:183], v[116:119]
  TR v[162:163], v4 offset:16640
  MF v[120:123], v[164:167], v[184:187], v[120:123]
  buffer_load_dword v233, v248, s[8:11], s84 offen
  MF v[124:127], v[164:167], v[188:191], v[124:127]
  s_lshl_b32 s84, s34, 3
  s_add_u32 s84, s84, s33
  MF v[96:99], v[168:171], v[192:195], v[96:99]
  TR v[164:165], v4 offset:18432
  s_mul_i32 s84, s84, 3
  s_add_u32 s84, s84, s35
  MF v[100:103], v[168:171], v[196:199], v[100:103]
  TR v[166:167], v4 offset:18688
  s_sub_u32 s84, s84, 5
  s_lshl_b32 s84, s84, 2
  MF v[104:107], v[168:171], v[200:203], v[104:107]
  s_add_u32 s84, s84, s32
  s_lshl_b32 s85, s34, 3
  s_add_u32 s85, s85, s33
  s_mul_i32 s85, s85, 7
  s_waitcnt lgkmcnt(6)
  MF v[108:111], v[168:171], v[204:207], v[108:111]
  s_sub_u32 s83, s35, 1
  s_waitcnt lgkmcnt(4)
  MF v[112:115], v[172:175], v[192:195], v[112:115]
  TR v[168:169], v4 offset:20480
  s_cmp_lt_u32 s35, 4
  s_cselect_b32 s83, s35, s83
  MF v[116:119], v[172:175], v[196:199], v[116:119]
  TR v[170:171], v4 offset:20736
  s_add_u32 s85, s85, s83
  s_lshl_b32 s85, s85, 2
  MF v[120:123], v[172:175], v[200:203], v[120:123]
  s_add_u32 s82, s85, s32
  s_mov_b32 s28, s98
  s_and_b32 s29, s99, 65535
  s_mov_b32 s30, 5308416
  MF v[124:127], v[172:175], v[204:207], v[124:127]
  s_mov_b32 s31, 131072
  s_waitcnt lgkmcnt(4)
  MF v[128:131], v[160:163], a[224:227], v[128:131]
  TR v[172:173], v4 offset:22528
  v_lshrrev_b32 v231, 5, v1
  MF v[132:135], v[160:163], a[228:231], v[132:135]
  TR v[174:175], v4 offset:22784
  v_mul_u32_u24 v231, 896, v231
  MF v[136:139], v[160:163], a[232:235], v[136:139]
  s_add_u32 s85, s82, 0
  v_add_u32 v231, s85, v231
  MF v[140:143], v[160:163], a[236:239], v[140:143]
  v_mul_u32_u24 v230, 7282, v231
  s_waitcnt lgkmcnt(4)
  MF v[144:147], v[164:167], a[224:227], v[144:147]
  TR v[160:161], v4 offset:24576
  v_lshrrev_b32 v230, 16, v230
  MF v[148:151], v[164:167], a[228:231], v[148:151]
  TR v[162:163], v4 offset:24832
  v_mul_u32_u24 v229, 9, v230
  MF v[152:155], v[164:167], a[232:235], v[152:155]
  v_sub_u32 v231, v231, v229
  v_lshlrev_b32 v231, 7, v231
  MF v[156:159], v[164:167], a[236:239], v[156:159]
  v_lshlrev_b32 v230, 5, v230
  s_waitcnt lgkmcnt(4)
  MF v[128:131], v[168:171], a[240:243], v[128:131]
  TR v[164:165], v4 offset:26624
  v_and_b32 v229, 31, v1
  MF v[132:135], v[168:171], a[244:247], v[132:135]
  TR v[166:167], v4 offset:26880
  v_add_u32 v230, v230, v229
  MF v[136:139], v[168:171], a[248:251], v[136:139]
  v_mul_u32_u24 v230, 1152, v230
  v_add_u32 v231, v231, v230
  MF v[140:143], v[168:171], a[252:255], v[140:143]
  s_waitcnt lgkmcnt(4)
  MF v[144:147], v[172:175], a[240:243], v[144:147]
  TR v[168:169], v4 offset:28672
  MF v[148:151], v[172:175], a[244:247], v[148:151]
  TR v[170:171], v4 offset:28928
  MF v[152:155], v[172:175], a[248:251], v[152:155]
  buffer_load_dword v233, v231, s[28:31], 0 offen
  MF v[156:159], v[172:175], a[252:255], v[156:159]
  v_max_f32 v96, 0, v96
  s_waitcnt lgkmcnt(4)
  MF v[128:131], v[160:163], v[176:179], v[128:131]
  TR v[172:173], v4 offset:30720
  v_max_f32 v97, 0, v97
  MF v[132:135], v[160:163], v[180:183], v[132:135]
  TR v[174:175], v4 offset:30976
  v_max_f32 v98, 0, v98
  MF v[136:139], v[160:163], v[184:187], v[136:139]
  v_max_f32 v99, 0, v99
  v_mul_f32 v96, v96, v112
  MF v[140:143], v[160:163], v[188:191], v[140:143]
  v_mul_f32 v97, v97, v113
  s_waitcnt lgkmcnt(4)
  MF v[144:147], v[164:167], v[176:179], v[144:147]
  ds_read_b128 v[160:163], v6 offset:32768
  v_mul_f32 v98, v98, v114
  MF v[148:151], v[164:167], v[180:183], v[148:151]
  v_mul_f32 v99, v99, v115
  v_cvt_pk_bf16_f32 v248, v96, v97
  MF v[152:155], v[164:167], v[184:187], v[152:155]
  v_cvt_pk_bf16_f32 v249, v98, v99
  v_max_f32 v100, 0, v100
  MF v[156:159], v[164:167], v[188:191], v[156:159]
  v_max_f32 v101, 0, v101
  s_waitcnt lgkmcnt(3)
  MF v[128:131], v[168:171], v[192:195], v[128:131]
  ds_read_b128 v[164:167], v6 offset:34816
  v_max_f32 v102, 0, v102
  MF v[132:135], v[168:171], v[196:199], v[132:135]
  v_max_f32 v103, 0, v103
  v_mul_f32 v100, v100, v116
  MF v[136:139], v[168:171], v[200:203], v[136:139]
  v_mul_f32 v101, v101, v117
  v_mul_f32 v102, v102, v118
  MF v[140:143], v[168:171], v[204:207], v[140:143]
  v_mul_f32 v103, v103, v119
  s_waitcnt lgkmcnt(2)
  MF v[144:147], v[172:175], v[192:195], v[144:147]
  ds_read_b128 v[168:171], v6 offset:36864
  v_cvt_pk_bf16_f32 v250, v100, v101
  MF v[148:151], v[172:175], v[196:199], v[148:151]
  v_cvt_pk_bf16_f32 v251, v102, v103
  v_max_f32 v104, 0, v104
  MF v[152:155], v[172:175], v[200:203], v[152:155]
  v_max_f32 v105, 0, v105
  v_max_f32 v106, 0, v106
  MF v[156:159], v[172:175], v[204:207], v[156:159]
  v_max_f32 v107, 0, v107
  s_waitcnt lgkmcnt(2)
  MF v[32:35], a[224:227], v[160:163], v[32:35]
  ds_read_b128 v[172:175], v6 offset:38912
  v_mul_f32 v104, v104, v120
  MF v[36:39], a[228:231], v[160:163], v[36:39]
  v_mul_f32 v105, v105, v121
  v_mul_f32 v106, v106, v122
  MF v[40:43], a[232:235], v[160:163], v[40:43]
  v_mul_f32 v107, v107, v123
  v_cvt_pk_bf16_f32 v252, v104, v105
  MF v[44:47], a[236:239], v[160:163], v[44:47]
  v_cvt_pk_bf16_f32 v253, v106, v107
  s_waitcnt lgkmcnt(2)
  MF v[48:51], a[224:227], v[164:167], v[48:51]
  ds_read_b128 v[160:163], v7 offset:32768
  v_max_f32 v108, 0, v108
  MF v[52:55], a[228:231], v[164:167], v[52:55]
  v_max_f32 v109, 0, v109
  v_max_f32 v110, 0, v110
  MF v[56:59], a[232:235], v[164:167], v[56:59]
  v_max_f32 v111, 0, v111
  v_mul_f32 v108, v108, v124
  MF v[60:63], a[236:239], v[164:167], v[60:63]
  v_mul_f32 v109, v109, v125
  s_waitcnt lgkmcnt(2)
  MF v[64:67], a[224:227], v[168:171], v[64:67]
  ds_read_b128 v[164:167], v7 offset:34816
  v_mul_f32 v110, v110, v126
  MF v[68:71], a[228:231], v[168:171], v[68:71]
  v_mul_f32 v111, v111, v127
  v_cvt_pk_bf16_f32 v254, v108, v109
  MF v[72:75], a[232:235], v[168:171], v[72:75]
  v_cvt_pk_bf16_f32 v255, v110, v111
  MF v[76:79], a[236:239], v[168:171], v[76:79]
  s_waitcnt lgkmcnt(2)
  MF v[80:83], a[224:227], v[172:175], v[80:83]
  ds_read_b128 v[168:171], v7 offset:36864
  MF v[84:87], a[228:231], v[172:175], v[84:87]
  MF v[88:91], a[232:235], v[172:175], v[88:91]
  MF v[92:95], a[236:239], v[172:175], v[92:95]
  s_waitcnt lgkmcnt(2)
  MF v[32:35], a[240:243], v[160:163], v[32:35]
  ds_read_b128 v[172:175], v7 offset:38912
  MF v[36:39], a[244:247], v[160:163], v[36:39]
  MF v[40:43], a[248:251], v[160:163], v[40:43]
  MF v[44:47], a[252:255], v[160:163], v[44:47]
  s_waitcnt lgkmcnt(2)
  MF v[48:51], a[240:243], v[164:167], v[48:51]
  ds_read_b128 v[160:163], v6 offset:40960
  MF v[52:55], a[244:247], v[164:167], v[52:55]
  MF v[56:59], a[248:251], v[164:167], v[56:59]
  MF v[60:63], a[252:255], v[164:167], v[60:63]
  s_waitcnt lgkmcnt(2)
  MF v[64:67], a[240:243], v[168:171], v[64:67]
  ds_read_b128 v[164:167], v6 offset:43008
  MF v[68:71], a[244:247], v[168:171], v[68:71]
  MF v[72:75], a[248:251], v[168:171], v[72:75]
  MF v[76:79], a[252:255], v[168:171], v[76:79]
  s_waitcnt lgkmcnt(2)
  MF v[80:83], a[240:243], v[172:175], v[80:83]
  ds_read_b128 v[168:171], v6 offset:45056
  MF v[84:87], a[244:247], v[172:175], v[84:87]
  MF v[88:91], a[248:251], v[172:175], v[88:91]
  MF v[92:95], a[252:255], v[172:175], v[92:95]
  s_waitcnt lgkmcnt(2)
  MF v[32:35], v[176:179], v[160:163], v[32:35]
  ds_read_b128 v[172:175], v6 offset:47104
  MF v[36:39], v[180:183], v[160:163], v[36:39]
  MF v[40:43], v[184:187], v[160:163], v[40:43]
  MF v[44:47], v[188:191], v[160:163], v[44:47]
  s_waitcnt lgkmcnt(2)
  MF v[48:51], v[176:179], v[164:167], v[48:51]
  ds_read_b128 v[160:163], v7 offset:40960
  MF v[52:55], v[180:183], v[164:167], v[52:55]
  MF v[56:59], v[184:187], v[164:167], v[56:59]
  MF v[60:63], v[188:191], v[164:167], v[60:63]
  s_waitcnt lgkmcnt(2)
  MF v[64:67], v[176:179], v[168:171], v[64:67]
  ds_read_b128 v[164:167], v7 offset:43008
  MF v[68:71], v[180:183], v[168:171], v[68:71]
  MF v[72:75], v[184:187], v[168:171], v[72:75]
  MF v[76:79], v[188:191], v[168:171], v[76:79]
  s_waitcnt lgkmcnt(2)
  MF v[80:83], v[176:179], v[172:175], v[80:83]
  ds_read_b128 v[168:171], v7 offset:45056
  MF v[84:87], v[180:183], v[172:175], v[84:87]
  MF v[88:91], v[184:187], v[172:175], v[88:91]
  MF v[92:95], v[188:191], v[172:175], v[92:95]
  s_waitcnt lgkmcnt(2)
  MF v[32:35], v[192:195], v[160:163], v[32:35]
  ds_read_b128 v[172:175], v7 offset:47104
  MF v[36:39], v[196:199], v[160:163], v[36:39]
  MF v[40:43], v[200:203], v[160:163], v[40:43]
  MF v[44:47], v[204:207], v[160:163], v[44:47]
  s_waitcnt lgkmcnt(2)
  MF v[48:51], v[192:195], v[164:167], v[48:51]
  s_waitcnt vmcnt(8)
  s_barrier
  TR v[160:161], v2 offset:49152
  MF v[52:55], v[196:199], v[164:167], v[52:55]
  TR v[162:163], v2 offset:49408
  MF v[56:59], v[200:203], v[164:167], v[56:59]
  MF v[60:63], v[204:207], v[164:167], v[60:63]
  s_waitcnt lgkmcnt(3)
  MF v[64:67], v[192:195], v[168:171], v[64:67]
  TR v[164:165], v2 offset:51200
  MF v[68:71], v[196:199], v[168:171], v[68:71]
  TR v[166:167], v2 offset:51456
  MF v[72:75], v[200:203], v[168:171], v[72:75]
  MF v[76:79], v[204:207], v[168:171], v[76:79]
  s_waitcnt lgkmcnt(4)
  MF v[80:83], v[192:195], v[172:175], v[80:83]
  TR v[168:169], v2 offset:53248
  MF v[84:87], v[196:199], v[172:175], v[84:87]
  TR v[170:171], v2 offset:53504
  MF v[88:91], v[200:203], v[172:175], v[88:91]
  MF v[92:95], v[204:207], v[172:175], v[92:95]
K1_TB_G1:
  s_waitcnt lgkmcnt(4)
  MF v[96:99], v[160:163], a[0:3], 0
  TR v[172:173], v2 offset:55296
  MF v[100:103], v[160:163], a[4:7], 0
  TR v[174:175], v2 offset:55552
  MF v[104:107], v[160:163], a[8:11], 0
  s_add_u32 m0, s37, 98304
  s_add_u32 s89, s52, 64
  BL4 v8, s[8:11], s89 offen lds
  MF v[108:111], v[160:163], a[12:15], 0
  s_add_u32 m0, s37, 102400
  s_add_u32 s89, s53, 64
  BL4 v8, s[8:11], s89 offen lds
  s_waitcnt lgkmcnt(4)
  MF v[112:115], v[164:167], a[0:3], 0
  TR v[160:161], v2 offset:57344
  s_cmp_eq_u32 s32, 0
  s_cselect_b32 s84, 1, 0
  MF v[116:119], v[164:167], a[4:7], 0
  TR v[162:163], v2 offset:57600
  MF v[120:123], v[164:167], a[8:11], 0
  s_mov_b32 s82, 262144
POLLR2:
  v_cmp_eq_u32 vcc, 1, v245
  s_nop 1
  s_and_b32 s80, vcc_lo, s84
  s_cmp_eq_u32 s80, s84
  s_cbranch_scc1 POLLEDR2
  s_sub_u32 s82, s82, 1
  s_cbranch_scc1 POLLEDR2
  s_sleep 2
  buffer_load_dword v245, v247, s[20:23], 0 offen sc1
  s_waitcnt vmcnt(0)
  s_branch POLLR2
POLLEDR2:
  MF v[124:127], v[164:167], a[12:15], 0
  s_lshl_b32 s80, s2, 2
  s_add_u32 s80, s80, 32636928
  s_waitcnt lgkmcnt(4)
  MF v[96:99], v[168:171], a[16:19], v[96:99]
  TR v[164:165], v2 offset:59392
  s_cmp_eq_u32 s32, 0
  s_cselect_b32 s80, s80, 1073741824
  MF v[100:103], v[168:171], a[20:23], v[100:103]
  TR v[166:167], v2 offset:59648
  v_mov_b32 v30, s80
  MF v[104:107], v[168:171], a[24:27], v[104:107]
  s_add_u32 m0, s37, 106496
  s_add_u32 s89, s54, 64
  BL4 v8, s[8:11], s89 offen lds
  MF v[108:111], v[168:171], a[28:31], v[108:111]
  s_add_u32 m0, s37, 110592
  s_add_u32 s89, s55, 64
  BL4 v8, s[8:11], s89 offen lds
  s_waitcnt lgkmcnt(4)
  MF v[112:115], v[172:175], a[16:19], v[112:115]
  TR v[168:169], v3
  v_mov_b32 v243, 1073741824
  MF v[116:119], v[172:175], a[20:23], v[116:119]
  TR v[170:171], v3 offset:256
  MF v[120:123], v[172:175], a[24:27], v[120:123]
  v_cmp_eq_u32 vcc, 0, v1
  s_nop 1
  v_cndmask_b32 v30, v243, v30, vcc
  MF v[124:127], v[172:175], a[28:31], v[124:127]
  s_add_u32 s88, s36, 0
  s_lshl_b32 s88, s88, 10
  s_waitcnt lgkmcnt(4)
  MF v[96:99], v[160:163], a[32:35], v[96:99]
  TR v[172:173], v3 offset:2048
  v_max_f32 v128, 0, v128
  MF v[100:103], v[160:163], a[36:39], v[100:103]
  TR v[174:175], v3 offset:2304
  v_max_f32 v129, 0, v129
  MF v[104:107], v[160:163], a[40:43], v[104:107]
  s_add_u32 m0, s37, 114688
  s_add_u32 s89, s56, 64
  BL4 v8, s[8:11], s89 offen lds
  MF v[108:111], v[160:163], a[44:47], v[108:111]
  s_add_u32 m0, s37, 118784
  s_add_u32 s89, s57, 64
  BL4 v8, s[8:11], s89 offen lds
  s_waitcnt lgkmcnt(4)
  MF v[112:115], v[164:167], a[32:35], v[112:115]
  TR v[160:161], v3 offset:4096
  v_max_f32 v130, 0, v130
  MF v[116:119], v[164:167], a[36:39], v[116:119]
  TR v[162:163], v3 offset:4352
  v_max_f32 v131, 0, v131
  MF v[120:123], v[164:167], a[40:43], v[120:123]
  v_mul_f32 v128, v128, v144
  v_mul_f32 v129, v129, v145
  MF v[124:127], v[164:167], a[44:47], v[124:127]
  v_mul_f32 v130, v130, v146
  s_waitcnt lgkmcnt(4)
  MF v[96:99], v[168:171], a[48:51], v[96:99]
  TR v[164:165], v3 offset:6144
  v_mul_f32 v131, v131, v147
  MF v[100:103], v[168:171], a[52:55], v[100:103]
  TR v[166:167], v3 offset:6400
  v_mov_b32 v240, v248
  MF v[104:107], v[168:171], a[56:59], v[104:107]
  v_mov_b32 v241, v249
  v_cvt_pk_bf16_f32 v242, v128, v129
  MF v[108:111], v[168:171], a[60:63], v[108:111]
  v_cvt_pk_bf16_f32 v243, v130, v131
  s_waitcnt lgkmcnt(4)
  MF v[112:115], v[172:175], a[48:51], v[112:115]
  TR v[168:169], v3 offset:8192
  s_add_u32 s80, s88, 0
  MF v[116:119], v[172:175], a[52:55], v[116:119]
  TR v[170:171], v3 offset:8448
  MF v[120:123], v[172:175], a[56:59], v[120:123]
  buffer_store_dwordx4 v[240:243], v10, s[16:19], s80 offen sc1
  MF v[124:127], v[172:175], a[60:63], v[124:127]
  v_max_f32 v132, 0, v132
  s_waitcnt lgkmcnt(4)
  MF v[96:99], v[160:163], a[64:67], v[96:99]
  TR v[172:173], v3 offset:10240
  v_max_f32 v133, 0, v133
  MF v[100:103], v[160:163], a[68:71], v[100:103]
  TR v[174:175], v3 offset:10496
  v_max_f32 v134, 0, v134
  MF v[104:107], v[160:163], a[72:75], v[104:107]
  v_max_f32 v135, 0, v135
  v_mul_f32 v132, v132, v148
  MF v[108:111], v[160:163], a[76:79], v[108:111]
  v_mul_f32 v133, v133, v149
  s_waitcnt lgkmcnt(4)
  MF v[112:115], v[164:167], a[64:67], v[112:115]
  TR v[160:161], v4 offset:49152
  v_mul_f32 v134, v134, v150
  MF v[116:119], v[164:167], a[68:71], v[116:119]
  TR v[162:163], v4 offset:49408
  v_mul_f32 v135, v135, v151
  MF v[120:123], v[164:167], a[72:75], v[120:123]
  v_mov_b32 v244, v250
  v_mov_b32 v245, v251
  MF v[124:127], v[164:167], a[76:79], v[124:127]
  v_cvt_pk_bf16_f32 v246, v132, v133
  s_waitcnt lgkmcnt(4)
  MF v[96:99], v[168:171], a[80:83], v[96:99]
  TR v[164:165], v4 offset:51200
  v_cvt_pk_bf16_f32 v247, v134, v135
  MF v[100:103], v[168:171], a[84:87], v[100:103]
  TR v[166:167], v4 offset:51456
  s_add_u32 s80, s88, 185344
  MF v[104:107], v[168:171], a[88:91], v[104:107]
  buffer_store_dwordx4 v[244:247], v10, s[16:19], s80 offen sc1
  MF v[108:111], v[168:171], a[92:95], v[108:111]
  v_max_f32 v136, 0, v136
  s_waitcnt lgkmcnt(4)
  MF v[112:115], v[172:175], a[80:83], v[112:115]
  TR v[168:169], v4 offset:53248
  v_max_f32 v137, 0, v137
  MF v[116:119], v[172:175], a[84:87], v[116:119]
  TR v[170:171], v4 offset:53504
  v_max_f32 v138, 0, v138
  MF v[120:123], v[172:175], a[88:91], v[120:123]
  v_max_f32 v139, 0, v139
  v_mul_f32 v136, v136, v152
  MF v[124:127], v[172:175], a[92:95], v[124:127]
  v_mul_f32 v137, v137, v153
  v_mul_f32 v138, v138, v154
  v_mul_f32 v139, v139, v155
  v_mov_b32 v240, v252
  v_mov_b32 v241, v253
  v_cvt_pk_bf16_f32 v242, v136, v137
  v_cvt_pk_bf16_f32 v243, v138, v139
  s_add_u32 s80, s88, 370688
  buffer_store_dwordx4 v[240:243], v10, s[16:19], s80 offen sc1
  v_max_f32 v140, 0, v140
  v_max_f32 v141, 0, v141
  v_max_f32 v142, 0, v142
  v_max_f32 v143, 0, v143
  v_mul_f32 v140, v140, v156
  v_mul_f32 v141, v141, v157
  v_mul_f32 v142, v142, v158
  v_mul_f32 v143, v143, v159
  v_mov_b32 v244, v254
  v_mov_b32 v245, v255
  v_cvt_pk_bf16_f32 v246, v140, v141
  v_cvt_pk_bf16_f32 v247, v142, v143
  s_add_u32 s80, s88, 556032
  buffer_store_dwordx4 v[244:247], v10, s[16:19], s80 offen sc1
  s_waitcnt lgkmcnt(4)
  MF v[128:131], v[160:163], a[0:3], 0
  TR v[172:173], v4 offset:55296
  v_fma_f32 v226, v210, v32, v33
  MF v[132:135], v[160:163], a[4:7], 0
  TR v[174:175], v4 offset:55552
  v_fma_f32 v238, v218, v64, v65
  MF v[136:139], v[160:163], a[8:11], 0
  v_fma_f32 v227, v210, v48, v49
  v_fma_f32 v239, v218, v80, v81
  MF v[140:143], v[160:163], a[12:15], 0
  v_fma_f32 v226, -v211, v48, v226
  s_waitcnt lgkmcnt(4)
  MF v[144:147], v[164:167], a[0:3], 0
  TR v[160:161], v4 offset:57344
  v_fma_f32 v238, -v219, v80, v238
  MF v[148:151], v[164:167], a[4:7], 0
  TR v[162:163], v4 offset:57600
  v_fma_f32 v227, v211, v32, v227
  MF v[152:155], v[164:167], a[8:11], 0
  v_fma_f32 v239, v219, v64, v239
  v_fma_f32 v224, v210, v226, v34
  MF v[156:159], v[164:167], a[12:15], 0
  v_fma_f32 v236, v218, v238, v66
  s_waitcnt lgkmcnt(4)
  MF v[128:131], v[168:171], a[16:19], v[128:131]
  TR v[164:165], v4 offset:59392
  v_fma_f32 v225, v210, v227, v50
  MF v[132:135], v[168:171], a[20:23], v[132:135]
  TR v[166:167], v4 offset:59648
  v_fma_f32 v237, v218, v239, v82
  MF v[136:139], v[168:171], a[24:27], v[136:139]
  v_fma_f32 v224, -v211, v227, v224
  v_fma_f32 v236, -v219, v239, v236
  MF v[140:143], v[168:171], a[28:31], v[140:143]
  v_fma_f32 v225, v211, v226, v225
  s_waitcnt lgkmcnt(4)
  MF v[144:147], v[172:175], a[16:19], v[144:147]
  TR v[168:169], v5
  v_fma_f32 v237, v219, v238, v237
  MF v[148:151], v[172:175], a[20:23], v[148:151]
  TR v[170:171], v5 offset:256
  v_fma_f32 v226, v210, v224, v35
  MF v[152:155], v[172:175], a[24:27], v[152:155]
  v_fma_f32 v238, v218, v236, v67
  v_fma_f32 v227, v210, v225, v51
  MF v[156:159], v[172:175], a[28:31], v[156:159]
  v_fma_f32 v239, v218, v237, v83
  s_waitcnt lgkmcnt(4)
  MF v[128:131], v[160:163], a[32:35], v[128:131]
  TR v[172:173], v5 offset:2048
  v_fma_f32 v226, -v211, v225, v226
  MF v[132:135], v[160:163], a[36:39], v[132:135]
  TR v[174:175], v5 offset:2304
  v_fma_f32 v238, -v219, v237, v238
  MF v[136:139], v[160:163], a[40:43], v[136:139]
  v_fma_f32 v227, v211, v224, v227
  v_fma_f32 v239, v219, v236, v239
  MF v[140:143], v[160:163], a[44:47], v[140:143]
  v_fma_f32 v224, v210, v226, v36
  s_waitcnt lgkmcnt(4)
  MF v[144:147], v[164:167], a[32:35], v[144:147]
  TR v[160:161], v5 offset:4096
  v_fma_f32 v236, v218, v238, v68
  MF v[148:151], v[164:167], a[36:39], v[148:151]
  TR v[162:163], v5 offset:4352
  v_fma_f32 v225, v210, v227, v52
  MF v[152:155], v[164:167], a[40:43], v[152:155]
  v_fma_f32 v237, v218, v239, v84
  v_fma_f32 v224, -v211, v227, v224
  MF v[156:159], v[164:167], a[44:47], v[156:159]
  v_fma_f32 v236, -v219, v239, v236
  s_waitcnt lgkmcnt(4)
  MF v[128:131], v[168:171], a[48:51], v[128:131]
  TR v[164:165], v5 offset:6144
  v_fma_f32 v225, v211, v226, v225
  MF v[132:135], v[168:171], a[52:55], v[132:135]
  TR v[166:167], v5 offset:6400
  v_fma_f32 v237, v219, v238, v237
  MF v[136:139], v[168:171], a[56:59], v[136:139]
  v_fma_f32 v226, v210, v224, v37
  v_fma_f32 v238, v218, v236, v69
  MF v[140:143], v[168:171], a[60:63], v[140:143]
  v_fma_f32 v227, v210, v225, v53
  s_waitcnt lgkmcnt(4)
  MF v[144:147], v[172:175], a[48:51], v[144:147]
  TR v[168:169], v5 offset:8192
  v_fma_f32 v239, v218, v237, v85
  MF v[148:151], v[172:175], a[52:55], v[148:151]
  TR v[170:171], v5 offset:8448
  v_fma_f32 v226, -v211, v225, v226
  MF v[152:155], v[172:175], a[56:59], v[152:155]
  v_fma_f32 v238, -v219, v237, v238
  v_fma_f32 v227, v211, v224, v227
  MF v[156:159], v[172:175], a[60:63], v[156:159]
  v_fma_f32 v239, v219, v236, v239
  s_waitcnt lgkmcnt(4)
  MF v[128:131], v[160:163], a[64:67], v[128:131]
  TR v[172:173], v5 offset:10240
  v_fma_f32 v224, v210, v226, v38
  MF v[132:135], v[160:163], a[68:71], v[132:135]
  TR v[174:175], v5 offset:10496
  v_fma_f32 v236, v218, v238, v70
  MF v[136:139], v[160:163], a[72:75], v[136:139]
  v_fma_f32 v225, v210, v227, v54
  v_fma_f32 v237, v218, v239, v86
  MF v[140:143], v[160:163], a[76:79], v[140:143]
  v_fma_f32 v224, -v211, v227, v224
  s_waitcnt lgkmcnt(4)
  MF v[144:147], v[164:167], a[64:67], v[144:147]
  s_waitcnt vmcnt(12)
  s_barrier
  TR v[160:161], v3 offset:12288
  v_fma_f32 v236, -v219, v239, v236
  MF v[148:151], v[164:167], a[68:71], v[148:151]
  TR v[162:163], v3 offset:12544
  v_fma_f32 v225, v211, v226, v225
  MF v[152:155], v[164:167], a[72:75], v[152:155]
  v_fma_f32 v237, v219, v238, v237
  v_fma_f32 v226, v210, v224, v39
  MF v[156:159], v[164:167], a[76:79], v[156:159]
  v_fma_f32 v238, v218, v236, v71
  s_waitcnt lgkmcnt(4)
  MF v[128:131], v[168:171], a[80:83], v[128:131]
  TR v[164:165], v3 offset:14336
  v_fma_f32 v227, v210, v225, v55
  MF v[132:135], v[168:171], a[84:87], v[132:135]
  TR v[166:167], v3 offset:14592
  v_fma_f32 v239, v218, v237, v87
  MF v[136:139], v[168:171], a[88:91], v[136:139]
  v_fma_f32 v226, -v211, v225, v226
  v_fma_f32 v238, -v219, v237, v238
  MF v[140:143], v[168:171], a[92:95], v[140:143]
  v_fma_f32 v227, v211, v224, v227
  s_waitcnt lgkmcnt(4)
  MF v[144:147], v[172:175], a[80:83], v[144:147]
  TR v[168:169], v5 offset:12288
  v_fma_f32 v239, v219, v236, v239
  MF v[148:151], v[172:175], a[84:87], v[148:151]
  TR v[170:171], v5 offset:12544
  v_fma_f32 v224, v210, v226, v40
  MF v[152:155], v[172:175], a[88:91], v[152:155]
  v_fma_f32 v236, v218, v238, v72
  v_fma_f32 v225, v210, v227, v56
  MF v[156:159], v[172:175], a[92:95], v[156:159]
  v_fma_f32 v237, v218, v239, v88
  s_waitcnt lgkmcnt(4)
  MF v[96:99], v[160:163], a[96:99], v[96:99]
  TR v[172:173], v5 offset:14336
  v_fma_f32 v224, -v211, v227, v224
  MF v[100:103], v[160:163], a[100:103], v[100:103]
  TR v[174:175], v5 offset:14592
  v_fma_f32 v236, -v219, v239, v236
  MF v[104:107], v[160:163], a[104:107], v[104:107]
  s_add_u32 m0, s37, 0
  s_add_u32 s89, s40, 128
  BL4 v8, s[8:11], s89 offen lds
  MF v[108:111], v[160:163], a[108:111], v[108:111]
  s_add_u32 m0, s37, 4096
  s_add_u32 s89, s41, 128
  BL4 v8, s[8:11], s89 offen lds
  s_waitcnt lgkmcnt(4)
  MF v[112:115], v[164:167], a[96:99], v[112:115]
  TR v[160:161], v3 offset:16384
  v_fma_f32 v225, v211, v226, v225
  MF v[116:119], v[164:167], a[100:103], v[116:119]
  TR v[162:163], v3 offset:16640
  v_fma_f32 v237, v219, v238, v237
  MF v[120:123], v[164:167], a[104:107], v[120:123]
  v_fma_f32 v226, v210, v224, v41
  v_fma_f32 v238, v218, v236, v73
  MF v[124:127], v[164:167], a[108:111], v[124:127]
  v_fma_f32 v227, v210, v225, v57
  s_waitcnt lgkmcnt(4)
  MF v[128:131], v[168:171], a[96:99], v[128:131]
  TR v[164:165], v3 offset:18432
  v_fma_f32 v239, v218, v237, v89
  MF v[132:135], v[168:171], a[100:103], v[132:135]
  TR v[166:167], v3 offset:18688
  v_fma_f32 v226, -v211, v225, v226
  MF v[136:139], v[168:171], a[104:107], v[136:139]
  v_fma_f32 v238, -v219, v237, v238
  v_fma_f32 v227, v211, v224, v227
  MF v[140:143], v[168:171], a[108:111], v[140:143]
  v_fma_f32 v239, v219, v236, v239
  s_waitcnt lgkmcnt(4)
  MF v[144:147], v[172:175], a[96:99], v[144:147]
  TR v[168:169], v5 offset:16384
  v_fma_f32 v224, v210, v226, v42
  MF v[148:151], v[172:175], a[100:103], v[148:151]
  TR v[170:171], v5 offset:16640
  v_fma_f32 v236, v218, v238, v74
  MF v[152:155], v[172:175], a[104:107], v[152:155]
  v_fma_f32 v225, v210, v227, v58
  v_fma_f32 v237, v218, v239, v90
  MF v[156:159], v[172:175], a[108:111], v[156:159]
  v_fma_f32 v224, -v211, v227, v224
  s_waitcnt lgkmcnt(4)
  MF v[96:99], v[160:163], a[112:115], v[96:99]
  TR v[172:173], v5 offset:18432
  v_fma_f32 v236, -v219, v239, v236
  MF v[100:103], v[160:163], a[116:119], v[100:103]
  TR v[174:175], v5 offset:18688
  v_fma_f32 v225, v211, v226, v225
  MF v[104:107], v[160:163], a[120:123], v[104:107]
  s_add_u32 m0, s37, 8192
  s_add_u32 s89, s42, 128
  BL4 v8, s[8:11], s89 offen lds
  MF v[108:111], v[160:163], a[124:127], v[108:111]
  s_add_u32 m0, s37, 12288
  s_add_u32 s89, s43, 128
  BL4 v8, s[8:11], s89 offen lds
  s_waitcnt lgkmcnt(4)
  MF v[112:115], v[164:167], a[112:115], v[112:115]
  TR v[160:161], v3 offset:20480
  v_fma_f32 v237, v219, v238, v237
  MF v[116:119], v[164:167], a[116:119], v[116:119]
  TR v[162:163], v3 offset:20736
  v_fma_f32 v226, v210, v224, v43
  MF v[120:123], v[164:167], a[120:123], v[120:123]
  v_fma_f32 v238, v218, v236, v75
  v_fma_f32 v227, v210, v225, v59
  MF v[124:127], v[164:167], a[124:127], v[124:127]
  v_fma_f32 v239, v218, v237, v91
  s_waitcnt lgkmcnt(4)
  MF v[128:131], v[168:171], a[112:115], v[128:131]
  TR v[164:165], v3 offset:22528
  v_fma_f32 v226, -v211, v225, v226
  MF v[132:135], v[168:171], a[116:119], v[132:135]
  TR v[166:167], v3 offset:22784
  v_fma_f32 v238, -v219, v237, v238
  MF v[136:139], v[168:171], a[120:123], v[136:139]
  v_fma_f32 v227, v211, v224, v227
  v_fma_f32 v239, v219, v236, v239
  MF v[140:143], v[168:171], a[124:127], v[140:143]
  v_fma_f32 v224, v210, v226, v44
  s_waitcnt lgkmcnt(4)
  MF v[144:147], v[172:175], a[112:115], v[144:147]
  TR v[168:169], v5 offset:20480
  v_fma_f32 v236, v218, v238, v76
  MF v[148:151], v[172:175], a[116:119], v[148:151]
  TR v[170:171], v5 offset:20736
  v_fma_f32 v225, v210, v227, v60
  MF v[152:155], v[172:175], a[120:123], v[152:155]
  v_fma_f32 v237, v218, v239, v92
  v_fma_f32 v224, -v211, v227, v224
  MF v[156:159], v[172:175], a[124:127], v[156:159]
  v_fma_f32 v236, -v219, v239, v236
  s_waitcnt lgkmcnt(4)
  MF v[96:99], v[160:163], a[128:131], v[96:99]
  TR v[172:173], v5 offset:22528
  v_fma_f32 v225, v211, v226, v225
  MF v[100:103], v[160:163], a[132:135], v[100:103]
  TR v[174:175], v5 offset:22784
  v_fma_f32 v237, v219, v238, v237
  MF v[104:107], v[160:163], a[136:139], v[104:107]
  s_add_u32 m0, s37, 16384
  s_add_u32 s89, s44, 128
  BL4 v8, s[8:11], s89 offen lds
  MF v[108:111], v[160:163], a[140:143], v[108:111]
  s_add_u32 m0, s37, 20480
  s_add_u32 s89, s45, 128
  BL4 v8, s[8:11], s89 offen lds
  s_waitcnt lgkmcnt(4)
  MF v[112:115], v[164:167], a[128:131], v[112:115]
  TR v[160:161], v3 offset:24576
  v_fma_f32 v226, v210, v224, v45
  MF v[116:119], v[164:167], a[132:135], v[116:119]
  TR v[162:163], v3 offset:24832
  v_fma_f32 v238, v218, v236, v77
  MF v[120:123], v[164:167], a[136:139], v[120:123]
  v_fma_f32 v227, v210, v225, v61
  v_fma_f32 v239, v218, v237, v93
  MF v[124:127], v[164:167], a[140:143], v[124:127]
  v_fma_f32 v226, -v211, v225, v226
  s_waitcnt lgkmcnt(4)
  MF v[128:131], v[168:171], a[128:131], v[128:131]
  TR v[164:165], v3 offset:26624
  v_fma_f32 v238, -v219, v237, v238
  MF v[132:135], v[168:171], a[132:135], v[132:135]
  TR v[166:167], v3 offset:26880
  v_fma_f32 v227, v211, v224, v227
  MF v[136:139], v[168:171], a[136:139], v[136:139]
  v_fma_f32 v239, v219, v236, v239
  v_fma_f32 v224, v210, v226, v46
  MF v[140:143], v[168:171], a[140:143], v[140:143]
  v_fma_f32 v236, v218, v238, v78
  s_waitcnt lgkmcnt(4)
  MF v[144:147], v[172:175], a[128:131], v[144:147]
  TR v[168:169], v5 offset:24576
  v_fma_f32 v225, v210, v227, v62
  MF v[148:151], v[172:175], a[132:135], v[148:151]
  TR v[170:171], v5 offset:24832
  v_fma_f32 v237, v218, v239, v94
  MF v[152:155], v[172:175], a[136:139], v[152:155]
  v_fma_f32 v224, -v211, v227, v224
  v_fma_f32 v236, -v219, v239, v236
  MF v[156:159], v[172:175], a[140:143], v[156:159]
  v_fma_f32 v225, v211, v226, v225
  s_waitcnt lgkmcnt(4)
  MF v[96:99], v[160:163], a[144:147], v[96:99]
  TR v[172:173], v5 offset:26624
  v_fma_f32 v237, v219, v238, v237
  MF v[100:103], v[160:163], a[148:151], v[100:103]
  TR v[174:175], v5 offset:26880
  v_fma_f32 v226, v210, v224, v47
  MF v[104:107], v[160:163], a[152:155], v[104:107]
  s_add_u32 m0, s37, 24576
  s_add_u32 s89, s46, 128
  BL4 v8, s[8:11], s89 offen lds
  MF v[108:111], v[160:163], a[156:159], v[108:111]
  v_fma_f32 v238, v218, v236, v79
  s_waitcnt lgkmcnt(4)
  MF v[112:115], v[164:167], a[144:147], v[112:115]
  TR v[160:161], v3 offset:28672
  v_fma_f32 v227, v210, v225, v63
  MF v[116:119], v[164:167], a[148:151], v[116:119]
  TR v[162:163], v3 offset:28928
  v_fma_f32 v239, v218, v237, v95
  MF v[120:123], v[164:167], a[152:155], v[120:123]
  v_fma_f32 v226, -v211, v225, v226
  v_fma_f32 v238, -v219, v237, v238
  MF v[124:127], v[164:167], a[156:159], v[124:127]
  v_fma_f32 v227, v211, v224, v227
  s_waitcnt lgkmcnt(4)
  MF v[128:131], v[168:171], a[144:147], v[128:131]
  TR v[164:165], v3 offset:30720
  v_fma_f32 v239, v219, v236, v239
  MF v[132:135], v[168:171], a[148:151], v[132:135]
  TR v[166:167], v3 offset:30976
  ds_bpermute_b32 v232, v16, v226
  MF v[136:139], v[168:171], a[152:155], v[136:139]
  ds_bpermute_b32 v244, v16, v238
  ds_bpermute_b32 v233, v16, v227
  MF v[140:143], v[168:171], a[156:159], v[140:143]
  ds_bpermute_b32 v245, v16, v239
  s_waitcnt lgkmcnt(8)
  MF v[144:147], v[172:175], a[144:147], v[144:147]
  TR v[168:169], v5 offset:28672
  v_mul_f32 v230, v214, v214
  MF v[148:151], v[172:175], a[148:151], v[148:151]
  TR v[170:171], v5 offset:28928
  v_mul_f32 v242, v222, v222
  MF v[152:155], v[172:175], a[152:155], v[152:155]
  v_mul_f32 v231, v214, v215
  v_mul_f32 v243, v222, v223
  MF v[156:159], v[172:175], a[156:159], v[156:159]
  v_fma_f32 v230, -v215, v215, v230
  s_waitcnt lgkmcnt(8)
  MF v[96:99], v[160:163], a[160:163], v[96:99]
  TR v[172:173], v5 offset:30720
  v_fma_f32 v242, -v223, v223, v242
  MF v[100:103], v[160:163], a[164:167], v[100:103]
  TR v[174:175], v5 offset:30976
  v_add_f32 v231, v231, v231
  MF v[104:107], v[160:163], a[168:171], v[104:107]
  s_add_u32 m0, s37, 28672
  s_add_u32 s89, s47, 128
  BL4 v8, s[8:11], s89 offen lds
  MF v[108:111], v[160:163], a[172:175], v[108:111]
  v_add_f32 v243, v243, v243
  s_waitcnt lgkmcnt(8)
  MF v[112:115], v[164:167], a[160:163], v[112:115]
  TR v[160:161], v3 offset:32768
  v_mul_f32 v230, v230, v19
  MF v[116:119], v[164:167], a[164:167], v[116:119]
  TR v[162:163], v3 offset:33024
  v_mul_f32 v242, v242, v19
  MF v[120:123], v[164:167], a[168:171], v[120:123]
  v_mul_f32 v231, v231, v19
  v_mul_f32 v243, v243, v19
  MF v[124:127], v[164:167], a[172:175], v[124:127]
  s_waitcnt lgkmcnt(9)
  v_fma_f32 v226, v214, v232, v226
  s_waitcnt lgkmcnt(4)
  MF v[128:131], v[168:171], a[160:163], v[128:131]
  TR v[164:165], v3 offset:34816
  v_fma_f32 v238, v222, v244, v238
  MF v[132:135], v[168:171], a[164:167], v[132:135]
  TR v[166:167], v3 offset:35072
  v_fma_f32 v227, v214, v233, v227
  MF v[136:139], v[168:171], a[168:171], v[136:139]
  v_fma_f32 v239, v222, v245, v239
  v_fma_f32 v226, -v215, v233, v226
  MF v[140:143], v[168:171], a[172:175], v[140:143]
  v_fma_f32 v238, -v223, v245, v238
  s_waitcnt lgkmcnt(4)
  MF v[144:147], v[172:175], a[160:163], v[144:147]
  TR v[168:169], v5 offset:32768
  v_fma_f32 v227, v215, v232, v227
  MF v[148:151], v[172:175], a[164:167], v[148:151]
  TR v[170:171], v5 offset:33024
  v_fma_f32 v239, v223, v244, v239
  MF v[152:155], v[172:175], a[168:171], v[152:155]
  ds_bpermute_b32 v232, v17, v226
  ds_bpermute_b32 v244, v17, v238
  MF v[156:159], v[172:175], a[172:175], v[156:159]
  ds_bpermute_b32 v233, v17, v227
  s_waitcnt lgkmcnt(7)
  MF v[96:99], v[160:163], a[176:179], v[96:99]
  TR v[172:173], v5 offset:34816
  ds_bpermute_b32 v245, v17, v239
  MF v[100:103], v[160:163], a[180:183], v[100:103]
  TR v[174:175], v5 offset:35072
  MF v[104:107], v[160:163], a[184:187], v[104:107]
  s_add_u32 m0, s37, 32768
  s_add_u32 s89, s48, 128
  BL4 v8, s[8:11], s89 offen lds
  MF v[108:111], v[160:163], a[188:191], v[108:111]
  s_waitcnt lgkmcnt(5)
  v_fma_f32 v226, v230, v232, v226
  s_waitcnt lgkmcnt(4)
  v_fma_f32 v238, v242, v244, v238
  s_waitcnt lgkmcnt(3)
  v_fma_f32 v227, v230, v233, v227
  s_waitcnt lgkmcnt(1)
  v_fma_f32 v239, v242, v245, v239
  v_fma_f32 v226, -v231, v233, v226
  v_fma_f32 v238, -v243, v245, v238
  v_fma_f32 v227, v231, v232, v227
  v_fma_f32 v239, v243, v244, v239
  ds_write_b64 v11, v[226:227]
  ds_write_b64 v11, v[238:239] offset:512
  MF v[112:115], v[164:167], a[176:179], v[112:115]
  s_waitcnt vmcnt(13) lgkmcnt(0)
  s_barrier
  TR v[160:161], v3 offset:36864
  ds_bpermute_b32 v212, v16, v226
  MF v[116:119], v[164:167], a[180:183], v[116:119]
  TR v[162:163], v3 offset:37120
  ds_bpermute_b32 v220, v16, v238
  MF v[120:123], v[164:167], a[184:187], v[120:123]
  ds_bpermute_b32 v213, v16, v227
  ds_bpermute_b32 v221, v16, v239
  MF v[124:127], v[164:167], a[188:191], v[124:127]
  MF v[128:131], v[168:171], a[176:179], v[128:131]
  TR v[164:165], v3 offset:38912
  MF v[132:135], v[168:171], a[180:183], v[132:135]
  TR v[166:167], v3 offset:39168
  MF v[136:139], v[168:171], a[184:187], v[136:139]
  MF v[140:143], v[168:171], a[188:191], v[140:143]
  s_waitcnt lgkmcnt(6)
  v_mul_f32 v212, v212, v18
  MF v[144:147], v[172:175], a[176:179], v[144:147]
  TR v[168:169], v3 offset:40960
  s_waitcnt lgkmcnt(5)
  v_mul_f32 v220, v220, v18
  MF v[148:151], v[172:175], a[180:183], v[148:151]
  TR v[170:171], v3 offset:41216
  s_waitcnt lgkmcnt(5)
  v_mul_f32 v213, v213, v18
  MF v[152:155], v[172:175], a[184:187], v[152:155]
  s_waitcnt lgkmcnt(4)
  v_mul_f32 v221, v221, v18
  MF v[156:159], v[172:175], a[188:191], v[156:159]
  MF v[96:99], v[160:163], a[192:195], v[96:99]
  TR v[172:173], v3 offset:43008
  MF v[100:103], v[160:163], a[196:199], v[100:103]
  TR v[174:175], v3 offset:43264
  MF v[104:107], v[160:163], a[200:203], v[104:107]
  s_add_u32 m0, s37, 36864
  s_add_u32 s89, s49, 128
  BL4 v8, s[8:11], s89 offen lds
  MF v[108:111], v[160:163], a[204:207], v[108:111]
  s_add_u32 m0, s37, 40960
  s_add_u32 s89, s50, 128
  BL4 v8, s[8:11], s89 offen lds
  s_waitcnt lgkmcnt(4)
  MF v[112:115], v[164:167], a[192:195], v[112:115]
  TR v[160:161], v3 offset:45056
  ds_read_b64 v[224:225], v12
  MF v[116:119], v[164:167], a[196:199], v[116:119]
  TR v[162:163], v3 offset:45312
  ds_read_b64 v[226:227], v12 offset:128
  MF v[120:123], v[164:167], a[200:203], v[120:123]
  ds_read_b64 v[228:229], v12 offset:256
  ds_read_b64 v[230:231], v12 offset:384
  MF v[124:127], v[164:167], a[204:207], v[124:127]
  v_mul_f32 v234, 0x42800000, v208
  s_waitcnt lgkmcnt(8)
  MF v[96:99], v[168:171], a[208:211], v[96:99]
  TR v[164:165], v3 offset:47104
  v_mul_f32 v235, 0x42800000, v209
  MF v[100:103], v[168:171], a[212:215], v[100:103]
  TR v[166:167], v3 offset:47360
  v_exp_f32 v232, v234
  MF v[104:107], v[168:171], a[216:219], v[104:107]
  s_add_u32 m0, s37, 45056
  s_add_u32 s89, s51, 128
  BL4 v8, s[8:11], s89 offen lds
  MF v[108:111], v[168:171], a[220:223], v[108:111]
  v_fract_f32 v235, v235
  s_waitcnt lgkmcnt(8)
  MF v[112:115], v[172:175], a[208:211], v[112:115]
  TR v[168:169], v3 offset:49152
  v_cos_f32 v234, v235
  MF v[116:119], v[172:175], a[212:215], v[116:119]
  TR v[170:171], v3 offset:49408
  v_sin_f32 v235, v235
  MF v[120:123], v[172:175], a[216:219], v[120:123]
  v_mul_f32 v233, v232, v235
  v_mul_f32 v232, v232, v234
  MF v[124:127], v[172:175], a[220:223], v[124:127]
  s_waitcnt lgkmcnt(6)
  v_fma_f32 v226, v232, v224, v226
  MF v[96:99], v[160:163], a[224:227], v[96:99]
  TR v[172:173], v3 offset:51200
  v_fma_f32 v227, v232, v225, v227
  MF v[100:103], v[160:163], a[228:231], v[100:103]
  TR v[174:175], v3 offset:51456
  v_fma_f32 v226, -v233, v225, v226
  MF v[104:107], v[160:163], a[232:235], v[104:107]
  s_add_u32 m0, s37, 49152
  s_add_u32 s89, s52, 128
  BL4 v8, s[8:11], s89 offen lds
  MF v[108:111], v[160:163], a[236:239], v[108:111]
  v_fma_f32 v227, v233, v224, v227
  s_waitcnt lgkmcnt(4)
  MF v[112:115], v[164:167], a[224:227], v[112:115]
  TR v[160:161], v3 offset:53248
  v_fma_f32 v228, v232, v226, v228
  MF v[116:119], v[164:167], a[228:231], v[116:119]
  TR v[162:163], v3 offset:53504
  v_fma_f32 v229, v232, v227, v229
  MF v[120:123], v[164:167], a[232:235], v[120:123]
  v_fma_f32 v228, -v233, v227, v228
  v_fma_f32 v229, v233, v226, v229
  MF v[124:127], v[164:167], a[236:239], v[124:127]
  v_fma_f32 v230, v232, v228, v230
  s_waitcnt lgkmcnt(4)
  MF v[96:99], v[168:171], a[240:243], v[96:99]
  TR v[164:165], v3 offset:55296
  v_fma_f32 v231, v232, v229, v231
  MF v[100:103], v[168:171], a[244:247], v[100:103]
  TR v[166:167], v3 offset:55552
  v_fma_f32 v230, -v233, v229, v230
  MF v[104:107], v[168:171], a[248:251], v[104:107]
  s_add_u32 m0, s37, 53248
  s_add_u32 s89, s53, 128
  BL4 v8, s[8:11], s89 offen lds
  MF v[108:111], v[168:171], a[252:255], v[108:111]
  v_fma_f32 v231, v233, v228, v231
  s_waitcnt lgkmcnt(4)
  MF v[112:115], v[172:175], a[240:243], v[112:115]
  TR v[168:169], v3 offset:57344
  MF v[116:119], v[172:175], a[244:247], v[116:119]
  TR v[170:171], v3 offset:57600
  MF v[120:123], v[172:175], a[248:251], v[120:123]
  buffer_store_dwordx2 v[230:231], v22, s[16:19], 0 offen sc1
  MF v[124:127], v[172:175], a[252:255], v[124:127]
  v_mul_f32 v234, s76, v224
  s_waitcnt lgkmcnt(4)
  MF v[96:99], v[160:163], v[176:179], v[96:99]
  TR v[172:173], v3 offset:59392
  v_mul_f32 v235, s76, v225
  MF v[100:103], v[160:163], v[180:183], v[100:103]
  TR v[174:175], v3 offset:59648
  v_fma_f32 v234, s77, v226, v234
  MF v[104:107], v[160:163], v[184:187], v[104:107]
  s_add_u32 m0, s37, 57344
  s_add_u32 s89, s54, 128
  BL4 v8, s[8:11], s89 offen lds
  MF v[108:111], v[160:163], v[188:191], v[108:111]
  v_fma_f32 v235, s77, v227, v235
  s_waitcnt lgkmcnt(4)
  MF v[112:115], v[164:167], v[176:179], v[112:115]
  TR v[160:161], v5 offset:36864
  v_fma_f32 v234, s78, v228, v234
  MF v[116:119], v[164:167], v[180:183], v[116:119]
  TR v[162:163], v5 offset:37120
  v_fma_f32 v235, s78, v229, v235
  MF v[120:123], v[164:167], v[184:187], v[120:123]
  v_mul_f32 v236, v20, v208
  v_mul_f32 v237, v20, v209
  MF v[124:127], v[164:167], v[188:191], v[124:127]
  v_exp_f32 v232, v236
  s_waitcnt lgkmcnt(4)
  MF v[96:99], v[168:171], v[192:195], v[96:99]
  TR v[164:165], v5 offset:38912
  v_fract_f32 v237, v237
  MF v[100:103], v[168:171], v[196:199], v[100:103]
  TR v[166:167], v5 offset:39168
  v_cos_f32 v236, v237
  MF v[104:107], v[168:171], v[200:203], v[104:107]
  s_add_u32 m0, s37, 61440
  s_add_u32 s89, s55, 128
  BL4 v8, s[8:11], s89 offen lds
  MF v[108:111], v[168:171], v[204:207], v[108:111]
  v_sin_f32 v237, v237
  s_waitcnt lgkmcnt(4)
  MF v[112:115], v[172:175], v[192:195], v[112:115]
  TR v[168:169], v5 offset:40960
  v_mul_f32 v233, v232, v237
  MF v[116:119], v[172:175], v[196:199], v[116:119]
  TR v[170:171], v5 offset:41216
  v_mul_f32 v232, v232, v236
  MF v[120:123], v[172:175], v[200:203], v[120:123]
  v_fma_f32 v212, v232, v234, v212
  v_fma_f32 v213, v232, v235, v213
  MF v[124:127], v[172:175], v[204:207], v[124:127]
  v_fma_f32 v212, -v233, v235, v212
  s_waitcnt lgkmcnt(4)
  MF v[128:131], v[160:163], a[192:195], v[128:131]
  TR v[172:173], v5 offset:43008
  v_fma_f32 v213, v233, v234, v213
  MF v[132:135], v[160:163], a[196:199], v[132:135]
  TR v[174:175], v5 offset:43264
  ds_read_b64 v[224:225], v12 offset:512
  MF v[136:139], v[160:163], a[200:203], v[136:139]
  ds_read_b64 v[226:227], v12 offset:640
  ds_read_b64 v[228:229], v12 offset:768
  MF v[140:143], v[160:163], a[204:207], v[140:143]
  ds_read_b64 v[230:231], v12 offset:896
  s_waitcnt lgkmcnt(8)
  MF v[144:147], v[164:167], a[192:195], v[144:147]
  TR v[160:161], v5 offset:45056
  v_mul_f32 v234, 0x42800000, v216
  MF v[148:151], v[164:167], a[196:199], v[148:151]
  TR v[162:163], v5 offset:45312
  v_mul_f32 v235, 0x42800000, v217
  MF v[152:155], v[164:167], a[200:203], v[152:155]
  v_exp_f32 v232, v234
  v_fract_f32 v235, v235
  MF v[156:159], v[164:167], a[204:207], v[156:159]
  v_cos_f32 v234, v235
  s_waitcnt lgkmcnt(8)
  MF v[128:131], v[168:171], a[208:211], v[128:131]
  TR v[164:165], v5 offset:47104
  v_sin_f32 v235, v235
  MF v[132:135], v[168:171], a[212:215], v[132:135]
  TR v[166:167], v5 offset:47360
  v_mul_f32 v233, v232, v235
  MF v[136:139], v[168:171], a[216:219], v[136:139]
  v_mul_f32 v232, v232, v234
  s_waitcnt lgkmcnt(6)
  v_fma_f32 v226, v232, v224, v226
  MF v[140:143], v[168:171], a[220:223], v[140:143]
  v_fma_f32 v227, v232, v225, v227
  MF v[144:147], v[172:175], a[208:211], v[144:147]
  TR v[168:169], v5 offset:49152
  v_fma_f32 v226, -v233, v225, v226
  MF v[148:151], v[172:175], a[212:215], v[148:151]
  TR v[170:171], v5 offset:49408
  v_fma_f32 v227, v233, v224, v227
  MF v[152:155], v[172:175], a[216:219], v[152:155]
  s_waitcnt lgkmcnt(7)
  v_fma_f32 v228, v232, v226, v228
  v_fma_f32 v229, v232, v227, v229
  MF v[156:159], v[172:175], a[220:223], v[156:159]
  v_fma_f32 v228, -v233, v227, v228
  s_waitcnt lgkmcnt(4)
  MF v[128:131], v[160:163], a[224:227], v[128:131]
  TR v[172:173], v5 offset:51200
  v_fma_f32 v229, v233, v226, v229
  MF v[132:135], v[160:163], a[228:231], v[132:135]
  TR v[174:175], v5 offset:51456
  v_fma_f32 v230, v232, v228, v230
  MF v[136:139], v[160:163], a[232:235], v[136:139]
  v_fma_f32 v231, v232, v229, v231
  v_fma_f32 v230, -v233, v229, v230
  MF v[140:143], v[160:163], a[236:239], v[140:143]
  v_fma_f32 v231, v233, v228, v231
  s_waitcnt lgkmcnt(4)
  MF v[144:147], v[164:167], a[224:227], v[144:147]
  TR v[160:161], v5 offset:53248
  MF v[148:151], v[164:167], a[228:231], v[148:151]
  TR v[162:163], v5 offset:53504
  MF v[152:155], v[164:167], a[232:235], v[152:155]
  buffer_store_dwordx2 v[230:231], v22, s[16:19], 0 offen offset:1024 sc1
  MF v[156:159], v[164:167], a[236:239], v[156:159]
  v_mul_f32 v234, s76, v224
  s_waitcnt lgkmcnt(4)
  MF v[128:131], v[168:171], a[240:243], v[128:131]
  TR v[164:165], v5 offset:55296
  v_mul_f32 v235, s76, v225
  MF v[132:135], v[168:171], a[244:247], v[132:135]
  TR v[166:167], v5 offset:55552
  v_fma_f32 v234, s77, v226, v234
  MF v[136:139], v[168:171], a[248:251], v[136:139]
  v_fma_f32 v235, s77, v227, v235
  v_fma_f32 v234, s78, v228, v234
  MF v[140:143], v[168:171], a[252:255], v[140:143]
  v_fma_f32 v235, s78, v229, v235
  s_waitcnt lgkmcnt(4)
  MF v[144:147], v[172:175], a[240:243], v[144:147]
  TR v[168:169], v5 offset:57344
  v_mul_f32 v236, v20, v216
  MF v[148:151], v[172:175], a[244:247], v[148:151]
  TR v[170:171], v5 offset:57600
  v_mul_f32 v237, v20, v217
  MF v[152:155], v[172:175], a[248:251], v[152:155]
  v_exp_f32 v232, v236
  v_fract_f32 v237, v237
  MF v[156:159], v[172:175], a[252:255], v[156:159]
  v_cos_f32 v236, v237
  s_waitcnt lgkmcnt(4)
  MF v[128:131], v[160:163], v[176:179], v[128:131]
  TR v[172:173], v5 offset:59392
  v_sin_f32 v237, v237
  MF v[132:135], v[160:163], v[180:183], v[132:135]
  TR v[174:175], v5 offset:59648
  v_mul_f32 v233, v232, v237
  MF v[136:139], v[160:163], v[184:187], v[136:139]
  v_mul_f32 v232, v232, v236
  v_fma_f32 v220, v232, v234, v220
  MF v[140:143], v[160:163], v[188:191], v[140:143]
  v_fma_f32 v221, v232, v235, v221
  s_waitcnt lgkmcnt(4)
  MF v[144:147], v[164:167], v[176:179], v[144:147]
  s_waitcnt vmcnt(12)
  s_barrier
  TR v[160:161], v2
  v_fma_f32 v220, -v233, v235, v220
  MF v[148:151], v[164:167], v[180:183], v[148:151]
  TR v[162:163], v2 offset:256
  v_fma_f32 v221, v233, v234, v221
  MF v[152:155], v[164:167], v[184:187], v[152:155]
  v_max_f32 v96, 0, v96
  v_max_f32 v97, 0, v97
  MF v[156:159], v[164:167], v[188:191], v[156:159]
  v_max_f32 v98, 0, v98
  s_waitcnt lgkmcnt(4)
  MF v[128:131], v[168:171], v[192:195], v[128:131]
  TR v[164:165], v2 offset:2048
  v_max_f32 v99, 0, v99
  MF v[132:135], v[168:171], v[196:199], v[132:135]
  TR v[166:167], v2 offset:2304
  v_mul_f32 v96, v96, v112
  MF v[136:139], v[168:171], v[200:203], v[136:139]
  v_mul_f32 v97, v97, v113
  v_mul_f32 v98, v98, v114
  MF v[140:143], v[168:171], v[204:207], v[140:143]
  v_mul_f32 v99, v99, v115
  s_waitcnt lgkmcnt(4)
  MF v[144:147], v[172:175], v[192:195], v[144:147]
  TR v[168:169], v2 offset:4096
  v_cvt_pk_bf16_f32 v248, v96, v97
  MF v[148:151], v[172:175], v[196:199], v[148:151]
  TR v[170:171], v2 offset:4352
  v_cvt_pk_bf16_f32 v249, v98, v99
  MF v[152:155], v[172:175], v[200:203], v[152:155]
  v_max_f32 v100, 0, v100
  v_max_f32 v101, 0, v101
  MF v[156:159], v[172:175], v[204:207], v[156:159]
  v_max_f32 v102, 0, v102
  v_max_f32 v103, 0, v103
  v_mul_f32 v100, v100, v116
  v_mul_f32 v101, v101, v117
  v_mul_f32 v102, v102, v118
  v_mul_f32 v103, v103, v119
  v_cvt_pk_bf16_f32 v250, v100, v101
  v_cvt_pk_bf16_f32 v251, v102, v103
  v_max_f32 v104, 0, v104
  v_max_f32 v105, 0, v105
  v_max_f32 v106, 0, v106
  v_max_f32 v107, 0, v107
  v_mul_f32 v104, v104, v120
  v_mul_f32 v105, v105, v121
  v_mul_f32 v106, v106, v122
  v_mul_f32 v107, v107, v123
  v_cvt_pk_bf16_f32 v252, v104, v105
  v_cvt_pk_bf16_f32 v253, v106, v107
  v_max_f32 v108, 0, v108
  v_max_f32 v109, 0, v109
  v_max_f32 v110, 0, v110
  v_max_f32 v111, 0, v111
  v_mul_f32 v108, v108, v124
  v_mul_f32 v109, v109, v125
  v_mul_f32 v110, v110, v126
  v_mul_f32 v111, v111, v127
  v_cvt_pk_bf16_f32 v254, v108, v109
  v_cvt_pk_bf16_f32 v255, v110, v111
K1_TB_G2:
  s_waitcnt lgkmcnt(4)
  MF v[96:99], v[160:163], a[0:3], 0
  TR v[172:173], v2 offset:6144
  MF v[100:103], v[160:163], a[4:7], 0
  TR v[174:175], v2 offset:6400
  MF v[104:107], v[160:163], a[8:11], 0
  s_add_u32 m0, s37, 65536
  s_add_u32 s89, s56, 128
  BL4 v8, s[8:11], s89 offen lds
  MF v[108:111], v[160:163], a[12:15], 0
  s_add_u32 m0, s37, 69632
  s_add_u32 s89, s57, 128
  BL4 v8, s[8:11], s89 offen lds
  s_waitcnt lgkmcnt(4)
  MF v[112:115], v[164:167], a[0:3], 0
  TR v[160:161], v2 offset:8192
  MF v[116:119], v[164:167], a[4:7], 0
  TR v[162:163], v2 offset:8448
  MF v[120:123], v[164:167], a[8:11], 0
  MF v[124:127], v[164:167], a[12:15], 0
  s_waitcnt lgkmcnt(4)
  MF v[96:99], v[168:171], a[16:19], v[96:99]
  TR v[164:165], v2 offset:10240
  MF v[100:103], v[168:171], a[20:23], v[100:103]
  TR v[166:167], v2 offset:10496
  s_add_u32 s88, s36, 1
  s_lshl_b32 s88, s88, 10
  MF v[104:107], v[168:171], a[24:27], v[104:107]
  s_add_u32 m0, s37, 73728
  s_add_u32 s89, s40, 192
  BL4 v8, s[8:11], s89 offen lds
  MF v[108:111], v[168:171], a[28:31], v[108:111]
  v_max_f32 v128, 0, v128
  s_waitcnt lgkmcnt(4)
  MF v[112:115], v[172:175], a[16:19], v[112:115]
  TR v[168:169], v2 offset:12288
  v_max_f32 v129, 0, v129
  MF v[116:119], v[172:175], a[20:23], v[116:119]
  TR v[170:171], v2 offset:12544
  v_max_f32 v130, 0, v130
  MF v[120:123], v[172:175], a[24:27], v[120:123]
  v_max_f32 v131, 0, v131
  v_mul_f32 v128, v128, v144
  MF v[124:127], v[172:175], a[28:31], v[124:127]
  v_mul_f32 v129, v129, v145
  s_waitcnt lgkmcnt(4)
  MF v[96:99], v[160:163], a[32:35], v[96:99]
  TR v[172:173], v2 offset:14336
  v_mul_f32 v130, v130, v146
  MF v[100:103], v[160:163], a[36:39], v[100:103]
  TR v[174:175], v2 offset:14592
  v_mul_f32 v131, v131, v147
  MF v[104:107], v[160:163], a[40:43], v[104:107]
  s_add_u32 m0, s37, 77824
  s_add_u32 s89, s41, 192
  BL4 v8, s[8:11], s89 offen lds
  MF v[108:111], v[160:163], a[44:47], v[108:111]
  v_mov_b32 v240, v248
  s_waitcnt lgkmcnt(4)
  MF v[112:115], v[164:167], a[32:35], v[112:115]
  TR v[160:161], v2 offset:16384
  v_mov_b32 v241, v249
  MF v[116:119], v[164:167], a[36:39], v[116:119]
  TR v[162:163], v2 offset:16640
  v_cvt_pk_bf16_f32 v242, v128, v129
  MF v[120:123], v[164:167], a[40:43], v[120:123]
  v_cvt_pk_bf16_f32 v243, v130, v131
  s_add_u32 s80, s88, 0
  MF v[124:127], v[164:167], a[44:47], v[124:127]
  s_waitcnt lgkmcnt(4)
  MF v[96:99], v[168:171], a[48:51], v[96:99]
  TR v[164:165], v2 offset:18432
  MF v[100:103], v[168:171], a[52:55], v[100:103]
  TR v[166:167], v2 offset:18688
  MF v[104:107], v[168:171], a[56:59], v[104:107]
  s_add_u32 m0, s37, 81920
  s_add_u32 s89, s42, 192
  BL4 v8, s[8:11], s89 offen lds
  MF v[108:111], v[168:171], a[60:63], v[108:111]
  s_waitcnt lgkmcnt(4)
  MF v[112:115], v[172:175], a[48:51], v[112:115]
  TR v[168:169], v2 offset:20480
  MF v[116:119], v[172:175], a[52:55], v[116:119]
  TR v[170:171], v2 offset:20736
  MF v[120:123], v[172:175], a[56:59], v[120:123]
  buffer_store_dwordx4 v[240:243], v10, s[16:19], s80 offen sc1
  MF v[124:127], v[172:175], a[60:63], v[124:127]
  v_max_f32 v132, 0, v132
  s_waitcnt lgkmcnt(4)
  MF v[96:99], v[160:163], a[64:67], v[96:99]
  TR v[172:173], v2 offset:22528
  v_max_f32 v133, 0, v133
  MF v[100:103], v[160:163], a[68:71], v[100:103]
  TR v[174:175], v2 offset:22784
  v_max_f32 v134, 0, v134
  MF v[104:107], v[160:163], a[72:75], v[104:107]
  s_add_u32 m0, s37, 86016
  s_add_u32 s89, s43, 192
  BL4 v8, s[8:11], s89 offen lds
  MF v[108:111], v[160:163], a[76:79], v[108:111]
  v_max_f32 v135, 0, v135
  s_waitcnt lgkmcnt(4)
  MF v[112:115], v[164:167], a[64:67], v[112:115]
  TR v[160:161], v4
  v_mul_f32 v132, v132, v148
  MF v[116:119], v[164:167], a[68:71], v[116:119]
  TR v[162:163], v4 offset:256
  v_mul_f32 v133, v133, v149
  MF v[120:123], v[164:167], a[72:75], v[120:123]
  v_mul_f32 v134, v134, v150
  v_mul_f32 v135, v135, v151
  MF v[124:127], v[164:167], a[76:79], v[124:127]
  v_mov_b32 v244, v250
  s_waitcnt lgkmcnt(4)
  MF v[96:99], v[168:171], a[80:83], v[96:99]
  TR v[164:165], v4 offset:2048
  v_mov_b32 v245, v251
  MF v[100:103], v[168:171], a[84:87], v[100:103]
  TR v[166:167], v4 offset:2304
  v_cvt_pk_bf16_f32 v246, v132, v133
  MF v[104:107], v[168:171], a[88:91], v[104:107]
  s_add_u32 m0, s37, 90112
  s_add_u32 s89, s44, 192
  BL4 v8, s[8:11], s89 offen lds
  MF v[108:111], v[168:171], a[92:95], v[108:111]
  v_cvt_pk_bf16_f32 v247, v134, v135
  s_waitcnt lgkmcnt(4)
  MF v[112:115], v[172:175], a[80:83], v[112:115]
  TR v[168:169], v4 offset:4096
  s_add_u32 s80, s88, 185344
  MF v[116:119], v[172:175], a[84:87], v[116:119]
  TR v[170:171], v4 offset:4352
  MF v[120:123], v[172:175], a[88:91], v[120:123]
  buffer_store_dwordx4 v[244:247], v10, s[16:19], s80 offen sc1
  MF v[124:127], v[172:175], a[92:95], v[124:127]
  v_max_f32 v136, 0, v136
  v_max_f32 v137, 0, v137
  v_max_f32 v138, 0, v138
  v_max_f32 v139, 0, v139
  v_mul_f32 v136, v136, v152
  v_mul_f32 v137, v137, v153
  v_mul_f32 v138, v138, v154
  v_mul_f32 v139, v139, v155
  v_mov_b32 v240, v252
  v_mov_b32 v241, v253
  v_cvt_pk_bf16_f32 v242, v136, v137
  v_cvt_pk_bf16_f32 v243, v138, v139
  s_add_u32 s80, s88, 370688
  buffer_store_dwordx4 v[240:243], v10, s[16:19], s80 offen sc1
  v_max_f32 v140, 0, v140
  v_max_f32 v141, 0, v141
  v_max_f32 v142, 0, v142
  v_max_f32 v143, 0, v143
  v_mul_f32 v140, v140, v156
  v_mul_f32 v141, v141, v157
  v_mul_f32 v142, v142, v158
  v_mul_f32 v143, v143, v159
  v_mov_b32 v244, v254
  v_mov_b32 v245, v255
  v_cvt_pk_bf16_f32 v246, v140, v141
  v_cvt_pk_bf16_f32 v247, v142, v143
  s_add_u32 s80, s88, 556032
  buffer_store_dwordx4 v[244:247], v10, s[16:19], s80 offen sc1
  s_waitcnt lgkmcnt(4)
  MF v[128:131], v[160:163], a[0:3], 0
  TR v[172:173], v4 offset:6144
  MF v[132:135], v[160:163], a[4:7], 0
  TR v[174:175], v4 offset:6400
  MF v[136:139], v[160:163], a[8:11], 0
  s_mov_b32 s24, s98
  s_and_b32 s25, s99, 65535
  s_mov_b32 s26, 5308416
  s_mov_b32 s27, 131072
  MF v[140:143], v[160:163], a[12:15], 0
  v_lshrrev_b32 v240, 3, v1
  s_waitcnt lgkmcnt(4)
  MF v[144:147], v[164:167], a[0:3], 0
  TR v[160:161], v4 offset:8192
  v_mul_u32_u24 v240, 1152, v240
  MF v[148:151], v[164:167], a[4:7], 0
  TR v[162:163], v4 offset:8448
  v_and_b32 v241, 7, v1
  MF v[152:155], v[164:167], a[8:11], 0
  v_lshlrev_b32 v241, 4, v241
  v_add_u32 v240, v240, v241
  MF v[156:159], v[164:167], a[12:15], 0
  s_lshl_b32 s62, s32, 13
  s_add_u32 s62, s62, 122880
  s_waitcnt lgkmcnt(4)
  MF v[128:131], v[168:171], a[16:19], v[128:131]
  TR v[164:165], v4 offset:10240
  s_lshl_b32 s63, s34, 3
  s_add_u32 s63, s63, s33
  MF v[132:135], v[168:171], a[20:23], v[132:135]
  TR v[166:167], v4 offset:10496
  s_mul_i32 s63, s63, 7
  s_sub_u32 s68, s35, 1
  MF v[136:139], v[168:171], a[24:27], v[136:139]
  s_cmp_lt_u32 s35, 4
  s_cselect_b32 s68, s35, s68
  s_add_u32 s63, s63, s68
  s_lshl_b32 s63, s63, 2
  MF v[140:143], v[168:171], a[28:31], v[140:143]
  s_add_u32 s63, s63, s32
  s_add_u32 s63, s63, 0
  s_waitcnt lgkmcnt(4)
  MF v[144:147], v[172:175], a[16:19], v[144:147]
  TR v[168:169], v4 offset:12288
  s_mul_i32 s64, s63, 7282
  s_lshr_b32 s64, s64, 16
  MF v[148:151], v[172:175], a[20:23], v[148:151]
  TR v[170:171], v4 offset:12544
  s_mul_i32 s68, s64, 9
  s_sub_u32 s60, s63, s68
  MF v[152:155], v[172:175], a[24:27], v[152:155]
  s_mul_i32 s65, s64, 1821
  s_lshr_b32 s65, s65, 16
  s_mul_i32 s68, s65, 36
  s_sub_u32 s66, s64, s68
  MF v[156:159], v[172:175], a[28:31], v[156:159]
  s_lshr_b32 s68, s66, 2
  s_sub_u32 s69, s66, 16
  s_waitcnt lgkmcnt(4)
  MF v[128:131], v[160:163], a[32:35], v[128:131]
  TR v[172:173], v4 offset:14336
  s_mul_i32 s70, s69, 52
  s_lshr_b32 s70, s70, 8
  MF v[132:135], v[160:163], a[36:39], v[132:135]
  TR v[174:175], v4 offset:14592
  s_mul_i32 s67, s70, 5
  s_sub_u32 s69, s69, s67
  MF v[136:139], v[160:163], a[40:43], v[136:139]
  s_add_u32 s70, s70, 4
  s_cmp_lt_u32 s66, 16
  s_cselect_b32 s68, s68, s70
  s_and_b32 s70, s66, 3
  MF v[140:143], v[160:163], a[44:47], v[140:143]
  s_add_u32 s70, s70, 1
  s_waitcnt lgkmcnt(4)
  MF v[144:147], v[164:167], a[32:35], v[144:147]
  TR v[160:161], v4 offset:16384
  s_cmp_lt_u32 s66, 16
  s_cselect_b32 s69, s70, s69
  MF v[148:151], v[164:167], a[36:39], v[148:151]
  TR v[162:163], v4 offset:16640
  s_sub_u32 s67, s66, s68
  s_add_u32 s70, s68, 37
  MF v[152:155], v[164:167], a[40:43], v[152:155]
  s_cmp_eq_u32 s69, 4
  s_cselect_b32 s67, s70, s67
  s_mul_i32 s68, s65, 180
  s_add_u32 s68, s68, s67
  MF v[156:159], v[164:167], a[44:47], v[156:159]
  s_mul_i32 s68, s68, 9216
  s_add_u32 s68, s68, 25165824
  s_waitcnt lgkmcnt(4)
  MF v[128:131], v[168:171], a[48:51], v[128:131]
  TR v[164:165], v4 offset:18432
  s_cmp_lt_u32 s63, 1296
  s_cselect_b32 s58, s68, 1073741824
  MF v[132:135], v[168:171], a[52:55], v[132:135]
  TR v[166:167], v4 offset:18688
  s_mul_i32 s68, s64, 36864
  s_lshl_b32 s69, s60, 7
  MF v[136:139], v[168:171], a[56:59], v[136:139]
  s_add_u32 s68, s68, s69
  s_cmp_lt_u32 s63, 1296
  s_cselect_b32 s71, s68, 1073741824
  s_add_u32 s73, s71, 0
  MF v[140:143], v[168:171], a[60:63], v[140:143]
  s_waitcnt lgkmcnt(4)
  MF v[144:147], v[172:175], a[48:51], v[144:147]
  TR v[168:169], v4 offset:20480
  MF v[148:151], v[172:175], a[52:55], v[148:151]
  TR v[170:171], v4 offset:20736
  MF v[152:155], v[172:175], a[56:59], v[152:155]
  s_add_u32 m0, s62, 0
  s_nop 0
  BL4 v240, s[24:27], s73 offen lds
  MF v[156:159], v[172:175], a[60:63], v[156:159]
  s_add_u32 s73, s71, 9216
  s_waitcnt lgkmcnt(4)
  MF v[128:131], v[160:163], a[64:67], v[128:131]
  TR v[172:173], v4 offset:22528
  MF v[132:135], v[160:163], a[68:71], v[132:135]
  TR v[174:175], v4 offset:22784
  MF v[136:139], v[160:163], a[72:75], v[136:139]
  s_add_u32 m0, s62, 1024
  s_nop 0
  BL4 v240, s[24:27], s73 offen lds
  MF v[140:143], v[160:163], a[76:79], v[140:143]
  s_add_u32 s73, s71, 18432
  s_waitcnt lgkmcnt(4)
  MF v[144:147], v[164:167], a[64:67], v[144:147]
  s_waitcnt vmcnt(19)
  s_barrier
  TR v[160:161], v2 offset:24576
  MF v[148:151], v[164:167], a[68:71], v[148:151]
  TR v[162:163], v2 offset:24832
  MF v[152:155], v[164:167], a[72:75], v[152:155]
  s_add_u32 m0, s62, 2048
  s_nop 0
  BL4 v240, s[24:27], s73 offen lds
  MF v[156:159], v[164:167], a[76:79], v[156:159]
  s_add_u32 s73, s71, 27648
  s_waitcnt lgkmcnt(4)
  MF v[128:131], v[168:171], a[80:83], v[128:131]
  TR v[164:165], v2 offset:26624
  MF v[132:135], v[168:171], a[84:87], v[132:135]
  TR v[166:167], v2 offset:26880
  MF v[136:139], v[168:171], a[88:91], v[136:139]
  s_add_u32 m0, s62, 3072
  s_nop 0
  BL4 v240, s[24:27], s73 offen lds
  MF v[140:143], v[168:171], a[92:95], v[140:143]
  s_lshl_b32 s63, s34, 3
  s_add_u32 s63, s63, s33
  s_waitcnt lgkmcnt(4)
  MF v[144:147], v[172:175], a[80:83], v[144:147]
  TR v[168:169], v4 offset:24576
  s_mul_i32 s63, s63, 7
  s_sub_u32 s68, s35, 1
  MF v[148:151], v[172:175], a[84:87], v[148:151]
  TR v[170:171], v4 offset:24832
  s_cmp_lt_u32 s35, 4
  s_cselect_b32 s68, s35, s68
  MF v[152:155], v[172:175], a[88:91], v[152:155]
  s_add_u32 s63, s63, s68
  s_lshl_b32 s63, s63, 2
  s_add_u32 s63, s63, s32
  s_add_u32 s63, s63, 896
  MF v[156:159], v[172:175], a[92:95], v[156:159]
  s_mul_i32 s64, s63, 7282
  s_lshr_b32 s64, s64, 16
  s_waitcnt lgkmcnt(4)
  MF v[96:99], v[160:163], a[96:99], v[96:99]
  TR v[172:173], v4 offset:26624
  s_mul_i32 s68, s64, 9
  s_sub_u32 s61, s63, s68
  MF v[100:103], v[160:163], a[100:103], v[100:103]
  TR v[174:175], v4 offset:26880
  s_mul_i32 s65, s64, 1821
  s_lshr_b32 s65, s65, 16
  MF v[104:107], v[160:163], a[104:107], v[104:107]
  s_add_u32 m0, s37, 94208
  s_add_u32 s89, s45, 192
  BL4 v8, s[8:11], s89 offen lds
  MF v[108:111], v[160:163], a[108:111], v[108:111]
  s_mul_i32 s68, s65, 36
  s_sub_u32 s66, s64, s68
  s_waitcnt lgkmcnt(4)
  MF v[112:115], v[164:167], a[96:99], v[112:115]
  TR v[160:161], v2 offset:28672
  s_lshr_b32 s68, s66, 2
  s_sub_u32 s69, s66, 16
  MF v[116:119], v[164:167], a[100:103], v[116:119]
  TR v[162:163], v2 offset:28928
  s_mul_i32 s70, s69, 52
  s_lshr_b32 s70, s70, 8
  MF v[120:123], v[164:167], a[104:107], v[120:123]
  s_mul_i32 s67, s70, 5
  s_sub_u32 s69, s69, s67
  s_add_u32 s70, s70, 4
  MF v[124:127], v[164:167], a[108:111], v[124:127]
  s_cmp_lt_u32 s66, 16
  s_cselect_b32 s68, s68, s70
  s_waitcnt lgkmcnt(4)
  MF v[128:131], v[168:171], a[96:99], v[128:131]
  TR v[164:165], v2 offset:30720
  s_and_b32 s70, s66, 3
  s_add_u32 s70, s70, 1
  MF v[132:135], v[168:171], a[100:103], v[132:135]
  TR v[166:167], v2 offset:30976
  s_cmp_lt_u32 s66, 16
  s_cselect_b32 s69, s70, s69
  MF v[136:139], v[168:171], a[104:107], v[136:139]
  s_sub_u32 s67, s66, s68
  s_add_u32 s70, s68, 37
  s_cmp_eq_u32 s69, 4
  s_cselect_b32 s67, s70, s67
  MF v[140:143], v[168:171], a[108:111], v[140:143]
  s_mul_i32 s68, s65, 180
  s_add_u32 s68, s68, s67
  s_waitcnt lgkmcnt(4)
  MF v[144:147], v[172:175], a[96:99], v[144:147]
  TR v[168:169], v4 offset:28672
  s_mul_i32 s68, s68, 9216
  s_add_u32 s68, s68, 25165824
  MF v[148:151], v[172:175], a[100:103], v[148:151]
  TR v[170:171], v4 offset:28928
  s_cmp_lt_u32 s63, 1296
  s_cselect_b32 s59, s68, 1073741824
  MF v[152:155], v[172:175], a[104:107], v[152:155]
  s_mul_i32 s68, s64, 36864
  s_lshl_b32 s69, s61, 7
  s_add_u32 s68, s68, s69
  MF v[156:159], v[172:175], a[108:111], v[156:159]
  s_cmp_lt_u32 s63, 1296
  s_cselect_b32 s72, s68, 1073741824
  s_waitcnt lgkmcnt(4)
  MF v[96:99], v[160:163], a[112:115], v[96:99]
  TR v[172:173], v4 offset:30720
  s_add_u32 s73, s72, 0
  MF v[100:103], v[160:163], a[116:119], v[100:103]
  TR v[174:175], v4 offset:30976
  MF v[104:107], v[160:163], a[120:123], v[104:107]
  s_add_u32 m0, s37, 98304
  s_add_u32 s89, s46, 192
  BL4 v8, s[8:11], s89 offen lds
  MF v[108:111], v[160:163], a[124:127], v[108:111]
  s_waitcnt lgkmcnt(4)
  MF v[112:115], v[164:167], a[112:115], v[112:115]
  TR v[160:161], v2 offset:32768
  MF v[116:119], v[164:167], a[116:119], v[116:119]
  TR v[162:163], v2 offset:33024
  MF v[120:123], v[164:167], a[120:123], v[120:123]
  s_add_u32 m0, s62, 4096
  s_nop 0
  BL4 v240, s[24:27], s73 offen lds
  MF v[124:127], v[164:167], a[124:127], v[124:127]
  s_add_u32 s73, s72, 9216
  s_waitcnt lgkmcnt(4)
  MF v[128:131], v[168:171], a[112:115], v[128:131]
  TR v[164:165], v2 offset:34816
  MF v[132:135], v[168:171], a[116:119], v[132:135]
  TR v[166:167], v2 offset:35072
  MF v[136:139], v[168:171], a[120:123], v[136:139]
  s_add_u32 m0, s62, 5120
  s_nop 0
  BL4 v240, s[24:27], s73 offen lds
  MF v[140:143], v[168:171], a[124:127], v[140:143]
  s_add_u32 s73, s72, 18432
  s_waitcnt lgkmcnt(4)
  MF v[144:147], v[172:175], a[112:115], v[144:147]
  TR v[168:169], v4 offset:32768
  MF v[148:151], v[172:175], a[116:119], v[148:151]
  TR v[170:171], v4 offset:33024
  MF v[152:155], v[172:175], a[120:123], v[152:155]
  s_add_u32 m0, s62, 6144
  s_nop 0
  BL4 v240, s[24:27], s73 offen lds
  MF v[156:159], v[172:175], a[124:127], v[156:159]
  s_add_u32 s73, s72, 27648
  s_waitcnt lgkmcnt(4)
  MF v[96:99], v[160:163], a[128:131], v[96:99]
  TR v[172:173], v4 offset:34816
  MF v[100:103], v[160:163], a[132:135], v[100:103]
  TR v[174:175], v4 offset:35072
  MF v[104:107], v[160:163], a[136:139], v[104:107]
  s_add_u32 m0, s37, 102400
  s_add_u32 s89, s47, 192
  BL4 v8, s[8:11], s89 offen lds
  MF v[108:111], v[160:163], a[140:143], v[108:111]
  s_waitcnt lgkmcnt(4)
  MF v[112:115], v[164:167], a[128:131], v[112:115]
  TR v[160:161], v2 offset:36864
  MF v[116:119], v[164:167], a[132:135], v[116:119]
  TR v[162:163], v2 offset:37120
  MF v[120:123], v[164:167], a[136:139], v[120:123]
  s_add_u32 m0, s62, 7168
  s_nop 0
  BL4 v240, s[24:27], s73 offen lds
  MF v[124:127], v[164:167], a[140:143], v[124:127]
  v_mov_b32 v244, 1
  s_waitcnt lgkmcnt(4)
  MF v[128:131], v[168:171], a[128:131], v[128:131]
  TR v[164:165], v2 offset:38912
  MF v[132:135], v[168:171], a[132:135], v[132:135]
  TR v[166:167], v2 offset:39168
  MF v[136:139], v[168:171], a[136:139], v[136:139]
  s_waitcnt vmcnt(22)
  buffer_store_dword v244, v23, s[16:19], 0 offen sc1
  MF v[140:143], v[168:171], a[140:143], v[140:143]
  s_waitcnt lgkmcnt(4)
  MF v[144:147], v[172:175], a[128:131], v[144:147]
  TR v[168:169], v4 offset:36864
  MF v[148:151], v[172:175], a[132:135], v[148:151]
  TR v[170:171], v4 offset:37120
  MF v[152:155], v[172:175], a[136:139], v[152:155]
  buffer_load_dword v246, v24, s[16:19], 0 offen sc1
  MF v[156:159], v[172:175], a[140:143], v[156:159]
  s_waitcnt lgkmcnt(4)
  MF v[96:99], v[160:163], a[144:147], v[96:99]
  TR v[172:173], v4 offset:38912
  MF v[100:103], v[160:163], a[148:151], v[100:103]
  TR v[174:175], v4 offset:39168
  MF v[104:107], v[160:163], a[152:155], v[104:107]
  s_add_u32 m0, s37, 106496
  s_add_u32 s89, s48, 192
  BL4 v8, s[8:11], s89 offen lds
  MF v[108:111], v[160:163], a[156:159], v[108:111]
  s_waitcnt lgkmcnt(4)
  MF v[112:115], v[164:167], a[144:147], v[112:115]
  TR v[160:161], v2 offset:40960
  MF v[116:119], v[164:167], a[148:151], v[116:119]
  TR v[162:163], v2 offset:41216
  MF v[120:123], v[164:167], a[152:155], v[120:123]
  v_lshrrev_b32 v241, 4, v1
  v_lshlrev_b32 v241, 2, v241
  MF v[124:127], v[164:167], a[156:159], v[124:127]
  v_and_b32 v242, 15, v1
  s_waitcnt lgkmcnt(4)
  MF v[128:131], v[168:171], a[144:147], v[128:131]
  TR v[164:165], v2 offset:43008
  v_lshrrev_b32 v242, 2, v242
  MF v[132:135], v[168:171], a[148:151], v[132:135]
  TR v[166:167], v2 offset:43264
  v_add_u32 v241, v241, v242
  MF v[136:139], v[168:171], a[152:155], v[136:139]
  v_lshlrev_b32 v241, 7, v241
  v_and_b32 v242, 3, v1
  MF v[140:143], v[168:171], a[156:159], v[140:143]
  v_lshlrev_b32 v242, 3, v242
  s_waitcnt lgkmcnt(4)
  MF v[144:147], v[172:175], a[144:147], v[144:147]
  TR v[168:169], v4 offset:40960
  v_add_u32 v241, v241, v242
  MF v[148:151], v[172:175], a[148:151], v[148:151]
  TR v[170:171], v4 offset:41216
  v_add_u32 v241, s62, v241
  MF v[152:155], v[172:175], a[152:155], v[152:155]
  v_lshlrev_b32 v242, 4, v1
  MF v[156:159], v[172:175], a[156:159], v[156:159]
  s_waitcnt lgkmcnt(4)
  MF v[96:99], v[160:163], a[160:163], v[96:99]
  TR v[172:173], v4 offset:43008
  s_waitcnt vmcnt(10)
  TR v[224:225], v241
  MF v[100:103], v[160:163], a[164:167], v[100:103]
  TR v[174:175], v4 offset:43264
  TR v[226:227], v241 offset:2048
  MF v[104:107], v[160:163], a[168:171], v[104:107]
  s_add_u32 m0, s37, 110592
  s_add_u32 s89, s49, 192
  BL4 v8, s[8:11], s89 offen lds
  MF v[108:111], v[160:163], a[172:175], v[108:111]
  TR v[228:229], v241 offset:32
  s_waitcnt lgkmcnt(7)
  MF v[112:115], v[164:167], a[160:163], v[112:115]
  TR v[160:161], v2 offset:45056
  TR v[230:231], v241 offset:2080
  MF v[116:119], v[164:167], a[164:167], v[116:119]
  TR v[162:163], v2 offset:45312
  TR v[232:233], v241 offset:64
  MF v[120:123], v[164:167], a[168:171], v[120:123]
  TR v[234:235], v241 offset:2112
  TR v[236:237], v241 offset:96
  MF v[124:127], v[164:167], a[172:175], v[124:127]
  TR v[238:239], v241 offset:2144
  s_waitcnt lgkmcnt(12)
  MF v[128:131], v[168:171], a[160:163], v[128:131]
  TR v[164:165], v2 offset:47104
  s_lshl_b32 s68, s60, 2
  s_add_u32 s68, s68, 0
  MF v[132:135], v[168:171], a[164:167], v[132:135]
  TR v[166:167], v2 offset:47360
  s_mul_i32 s69, s68, 7282
  s_lshr_b32 s69, s69, 16
  MF v[136:139], v[168:171], a[168:171], v[136:139]
  s_mul_i32 s70, s69, 9
  s_sub_u32 s68, s68, s70
  s_mul_i32 s69, s69, 414720
  s_lshl_b32 s68, s68, 10
  MF v[140:143], v[168:171], a[172:175], v[140:143]
  s_add_u32 s68, s68, s69
  s_add_u32 s68, s68, s58
  s_waitcnt lgkmcnt(11)
  MF v[144:147], v[172:175], a[160:163], v[144:147]
  TR v[168:169], v4 offset:45056
  MF v[148:151], v[172:175], a[164:167], v[148:151]
  TR v[170:171], v4 offset:45312
  MF v[152:155], v[172:175], a[168:171], v[152:155]
  s_waitcnt lgkmcnt(12)
  buffer_store_dwordx4 v[224:227], v242, s[16:19], s68 offen sc1
  MF v[156:159], v[172:175], a[172:175], v[156:159]
  s_lshl_b32 s68, s60, 2
  s_add_u32 s68, s68, 1
  s_waitcnt lgkmcnt(8)
  MF v[96:99], v[160:163], a[176:179], v[96:99]
  TR v[172:173], v4 offset:47104
  s_mul_i32 s69, s68, 7282
  s_lshr_b32 s69, s69, 16
  MF v[100:103], v[160:163], a[180:183], v[100:103]
  TR v[174:175], v4 offset:47360
  s_mul_i32 s70, s69, 9
  s_sub_u32 s68, s68, s70
  MF v[104:107], v[160:163], a[184:187], v[104:107]
  s_add_u32 m0, s37, 114688
  s_add_u32 s89, s50, 192
  BL4 v8, s[8:11], s89 offen lds
  MF v[108:111], v[160:163], a[188:191], v[108:111]
  s_mul_i32 s69, s69, 414720
  s_lshl_b32 s68, s68, 10
  s_waitcnt lgkmcnt(4)
  MF v[112:115], v[164:167], a[176:179], v[112:115]
  s_barrier
  TR v[160:161], v2 offset:49152
  s_add_u32 s68, s68, s69
  s_add_u32 s68, s68, s58
  MF v[116:119], v[164:167], a[180:183], v[116:119]
  TR v[162:163], v2 offset:49408
  MF v[120:123], v[164:167], a[184:187], v[120:123]
  buffer_store_dwordx4 v[228:231], v242, s[16:19], s68 offen sc1
  MF v[124:127], v[164:167], a[188:191], v[124:127]
  s_lshl_b32 s68, s60, 2
  s_add_u32 s68, s68, 2
  s_waitcnt lgkmcnt(4)
  MF v[128:131], v[168:171], a[176:179], v[128:131]
  TR v[164:165], v2 offset:51200
  s_mul_i32 s69, s68, 7282
  s_lshr_b32 s69, s69, 16
  MF v[132:135], v[168:171], a[180:183], v[132:135]
  TR v[166:167], v2 offset:51456
  s_mul_i32 s70, s69, 9
  s_sub_u32 s68, s68, s70
  MF v[136:139], v[168:171], a[184:187], v[136:139]
  s_mul_i32 s69, s69, 414720
  s_lshl_b32 s68, s68, 10
  s_add_u32 s68, s68, s69
  s_add_u32 s68, s68, s58
  MF v[140:143], v[168:171], a[188:191], v[140:143]
  s_waitcnt lgkmcnt(4)
  MF v[144:147], v[172:175], a[176:179], v[144:147]
  TR v[168:169], v2 offset:53248
  MF v[148:151], v[172:175], a[180:183], v[148:151]
  TR v[170:171], v2 offset:53504
  MF v[152:155], v[172:175], a[184:187], v[152:155]
  buffer_store_dwordx4 v[232:235], v242, s[16:19], s68 offen sc1
  MF v[156:159], v[172:175], a[188:191], v[156:159]
  s_lshl_b32 s68, s60, 2
  s_add_u32 s68, s68, 3
  s_waitcnt lgkmcnt(4)
  MF v[96:99], v[160:163], a[192:195], v[96:99]
  TR v[172:173], v2 offset:55296
  s_mul_i32 s69, s68, 7282
  s_lshr_b32 s69, s69, 16
  MF v[100:103], v[160:163], a[196:199], v[100:103]
  TR v[174:175], v2 offset:55552
  s_mul_i32 s70, s69, 9
  s_sub_u32 s68, s68, s70
  MF v[104:107], v[160:163], a[200:203], v[104:107]
  s_add_u32 m0, s37, 118784
  s_add_u32 s89, s51, 192
  BL4 v8, s[8:11], s89 offen lds
  MF v[108:111], v[160:163], a[204:207], v[108:111]
  s_mul_i32 s69, s69, 414720
  s_lshl_b32 s68, s68, 10
  s_waitcnt lgkmcnt(4)
  MF v[112:115], v[164:167], a[192:195], v[112:115]
  TR v[160:161], v2 offset:57344
  s_add_u32 s68, s68, s69
  s_add_u32 s68, s68, s58
  MF v[116:119], v[164:167], a[196:199], v[116:119]
  TR v[162:163], v2 offset:57600
  MF v[120:123], v[164:167], a[200:203], v[120:123]
  buffer_store_dwordx4 v[236:239], v242, s[16:19], s68 offen sc1
  MF v[124:127], v[164:167], a[204:207], v[124:127]
  s_waitcnt lgkmcnt(4)
  MF v[96:99], v[168:171], a[208:211], v[96:99]
  TR v[164:165], v2 offset:59392
  MF v[100:103], v[168:171], a[212:215], v[100:103]
  TR v[166:167], v2 offset:59648
  MF v[104:107], v[168:171], a[216:219], v[104:107]
  s_add_u32 m0, s37, 0
  s_add_u32 s89, s52, 192
  BL4 v8, s[8:11], s89 offen lds
  MF v[108:111], v[168:171], a[220:223], v[108:111]
  s_waitcnt lgkmcnt(4)
  MF v[112:115], v[172:175], a[208:211], v[112:115]
  TR v[168:169], v3
  s_waitcnt vmcnt(11)
  TR v[224:225], v241 offset:4096
  MF v[116:119], v[172:175], a[212:215], v[116:119]
  TR v[170:171], v3 offset:256
  TR v[226:227], v241 offset:6144
  MF v[120:123], v[172:175], a[216:219], v[120:123]
  TR v[228:229], v241 offset:4128
  TR v[230:231], v241 offset:6176
  MF v[124:127], v[172:175], a[220:223], v[124:127]
  TR v[232:233], v241 offset:4160
  s_waitcnt lgkmcnt(9)
  MF v[96:99], v[160:163], a[224:227], v[96:99]
  TR v[172:173], v3 offset:2048
  TR v[234:235], v241 offset:6208
  MF v[100:103], v[160:163], a[228:231], v[100:103]
  TR v[174:175], v3 offset:2304
  TR v[236:237], v241 offset:4192
  MF v[104:107], v[160:163], a[232:235], v[104:107]
  s_add_u32 m0, s37, 4096
  s_add_u32 s89, s53, 192
  BL4 v8, s[8:11], s89 offen lds
  MF v[108:111], v[160:163], a[236:239], v[108:111]
  TR v[238:239], v241 offset:6240
  s_waitcnt lgkmcnt(12)
  MF v[112:115], v[164:167], a[224:227], v[112:115]
  TR v[160:161], v3 offset:4096
  s_lshl_b32 s68, s61, 2
  s_add_u32 s68, s68, 0
  MF v[116:119], v[164:167], a[228:231], v[116:119]
  TR v[162:163], v3 offset:4352
  s_mul_i32 s69, s68, 7282
  s_lshr_b32 s69, s69, 16
  MF v[120:123], v[164:167], a[232:235], v[120:123]
  s_mul_i32 s70, s69, 9
  s_sub_u32 s68, s68, s70
  s_mul_i32 s69, s69, 414720
  s_lshl_b32 s68, s68, 10
  MF v[124:127], v[164:167], a[236:239], v[124:127]
  s_add_u32 s68, s68, s69
  s_add_u32 s68, s68, s59
  s_waitcnt lgkmcnt(11)
  MF v[96:99], v[168:171], a[240:243], v[96:99]
  TR v[164:165], v3 offset:6144
  MF v[100:103], v[168:171], a[244:247], v[100:103]
  TR v[166:167], v3 offset:6400
  MF v[104:107], v[168:171], a[248:251], v[104:107]
  s_add_u32 m0, s37, 8192
  s_add_u32 s89, s54, 192
  BL4 v8, s[8:11], s89 offen lds
  MF v[108:111], v[168:171], a[252:255], v[108:111]
  s_waitcnt lgkmcnt(6)
  MF v[112:115], v[172:175], a[240:243], v[112:115]
  TR v[168:169], v3 offset:8192
  MF v[116:119], v[172:175], a[244:247], v[116:119]
  TR v[170:171], v3 offset:8448
  MF v[120:123], v[172:175], a[248:251], v[120:123]
  buffer_store_dwordx4 v[224:227], v242, s[16:19], s68 offen sc1
  MF v[124:127], v[172:175], a[252:255], v[124:127]
  s_lshl_b32 s68, s61, 2
  s_add_u32 s68, s68, 1
  s_waitcnt lgkmcnt(4)
  MF v[96:99], v[160:163], v[176:179], v[96:99]
  TR v[172:173], v3 offset:10240
  s_mul_i32 s69, s68, 7282
  s_lshr_b32 s69, s69, 16
  MF v[100:103], v[160:163], v[180:183], v[100:103]
  TR v[174:175], v3 offset:10496
  s_mul_i32 s70, s69, 9
  s_sub_u32 s68, s68, s70
  MF v[104:107], v[160:163], v[184:187], v[104:107]
  s_add_u32 m0, s37, 12288
  s_add_u32 s89, s55, 192
  BL4 v8, s[8:11], s89 offen lds
  MF v[108:111], v[160:163], v[188:191], v[108:111]
  s_mul_i32 s69, s69, 414720
  s_lshl_b32 s68, s68, 10
  s_waitcnt lgkmcnt(4)
  MF v[112:115], v[164:167], v[176:179], v[112:115]
  TR v[160:161], v4 offset:49152
  s_add_u32 s68, s68, s69
  s_add_u32 s68, s68, s59
  MF v[116:119], v[164:167], v[180:183], v[116:119]
  TR v[162:163], v4 offset:49408
  MF v[120:123], v[164:167], v[184:187], v[120:123]
  buffer_store_dwordx4 v[228:231], v242, s[16:19], s68 offen sc1
  MF v[124:127], v[164:167], v[188:191], v[124:127]
  s_lshl_b32 s68, s61, 2
  s_add_u32 s68, s68, 2
  s_waitcnt lgkmcnt(4)
  MF v[96:99], v[168:171], v[192:195], v[96:99]
  TR v[164:165], v4 offset:51200
  s_mul_i32 s69, s68, 7282
  s_lshr_b32 s69, s69, 16
  MF v[100:103], v[168:171], v[196:199], v[100:103]
  TR v[166:167], v4 offset:51456
  s_mul_i32 s70, s69, 9
  s_sub_u32 s68, s68, s70
  MF v[104:107], v[168:171], v[200:203], v[104:107]
  s_add_u32 m0, s37, 16384
  s_add_u32 s89, s56, 192
  BL4 v8, s[8:11], s89 offen lds
  MF v[108:111], v[168:171], v[204:207], v[108:111]
  s_mul_i32 s69, s69, 414720
  s_lshl_b32 s68, s68, 10
  s_waitcnt lgkmcnt(4)
  MF v[112:115], v[172:175], v[192:195], v[112:115]
  TR v[168:169], v4 offset:53248
  s_add_u32 s68, s68, s69
  s_add_u32 s68, s68, s59
  MF v[116:119], v[172:175], v[196:199], v[116:119]
  TR v[170:171], v4 offset:53504
  MF v[120:123], v[172:175], v[200:203], v[120:123]
  buffer_store_dwordx4 v[232:235], v242, s[16:19], s68 offen sc1
  MF v[124:127], v[172:175], v[204:207], v[124:127]
  s_lshl_b32 s68, s61, 2
  s_add_u32 s68, s68, 3
  s_waitcnt lgkmcnt(4)
  MF v[128:131], v[160:163], a[192:195], v[128:131]
  TR v[172:173], v4 offset:55296
  s_mul_i32 s69, s68, 7282
  s_lshr_b32 s69, s69, 16
  MF v[132:135], v[160:163], a[196:199], v[132:135]
  TR v[174:175], v4 offset:55552
  s_mul_i32 s70, s69, 9
  s_sub_u32 s68, s68, s70
  MF v[136:139], v[160:163], a[200:203], v[136:139]
  s_mul_i32 s69, s69, 414720
  s_lshl_b32 s68, s68, 10
  s_add_u32 s68, s68, s69
  s_add_u32 s68, s68, s59
  MF v[140:143], v[160:163], a[204:207], v[140:143]
  s_waitcnt lgkmcnt(4)
  MF v[144:147], v[164:167], a[192:195], v[144:147]
  TR v[160:161], v4 offset:57344
  MF v[148:151], v[164:167], a[196:199], v[148:151]
  TR v[162:163], v4 offset:57600
  MF v[152:155], v[164:167], a[200:203], v[152:155]
  buffer_store_dwordx4 v[236:239], v242, s[16:19], s68 offen sc1
  MF v[156:159], v[164:167], a[204:207], v[156:159]
  s_waitcnt lgkmcnt(4)
  MF v[128:131], v[168:171], a[208:211], v[128:131]
  TR v[164:165], v4 offset:59392
  MF v[132:135], v[168:171], a[212:215], v[132:135]
  TR v[166:167], v4 offset:59648
  MF v[136:139], v[168:171], a[216:219], v[136:139]
  s_mov_b32 s82, 262144
POLLE3:
  s_waitcnt vmcnt(17)
  v_cmp_eq_u32 vcc, 1, v246
  s_nop 1
  s_and_b32 s80, vcc_lo, s86
  s_cmp_eq_u32 s80, s86
  s_cbranch_scc1 POLLEDE3
  s_sub_u32 s82, s82, 1
  s_cbranch_scc1 POLLEDE3
  s_sleep 2
  buffer_load_dword v246, v24, s[16:19], 0 offen sc1
  s_waitcnt vmcnt(0)
  s_branch POLLE3
POLLEDE3:
  MF v[140:143], v[168:171], a[220:223], v[140:143]
  v_lshrrev_b32 v242, 4, v1
  s_waitcnt lgkmcnt(4)
  MF v[144:147], v[172:175], a[208:211], v[144:147]
  TR v[168:169], v5
  v_and_b32 v242, 1, v242
  MF v[148:151], v[172:175], a[212:215], v[148:151]
  TR v[170:171], v5 offset:256
  v_lshlrev_b32 v242, 10, v242
  MF v[152:155], v[172:175], a[216:219], v[152:155]
  v_add_u32 v242, v242, v15
  s_sub_u32 s80, s33, 7
  s_lshl_b32 s81, s80, 7
  MF v[156:159], v[172:175], a[220:223], v[156:159]
  s_cmp_ge_u32 s33, 7
  s_cselect_b32 s81, s81, 1073741824
  s_waitcnt lgkmcnt(4)
  MF v[128:131], v[160:163], a[224:227], v[128:131]
  TR v[172:173], v5 offset:2048
  MF v[132:135], v[160:163], a[228:231], v[132:135]
  TR v[174:175], v5 offset:2304
  MF v[136:139], v[160:163], a[232:235], v[136:139]
  buffer_load_dwordx2 v[224:225], v242, s[16:19], s81 offen sc1
  MF v[140:143], v[160:163], a[236:239], v[140:143]
  s_sub_u32 s80, s33, 6
  s_lshl_b32 s81, s80, 7
  s_waitcnt lgkmcnt(4)
  MF v[144:147], v[164:167], a[224:227], v[144:147]
  TR v[160:161], v5 offset:4096
  s_cmp_ge_u32 s33, 6
  s_cselect_b32 s81, s81, 1073741824
  MF v[148:151], v[164:167], a[228:231], v[148:151]
  TR v[162:163], v5 offset:4352
  MF v[152:155], v[164:167], a[232:235], v[152:155]
  buffer_load_dwordx2 v[226:227], v242, s[16:19], s81 offen sc1
  MF v[156:159], v[164:167], a[236:239], v[156:159]
  s_sub_u32 s80, s33, 5
  s_lshl_b32 s81, s80, 7
  s_waitcnt lgkmcnt(4)
  MF v[128:131], v[168:171], a[240:243], v[128:131]
  TR v[164:165], v5 offset:6144
  s_cmp_ge_u32 s33, 5
  s_cselect_b32 s81, s81, 1073741824
  MF v[132:135], v[168:171], a[244:247], v[132:135]
  TR v[166:167], v5 offset:6400
  MF v[136:139], v[168:171], a[248:251], v[136:139]
  buffer_load_dwordx2 v[228:229], v242, s[16:19], s81 offen sc1
  MF v[140:143], v[168:171], a[252:255], v[140:143]
  s_sub_u32 s80, s33, 4
  s_lshl_b32 s81, s80, 7
  s_waitcnt lgkmcnt(4)
  MF v[144:147], v[172:175], a[240:243], v[144:147]
  TR v[168:169], v5 offset:8192
  s_cmp_ge_u32 s33, 4
  s_cselect_b32 s81, s81, 1073741824
  MF v[148:151], v[172:175], a[244:247], v[148:151]
  TR v[170:171], v5 offset:8448
  MF v[152:155], v[172:175], a[248:251], v[152:155]
  buffer_load_dwordx2 v[230:231], v242, s[16:19], s81 offen sc1
  MF v[156:159], v[172:175], a[252:255], v[156:159]
  s_sub_u32 s80, s33, 3
  s_lshl_b32 s81, s80, 7
  s_waitcnt lgkmcnt(4)
  MF v[128:131], v[160:163], v[176:179], v[128:131]
  TR v[172:173], v5 offset:10240
  s_cmp_ge_u32 s33, 3
  s_cselect_b32 s81, s81, 1073741824
  MF v[132:135], v[160:163], v[180:183], v[132:135]
  TR v[174:175], v5 offset:10496
  MF v[136:139], v[160:163], v[184:187], v[136:139]
  buffer_load_dwordx2 v[232:233], v242, s[16:19], s81 offen sc1
  MF v[140:143], v[160:163], v[188:191], v[140:143]
  s_sub_u32 s80, s33, 2
  s_lshl_b32 s81, s80, 7
  s_waitcnt lgkmcnt(4)
  MF v[144:147], v[164:167], v[176:179], v[144:147]
  s_barrier
  TR v[160:161], v3 offset:12288
  s_cmp_ge_u32 s33, 2
  s_cselect_b32 s81, s81, 1073741824
  MF v[148:151], v[164:167], v[180:183], v[148:151]
  TR v[162:163], v3 offset:12544
  MF v[152:155], v[164:167], v[184:187], v[152:155]
  buffer_load_dwordx2 v[234:235], v242, s[16:19], s81 offen sc1
  MF v[156:159], v[164:167], v[188:191], v[156:159]
  s_sub_u32 s80, s33, 1
  s_lshl_b32 s81, s80, 7
  s_waitcnt lgkmcnt(4)
  MF v[128:131], v[168:171], v[192:195], v[128:131]
  TR v[164:165], v3 offset:14336
  s_cmp_ge_u32 s33, 1
  s_cselect_b32 s81, s81, 1073741824
  MF v[132:135], v[168:171], v[196:199], v[132:135]
  TR v[166:167], v3 offset:14592
  MF v[136:139], v[168:171], v[200:203], v[136:139]
  buffer_load_dwordx2 v[236:237], v242, s[16:19], s81 offen sc1
  MF v[140:143], v[168:171], v[204:207], v[140:143]
  v_max_f32 v96, 0, v96
  s_waitcnt lgkmcnt(4)
  MF v[144:147], v[172:175], v[192:195], v[144:147]
  TR v[168:169], v3 offset:16384
  v_max_f32 v97, 0, v97
  MF v[148:151], v[172:175], v[196:199], v[148:151]
  TR v[170:171], v3 offset:16640
  v_max_f32 v98, 0, v98
  MF v[152:155], v[172:175], v[200:203], v[152:155]
  v_max_f32 v99, 0, v99
  v_mul_f32 v96, v96, v112
  MF v[156:159], v[172:175], v[204:207], v[156:159]
  v_mul_f32 v97, v97, v113
  v_mul_f32 v98, v98, v114
  v_mul_f32 v99, v99, v115
  v_cvt_pk_bf16_f32 v248, v96, v97
  v_cvt_pk_bf16_f32 v249, v98, v99
  v_max_f32 v100, 0, v100
  v_max_f32 v101, 0, v101
  v_max_f32 v102, 0, v102
  v_max_f32 v103, 0, v103
  v_mul_f32 v100, v100, v116
  v_mul_f32 v101, v101, v117
  v_mul_f32 v102, v102, v118
  v_mul_f32 v103, v103, v119
  v_cvt_pk_bf16_f32 v250, v100, v101
  v_cvt_pk_bf16_f32 v251, v102, v103
  v_max_f32 v104, 0, v104
  v_max_f32 v105, 0, v105
  v_max_f32 v106, 0, v106
  v_max_f32 v107, 0, v107
  v_mul_f32 v104, v104, v120
  v_mul_f32 v105, v105, v121
  v_mul_f32 v106, v106, v122
  v_mul_f32 v107, v107, v123
  v_cvt_pk_bf16_f32 v252, v104, v105
  v_cvt_pk_bf16_f32 v253, v106, v107
  v_max_f32 v108, 0, v108
  v_max_f32 v109, 0, v109
  v_max_f32 v110, 0, v110
  v_max_f32 v111, 0, v111
  v_mul_f32 v108, v108, v124
  v_mul_f32 v109, v109, v125
  v_mul_f32 v110, v110, v126
  v_mul_f32 v111, v111, v127
  v_cvt_pk_bf16_f32 v254, v108, v109
  v_cvt_pk_bf16_f32 v255, v110, v111
K1_TB_G3:
  s_waitcnt lgkmcnt(4)
  MF v[96:99], v[160:163], a[0:3], 0
  TR v[172:173], v3 offset:18432
  MF v[100:103], v[160:163], a[4:7], 0
  TR v[174:175], v3 offset:18688
  MF v[104:107], v[160:163], a[8:11], 0
  s_add_u32 m0, s37, 20480
  s_add_u32 s89, s57, 192
  BL4 v8, s[8:11], s89 offen lds
  MF v[108:111], v[160:163], a[12:15], 0
  s_waitcnt lgkmcnt(4)
  MF v[112:115], v[164:167], a[0:3], 0
  TR v[160:161], v3 offset:20480
  MF v[116:119], v[164:167], a[4:7], 0
  TR v[162:163], v3 offset:20736
  MF v[120:123], v[164:167], a[8:11], 0
  MF v[124:127], v[164:167], a[12:15], 0
  s_waitcnt lgkmcnt(4)
  MF v[96:99], v[168:171], a[16:19], v[96:99]
  TR v[164:165], v3 offset:22528
  MF v[100:103], v[168:171], a[20:23], v[100:103]
  TR v[166:167], v3 offset:22784
  s_add_u32 s88, s36, 2
  s_lshl_b32 s88, s88, 10
  MF v[104:107], v[168:171], a[24:27], v[104:107]
  v_max_f32 v128, 0, v128
  v_max_f32 v129, 0, v129
  MF v[108:111], v[168:171], a[28:31], v[108:111]
  v_max_f32 v130, 0, v130
  s_waitcnt lgkmcnt(4)
  MF v[112:115], v[172:175], a[16:19], v[112:115]
  TR v[168:169], v3 offset:24576
  v_max_f32 v131, 0, v131
  MF v[116:119], v[172:175], a[20:23], v[116:119]
  TR v[170:171], v3 offset:24832
  v_mul_f32 v128, v128, v144
  MF v[120:123], v[172:175], a[24:27], v[120:123]
  v_mul_f32 v129, v129, v145
  v_mul_f32 v130, v130, v146
  MF v[124:127], v[172:175], a[28:31], v[124:127]
  v_mul_f32 v131, v131, v147
  s_waitcnt lgkmcnt(4)
  MF v[96:99], v[160:163], a[32:35], v[96:99]
  TR v[172:173], v3 offset:26624
  v_mov_b32 v240, v248
  MF v[100:103], v[160:163], a[36:39], v[100:103]
  TR v[174:175], v3 offset:26880
  v_mov_b32 v241, v249
  MF v[104:107], v[160:163], a[40:43], v[104:107]
  v_cvt_pk_bf16_f32 v242, v128, v129
  v_cvt_pk_bf16_f32 v243, v130, v131
  MF v[108:111], v[160:163], a[44:47], v[108:111]
  s_add_u32 s80, s88, 0
  s_waitcnt lgkmcnt(4)
  MF v[112:115], v[164:167], a[32:35], v[112:115]
  TR v[160:161], v3 offset:28672
  MF v[116:119], v[164:167], a[36:39], v[116:119]
  TR v[162:163], v3 offset:28928
  MF v[120:123], v[164:167], a[40:43], v[120:123]
  buffer_store_dwordx4 v[240:243], v10, s[16:19], s80 offen sc1
  MF v[124:127], v[164:167], a[44:47], v[124:127]
  v_max_f32 v132, 0, v132
  s_waitcnt lgkmcnt(4)
  MF v[96:99], v[168:171], a[48:51], v[96:99]
  TR v[164:165], v3 offset:30720
  v_max_f32 v133, 0, v133
  MF v[100:103], v[168:171], a[52:55], v[100:103]
  TR v[166:167], v3 offset:30976
  v_max_f32 v134, 0, v134
  MF v[104:107], v[168:171], a[56:59], v[104:107]
  v_max_f32 v135, 0, v135
  v_mul_f32 v132, v132, v148
  MF v[108:111], v[168:171], a[60:63], v[108:111]
  v_mul_f32 v133, v133, v149
  s_waitcnt lgkmcnt(4)
  MF v[112:115], v[172:175], a[48:51], v[112:115]
  TR v[168:169], v3 offset:32768
  v_mul_f32 v134, v134, v150
  MF v[116:119], v[172:175], a[52:55], v[116:119]
  TR v[170:171], v3 offset:33024
  v_mul_f32 v135, v135, v151
  MF v[120:123], v[172:175], a[56:59], v[120:123]
  v_mov_b32 v244, v250
  v_mov_b32 v245, v251
  MF v[124:127], v[172:175], a[60:63], v[124:127]
  v_cvt_pk_bf16_f32 v246, v132, v133
  s_waitcnt lgkmcnt(4)
  MF v[96:99], v[160:163], a[64:67], v[96:99]
  TR v[172:173], v3 offset:34816
  v_cvt_pk_bf16_f32 v247, v134, v135
  MF v[100:103], v[160:163], a[68:71], v[100:103]
  TR v[174:175], v3 offset:35072
  s_add_u32 s80, s88, 185344
  MF v[104:107], v[160:163], a[72:75], v[104:107]
  buffer_store_dwordx4 v[244:247], v10, s[16:19], s80 offen sc1
  MF v[108:111], v[160:163], a[76:79], v[108:111]
  v_max_f32 v136, 0, v136
  s_waitcnt lgkmcnt(4)
  MF v[112:115], v[164:167], a[64:67], v[112:115]
  TR v[160:161], v5 offset:12288
  v_max_f32 v137, 0, v137
  MF v[116:119], v[164:167], a[68:71], v[116:119]
  TR v[162:163], v5 offset:12544
  v_max_f32 v138, 0, v138
  MF v[120:123], v[164:167], a[72:75], v[120:123]
  v_max_f32 v139, 0, v139
  v_mul_f32 v136, v136, v152
  MF v[124:127], v[164:167], a[76:79], v[124:127]
  v_mul_f32 v137, v137, v153
  s_waitcnt lgkmcnt(4)
  MF v[96:99], v[168:171], a[80:83], v[96:99]
  TR v[164:165], v5 offset:14336
  v_mul_f32 v138, v138, v154
  MF v[100:103], v[168:171], a[84:87], v[100:103]
  TR v[166:167], v5 offset:14592
  v_mul_f32 v139, v139, v155
  MF v[104:107], v[168:171], a[88:91], v[104:107]
  v_mov_b32 v240, v252
  v_mov_b32 v241, v253
  MF v[108:111], v[168:171], a[92:95], v[108:111]
  v_cvt_pk_bf16_f32 v242, v136, v137
  s_waitcnt lgkmcnt(4)
  MF v[112:115], v[172:175], a[80:83], v[112:115]
  TR v[168:169], v5 offset:16384
  v_cvt_pk_bf16_f32 v243, v138, v139
  MF v[116:119], v[172:175], a[84:87], v[116:119]
  TR v[170:171], v5 offset:16640
  s_add_u32 s80, s88, 370688
  MF v[120:123], v[172:175], a[88:91], v[120:123]
  buffer_store_dwordx4 v[240:243], v10, s[16:19], s80 offen sc1
  MF v[124:127], v[172:175], a[92:95], v[124:127]
  v_max_f32 v140, 0, v140
  v_max_f32 v141, 0, v141
  v_max_f32 v142, 0, v142
  v_max_f32 v143, 0, v143
  v_mul_f32 v140, v140, v156
  v_mul_f32 v141, v141, v157
  v_mul_f32 v142, v142, v158
  v_mul_f32 v143, v143, v159
  v_mov_b32 v244, v254
  v_mov_b32 v245, v255
  v_cvt_pk_bf16_f32 v246, v140, v141
  v_cvt_pk_bf16_f32 v247, v142, v143
  s_add_u32 s80, s88, 556032
  buffer_store_dwordx4 v[244:247], v10, s[16:19], s80 offen sc1
  s_waitcnt lgkmcnt(4)
  MF v[128:131], v[160:163], a[0:3], 0
  TR v[172:173], v5 offset:18432
  v_and_b32 v240, 16, v1
  MF v[132:135], v[160:163], a[4:7], 0
  TR v[174:175], v5 offset:18688
  MF v[136:139], v[160:163], a[8:11], 0
  v_cmp_ne_u32 vcc, 0, v240
  s_nop 1
  v_cndmask_b32 v242, v208, v216, vcc
  v_cndmask_b32 v243, v209, v217, vcc
  MF v[140:143], v[160:163], a[12:15], 0
  v_mul_f32 v240, 0x43800000, v242
  s_waitcnt lgkmcnt(4)
  MF v[144:147], v[164:167], a[0:3], 0
  TR v[160:161], v5 offset:20480
  v_mul_f32 v241, 0x43800000, v243
  MF v[148:151], v[164:167], a[4:7], 0
  TR v[162:163], v5 offset:20736
  v_exp_f32 v238, v240
  MF v[152:155], v[164:167], a[8:11], 0
  v_fract_f32 v241, v241
  v_cos_f32 v240, v241
  MF v[156:159], v[164:167], a[12:15], 0
  v_sin_f32 v241, v241
  s_waitcnt lgkmcnt(4)
  MF v[128:131], v[168:171], a[16:19], v[128:131]
  TR v[164:165], v5 offset:22528
  v_mul_f32 v239, v238, v241
  MF v[132:135], v[168:171], a[20:23], v[132:135]
  TR v[166:167], v5 offset:22784
  v_mul_f32 v238, v238, v240
  MF v[136:139], v[168:171], a[24:27], v[136:139]
  s_waitcnt vmcnt(10)
  v_fma_f32 v226, v238, v224, v226
  v_fma_f32 v227, v238, v225, v227
  MF v[140:143], v[168:171], a[28:31], v[140:143]
  v_fma_f32 v226, -v239, v225, v226
  s_waitcnt lgkmcnt(4)
  MF v[144:147], v[172:175], a[16:19], v[144:147]
  TR v[168:169], v5 offset:24576
  v_fma_f32 v227, v239, v224, v227
  MF v[148:151], v[172:175], a[20:23], v[148:151]
  TR v[170:171], v5 offset:24832
  s_waitcnt vmcnt(9)
  v_fma_f32 v228, v238, v226, v228
  MF v[152:155], v[172:175], a[24:27], v[152:155]
  v_fma_f32 v229, v238, v227, v229
  v_fma_f32 v228, -v239, v227, v228
  MF v[156:159], v[172:175], a[28:31], v[156:159]
  v_fma_f32 v229, v239, v226, v229
  s_waitcnt lgkmcnt(4)
  MF v[128:131], v[160:163], a[32:35], v[128:131]
  TR v[172:173], v5 offset:26624
  s_waitcnt vmcnt(8)
  v_fma_f32 v230, v238, v228, v230
  MF v[132:135], v[160:163], a[36:39], v[132:135]
  TR v[174:175], v5 offset:26880
  v_fma_f32 v231, v238, v229, v231
  MF v[136:139], v[160:163], a[40:43], v[136:139]
  v_fma_f32 v230, -v239, v229, v230
  v_fma_f32 v231, v239, v228, v231
  MF v[140:143], v[160:163], a[44:47], v[140:143]
  s_waitcnt vmcnt(7)
  v_fma_f32 v232, v238, v230, v232
  s_waitcnt lgkmcnt(4)
  MF v[144:147], v[164:167], a[32:35], v[144:147]
  TR v[160:161], v5 offset:28672
  v_fma_f32 v233, v238, v231, v233
  MF v[148:151], v[164:167], a[36:39], v[148:151]
  TR v[162:163], v5 offset:28928
  v_fma_f32 v232, -v239, v231, v232
  MF v[152:155], v[164:167], a[40:43], v[152:155]
  v_fma_f32 v233, v239, v230, v233
  s_waitcnt vmcnt(6)
  v_fma_f32 v234, v238, v232, v234
  MF v[156:159], v[164:167], a[44:47], v[156:159]
  v_fma_f32 v235, v238, v233, v235
  s_waitcnt lgkmcnt(4)
  MF v[128:131], v[168:171], a[48:51], v[128:131]
  TR v[164:165], v5 offset:30720
  v_fma_f32 v234, -v239, v233, v234
  MF v[132:135], v[168:171], a[52:55], v[132:135]
  TR v[166:167], v5 offset:30976
  v_fma_f32 v235, v239, v232, v235
  MF v[136:139], v[168:171], a[56:59], v[136:139]
  s_waitcnt vmcnt(5)
  v_fma_f32 v236, v238, v234, v236
  v_fma_f32 v237, v238, v235, v237
  MF v[140:143], v[168:171], a[60:63], v[140:143]
  v_fma_f32 v236, -v239, v235, v236
  s_waitcnt lgkmcnt(4)
  MF v[144:147], v[172:175], a[48:51], v[144:147]
  TR v[168:169], v5 offset:32768
  v_fma_f32 v237, v239, v234, v237
  MF v[148:151], v[172:175], a[52:55], v[148:151]
  TR v[170:171], v5 offset:33024
  v_lshlrev_b32 v240, 3, v1
  MF v[152:155], v[172:175], a[56:59], v[152:155]
  v_add_u32 v240, s3, v240
  ds_write_b64 v240, v[236:237]
  MF v[156:159], v[172:175], a[60:63], v[156:159]
  s_waitcnt lgkmcnt(5)
  MF v[128:131], v[160:163], a[64:67], v[128:131]
  TR v[172:173], v5 offset:34816
  MF v[132:135], v[160:163], a[68:71], v[132:135]
  TR v[174:175], v5 offset:35072
  MF v[136:139], v[160:163], a[72:75], v[136:139]
  MF v[140:143], v[160:163], a[76:79], v[140:143]
  s_waitcnt lgkmcnt(5)
  MF v[144:147], v[164:167], a[64:67], v[144:147]
  s_waitcnt lgkmcnt(2)
  s_barrier
  TR v[160:161], v3 offset:36864
  MF v[148:151], v[164:167], a[68:71], v[148:151]
  TR v[162:163], v3 offset:37120
  MF v[152:155], v[164:167], a[72:75], v[152:155]
  MF v[156:159], v[164:167], a[76:79], v[156:159]
  MF v[128:131], v[168:171], a[80:83], v[128:131]
  TR v[164:165], v3 offset:38912
  MF v[132:135], v[168:171], a[84:87], v[132:135]
  TR v[166:167], v3 offset:39168
  MF v[136:139], v[168:171], a[88:91], v[136:139]
  MF v[140:143], v[168:171], a[92:95], v[140:143]
  s_waitcnt lgkmcnt(4)
  MF v[144:147], v[172:175], a[80:83], v[144:147]
  TR v[168:169], v5 offset:36864
  MF v[148:151], v[172:175], a[84:87], v[148:151]
  TR v[170:171], v5 offset:37120
  MF v[152:155], v[172:175], a[88:91], v[152:155]
  MF v[156:159], v[172:175], a[92:95], v[156:159]
  s_waitcnt lgkmcnt(4)
  MF v[96:99], v[160:163], a[96:99], v[96:99]
  TR v[172:173], v5 offset:38912
  MF v[100:103], v[160:163], a[100:103], v[100:103]
  TR v[174:175], v5 offset:39168
  MF v[104:107], v[160:163], a[104:107], v[104:107]
  MF v[108:111], v[160:163], a[108:111], v[108:111]
  s_waitcnt lgkmcnt(4)
  MF v[112:115], v[164:167], a[96:99], v[112:115]
  TR v[160:161], v3 offset:40960
  s_mul_i32 s79, s34, 36
  s_add_u32 s79, s79, 28
  MF v[116:119], v[164:167], a[100:103], v[116:119]
  TR v[162:163], v3 offset:41216
  s_add_u32 s79, s79, s39
  s_lshl_b32 s79, s79, 10
  MF v[120:123], v[164:167], a[104:107], v[120:123]
  v_and_b32 v226, 15, v1
  v_and_b32 v232, 15, v1
  MF v[124:127], v[164:167], a[108:111], v[124:127]
  v_lshlrev_b32 v226, 3, v226
  s_waitcnt lgkmcnt(4)
  MF v[128:131], v[168:171], a[96:99], v[128:131]
  TR v[164:165], v3 offset:43008
  v_lshlrev_b32 v232, 3, v232
  MF v[132:135], v[168:171], a[100:103], v[132:135]
  TR v[166:167], v3 offset:43264
  v_add_u32 v226, 143360, v226
  MF v[136:139], v[168:171], a[104:107], v[136:139]
  v_add_u32 v232, 143360, v232
  ds_read_b64 v[228:229], v226
  MF v[140:143], v[168:171], a[108:111], v[140:143]
  ds_read_b64 v[234:235], v232 offset:128
  s_waitcnt lgkmcnt(6)
  MF v[144:147], v[172:175], a[96:99], v[144:147]
  TR v[168:169], v5 offset:40960
  v_mul_f32 v226, v21, v208
  MF v[148:151], v[172:175], a[100:103], v[148:151]
  TR v[170:171], v5 offset:41216
  v_mul_f32 v232, v21, v216
  MF v[152:155], v[172:175], a[104:107], v[152:155]
  v_mul_f32 v227, v21, v209
  v_mul_f32 v233, v21, v217
  MF v[156:159], v[172:175], a[108:111], v[156:159]
  v_exp_f32 v224, v226
  s_waitcnt lgkmcnt(6)
  MF v[96:99], v[160:163], a[112:115], v[96:99]
  TR v[172:173], v5 offset:43008
  v_exp_f32 v230, v232
  MF v[100:103], v[160:163], a[116:119], v[100:103]
  TR v[174:175], v5 offset:43264
  v_fract_f32 v227, v227
  MF v[104:107], v[160:163], a[120:123], v[104:107]
  v_fract_f32 v233, v233
  v_cos_f32 v226, v227
  MF v[108:111], v[160:163], a[124:127], v[108:111]
  v_cos_f32 v232, v233
  s_waitcnt lgkmcnt(6)
  MF v[112:115], v[164:167], a[112:115], v[112:115]
  TR v[160:161], v3 offset:45056
  v_sin_f32 v227, v227
  MF v[116:119], v[164:167], a[116:119], v[116:119]
  TR v[162:163], v3 offset:45312
  v_sin_f32 v233, v233
  MF v[120:123], v[164:167], a[120:123], v[120:123]
  v_mul_f32 v225, v224, v227
  v_mul_f32 v231, v230, v233
  MF v[124:127], v[164:167], a[124:127], v[124:127]
  v_mul_f32 v224, v224, v226
  s_waitcnt lgkmcnt(4)
  MF v[128:131], v[168:171], a[112:115], v[128:131]
  TR v[164:165], v3 offset:47104
  v_mul_f32 v230, v230, v232
  MF v[132:135], v[168:171], a[116:119], v[132:135]
  TR v[166:167], v3 offset:47360
  v_fma_f32 v212, v224, v228, v212
  MF v[136:139], v[168:171], a[120:123], v[136:139]
  v_fma_f32 v220, v230, v234, v220
  v_fma_f32 v213, v224, v229, v213
  MF v[140:143], v[168:171], a[124:127], v[140:143]
  v_fma_f32 v221, v230, v235, v221
  s_waitcnt lgkmcnt(4)
  MF v[144:147], v[172:175], a[112:115], v[144:147]
  TR v[168:169], v5 offset:45056
  v_fma_f32 v212, -v225, v229, v212
  MF v[148:151], v[172:175], a[116:119], v[148:151]
  TR v[170:171], v5 offset:45312
  v_fma_f32 v220, -v231, v235, v220
  MF v[152:155], v[172:175], a[120:123], v[152:155]
  v_fma_f32 v213, v225, v228, v213
  v_fma_f32 v221, v231, v234, v221
  MF v[156:159], v[172:175], a[124:127], v[156:159]
  v_fma_f32 v32, v210, v212, v32
  s_waitcnt lgkmcnt(4)
  MF v[96:99], v[160:163], a[128:131], v[96:99]
  TR v[172:173], v5 offset:47104
  v_fma_f32 v64, v218, v220, v64
  MF v[100:103], v[160:163], a[132:135], v[100:103]
  TR v[174:175], v5 offset:47360
  v_fma_f32 v48, v210, v213, v48
  MF v[104:107], v[160:163], a[136:139], v[104:107]
  v_fma_f32 v80, v218, v221, v80
  v_fma_f32 v32, -v211, v213, v32
  MF v[108:111], v[160:163], a[140:143], v[108:111]
  v_fma_f32 v64, -v219, v221, v64
  s_waitcnt lgkmcnt(4)
  MF v[112:115], v[164:167], a[128:131], v[112:115]
  TR v[160:161], v3 offset:49152
  v_fma_f32 v48, v211, v212, v48
  MF v[116:119], v[164:167], a[132:135], v[116:119]
  TR v[162:163], v3 offset:49408
  v_fma_f32 v80, v219, v220, v80
  MF v[120:123], v[164:167], a[136:139], v[120:123]
  v_fma_f32 v33, v210, v32, v33
  v_fma_f32 v65, v218, v64, v65
  MF v[124:127], v[164:167], a[140:143], v[124:127]
  v_fma_f32 v49, v210, v48, v49
  s_waitcnt lgkmcnt(4)
  MF v[128:131], v[168:171], a[128:131], v[128:131]
  TR v[164:165], v3 offset:51200
  v_fma_f32 v81, v218, v80, v81
  MF v[132:135], v[168:171], a[132:135], v[132:135]
  TR v[166:167], v3 offset:51456
  v_fma_f32 v33, -v211, v48, v33
  MF v[136:139], v[168:171], a[136:139], v[136:139]
  v_fma_f32 v65, -v219, v80, v65
  v_fma_f32 v49, v211, v32, v49
  MF v[140:143], v[168:171], a[140:143], v[140:143]
  v_fma_f32 v81, v219, v64, v81
  s_waitcnt lgkmcnt(4)
  MF v[144:147], v[172:175], a[128:131], v[144:147]
  TR v[168:169], v5 offset:49152
  v_fma_f32 v34, v210, v33, v34
  MF v[148:151], v[172:175], a[132:135], v[148:151]
  TR v[170:171], v5 offset:49408
  v_fma_f32 v66, v218, v65, v66
  MF v[152:155], v[172:175], a[136:139], v[152:155]
  v_fma_f32 v50, v210, v49, v50
  v_fma_f32 v82, v218, v81, v82
  MF v[156:159], v[172:175], a[140:143], v[156:159]
  v_fma_f32 v34, -v211, v49, v34
  s_waitcnt lgkmcnt(4)
  MF v[96:99], v[160:163], a[144:147], v[96:99]
  TR v[172:173], v5 offset:51200
  v_fma_f32 v66, -v219, v81, v66
  MF v[100:103], v[160:163], a[148:151], v[100:103]
  TR v[174:175], v5 offset:51456
  v_fma_f32 v50, v211, v33, v50
  MF v[104:107], v[160:163], a[152:155], v[104:107]
  v_fma_f32 v82, v219, v65, v82
  v_fma_f32 v35, v210, v34, v35
  MF v[108:111], v[160:163], a[156:159], v[108:111]
  v_fma_f32 v67, v218, v66, v67
  s_waitcnt lgkmcnt(4)
  MF v[112:115], v[164:167], a[144:147], v[112:115]
  TR v[160:161], v3 offset:53248
  v_fma_f32 v51, v210, v50, v51
  MF v[116:119], v[164:167], a[148:151], v[116:119]
  TR v[162:163], v3 offset:53504
  v_fma_f32 v83, v218, v82, v83
  MF v[120:123], v[164:167], a[152:155], v[120:123]
  v_fma_f32 v35, -v211, v50, v35
  v_fma_f32 v67, -v219, v82, v67
  MF v[124:127], v[164:167], a[156:159], v[124:127]
  v_fma_f32 v51, v211, v34, v51
  s_waitcnt lgkmcnt(4)
  MF v[128:131], v[168:171], a[144:147], v[128:131]
  TR v[164:165], v3 offset:55296
  v_fma_f32 v83, v219, v66, v83
  MF v[132:135], v[168:171], a[148:151], v[132:135]
  TR v[166:167], v3 offset:55552
  v_fma_f32 v36, v210, v35, v36
  MF v[136:139], v[168:171], a[152:155], v[136:139]
  v_fma_f32 v68, v218, v67, v68
  v_fma_f32 v52, v210, v51, v52
  MF v[140:143], v[168:171], a[156:159], v[140:143]
  v_fma_f32 v84, v218, v83, v84
  s_waitcnt lgkmcnt(4)
  MF v[144:147], v[172:175], a[144:147], v[144:147]
  TR v[168:169], v5 offset:53248
  v_fma_f32 v36, -v211, v51, v36
  MF v[148:151], v[172:175], a[148:151], v[148:151]
  TR v[170:171], v5 offset:53504
  v_fma_f32 v68, -v219, v83, v68
  MF v[152:155], v[172:175], a[152:155], v[152:155]
  v_fma_f32 v52, v211, v35, v52
  v_fma_f32 v84, v219, v67, v84
  MF v[156:159], v[172:175], a[156:159], v[156:159]
  v_fma_f32 v37, v210, v36, v37
  s_waitcnt lgkmcnt(4)
  MF v[96:99], v[160:163], a[160:163], v[96:99]
  TR v[172:173], v5 offset:55296
  v_fma_f32 v69, v218, v68, v69
  MF v[100:103], v[160:163], a[164:167], v[100:103]
  TR v[174:175], v5 offset:55552
  v_fma_f32 v53, v210, v52, v53
  MF v[104:107], v[160:163], a[168:171], v[104:107]
  v_fma_f32 v85, v218, v84, v85
  v_fma_f32 v37, -v211, v52, v37
  MF v[108:111], v[160:163], a[172:175], v[108:111]
  v_fma_f32 v69, -v219, v84, v69
  s_waitcnt lgkmcnt(4)
  MF v[112:115], v[164:167], a[160:163], v[112:115]
  TR v[160:161], v3 offset:57344
  v_fma_f32 v53, v211, v36, v53
  MF v[116:119], v[164:167], a[164:167], v[116:119]
  TR v[162:163], v3 offset:57600
  v_fma_f32 v85, v219, v68, v85
  MF v[120:123], v[164:167], a[168:171], v[120:123]
  v_fma_f32 v38, v210, v37, v38
  v_fma_f32 v70, v218, v69, v70
  MF v[124:127], v[164:167], a[172:175], v[124:127]
  v_fma_f32 v54, v210, v53, v54
  s_waitcnt lgkmcnt(4)
  MF v[128:131], v[168:171], a[160:163], v[128:131]
  TR v[164:165], v3 offset:59392
  v_fma_f32 v86, v218, v85, v86
  MF v[132:135], v[168:171], a[164:167], v[132:135]
  TR v[166:167], v3 offset:59648
  v_fma_f32 v38, -v211, v53, v38
  MF v[136:139], v[168:171], a[168:171], v[136:139]
  v_fma_f32 v70, -v219, v85, v70
  v_fma_f32 v54, v211, v37, v54
  MF v[140:143], v[168:171], a[172:175], v[140:143]
  v_fma_f32 v86, v219, v69, v86
  s_waitcnt lgkmcnt(4)
  MF v[144:147], v[172:175], a[160:163], v[144:147]
  TR v[168:169], v5 offset:57344
  v_fma_f32 v39, v210, v38, v39
  MF v[148:151], v[172:175], a[164:167], v[148:151]
  TR v[170:171], v5 offset:57600
  v_fma_f32 v71, v218, v70, v71
  MF v[152:155], v[172:175], a[168:171], v[152:155]
  v_fma_f32 v55, v210, v54, v55
  v_fma_f32 v87, v218, v86, v87
  MF v[156:159], v[172:175], a[172:175], v[156:159]
  v_fma_f32 v39, -v211, v54, v39
  s_waitcnt lgkmcnt(4)
  MF v[96:99], v[160:163], a[176:179], v[96:99]
  TR v[172:173], v5 offset:59392
  v_fma_f32 v71, -v219, v86, v71
  MF v[100:103], v[160:163], a[180:183], v[100:103]
  TR v[174:175], v5 offset:59648
  v_fma_f32 v55, v211, v38, v55
  MF v[104:107], v[160:163], a[184:187], v[104:107]
  v_fma_f32 v87, v219, v70, v87
  v_fma_f32 v40, v210, v39, v40
  MF v[108:111], v[160:163], a[188:191], v[108:111]
  v_fma_f32 v72, v218, v71, v72
  s_waitcnt lgkmcnt(4)
  MF v[112:115], v[164:167], a[176:179], v[112:115]
  s_waitcnt vmcnt(0)
  s_barrier
  v_mov_b32 v243, 1
  buffer_store_dword v243, v30, s[16:19], 0 offen sc1
  TR v[160:161], v2
  v_fma_f32 v56, v210, v55, v56
  MF v[116:119], v[164:167], a[180:183], v[116:119]
  TR v[162:163], v2 offset:256
  v_fma_f32 v88, v218, v87, v88
  MF v[120:123], v[164:167], a[184:187], v[120:123]
  v_fma_f32 v40, -v211, v55, v40
  v_fma_f32 v72, -v219, v87, v72
  MF v[124:127], v[164:167], a[188:191], v[124:127]
  v_fma_f32 v56, v211, v39, v56
  s_waitcnt lgkmcnt(4)
  MF v[128:131], v[168:171], a[176:179], v[128:131]
  TR v[164:165], v2 offset:2048
  v_fma_f32 v88, v219, v71, v88
  MF v[132:135], v[168:171], a[180:183], v[132:135]
  TR v[166:167], v2 offset:2304
  v_fma_f32 v41, v210, v40, v41
  MF v[136:139], v[168:171], a[184:187], v[136:139]
  v_fma_f32 v73, v218, v72, v73
  v_fma_f32 v57, v210, v56, v57
  MF v[140:143], v[168:171], a[188:191], v[140:143]
  v_fma_f32 v89, v218, v88, v89
  s_waitcnt lgkmcnt(4)
  MF v[144:147], v[172:175], a[176:179], v[144:147]
  TR v[168:169], v2 offset:4096
  v_fma_f32 v41, -v211, v56, v41
  MF v[148:151], v[172:175], a[180:183], v[148:151]
  TR v[170:171], v2 offset:4352
  v_fma_f32 v73, -v219, v88, v73
  MF v[152:155], v[172:175], a[184:187], v[152:155]
  v_fma_f32 v57, v211, v40, v57
  v_fma_f32 v89, v219, v72, v89
  MF v[156:159], v[172:175], a[188:191], v[156:159]
  v_fma_f32 v42, v210, v41, v42
  s_waitcnt lgkmcnt(4)
  MF v[96:99], v[160:163], a[192:195], v[96:99]
  TR v[172:173], v2 offset:6144
  v_fma_f32 v74, v218, v73, v74
  MF v[100:103], v[160:163], a[196:199], v[100:103]
  TR v[174:175], v2 offset:6400
  v_fma_f32 v58, v210, v57, v58
  MF v[104:107], v[160:163], a[200:203], v[104:107]
  v_fma_f32 v90, v218, v89, v90
  v_fma_f32 v42, -v211, v57, v42
  MF v[108:111], v[160:163], a[204:207], v[108:111]
  v_fma_f32 v74, -v219, v89, v74
  s_waitcnt lgkmcnt(4)
  MF v[112:115], v[164:167], a[192:195], v[112:115]
  TR v[160:161], v2 offset:8192
  v_fma_f32 v58, v211, v41, v58
  MF v[116:119], v[164:167], a[196:199], v[116:119]
  TR v[162:163], v2 offset:8448
  v_fma_f32 v90, v219, v73, v90
  MF v[120:123], v[164:167], a[200:203], v[120:123]
  v_fma_f32 v43, v210, v42, v43
  v_fma_f32 v75, v218, v74, v75
  MF v[124:127], v[164:167], a[204:207], v[124:127]
  v_fma_f32 v59, v210, v58, v59
  s_waitcnt lgkmcnt(4)
  MF v[96:99], v[168:171], a[208:211], v[96:99]
  TR v[164:165], v2 offset:10240
  v_fma_f32 v91, v218, v90, v91
  MF v[100:103], v[168:171], a[212:215], v[100:103]
  TR v[166:167], v2 offset:10496
  v_fma_f32 v43, -v211, v58, v43
  MF v[104:107], v[168:171], a[216:219], v[104:107]
  v_fma_f32 v75, -v219, v90, v75
  v_fma_f32 v59, v211, v42, v59
  MF v[108:111], v[168:171], a[220:223], v[108:111]
  v_fma_f32 v91, v219, v74, v91
  s_waitcnt lgkmcnt(4)
  MF v[112:115], v[172:175], a[208:211], v[112:115]
  TR v[168:169], v2 offset:12288
  v_fma_f32 v44, v210, v43, v44
  MF v[116:119], v[172:175], a[212:215], v[116:119]
  TR v[170:171], v2 offset:12544
  v_fma_f32 v76, v218, v75, v76
  MF v[120:123], v[172:175], a[216:219], v[120:123]
  v_fma_f32 v60, v210, v59, v60
  v_fma_f32 v92, v218, v91, v92
  MF v[124:127], v[172:175], a[220:223], v[124:127]
  v_fma_f32 v44, -v211, v59, v44
  s_waitcnt lgkmcnt(4)
  MF v[96:99], v[160:163], a[224:227], v[96:99]
  TR v[172:173], v2 offset:14336
  v_fma_f32 v76, -v219, v91, v76
  MF v[100:103], v[160:163], a[228:231], v[100:103]
  TR v[174:175], v2 offset:14592
  v_fma_f32 v60, v211, v43, v60
  MF v[104:107], v[160:163], a[232:235], v[104:107]
  v_fma_f32 v92, v219, v75, v92
  v_fma_f32 v45, v210, v44, v45
  MF v[108:111], v[160:163], a[236:239], v[108:111]
  v_fma_f32 v77, v218, v76, v77
  s_waitcnt lgkmcnt(4)
  MF v[112:115], v[164:167], a[224:227], v[112:115]
  TR v[160:161], v2 offset:16384
  v_fma_f32 v61, v210, v60, v61
  MF v[116:119], v[164:167], a[228:231], v[116:119]
  TR v[162:163], v2 offset:16640
  v_fma_f32 v93, v218, v92, v93
  MF v[120:123], v[164:167], a[232:235], v[120:123]
  v_fma_f32 v45, -v211, v60, v45
  v_fma_f32 v77, -v219, v92, v77
  MF v[124:127], v[164:167], a[236:239], v[124:127]
  v_fma_f32 v61, v211, v44, v61
  s_waitcnt lgkmcnt(4)
  MF v[96:99], v[168:171], a[240:243], v[96:99]
  TR v[164:165], v2 offset:18432
  v_fma_f32 v93, v219, v76, v93
  MF v[100:103], v[168:171], a[244:247], v[100:103]
  TR v[166:167], v2 offset:18688
  v_fma_f32 v46, v210, v45, v46
  MF v[104:107], v[168:171], a[248:251], v[104:107]
  v_fma_f32 v78, v218, v77, v78
  v_fma_f32 v62, v210, v61, v62
  MF v[108:111], v[168:171], a[252:255], v[108:111]
  v_fma_f32 v94, v218, v93, v94
  s_waitcnt lgkmcnt(4)
  MF v[112:115], v[172:175], a[240:243], v[112:115]
  TR v[168:169], v2 offset:20480
  v_fma_f32 v46, -v211, v61, v46
  MF v[116:119], v[172:175], a[244:247], v[116:119]
  TR v[170:171], v2 offset:20736
  v_fma_f32 v78, -v219, v93, v78
  MF v[120:123], v[172:175], a[248:251], v[120:123]
  v_fma_f32 v62, v211, v45, v62
  v_fma_f32 v94, v219, v77, v94
  MF v[124:127], v[172:175], a[252:255], v[124:127]
  v_fma_f32 v47, v210, v46, v47
  s_waitcnt lgkmcnt(4)
  MF v[96:99], v[160:163], v[176:179], v[96:99]
  TR v[172:173], v2 offset:22528
  v_fma_f32 v79, v218, v78, v79
  MF v[100:103], v[160:163], v[180:183], v[100:103]
  TR v[174:175], v2 offset:22784
  v_fma_f32 v63, v210, v62, v63
  MF v[104:107], v[160:163], v[184:187], v[104:107]
  v_fma_f32 v95, v218, v94, v95
  v_fma_f32 v47, -v211, v62, v47
  MF v[108:111], v[160:163], v[188:191], v[108:111]
  v_fma_f32 v79, -v219, v94, v79
  s_waitcnt lgkmcnt(4)
  MF v[112:115], v[164:167], v[176:179], v[112:115]
  TR v[160:161], v4
  v_fma_f32 v63, v211, v46, v63
  MF v[116:119], v[164:167], v[180:183], v[116:119]
  TR v[162:163], v4 offset:256
  v_fma_f32 v95, v219, v78, v95
  MF v[120:123], v[164:167], v[184:187], v[120:123]
  v_cvt_pk_bf16_f32 v32, v32, v33
  v_cvt_pk_bf16_f32 v64, v64, v65
  MF v[124:127], v[164:167], v[188:191], v[124:127]
  v_cvt_pk_bf16_f32 v33, v34, v35
  s_waitcnt lgkmcnt(4)
  MF v[96:99], v[168:171], v[192:195], v[96:99]
  TR v[164:165], v4 offset:2048
  v_cvt_pk_bf16_f32 v65, v66, v67
  MF v[100:103], v[168:171], v[196:199], v[100:103]
  TR v[166:167], v4 offset:2304
  v_cvt_pk_bf16_f32 v34, v36, v37
  MF v[104:107], v[168:171], v[200:203], v[104:107]
  v_cvt_pk_bf16_f32 v66, v68, v69
  v_cvt_pk_bf16_f32 v35, v38, v39
  MF v[108:111], v[168:171], v[204:207], v[108:111]
  v_cvt_pk_bf16_f32 v67, v70, v71
  s_waitcnt lgkmcnt(4)
  MF v[112:115], v[172:175], v[192:195], v[112:115]
  TR v[168:169], v4 offset:4096
  v_cvt_pk_bf16_f32 v36, v40, v41
  MF v[116:119], v[172:175], v[196:199], v[116:119]
  TR v[170:171], v4 offset:4352
  v_cvt_pk_bf16_f32 v68, v72, v73
  MF v[120:123], v[172:175], v[200:203], v[120:123]
  v_cvt_pk_bf16_f32 v37, v42, v43
  v_cvt_pk_bf16_f32 v69, v74, v75
  MF v[124:127], v[172:175], v[204:207], v[124:127]
  v_cvt_pk_bf16_f32 v38, v44, v45
  s_waitcnt lgkmcnt(4)
  MF v[128:131], v[160:163], a[192:195], v[128:131]
  TR v[172:173], v4 offset:6144
  v_cvt_pk_bf16_f32 v70, v76, v77
  MF v[132:135], v[160:163], a[196:199], v[132:135]
  TR v[174:175], v4 offset:6400
  v_cvt_pk_bf16_f32 v39, v46, v47
  MF v[136:139], v[160:163], a[200:203], v[136:139]
  v_cvt_pk_bf16_f32 v71, v78, v79
  v_cvt_pk_bf16_f32 v48, v48, v49
  MF v[140:143], v[160:163], a[204:207], v[140:143]
  v_cvt_pk_bf16_f32 v80, v80, v81
  s_waitcnt lgkmcnt(4)
  MF v[144:147], v[164:167], a[192:195], v[144:147]
  TR v[160:161], v4 offset:8192
  v_cvt_pk_bf16_f32 v49, v50, v51
  MF v[148:151], v[164:167], a[196:199], v[148:151]
  TR v[162:163], v4 offset:8448
  v_cvt_pk_bf16_f32 v81, v82, v83
  MF v[152:155], v[164:167], a[200:203], v[152:155]
  v_cvt_pk_bf16_f32 v50, v52, v53
  v_cvt_pk_bf16_f32 v82, v84, v85
  MF v[156:159], v[164:167], a[204:207], v[156:159]
  v_cvt_pk_bf16_f32 v51, v54, v55
  s_waitcnt lgkmcnt(4)
  MF v[128:131], v[168:171], a[208:211], v[128:131]
  TR v[164:165], v4 offset:10240
  v_cvt_pk_bf16_f32 v83, v86, v87
  MF v[132:135], v[168:171], a[212:215], v[132:135]
  TR v[166:167], v4 offset:10496
  v_cvt_pk_bf16_f32 v52, v56, v57
  MF v[136:139], v[168:171], a[216:219], v[136:139]
  v_cvt_pk_bf16_f32 v84, v88, v89
  v_cvt_pk_bf16_f32 v53, v58, v59
  MF v[140:143], v[168:171], a[220:223], v[140:143]
  v_cvt_pk_bf16_f32 v85, v90, v91
  s_waitcnt lgkmcnt(4)
  MF v[144:147], v[172:175], a[208:211], v[144:147]
  TR v[168:169], v4 offset:12288
  v_cvt_pk_bf16_f32 v54, v60, v61
  MF v[148:151], v[172:175], a[212:215], v[148:151]
  TR v[170:171], v4 offset:12544
  v_cvt_pk_bf16_f32 v86, v92, v93
  MF v[152:155], v[172:175], a[216:219], v[152:155]
  v_cvt_pk_bf16_f32 v55, v62, v63
  v_cvt_pk_bf16_f32 v87, v94, v95
  MF v[156:159], v[172:175], a[220:223], v[156:159]
  ds_write_b128 v13, v[32:35]
  s_waitcnt lgkmcnt(5)
  MF v[128:131], v[160:163], a[224:227], v[128:131]
  TR v[172:173], v4 offset:14336
  ds_write_b128 v13, v[36:39] offset:16
  MF v[132:135], v[160:163], a[228:231], v[132:135]
  TR v[174:175], v4 offset:14592
  ds_write_b128 v13, v[48:51] offset:2304
  MF v[136:139], v[160:163], a[232:235], v[136:139]
  ds_write_b128 v13, v[52:55] offset:2320
  TR v[40:41], v14
  MF v[140:143], v[160:163], a[236:239], v[140:143]
  TR v[42:43], v14 offset:2304
  s_waitcnt lgkmcnt(10)
  MF v[144:147], v[164:167], a[224:227], v[144:147]
  TR v[160:161], v4 offset:16384
  TR v[44:45], v14 offset:8
  MF v[148:151], v[164:167], a[228:231], v[148:151]
  TR v[162:163], v4 offset:16640
  TR v[46:47], v14 offset:2312
  MF v[152:155], v[164:167], a[232:235], v[152:155]
  TR v[56:57], v14 offset:16
  TR v[58:59], v14 offset:2320
  MF v[156:159], v[164:167], a[236:239], v[156:159]
  TR v[60:61], v14 offset:24
  s_waitcnt lgkmcnt(15)
  MF v[128:131], v[168:171], a[240:243], v[128:131]
  TR v[164:165], v4 offset:18432
  TR v[62:63], v14 offset:2328
  MF v[132:135], v[168:171], a[244:247], v[132:135]
  TR v[166:167], v4 offset:18688
  s_add_u32 s80, s79, 0
  MF v[136:139], v[168:171], a[248:251], v[136:139]
  s_waitcnt lgkmcnt(10)
  buffer_store_dwordx4 v[40:43], v10, s[16:19], s80 offen sc1
  MF v[140:143], v[168:171], a[252:255], v[140:143]
  s_add_u32 s80, s79, 185344
  MF v[144:147], v[172:175], a[240:243], v[144:147]
  TR v[168:169], v4 offset:20480
  MF v[148:151], v[172:175], a[244:247], v[148:151]
  TR v[170:171], v4 offset:20736
  MF v[152:155], v[172:175], a[248:251], v[152:155]
  s_waitcnt lgkmcnt(8)
  buffer_store_dwordx4 v[44:47], v10, s[16:19], s80 offen sc1
  MF v[156:159], v[172:175], a[252:255], v[156:159]
  s_add_u32 s80, s79, 370688
  MF v[128:131], v[160:163], v[176:179], v[128:131]
  TR v[172:173], v4 offset:22528
  MF v[132:135], v[160:163], v[180:183], v[132:135]
  TR v[174:175], v4 offset:22784
  MF v[136:139], v[160:163], v[184:187], v[136:139]
  s_waitcnt lgkmcnt(8)
  buffer_store_dwordx4 v[56:59], v10, s[16:19], s80 offen sc1
  MF v[140:143], v[160:163], v[188:191], v[140:143]
  s_add_u32 s80, s79, 556032
  s_waitcnt lgkmcnt(4)
  MF v[144:147], v[164:167], v[176:179], v[144:147]
  buffer_store_dwordx4 v[60:63], v10, s[16:19], s80 offen sc1
  MF v[148:151], v[164:167], v[180:183], v[148:151]
  ds_write_b128 v13, v[64:67]
  ds_write_b128 v13, v[68:71] offset:16
  MF v[152:155], v[164:167], v[184:187], v[152:155]
  ds_write_b128 v13, v[80:83] offset:2304
  ds_write_b128 v13, v[84:87] offset:2320
  MF v[156:159], v[164:167], v[188:191], v[156:159]
  TR v[72:73], v14
  s_waitcnt lgkmcnt(7)
  MF v[128:131], v[168:171], v[192:195], v[128:131]
  TR v[74:75], v14 offset:2304
  TR v[76:77], v14 offset:8
  MF v[132:135], v[168:171], v[196:199], v[132:135]
  TR v[78:79], v14 offset:2312
  TR v[88:89], v14 offset:16
  MF v[136:139], v[168:171], v[200:203], v[136:139]
  TR v[90:91], v14 offset:2320
  TR v[92:93], v14 offset:24
  MF v[140:143], v[168:171], v[204:207], v[140:143]
  TR v[94:95], v14 offset:2328
  s_waitcnt lgkmcnt(12)
  MF v[144:147], v[172:175], v[192:195], v[144:147]
  s_add_u32 s80, s79, 1024
  MF v[148:151], v[172:175], v[196:199], v[148:151]
  MF v[152:155], v[172:175], v[200:203], v[152:155]
  MF v[156:159], v[172:175], v[204:207], v[156:159]
  s_waitcnt lgkmcnt(6)
  buffer_store_dwordx4 v[72:75], v10, s[16:19], s80 offen sc1
  s_add_u32 s80, s79, 186368
  s_waitcnt lgkmcnt(4)
  buffer_store_dwordx4 v[76:79], v10, s[16:19], s80 offen sc1
  s_add_u32 s80, s79, 371712
  s_waitcnt lgkmcnt(2)
  buffer_store_dwordx4 v[88:91], v10, s[16:19], s80 offen sc1
  s_add_u32 s80, s79, 557056
  s_waitcnt lgkmcnt(0)
  buffer_store_dwordx4 v[92:95], v10, s[16:19], s80 offen sc1
  v_max_f32 v96, 0, v96
  v_max_f32 v97, 0, v97
  v_max_f32 v98, 0, v98
  v_max_f32 v99, 0, v99
  v_mul_f32 v96, v96, v112
  v_mul_f32 v97, v97, v113
  v_mul_f32 v98, v98, v114
  v_mul_f32 v99, v99, v115
  v_cvt_pk_bf16_f32 v248, v96, v97
  v_cvt_pk_bf16_f32 v249, v98, v99
  v_max_f32 v100, 0, v100
  v_max_f32 v101, 0, v101
  v_max_f32 v102, 0, v102
  v_max_f32 v103, 0, v103
  v_mul_f32 v100, v100, v116
  v_mul_f32 v101, v101, v117
  v_mul_f32 v102, v102, v118
  v_mul_f32 v103, v103, v119
  v_cvt_pk_bf16_f32 v250, v100, v101
  v_cvt_pk_bf16_f32 v251, v102, v103
  v_max_f32 v104, 0, v104
  v_max_f32 v105, 0, v105
  v_max_f32 v106, 0, v106
  v_max_f32 v107, 0, v107
  v_mul_f32 v104, v104, v120
  v_mul_f32 v105, v105, v121
  v_mul_f32 v106, v106, v122
  v_mul_f32 v107, v107, v123
  v_cvt_pk_bf16_f32 v252, v104, v105
  v_cvt_pk_bf16_f32 v253, v106, v107
  v_max_f32 v108, 0, v108
  v_max_f32 v109, 0, v109
  v_max_f32 v110, 0, v110
  v_max_f32 v111, 0, v111
  v_mul_f32 v108, v108, v124
  v_mul_f32 v109, v109, v125
  v_mul_f32 v110, v110, v126
  v_mul_f32 v111, v111, v127
  v_cvt_pk_bf16_f32 v254, v108, v109
  v_cvt_pk_bf16_f32 v255, v110, v111
  s_cmp_eq_u32 s32, 0
  s_cselect_b32 s80, 32636928, 1073741824
  v_lshlrev_b32 v31, 4, v1
  v_add_u32 v31, s80, v31
  BL4 v[224:227], v31, s[16:19], 0 offen sc1
  s_mul_i32 s88, s34, 45
  s_add_u32 s88, s88, s35
  s_add_u32 s88, s88, 37
  s_lshl_b32 s88, s88, 10
  v_max_f32 v128, 0, v128
  v_max_f32 v129, 0, v129
  v_max_f32 v130, 0, v130
  v_max_f32 v131, 0, v131
  v_mul_f32 v128, v128, v144
  v_mul_f32 v129, v129, v145
  v_mul_f32 v130, v130, v146
  v_mul_f32 v131, v131, v147
  v_mov_b32 v240, v248
  v_mov_b32 v241, v249
  v_cvt_pk_bf16_f32 v242, v128, v129
  v_cvt_pk_bf16_f32 v243, v130, v131
  s_add_u32 s80, s88, 0
  buffer_store_dwordx4 v[240:243], v10, s[16:19], s80 offen sc1
  v_max_f32 v132, 0, v132
  v_max_f32 v133, 0, v133
  v_max_f32 v134, 0, v134
  v_max_f32 v135, 0, v135
  v_mul_f32 v132, v132, v148
  v_mul_f32 v133, v133, v149
  v_mul_f32 v134, v134, v150
  v_mul_f32 v135, v135, v151
  v_mov_b32 v244, v250
  v_mov_b32 v245, v251
  v_cvt_pk_bf16_f32 v246, v132, v133
  v_cvt_pk_bf16_f32 v247, v134, v135
  s_add_u32 s80, s88, 185344
  buffer_store_dwordx4 v[244:247], v10, s[16:19], s80 offen sc1
  v_max_f32 v136, 0, v136
  v_max_f32 v137, 0, v137
  v_max_f32 v138, 0, v138
  v_max_f32 v139, 0, v139
  v_mul_f32 v136, v136, v152
  v_mul_f32 v137, v137, v153
  v_mul_f32 v138, v138, v154
  v_mul_f32 v139, v139, v155
  v_mov_b32 v240, v252
  v_mov_b32 v241, v253
  v_cvt_pk_bf16_f32 v242, v136, v137
  v_cvt_pk_bf16_f32 v243, v138, v139
  s_add_u32 s80, s88, 370688
  buffer_store_dwordx4 v[240:243], v10, s[16:19], s80 offen sc1
  v_max_f32 v140, 0, v140
  v_max_f32 v141, 0, v141
  v_max_f32 v142, 0, v142
  v_max_f32 v143, 0, v143
  v_mul_f32 v140, v140, v156
  v_mul_f32 v141, v141, v157
  v_mul_f32 v142, v142, v158
  v_mul_f32 v143, v143, v159
  v_mov_b32 v244, v254
  v_mov_b32 v245, v255
  v_cvt_pk_bf16_f32 v246, v140, v141
  v_cvt_pk_bf16_f32 v247, v142, v143
  s_add_u32 s80, s88, 556032
  buffer_store_dwordx4 v[244:247], v10, s[16:19], s80 offen sc1
  s_branch P2_START
K1_TA1_MAIN:
  s_add_u32 m0, s37, 16384
  s_add_u32 s89, s42, 0
  BL4 v8, s[8:11], s89 offen lds
  s_add_u32 m0, s38, 24576
  s_nop 0
  BL4 v9, s[12:15], s60 offen lds
  s_add_u32 m0, s37, 20480
  s_add_u32 s89, s43, 0
  BL4 v8, s[8:11], s89 offen lds
  s_add_u32 m0, s38, 25600
  s_nop 0
  BL4 v27, s[12:15], s60 offen lds
  s_add_u32 s90, s60, 0
  s_add_u32 m0, s91, 8192
  s_nop 0
  BL4 v30, s[4:7], s90 offen lds
  s_add_u32 m0, s91, 9216
  s_nop 0
  BL4 v31, s[4:7], s90 offen lds
  s_add_u32 s90, s60, 4608
  s_add_u32 m0, s91, 10240
  s_nop 0
  BL4 v30, s[4:7], s90 offen lds
  s_add_u32 m0, s91, 11264
  s_nop 0
  BL4 v31, s[4:7], s90 offen lds
  s_add_u32 s90, s60, 9216
  s_add_u32 m0, s91, 12288
  s_nop 0
  BL4 v30, s[4:7], s90 offen lds
  s_add_u32 m0, s91, 13312
  s_nop 0
  BL4 v31, s[4:7], s90 offen lds
  s_and_b32 s17, s17, 65535
  s_mov_b32 s18, 67108864
  s_mov_b32 s19, 131072
  s_and_b32 s21, s21, 65535
  s_mov_b32 s22, 256
  s_mov_b32 s23, 131072
  s_and_b32 s25, s25, 65535
  s_mov_b32 s26, 1152
  s_mov_b32 s27, 131072
  s_lshl_b32 s80, s33, 4
  s_lshl_b32 s81, s32, 2
  s_add_u32 s80, s80, s81
  s_mul_i32 s80, s80, 185344
  v_lshlrev_b32 v10, 4, v1
  v_add_u32 v10, s80, v10
  s_add_u32 s80, s39, 0
  s_lshl_b32 s80, s80, 5
  v_and_b32 v242, 15, v1
  v_lshlrev_b32 v242, 1, v242
  v_add_u32 v242, s80, v242
  s_mov_b32 s28, s92
  s_and_b32 s29, s93, 65535
  s_mov_b32 s30, 1152
  s_mov_b32 s31, 131072
  buffer_load_ushort v234, v242, s[28:31], 0 offen
  s_mov_b32 s28, s94
  s_and_b32 s29, s95, 65535
  s_mov_b32 s30, 1152
  s_mov_b32 s31, 131072
  buffer_load_ushort v235, v242, s[28:31], 0 offen
  s_mov_b32 s28, s96
  s_and_b32 s29, s97, 65535
  s_mov_b32 s30, 1152
  s_mov_b32 s31, 131072
  buffer_load_ushort v236, v242, s[28:31], 0 offen
  v_lshrrev_b32 v26, 4, v1
  v_and_b32 v255, 15, v1
  s_lshl_b32 s80, s32, 7
  s_add_u32 s80, s80, 141312
  v_lshlrev_b32 v240, 3, v255
  v_add_u32 v12, 141312, v240
  v_add_u32 v240, s80, v240
  v_lshlrev_b32 v241, 3, v1
  v_add_u32 v241, 142336, v241
  v_cmp_eq_u32 vcc, 3, v26
  s_nop 1
  v_cndmask_b32 v11, v241, v240, vcc
  s_mul_i32 s80, s32, 4608
  s_add_u32 s80, s80, 122880
  v_mul_u32_u24 v240, 144, v255
  v_lshlrev_b32 v241, 5, v26
  v_add_u32 v240, v240, v241
  v_add_u32 v13, s80, v240
  v_lshlrev_b32 v240, 2, v26
  v_lshrrev_b32 v241, 2, v255
  v_add_u32 v240, v240, v241
  v_mul_u32_u24 v240, 144, v240
  v_and_b32 v241, 3, v255
  v_lshlrev_b32 v241, 5, v241
  v_add_u32 v240, v240, v241
  v_add_u32 v14, s80, v240
  s_lshl_b32 s80, s39, 10
  s_add_u32 s80, s80, 32571392
  v_lshlrev_b32 v240, 3, v255
  v_add_u32 v15, s80, v240
  s_lshl_b32 s80, s33, 7
  s_cmp_eq_u32 s32, 0
  s_cselect_b32 s80, s80, 1073741824
  v_add_u32 v22, s80, v15
  v_add_u32 v240, 48, v1
  v_and_b32 v240, 63, v240
  v_lshlrev_b32 v16, 2, v240
  v_add_u32 v240, 32, v1
  v_and_b32 v240, 63, v240
  v_lshlrev_b32 v17, 2, v240
  v_cmp_le_u32 vcc, 1, v26
  v_mov_b32 v240, 0
  v_mov_b32 v241, 1.0
  v_cndmask_b32 v18, v240, v241, vcc
  v_cmp_le_u32 vcc, 2, v26
  s_nop 1
  v_cndmask_b32 v19, v240, v241, vcc
  v_lshlrev_b32 v240, 4, v26
  v_cvt_f32_u32 v20, v240
  s_lshl_b32 s80, s32, 6
  v_add_u32 v240, s80, v240
  v_cvt_f32_u32 v21, v240
  s_cmp_eq_u32 s32, 1
  s_cselect_b32 s76, 0x3f800000, 0
  s_cmp_eq_u32 s32, 2
  s_cselect_b32 s77, 0x3f800000, 0
  s_cmp_eq_u32 s32, 3
  s_cselect_b32 s78, 0x3f800000, 0
  s_mul_i32 s80, s34, 5
  s_add_u32 s80, s80, s35
  s_lshl_b32 s80, s80, 7
  s_add_u32 s80, s80, 32638976
  v_lshlrev_b32 v240, 2, v1
  v_add_u32 v240, s80, v240
  v_mov_b32 v241, 1073741824
  s_cmp_eq_u32 s32, 0
  s_cselect_b32 s81, s33, 0
  v_cmp_gt_u32 vcc, s81, v1
  s_nop 1
  v_cndmask_b32 v24, v241, v240, vcc
  s_lshl_b32 s81, s33, 2
  s_add_u32 s80, s80, s81
  s_cmp_eq_u32 s32, 0
  s_cselect_b32 s80, s80, 1073741824
  v_mov_b32 v240, s80
  v_cmp_eq_u32 vcc, 0, v1
  s_nop 1
  v_cndmask_b32 v23, v241, v240, vcc
  s_cmp_eq_u32 s32, 0
  s_cselect_b32 s81, s33, 0
  s_lshl_b32 s86, 1, s81
  s_sub_u32 s86, s86, 1
  s_cmp_eq_u32 s32, 0
  s_cselect_b32 s3, 1024, 0
  s_add_u32 s3, s3, 142336
  s_cmp_eq_u32 s32, 0
  s_cselect_b32 s80, 0, 1073741824
  v_add_u32 v15, s80, v15
  s_mul_i32 s80, s33, 72
  s_lshr_b32 s81, s32, 1
  s_mul_i32 s81, s81, 36
  s_add_u32 s80, s80, s81
  v_add_u32 v25, s80, v1
  s_mov_b32 s81, 9216
  v_mul_lo_u32 v25, v25, s81
  s_lshl_b32 s80, s35, 2
  s_mul_i32 s81, s35, 5
  s_sub_u32 s81, s81, 4
  s_cmp_lt_u32 s35, 4
  s_cselect_b32 s80, s80, s81
  s_mul_i32 s81, s34, 36
  s_add_u32 s80, s80, s81
  s_lshl_b32 s80, s80, 6
  v_add_u32 v25, s80, v25
  v_mov_b32 v232, 1073741824
  v_cmp_gt_u32 vcc, 36, v1
  s_nop 1
  v_cndmask_b32 v25, v232, v25, vcc
  s_waitcnt vmcnt(24)
  ds_read_b128 a[0:3], v252
  ds_read_b128 a[16:19], v253
  s_add_u32 s90, s60, 13824
  s_add_u32 m0, s91, 14336
  s_nop 0
  BL4 v30, s[4:7], s90 offen lds
  s_add_u32 m0, s91, 15360
  s_nop 0
  BL4 v31, s[4:7], s90 offen lds
  s_waitcnt vmcnt(24)
  ds_read_b128 a[4:7], v252 offset:2048
  ds_read_b128 a[20:23], v253 offset:2048
  s_add_u32 s90, s62, 0
  s_add_u32 m0, s91, 0
  s_nop 0
  s_waitcnt lgkmcnt(2)
  BL4 v30, s[4:7], s90 offen lds
  s_add_u32 m0, s91, 1024
  s_nop 0
  BL4 v31, s[4:7], s90 offen lds
  s_waitcnt vmcnt(24)
  ds_read_b128 a[8:11], v252 offset:4096
  ds_read_b128 a[24:27], v253 offset:4096
  s_add_u32 s90, s62, 4608
  s_add_u32 m0, s91, 2048
  s_nop 0
  s_waitcnt lgkmcnt(2)
  BL4 v30, s[4:7], s90 offen lds
  s_add_u32 m0, s91, 3072
  s_nop 0
  BL4 v31, s[4:7], s90 offen lds
  s_waitcnt vmcnt(24)
  ds_read_b128 a[12:15], v252 offset:6144
  ds_read_b128 a[28:31], v253 offset:6144
  s_add_u32 s90, s62, 9216
  s_add_u32 m0, s91, 4096
  s_nop 0
  s_waitcnt lgkmcnt(2)
  BL4 v30, s[4:7], s90 offen lds
  s_add_u32 m0, s91, 5120
  s_nop 0
  BL4 v31, s[4:7], s90 offen lds
  s_waitcnt vmcnt(22)
  s_barrier
  TR v[160:161], v2
  TR v[162:163], v2 offset:256
  TR v[164:165], v2 offset:2048
  TR v[166:167], v2 offset:2304
  TR v[168:169], v4
  TR v[170:171], v4 offset:256
  s_waitcnt lgkmcnt(4)
  MF v[96:99], v[160:163], a[0:3], 0
  TR v[172:173], v4 offset:2048
  MF v[100:103], v[160:163], a[4:7], 0
  TR v[174:175], v4 offset:2304
  MF v[104:107], v[160:163], a[8:11], 0
  s_add_u32 m0, s37, 32768
  s_add_u32 s89, s44, 0
  BL4 v8, s[8:11], s89 offen lds
  MF v[108:111], v[160:163], a[12:15], 0
  s_add_u32 m0, s38, 40960
  s_nop 0
  BL4 v9, s[12:15], s62 offen lds
  s_waitcnt lgkmcnt(4)
  MF v[112:115], v[164:167], a[0:3], 0
  ds_read_b128 v[160:163], v6 offset:8192
  MF v[116:119], v[164:167], a[4:7], 0
  s_cmp_eq_u32 s2, 0
  s_cbranch_scc0 ZSKIP3
  v_mov_b32 v244, 0
  v_mov_b32 v245, 0
  v_mov_b32 v246, 0
  v_mov_b32 v247, 0
  v_lshlrev_b32 v243, 4, v1
  s_add_u32 s80, s32, 0
  s_lshl_b32 s81, s80, 10
  s_add_u32 s81, s81, 32636928
  s_cmp_lt_u32 s80, 14
  s_cselect_b32 s81, s81, 1073741824
  buffer_store_dwordx4 v[244:247], v243, s[16:19], s81 offen sc1
  s_add_u32 s80, s32, 4
  s_lshl_b32 s81, s80, 10
  s_add_u32 s81, s81, 32636928
  s_cmp_lt_u32 s80, 14
  s_cselect_b32 s81, s81, 1073741824
  buffer_store_dwordx4 v[244:247], v243, s[16:19], s81 offen sc1
  s_add_u32 s80, s32, 8
  s_lshl_b32 s81, s80, 10
  s_add_u32 s81, s81, 32636928
  s_cmp_lt_u32 s80, 14
  s_cselect_b32 s81, s81, 1073741824
  buffer_store_dwordx4 v[244:247], v243, s[16:19], s81 offen sc1
  s_add_u32 s80, s32, 12
  s_lshl_b32 s81, s80, 10
  s_add_u32 s81, s81, 32636928
  s_cmp_lt_u32 s80, 14
  s_cselect_b32 s81, s81, 1073741824
  buffer_store_dwordx4 v[244:247], v243, s[16:19], s81 offen sc1
  s_waitcnt vmcnt(0)
ZSKIP3:
  MF v[120:123], v[164:167], a[8:11], 0
  s_waitcnt vmcnt(17)
  ds_read_b128 a[32:35], v252 offset:8192
  MF v[124:127], v[164:167], a[12:15], 0
  ds_read_b128 a[48:51], v253 offset:8192
  s_waitcnt lgkmcnt(5)
  MF v[128:131], v[168:171], a[0:3], 0
  ds_read_b128 v[164:167], v6 offset:10240
  MF v[132:135], v[168:171], a[4:7], 0
  MF v[136:139], v[168:171], a[8:11], 0
  s_add_u32 s90, s62, 13824
  s_add_u32 m0, s91, 6144
  s_nop 0
  BL4 v30, s[4:7], s90 offen lds
  MF v[140:143], v[168:171], a[12:15], 0
  s_add_u32 m0, s91, 7168
  s_nop 0
  BL4 v31, s[4:7], s90 offen lds
  s_waitcnt lgkmcnt(4)
  MF v[144:147], v[172:175], a[0:3], 0
  TR v[168:169], v2 offset:4096
  MF v[148:151], v[172:175], a[4:7], 0
  TR v[170:171], v2 offset:4352
  MF v[152:155], v[172:175], a[8:11], 0
  s_waitcnt vmcnt(17)
  ds_read_b128 a[36:39], v252 offset:10240
  MF v[156:159], v[172:175], a[12:15], 0
  ds_read_b128 a[52:55], v253 offset:10240
  s_add_u32 s90, s64, 0
  s_add_u32 m0, s91, 8192
  s_nop 0
  s_waitcnt lgkmcnt(5)
  BL4 v30, s[4:7], s90 offen lds
  s_add_u32 m0, s91, 9216
  s_nop 0
  BL4 v31, s[4:7], s90 offen lds
  MF v[32:35], a[0:3], v[160:163], 0
  TR v[172:173], v2 offset:6144
  MF v[36:39], a[4:7], v[160:163], 0
  TR v[174:175], v2 offset:6400
  MF v[40:43], a[8:11], v[160:163], 0
  s_add_u32 m0, s37, 36864
  s_add_u32 s89, s45, 0
  BL4 v8, s[8:11], s89 offen lds
  MF v[44:47], a[12:15], v[160:163], 0
  s_add_u32 m0, s38, 41984
  s_nop 0
  BL4 v27, s[12:15], s62 offen lds
  s_waitcnt lgkmcnt(6)
  MF v[48:51], a[0:3], v[164:167], 0
  TR v[160:161], v4 offset:4096
  MF v[52:55], a[4:7], v[164:167], 0
  TR v[162:163], v4 offset:4352
  MF v[56:59], a[8:11], v[164:167], 0
  MF v[60:63], a[12:15], v[164:167], 0
  s_waitcnt lgkmcnt(6)
  MF v[96:99], v[168:171], a[16:19], v[96:99]
  TR v[164:165], v4 offset:6144
  MF v[100:103], v[168:171], a[20:23], v[100:103]
  TR v[166:167], v4 offset:6400
  MF v[104:107], v[168:171], a[24:27], v[104:107]
  s_add_u32 m0, s37, 49152
  s_add_u32 s89, s46, 0
  BL4 v8, s[8:11], s89 offen lds
  MF v[108:111], v[168:171], a[28:31], v[108:111]
  s_add_u32 m0, s38, 57344
  s_nop 0
  BL4 v9, s[12:15], s64 offen lds
  s_waitcnt lgkmcnt(4)
  MF v[112:115], v[172:175], a[16:19], v[112:115]
  ds_read_b128 v[168:171], v7 offset:8192
  MF v[116:119], v[172:175], a[20:23], v[116:119]
  MF v[120:123], v[172:175], a[24:27], v[120:123]
  s_waitcnt vmcnt(21)
  ds_read_b128 a[40:43], v252 offset:12288
  MF v[124:127], v[172:175], a[28:31], v[124:127]
  ds_read_b128 a[56:59], v253 offset:12288
  s_waitcnt lgkmcnt(5)
  MF v[128:131], v[160:163], a[16:19], v[128:131]
  ds_read_b128 v[172:175], v7 offset:10240
  MF v[132:135], v[160:163], a[20:23], v[132:135]
  MF v[136:139], v[160:163], a[24:27], v[136:139]
  s_add_u32 s90, s64, 4608
  s_add_u32 m0, s91, 10240
  s_nop 0
  BL4 v30, s[4:7], s90 offen lds
  MF v[140:143], v[160:163], a[28:31], v[140:143]
  s_add_u32 m0, s91, 11264
  s_nop 0
  BL4 v31, s[4:7], s90 offen lds
  s_waitcnt lgkmcnt(4)
  MF v[144:147], v[164:167], a[16:19], v[144:147]
  s_barrier
  TR v[160:161], v2 offset:16384
  MF v[148:151], v[164:167], a[20:23], v[148:151]
  TR v[162:163], v2 offset:16640
  MF v[152:155], v[164:167], a[24:27], v[152:155]
  s_waitcnt vmcnt(18)
  ds_read_b128 a[44:47], v252 offset:14336
  MF v[156:159], v[164:167], a[28:31], v[156:159]
  ds_read_b128 a[60:63], v253 offset:14336
  s_add_u32 s90, s64, 9216
  s_add_u32 m0, s91, 12288
  s_nop 0
  s_waitcnt lgkmcnt(5)
  BL4 v30, s[4:7], s90 offen lds
  s_add_u32 m0, s91, 13312
  s_nop 0
  BL4 v31, s[4:7], s90 offen lds
  MF v[32:35], a[16:19], v[168:171], v[32:35]
  TR v[164:165], v2 offset:18432
  s_mov_b32 s84, 64
  MF v[36:39], a[20:23], v[168:171], v[36:39]
  TR v[166:167], v2 offset:18688
  MF v[40:43], a[24:27], v[168:171], v[40:43]
  s_add_u32 m0, s37, 53248
  s_add_u32 s89, s47, 0
  BL4 v8, s[8:11], s89 offen lds
  MF v[44:47], a[28:31], v[168:171], v[44:47]
  s_add_u32 m0, s38, 58368
  s_nop 0
  BL4 v27, s[12:15], s64 offen lds
  s_waitcnt lgkmcnt(6)
  MF v[48:51], a[16:19], v[172:175], v[48:51]
  TR v[168:169], v4 offset:16384
  MF v[52:55], a[20:23], v[172:175], v[52:55]
  TR v[170:171], v4 offset:16640
  MF v[56:59], a[24:27], v[172:175], v[56:59]
  buffer_load_dword v233, v25, s[8:11], s84 offen
  MF v[60:63], a[28:31], v[172:175], v[60:63]
  s_waitcnt lgkmcnt(6)
  MF v[96:99], v[160:163], a[32:35], v[96:99]
  TR v[172:173], v4 offset:18432
  MF v[100:103], v[160:163], a[36:39], v[100:103]
  TR v[174:175], v4 offset:18688
  MF v[104:107], v[160:163], a[40:43], v[104:107]
  s_add_u32 m0, s37, 65536
  s_add_u32 s89, s48, 0
  BL4 v8, s[8:11], s89 offen lds
  s_waitcnt lgkmcnt(7)
  MF v[108:111], v[160:163], a[44:47], v[108:111]
  s_add_u32 m0, s38, 73728
  s_nop 0
  BL4 v9, s[12:15], s66 offen lds
  s_waitcnt lgkmcnt(4)
  MF v[112:115], v[164:167], a[32:35], v[112:115]
  ds_read_b128 v[160:163], v6 offset:24576
  MF v[116:119], v[164:167], a[36:39], v[116:119]
  MF v[120:123], v[164:167], a[40:43], v[120:123]
  s_waitcnt vmcnt(23)
  ds_read_b128 a[64:67], v252
  MF v[124:127], v[164:167], a[44:47], v[124:127]
  ds_read_b128 a[80:83], v253
  s_waitcnt lgkmcnt(5)
  MF v[128:131], v[168:171], a[32:35], v[128:131]
  ds_read_b128 v[164:167], v6 offset:26624
  MF v[132:135], v[168:171], a[36:39], v[132:135]
  MF v[136:139], v[168:171], a[40:43], v[136:139]
  s_add_u32 s90, s64, 13824
  s_add_u32 m0, s91, 14336
  s_nop 0
  BL4 v30, s[4:7], s90 offen lds
  MF v[140:143], v[168:171], a[44:47], v[140:143]
  s_add_u32 m0, s91, 15360
  s_nop 0
  BL4 v31, s[4:7], s90 offen lds
  s_waitcnt lgkmcnt(4)
  MF v[144:147], v[172:175], a[32:35], v[144:147]
  TR v[168:169], v2 offset:20480
  MF v[148:151], v[172:175], a[36:39], v[148:151]
  TR v[170:171], v2 offset:20736
  MF v[152:155], v[172:175], a[40:43], v[152:155]
  s_waitcnt vmcnt(23)
  ds_read_b128 a[68:71], v252 offset:2048
  MF v[156:159], v[172:175], a[44:47], v[156:159]
  ds_read_b128 a[84:87], v253 offset:2048
  s_add_u32 s90, s66, 0
  s_add_u32 m0, s91, 0
  s_nop 0
  s_waitcnt lgkmcnt(5)
  BL4 v30, s[4:7], s90 offen lds
  s_add_u32 m0, s91, 1024
  s_nop 0
  BL4 v31, s[4:7], s90 offen lds
  MF v[32:35], a[32:35], v[160:163], v[32:35]
  TR v[172:173], v2 offset:22528
  MF v[36:39], a[36:39], v[160:163], v[36:39]
  TR v[174:175], v2 offset:22784
  MF v[40:43], a[40:43], v[160:163], v[40:43]
  s_add_u32 m0, s37, 69632
  s_add_u32 s89, s49, 0
  BL4 v8, s[8:11], s89 offen lds
  MF v[44:47], a[44:47], v[160:163], v[44:47]
  s_add_u32 m0, s38, 74752
  s_nop 0
  BL4 v27, s[12:15], s66 offen lds
  s_waitcnt lgkmcnt(6)
  MF v[48:51], a[32:35], v[164:167], v[48:51]
  TR v[160:161], v4 offset:20480
  MF v[52:55], a[36:39], v[164:167], v[52:55]
  TR v[162:163], v4 offset:20736
  MF v[56:59], a[40:43], v[164:167], v[56:59]
  MF v[60:63], a[44:47], v[164:167], v[60:63]
  s_waitcnt lgkmcnt(6)
  MF v[96:99], v[168:171], a[48:51], v[96:99]
  TR v[164:165], v4 offset:22528
  MF v[100:103], v[168:171], a[52:55], v[100:103]
  TR v[166:167], v4 offset:22784
  MF v[104:107], v[168:171], a[56:59], v[104:107]
  s_add_u32 m0, s37, 81920
  s_add_u32 s89, s50, 0
  BL4 v8, s[8:11], s89 offen lds
  MF v[108:111], v[168:171], a[60:63], v[108:111]
  s_waitcnt vmcnt(26)
  ds_read_b128 a[72:75], v252 offset:4096
  s_waitcnt lgkmcnt(5)
  MF v[112:115], v[172:175], a[48:51], v[112:115]
  ds_read_b128 v[168:171], v7 offset:24576
  MF v[116:119], v[172:175], a[52:55], v[116:119]
  MF v[120:123], v[172:175], a[56:59], v[120:123]
  ds_read_b128 a[88:91], v253 offset:4096
  MF v[124:127], v[172:175], a[60:63], v[124:127]
  s_add_u32 s90, s66, 4608
  s_add_u32 m0, s91, 2048
  s_nop 0
  BL4 v30, s[4:7], s90 offen lds
  s_waitcnt lgkmcnt(5)
  MF v[128:131], v[160:163], a[48:51], v[128:131]
  ds_read_b128 v[172:175], v7 offset:26624
  MF v[132:135], v[160:163], a[52:55], v[132:135]
  MF v[136:139], v[160:163], a[56:59], v[136:139]
  s_add_u32 m0, s91, 3072
  s_nop 0
  BL4 v31, s[4:7], s90 offen lds
  MF v[140:143], v[160:163], a[60:63], v[140:143]
  s_waitcnt vmcnt(24)
  ds_read_b128 a[76:79], v252 offset:6144
  s_waitcnt lgkmcnt(5)
  MF v[144:147], v[164:167], a[48:51], v[144:147]
  s_waitcnt vmcnt(20)
  s_barrier
  TR v[160:161], v2 offset:32768
  MF v[148:151], v[164:167], a[52:55], v[148:151]
  TR v[162:163], v2 offset:33024
  MF v[152:155], v[164:167], a[56:59], v[152:155]
  ds_read_b128 a[92:95], v253 offset:6144
  MF v[156:159], v[164:167], a[60:63], v[156:159]
  s_add_u32 s90, s66, 9216
  s_add_u32 m0, s91, 4096
  s_nop 0
  s_waitcnt lgkmcnt(5)
  BL4 v30, s[4:7], s90 offen lds
  s_add_u32 m0, s91, 5120
  s_nop 0
  BL4 v31, s[4:7], s90 offen lds
  MF v[32:35], a[48:51], v[168:171], v[32:35]
  TR v[164:165], v2 offset:34816
  MF v[36:39], a[52:55], v[168:171], v[36:39]
  TR v[166:167], v2 offset:35072
  MF v[40:43], a[56:59], v[168:171], v[40:43]
  s_add_u32 m0, s38, 90112
  s_nop 0
  BL4 v9, s[12:15], s68 offen lds
  MF v[44:47], a[60:63], v[168:171], v[44:47]
  s_waitcnt lgkmcnt(6)
  MF v[48:51], a[48:51], v[172:175], v[48:51]
  TR v[168:169], v4 offset:32768
  MF v[52:55], a[52:55], v[172:175], v[52:55]
  TR v[170:171], v4 offset:33024
  MF v[56:59], a[56:59], v[172:175], v[56:59]
  MF v[60:63], a[60:63], v[172:175], v[60:63]
  s_waitcnt lgkmcnt(5)
  MF v[96:99], v[160:163], a[64:67], v[96:99]
  TR v[172:173], v4 offset:34816
  MF v[100:103], v[160:163], a[68:71], v[100:103]
  TR v[174:175], v4 offset:35072
  MF v[104:107], v[160:163], a[72:75], v[104:107]
  s_add_u32 m0, s37, 86016
  s_add_u32 s89, s51, 0
  BL4 v8, s[8:11], s89 offen lds
  MF v[108:111], v[160:163], a[76:79], v[108:111]
  s_add_u32 m0, s38, 91136
  s_nop 0
  BL4 v27, s[12:15], s68 offen lds
  s_waitcnt lgkmcnt(4)
  MF v[112:115], v[164:167], a[64:67], v[112:115]
  ds_read_b128 v[160:163], v6 offset:40960
  MF v[116:119], v[164:167], a[68:71], v[116:119]
  MF v[120:123], v[164:167], a[72:75], v[120:123]
  ds_read_b128 a[96:99], v252 offset:8192
  MF v[124:127], v[164:167], a[76:79], v[124:127]
  ds_read_b128 a[112:115], v253 offset:8192
  s_waitcnt lgkmcnt(5)
  MF v[128:131], v[168:171], a[64:67], v[128:131]
  ds_read_b128 v[164:167], v6 offset:43008
  MF v[132:135], v[168:171], a[68:71], v[132:135]
  MF v[136:139], v[168:171], a[72:75], v[136:139]
  s_add_u32 s90, s66, 13824
  s_add_u32 m0, s91, 6144
  s_nop 0
  BL4 v30, s[4:7], s90 offen lds
  MF v[140:143], v[168:171], a[76:79], v[140:143]
  s_add_u32 m0, s91, 7168
  s_nop 0
  BL4 v31, s[4:7], s90 offen lds
  s_waitcnt lgkmcnt(4)
  MF v[144:147], v[172:175], a[64:67], v[144:147]
  TR v[168:169], v2 offset:36864
  MF v[148:151], v[172:175], a[68:71], v[148:151]
  TR v[170:171], v2 offset:37120
  MF v[152:155], v[172:175], a[72:75], v[152:155]
  s_waitcnt vmcnt(23)
  ds_read_b128 a[100:103], v252 offset:10240
  MF v[156:159], v[172:175], a[76:79], v[156:159]
  ds_read_b128 a[116:119], v253 offset:10240
  s_add_u32 s90, s68, 0
  s_add_u32 m0, s91, 8192
  s_nop 0
  s_waitcnt lgkmcnt(5)
  BL4 v30, s[4:7], s90 offen lds
  s_add_u32 m0, s91, 9216
  s_nop 0
  BL4 v31, s[4:7], s90 offen lds
  MF v[32:35], a[64:67], v[160:163], v[32:35]
  TR v[172:173], v2 offset:38912
  MF v[36:39], a[68:71], v[160:163], v[36:39]
  TR v[174:175], v2 offset:39168
  MF v[40:43], a[72:75], v[160:163], v[40:43]
  s_add_u32 m0, s37, 0
  s_add_u32 s89, s52, 0
  BL4 v8, s[8:11], s89 offen lds
  MF v[44:47], a[76:79], v[160:163], v[44:47]
  s_waitcnt lgkmcnt(6)
  MF v[48:51], a[64:67], v[164:167], v[48:51]
  TR v[160:161], v4 offset:36864
  MF v[52:55], a[68:71], v[164:167], v[52:55]
  TR v[162:163], v4 offset:37120
  MF v[56:59], a[72:75], v[164:167], v[56:59]
  MF v[60:63], a[76:79], v[164:167], v[60:63]
  s_waitcnt lgkmcnt(6)
  MF v[96:99], v[168:171], a[80:83], v[96:99]
  TR v[164:165], v4 offset:38912
  MF v[100:103], v[168:171], a[84:87], v[100:103]
  TR v[166:167], v4 offset:39168
  MF v[104:107], v[168:171], a[88:91], v[104:107]
  s_add_u32 m0, s38, 8192
  s_nop 0
  BL4 v9, s[12:15], s70 offen lds
  MF v[108:111], v[168:171], a[92:95], v[108:111]
  s_waitcnt vmcnt(25)
  ds_read_b128 a[104:107], v252 offset:12288
  s_waitcnt lgkmcnt(5)
  MF v[112:115], v[172:175], a[80:83], v[112:115]
  ds_read_b128 v[168:171], v7 offset:40960
  MF v[116:119], v[172:175], a[84:87], v[116:119]
  MF v[120:123], v[172:175], a[88:91], v[120:123]
  ds_read_b128 a[120:123], v253 offset:12288
  MF v[124:127], v[172:175], a[92:95], v[124:127]
  s_add_u32 s90, s68, 4608
  s_add_u32 m0, s91, 10240
  s_nop 0
  BL4 v30, s[4:7], s90 offen lds
  s_waitcnt lgkmcnt(5)
  MF v[128:131], v[160:163], a[80:83], v[128:131]
  ds_read_b128 v[172:175], v7 offset:43008
  MF v[132:135], v[160:163], a[84:87], v[132:135]
  MF v[136:139], v[160:163], a[88:91], v[136:139]
  s_add_u32 m0, s91, 11264
  s_nop 0
  BL4 v31, s[4:7], s90 offen lds
  MF v[140:143], v[160:163], a[92:95], v[140:143]
  s_waitcnt vmcnt(20)
  ds_read_b128 a[108:111], v252 offset:14336
  s_waitcnt lgkmcnt(5)
  MF v[144:147], v[164:167], a[80:83], v[144:147]
  s_barrier
  TR v[160:161], v2 offset:49152
  MF v[148:151], v[164:167], a[84:87], v[148:151]
  TR v[162:163], v2 offset:49408
  MF v[152:155], v[164:167], a[88:91], v[152:155]
  ds_read_b128 a[124:127], v253 offset:14336
  MF v[156:159], v[164:167], a[92:95], v[156:159]
  s_add_u32 s90, s68, 9216
  s_add_u32 m0, s91, 12288
  s_nop 0
  s_waitcnt lgkmcnt(5)
  BL4 v30, s[4:7], s90 offen lds
  s_add_u32 m0, s91, 13312
  s_nop 0
  BL4 v31, s[4:7], s90 offen lds
  MF v[32:35], a[80:83], v[168:171], v[32:35]
  TR v[164:165], v2 offset:51200
  MF v[36:39], a[84:87], v[168:171], v[36:39]
  TR v[166:167], v2 offset:51456
  MF v[40:43], a[88:91], v[168:171], v[40:43]
  s_add_u32 m0, s37, 4096
  s_add_u32 s89, s53, 0
  BL4 v8, s[8:11], s89 offen lds
  MF v[44:47], a[92:95], v[168:171], v[44:47]
  s_waitcnt lgkmcnt(6)
  MF v[48:51], a[80:83], v[172:175], v[48:51]
  TR v[168:169], v4 offset:49152
  s_or_b32 s80, s2, s32
  MF v[52:55], a[84:87], v[172:175], v[52:55]
  TR v[170:171], v4 offset:49408
  s_cmp_eq_u32 s80, 0
  s_cselect_b32 s80, 0, 1073741824
  MF v[56:59], a[88:91], v[172:175], v[56:59]
  v_mov_b32 v229, s80
  v_mov_b32 v230, 1073741824
  MF v[60:63], a[92:95], v[172:175], v[60:63]
  s_waitcnt lgkmcnt(5)
  MF v[96:99], v[160:163], a[96:99], v[96:99]
  TR v[172:173], v4 offset:51200
  MF v[100:103], v[160:163], a[100:103], v[100:103]
  TR v[174:175], v4 offset:51456
  MF v[104:107], v[160:163], a[104:107], v[104:107]
  s_add_u32 m0, s38, 9216
  s_nop 0
  BL4 v27, s[12:15], s70 offen lds
  MF v[108:111], v[160:163], a[108:111], v[108:111]
  s_waitcnt vmcnt(22)
  ds_read_b128 a[128:131], v252
  s_waitcnt lgkmcnt(5)
  MF v[112:115], v[164:167], a[96:99], v[112:115]
  ds_read_b128 v[160:163], v6 offset:57344
  MF v[116:119], v[164:167], a[100:103], v[116:119]
  v_cmp_eq_u32 vcc, 0, v1
  s_nop 1
  v_cndmask_b32 v229, v230, v229, vcc
  MF v[120:123], v[164:167], a[104:107], v[120:123]
  ds_read_b128 a[144:147], v253
  MF v[124:127], v[164:167], a[108:111], v[124:127]
  s_add_u32 s90, s68, 13824
  s_add_u32 m0, s91, 14336
  s_nop 0
  BL4 v30, s[4:7], s90 offen lds
  s_waitcnt lgkmcnt(5)
  MF v[128:131], v[168:171], a[96:99], v[128:131]
  ds_read_b128 v[164:167], v6 offset:59392
  v_mov_b32 v230, 1
  MF v[132:135], v[168:171], a[100:103], v[132:135]
  buffer_store_dword v230, v229, s[20:23], 0 offen sc1
  MF v[136:139], v[168:171], a[104:107], v[136:139]
  s_add_u32 m0, s91, 15360
  s_nop 0
  BL4 v31, s[4:7], s90 offen lds
  MF v[140:143], v[168:171], a[108:111], v[140:143]
  s_waitcnt vmcnt(20)
  ds_read_b128 a[132:135], v252 offset:2048
  s_waitcnt lgkmcnt(5)
  MF v[144:147], v[172:175], a[96:99], v[144:147]
  TR v[168:169], v2 offset:53248
  v_lshlrev_b32 v234, 16, v234
  MF v[148:151], v[172:175], a[100:103], v[148:151]
  TR v[170:171], v2 offset:53504
  v_lshlrev_b32 v235, 16, v235
  MF v[152:155], v[172:175], a[104:107], v[152:155]
  ds_read_b128 a[148:151], v253 offset:2048
  MF v[156:159], v[172:175], a[108:111], v[156:159]
  s_add_u32 s90, s70, 0
  s_add_u32 m0, s91, 0
  s_nop 0
  s_waitcnt lgkmcnt(5)
  BL4 v30, s[4:7], s90 offen lds
  s_add_u32 m0, s91, 1024
  s_nop 0
  BL4 v31, s[4:7], s90 offen lds
  MF v[32:35], a[96:99], v[160:163], v[32:35]
  TR v[172:173], v2 offset:55296
  v_lshlrev_b32 v236, 16, v236
  MF v[36:39], a[100:103], v[160:163], v[36:39]
  TR v[174:175], v2 offset:55552
  v_mul_f32 v236, 0x3fb8aa3b, v236
  MF v[40:43], a[104:107], v[160:163], v[40:43]
  v_exp_f32 v236, v236
  s_nop 0
  v_cvt_pk_bf16_f32 v236, v236, v236
  MF v[44:47], a[108:111], v[160:163], v[44:47]
  v_lshlrev_b32 v236, 16, v236
  s_waitcnt lgkmcnt(6)
  MF v[48:51], a[96:99], v[164:167], v[48:51]
  TR v[160:161], v4 offset:53248
  v_mul_f32 v234, v236, v234
  MF v[52:55], a[100:103], v[164:167], v[52:55]
  TR v[162:163], v4 offset:53504
  v_mul_f32 v235, v236, v235
  MF v[56:59], a[104:107], v[164:167], v[56:59]
  v_mul_f32 v208, 0x3fb8aa3b, v234
  v_mul_f32 v209, 0x3e22f983, v235
  MF v[60:63], a[108:111], v[164:167], v[60:63]
  v_exp_f32 v210, v208
  s_waitcnt lgkmcnt(5)
  MF v[96:99], v[168:171], a[112:115], v[96:99]
  TR v[164:165], v4 offset:55296
  v_fract_f32 v241, v209
  MF v[100:103], v[168:171], a[116:119], v[100:103]
  TR v[166:167], v4 offset:55552
  v_cos_f32 v240, v241
  MF v[104:107], v[168:171], a[120:123], v[104:107]
  s_waitcnt vmcnt(20)
  ds_read_b128 a[136:139], v252 offset:4096
  MF v[108:111], v[168:171], a[124:127], v[108:111]
  ds_read_b128 a[152:155], v253 offset:4096
  s_waitcnt lgkmcnt(6)
  MF v[112:115], v[172:175], a[112:115], v[112:115]
  ds_read_b128 v[168:171], v7 offset:57344
  v_sin_f32 v241, v241
  MF v[116:119], v[172:175], a[116:119], v[116:119]
  v_mul_f32 v211, v210, v241
  v_mul_f32 v210, v210, v240
  MF v[120:123], v[172:175], a[120:123], v[120:123]
  s_add_u32 s90, s70, 4608
  s_add_u32 m0, s91, 2048
  s_nop 0
  BL4 v30, s[4:7], s90 offen lds
  MF v[124:127], v[172:175], a[124:127], v[124:127]
  s_add_u32 m0, s91, 3072
  s_nop 0
  BL4 v31, s[4:7], s90 offen lds
  s_waitcnt lgkmcnt(5)
  MF v[128:131], v[160:163], a[112:115], v[128:131]
  ds_read_b128 v[172:175], v7 offset:59392
  v_mul_f32 v240, 0x41800000, v208
  MF v[132:135], v[160:163], a[116:119], v[132:135]
  v_mul_f32 v241, 0x41800000, v209
  v_exp_f32 v214, v240
  MF v[136:139], v[160:163], a[120:123], v[136:139]
  s_waitcnt vmcnt(17)
  ds_read_b128 a[140:143], v252 offset:6144
  MF v[140:143], v[160:163], a[124:127], v[140:143]
  ds_read_b128 a[156:159], v253 offset:6144
  s_waitcnt lgkmcnt(6)
  MF v[144:147], v[164:167], a[112:115], v[144:147]
  s_barrier
  TR v[160:161], v3 offset:4096
  v_fract_f32 v241, v241
  MF v[148:151], v[164:167], a[116:119], v[148:151]
  TR v[162:163], v3 offset:4352
  v_mul_f32 v214, v214, v18
  MF v[152:155], v[164:167], a[120:123], v[152:155]
  s_add_u32 s90, s70, 9216
  s_add_u32 m0, s91, 4096
  s_nop 0
  s_waitcnt lgkmcnt(6)
  BL4 v30, s[4:7], s90 offen lds
  MF v[156:159], v[164:167], a[124:127], v[156:159]
  s_add_u32 m0, s91, 5120
  s_nop 0
  BL4 v31, s[4:7], s90 offen lds
  s_waitcnt lgkmcnt(5)
  MF v[32:35], a[112:115], v[168:171], v[32:35]
  TR v[164:165], v3 offset:6144
  v_cos_f32 v240, v241
  MF v[36:39], a[116:119], v[168:171], v[36:39]
  TR v[166:167], v3 offset:6400
  v_sin_f32 v241, v241
  MF v[40:43], a[120:123], v[168:171], v[40:43]
  v_mul_f32 v215, v214, v241
  v_mul_f32 v214, v214, v240
  MF v[44:47], a[124:127], v[168:171], v[44:47]
  s_waitcnt lgkmcnt(6)
  MF v[48:51], a[112:115], v[172:175], v[48:51]
  TR v[168:169], v5 offset:4096
  MF v[52:55], a[116:119], v[172:175], v[52:55]
  TR v[170:171], v5 offset:4352
  MF v[56:59], a[120:123], v[172:175], v[56:59]
  MF v[60:63], a[124:127], v[172:175], v[60:63]
  s_waitcnt lgkmcnt(4)
  MF v[96:99], v[160:163], a[128:131], v[96:99]
  TR v[172:173], v5 offset:6144
  MF v[100:103], v[160:163], a[132:135], v[100:103]
  TR v[174:175], v5 offset:6400
  MF v[104:107], v[160:163], a[136:139], v[104:107]
  s_add_u32 m0, s37, 16384
  s_add_u32 s89, s54, 0
  BL4 v8, s[8:11], s89 offen lds
  MF v[108:111], v[160:163], a[140:143], v[108:111]
  s_add_u32 m0, s38, 32768
  s_nop 0
  BL4 v9, s[12:15], s72 offen lds
  s_waitcnt lgkmcnt(4)
  MF v[112:115], v[164:167], a[128:131], v[112:115]
  ds_read_b128 v[160:163], v28 offset:12288
  MF v[116:119], v[164:167], a[132:135], v[116:119]
  MF v[120:123], v[164:167], a[136:139], v[120:123]
  s_waitcnt vmcnt(19)
  ds_read_b128 a[160:163], v252 offset:8192
  MF v[124:127], v[164:167], a[140:143], v[124:127]
  ds_read_b128 a[176:179], v253 offset:8192
  s_waitcnt lgkmcnt(5)
  MF v[128:131], v[168:171], a[128:131], v[128:131]
  ds_read_b128 v[164:167], v28 offset:14336
  MF v[132:135], v[168:171], a[132:135], v[132:135]
  MF v[136:139], v[168:171], a[136:139], v[136:139]
  s_add_u32 s90, s70, 13824
  s_add_u32 m0, s91, 6144
  s_nop 0
  BL4 v30, s[4:7], s90 offen lds
  MF v[140:143], v[168:171], a[140:143], v[140:143]
  s_add_u32 m0, s91, 7168
  s_nop 0
  BL4 v31, s[4:7], s90 offen lds
  s_waitcnt lgkmcnt(4)
  MF v[144:147], v[172:175], a[128:131], v[144:147]
  TR v[168:169], v3 offset:8192
  MF v[148:151], v[172:175], a[132:135], v[148:151]
  TR v[170:171], v3 offset:8448
  MF v[152:155], v[172:175], a[136:139], v[152:155]
  s_waitcnt vmcnt(17)
  ds_read_b128 a[164:167], v252 offset:10240
  MF v[156:159], v[172:175], a[140:143], v[156:159]
  ds_read_b128 a[180:183], v253 offset:10240
  s_add_u32 s90, s72, 0
  s_add_u32 m0, s91, 8192
  s_nop 0
  s_waitcnt lgkmcnt(5)
  BL4 v30, s[4:7], s90 offen lds
  s_add_u32 m0, s91, 9216
  s_nop 0
  BL4 v31, s[4:7], s90 offen lds
  MF v[32:35], a[128:131], v[160:163], v[32:35]
  TR v[172:173], v3 offset:10240
  MF v[36:39], a[132:135], v[160:163], v[36:39]
  TR v[174:175], v3 offset:10496
  MF v[40:43], a[136:139], v[160:163], v[40:43]
  s_add_u32 m0, s37, 20480
  s_add_u32 s89, s55, 0
  BL4 v8, s[8:11], s89 offen lds
  MF v[44:47], a[140:143], v[160:163], v[44:47]
  s_add_u32 m0, s38, 33792
  s_nop 0
  BL4 v27, s[12:15], s72 offen lds
  s_waitcnt lgkmcnt(6)
  MF v[48:51], a[128:131], v[164:167], v[48:51]
  TR v[160:161], v5 offset:8192
  MF v[52:55], a[132:135], v[164:167], v[52:55]
  TR v[162:163], v5 offset:8448
  MF v[56:59], a[136:139], v[164:167], v[56:59]
  MF v[60:63], a[140:143], v[164:167], v[60:63]
  s_waitcnt lgkmcnt(6)
  MF v[96:99], v[168:171], a[144:147], v[96:99]
  TR v[164:165], v5 offset:10240
  MF v[100:103], v[168:171], a[148:151], v[100:103]
  TR v[166:167], v5 offset:10496
  MF v[104:107], v[168:171], a[152:155], v[104:107]
  s_add_u32 m0, s37, 24576
  s_add_u32 s89, s56, 0
  BL4 v8, s[8:11], s89 offen lds
  MF v[108:111], v[168:171], a[156:159], v[108:111]
  s_add_u32 m0, s38, 40960
  s_nop 0
  BL4 v9, s[12:15], s74 offen lds
  s_waitcnt lgkmcnt(4)
  MF v[112:115], v[172:175], a[144:147], v[112:115]
  ds_read_b128 v[168:171], v29 offset:12288
  MF v[116:119], v[172:175], a[148:151], v[116:119]
  MF v[120:123], v[172:175], a[152:155], v[120:123]
  s_waitcnt vmcnt(21)
  ds_read_b128 a[168:171], v252 offset:12288
  MF v[124:127], v[172:175], a[156:159], v[124:127]
  ds_read_b128 a[184:187], v253 offset:12288
  s_waitcnt lgkmcnt(5)
  MF v[128:131], v[160:163], a[144:147], v[128:131]
  ds_read_b128 v[172:175], v29 offset:14336
  MF v[132:135], v[160:163], a[148:151], v[132:135]
  MF v[136:139], v[160:163], a[152:155], v[136:139]
  s_add_u32 s90, s72, 4608
  s_add_u32 m0, s91, 10240
  s_nop 0
  BL4 v30, s[4:7], s90 offen lds
  MF v[140:143], v[160:163], a[156:159], v[140:143]
  s_add_u32 m0, s91, 11264
  s_nop 0
  BL4 v31, s[4:7], s90 offen lds
  s_waitcnt lgkmcnt(4)
  MF v[144:147], v[164:167], a[144:147], v[144:147]
  s_barrier
  TR v[160:161], v3 offset:20480
  MF v[148:151], v[164:167], a[148:151], v[148:151]
  TR v[162:163], v3 offset:20736
  MF v[152:155], v[164:167], a[152:155], v[152:155]
  s_waitcnt vmcnt(18)
  ds_read_b128 a[172:175], v252 offset:14336
  MF v[156:159], v[164:167], a[156:159], v[156:159]
  ds_read_b128 a[188:191], v253 offset:14336
  s_add_u32 s90, s72, 9216
  s_add_u32 m0, s91, 12288
  s_nop 0
  s_waitcnt lgkmcnt(5)
  BL4 v30, s[4:7], s90 offen lds
  s_add_u32 m0, s91, 13312
  s_nop 0
  BL4 v31, s[4:7], s90 offen lds
  MF v[32:35], a[144:147], v[168:171], v[32:35]
  TR v[164:165], v3 offset:22528
  MF v[36:39], a[148:151], v[168:171], v[36:39]
  TR v[166:167], v3 offset:22784
  MF v[40:43], a[152:155], v[168:171], v[40:43]
  s_add_u32 m0, s37, 28672
  s_add_u32 s89, s57, 0
  BL4 v8, s[8:11], s89 offen lds
  MF v[44:47], a[156:159], v[168:171], v[44:47]
  s_add_u32 m0, s38, 41984
  s_nop 0
  BL4 v27, s[12:15], s74 offen lds
  s_waitcnt lgkmcnt(6)
  MF v[48:51], a[144:147], v[172:175], v[48:51]
  TR v[168:169], v5 offset:20480
  MF v[52:55], a[148:151], v[172:175], v[52:55]
  TR v[170:171], v5 offset:20736
  MF v[56:59], a[152:155], v[172:175], v[56:59]
  MF v[60:63], a[156:159], v[172:175], v[60:63]
  s_waitcnt lgkmcnt(6)
  MF v[96:99], v[160:163], a[160:163], v[96:99]
  TR v[172:173], v5 offset:22528
  MF v[100:103], v[160:163], a[164:167], v[100:103]
  TR v[174:175], v5 offset:22784
  MF v[104:107], v[160:163], a[168:171], v[104:107]
  s_waitcnt vmcnt(20)
  ds_read_b128 a[192:195], v252
  s_waitcnt lgkmcnt(8)
  MF v[108:111], v[160:163], a[172:175], v[108:111]
  ds_read_b128 a[208:211], v253
  s_waitcnt lgkmcnt(6)
  MF v[112:115], v[164:167], a[160:163], v[112:115]
  ds_read_b128 v[160:163], v28 offset:28672
  MF v[116:119], v[164:167], a[164:167], v[116:119]
  MF v[120:123], v[164:167], a[168:171], v[120:123]
  s_add_u32 s90, s72, 13824
  s_add_u32 m0, s91, 14336
  s_nop 0
  BL4 v30, s[4:7], s90 offen lds
  MF v[124:127], v[164:167], a[172:175], v[124:127]
  s_add_u32 m0, s91, 15360
  s_nop 0
  BL4 v31, s[4:7], s90 offen lds
  s_waitcnt lgkmcnt(5)
  MF v[128:131], v[168:171], a[160:163], v[128:131]
  ds_read_b128 v[164:167], v28 offset:30720
  MF v[132:135], v[168:171], a[164:167], v[132:135]
  MF v[136:139], v[168:171], a[168:171], v[136:139]
  s_waitcnt vmcnt(20)
  ds_read_b128 a[196:199], v252 offset:2048
  MF v[140:143], v[168:171], a[172:175], v[140:143]
  ds_read_b128 a[212:215], v253 offset:2048
  s_waitcnt lgkmcnt(6)
  MF v[144:147], v[172:175], a[160:163], v[144:147]
  TR v[168:169], v3 offset:24576
  s_mov_b32 s84, 128
  MF v[148:151], v[172:175], a[164:167], v[148:151]
  TR v[170:171], v3 offset:24832
  MF v[152:155], v[172:175], a[168:171], v[152:155]
  s_add_u32 s90, s74, 0
  s_add_u32 m0, s91, 0
  s_nop 0
  s_waitcnt lgkmcnt(6)
  BL4 v30, s[4:7], s90 offen lds
  MF v[156:159], v[172:175], a[172:175], v[156:159]
  s_add_u32 m0, s91, 1024
  s_nop 0
  BL4 v31, s[4:7], s90 offen lds
  s_waitcnt lgkmcnt(5)
  MF v[32:35], a[160:163], v[160:163], v[32:35]
  TR v[172:173], v3 offset:26624
  MF v[36:39], a[164:167], v[160:163], v[36:39]
  TR v[174:175], v3 offset:26880
  MF v[40:43], a[168:171], v[160:163], v[40:43]
  buffer_load_dword v233, v25, s[8:11], s84 offen
  MF v[44:47], a[172:175], v[160:163], v[44:47]
  s_waitcnt lgkmcnt(6)
  MF v[48:51], a[160:163], v[164:167], v[48:51]
  TR v[160:161], v5 offset:24576
  MF v[52:55], a[164:167], v[164:167], v[52:55]
  TR v[162:163], v5 offset:24832
  MF v[56:59], a[168:171], v[164:167], v[56:59]
  MF v[60:63], a[172:175], v[164:167], v[60:63]
  s_waitcnt lgkmcnt(4)
  MF v[96:99], v[168:171], a[176:179], v[96:99]
  TR v[164:165], v5 offset:26624
  MF v[100:103], v[168:171], a[180:183], v[100:103]
  TR v[166:167], v5 offset:26880
  MF v[104:107], v[168:171], a[184:187], v[104:107]
  s_waitcnt vmcnt(21)
  ds_read_b128 a[200:203], v252 offset:4096
  MF v[108:111], v[168:171], a[188:191], v[108:111]
  ds_read_b128 a[216:219], v253 offset:4096
  s_waitcnt lgkmcnt(6)
  MF v[112:115], v[172:175], a[176:179], v[112:115]
  ds_read_b128 v[168:171], v29 offset:28672
  MF v[116:119], v[172:175], a[180:183], v[116:119]
  MF v[120:123], v[172:175], a[184:187], v[120:123]
  s_add_u32 s90, s74, 4608
  s_add_u32 m0, s91, 2048
  s_nop 0
  BL4 v30, s[4:7], s90 offen lds
  MF v[124:127], v[172:175], a[188:191], v[124:127]
  s_add_u32 m0, s91, 3072
  s_nop 0
  BL4 v31, s[4:7], s90 offen lds
  s_waitcnt lgkmcnt(5)
  MF v[128:131], v[160:163], a[176:179], v[128:131]
  ds_read_b128 v[172:175], v29 offset:30720
  MF v[132:135], v[160:163], a[180:183], v[132:135]
  MF v[136:139], v[160:163], a[184:187], v[136:139]
  s_waitcnt vmcnt(19)
  ds_read_b128 a[204:207], v252 offset:6144
  MF v[140:143], v[160:163], a[188:191], v[140:143]
  ds_read_b128 a[220:223], v253 offset:6144
  s_waitcnt lgkmcnt(6)
  MF v[144:147], v[164:167], a[176:179], v[144:147]
  s_barrier
  TR v[160:161], v2
  MF v[148:151], v[164:167], a[180:183], v[148:151]
  TR v[162:163], v2 offset:256
  MF v[152:155], v[164:167], a[184:187], v[152:155]
  s_add_u32 s90, s74, 9216
  s_add_u32 m0, s91, 4096
  s_nop 0
  s_waitcnt lgkmcnt(6)
  BL4 v30, s[4:7], s90 offen lds
  MF v[156:159], v[164:167], a[188:191], v[156:159]
  s_add_u32 m0, s91, 5120
  s_nop 0
  BL4 v31, s[4:7], s90 offen lds
  s_waitcnt lgkmcnt(5)
  MF v[32:35], a[176:179], v[168:171], v[32:35]
  TR v[164:165], v2 offset:2048
  MF v[36:39], a[180:183], v[168:171], v[36:39]
  TR v[166:167], v2 offset:2304
  MF v[40:43], a[184:187], v[168:171], v[40:43]
  MF v[44:47], a[188:191], v[168:171], v[44:47]
  s_waitcnt lgkmcnt(6)
  MF v[48:51], a[176:179], v[172:175], v[48:51]
  TR v[168:169], v4
  MF v[52:55], a[180:183], v[172:175], v[52:55]
  TR v[170:171], v4 offset:256
  MF v[56:59], a[184:187], v[172:175], v[56:59]
  MF v[60:63], a[188:191], v[172:175], v[60:63]
  s_waitcnt lgkmcnt(4)
  MF v[96:99], v[160:163], a[192:195], v[96:99]
  TR v[172:173], v4 offset:2048
  MF v[100:103], v[160:163], a[196:199], v[100:103]
  TR v[174:175], v4 offset:2304
  MF v[104:107], v[160:163], a[200:203], v[104:107]
  s_add_u32 m0, s37, 49152
  s_add_u32 s89, s40, 64
  BL4 v8, s[8:11], s89 offen lds
  MF v[108:111], v[160:163], a[204:207], v[108:111]
  s_add_u32 m0, s37, 53248
  s_add_u32 s89, s41, 64
  BL4 v8, s[8:11], s89 offen lds
  s_waitcnt lgkmcnt(4)
  MF v[112:115], v[164:167], a[192:195], v[112:115]
  ds_read_b128 v[160:163], v6 offset:8192
  MF v[116:119], v[164:167], a[196:199], v[116:119]
  MF v[120:123], v[164:167], a[200:203], v[120:123]
  s_waitcnt vmcnt(21)
  ds_read_b128 a[224:227], v252 offset:8192
  MF v[124:127], v[164:167], a[204:207], v[124:127]
  ds_read_b128 a[240:243], v253 offset:8192
  s_waitcnt lgkmcnt(5)
  MF v[128:131], v[168:171], a[192:195], v[128:131]
  ds_read_b128 v[164:167], v6 offset:10240
  MF v[132:135], v[168:171], a[196:199], v[132:135]
  MF v[136:139], v[168:171], a[200:203], v[136:139]
  s_add_u32 s90, s74, 13824
  s_add_u32 m0, s91, 6144
  s_nop 0
  BL4 v30, s[4:7], s90 offen lds
  MF v[140:143], v[168:171], a[204:207], v[140:143]
  s_add_u32 m0, s91, 7168
  s_nop 0
  BL4 v31, s[4:7], s90 offen lds
  s_waitcnt lgkmcnt(4)
  MF v[144:147], v[172:175], a[192:195], v[144:147]
  TR v[168:169], v2 offset:4096
  MF v[148:151], v[172:175], a[196:199], v[148:151]
  TR v[170:171], v2 offset:4352
  MF v[152:155], v[172:175], a[200:203], v[152:155]
  s_waitcnt vmcnt(17)
  ds_read_b128 a[228:231], v252 offset:10240
  MF v[156:159], v[172:175], a[204:207], v[156:159]
  ds_read_b128 a[244:247], v253 offset:10240
  s_waitcnt lgkmcnt(7)
  MF v[32:35], a[192:195], v[160:163], v[32:35]
  TR v[172:173], v2 offset:6144
  s_mov_b32 s84, 192
  MF v[36:39], a[196:199], v[160:163], v[36:39]
  TR v[174:175], v2 offset:6400
  MF v[40:43], a[200:203], v[160:163], v[40:43]
  s_add_u32 m0, s37, 57344
  s_add_u32 s89, s42, 64
  BL4 v8, s[8:11], s89 offen lds
  MF v[44:47], a[204:207], v[160:163], v[44:47]
  s_add_u32 m0, s37, 61440
  s_add_u32 s89, s43, 64
  BL4 v8, s[8:11], s89 offen lds
  s_waitcnt lgkmcnt(6)
  MF v[48:51], a[192:195], v[164:167], v[48:51]
  TR v[160:161], v4 offset:4096
  MF v[52:55], a[196:199], v[164:167], v[52:55]
  TR v[162:163], v4 offset:4352
  MF v[56:59], a[200:203], v[164:167], v[56:59]
  buffer_load_dword v233, v25, s[8:11], s84 offen
  MF v[60:63], a[204:207], v[164:167], v[60:63]
  s_cmp_eq_u32 s32, 0
  s_cselect_b32 s80, 0, 1073741824
  s_waitcnt lgkmcnt(6)
  MF v[96:99], v[168:171], a[208:211], v[96:99]
  TR v[164:165], v4 offset:6144
  v_mov_b32 v247, s80
  MF v[100:103], v[168:171], a[212:215], v[100:103]
  TR v[166:167], v4 offset:6400
  MF v[104:107], v[168:171], a[216:219], v[104:107]
  s_add_u32 m0, s37, 65536
  s_add_u32 s89, s44, 64
  BL4 v8, s[8:11], s89 offen lds
  MF v[108:111], v[168:171], a[220:223], v[108:111]
  s_add_u32 m0, s37, 69632
  s_add_u32 s89, s45, 64
  BL4 v8, s[8:11], s89 offen lds
  s_waitcnt lgkmcnt(4)
  MF v[112:115], v[172:175], a[208:211], v[112:115]
  ds_read_b128 v[168:171], v7 offset:8192
  MF v[116:119], v[172:175], a[212:215], v[116:119]
  buffer_load_dword v245, v247, s[20:23], 0 offen sc1
  MF v[120:123], v[172:175], a[216:219], v[120:123]
  s_waitcnt vmcnt(21)
  ds_read_b128 a[232:235], v252 offset:12288
  MF v[124:127], v[172:175], a[220:223], v[124:127]
  ds_read_b128 a[248:251], v253 offset:12288
  s_waitcnt lgkmcnt(5)
  MF v[128:131], v[160:163], a[208:211], v[128:131]
  ds_read_b128 v[172:175], v7 offset:10240
  MF v[132:135], v[160:163], a[212:215], v[132:135]
  MF v[136:139], v[160:163], a[216:219], v[136:139]
  s_waitcnt vmcnt(17)
  ds_read_b128 a[236:239], v252 offset:14336
  MF v[140:143], v[160:163], a[220:223], v[140:143]
  ds_read_b128 a[252:255], v253 offset:14336
  s_waitcnt lgkmcnt(6)
  MF v[144:147], v[164:167], a[208:211], v[144:147]
  s_barrier
  TR v[160:161], v2 offset:16384
  MF v[148:151], v[164:167], a[212:215], v[148:151]
  TR v[162:163], v2 offset:16640
  MF v[152:155], v[164:167], a[216:219], v[152:155]
  MF v[156:159], v[164:167], a[220:223], v[156:159]
  s_waitcnt lgkmcnt(7)
  MF v[32:35], a[208:211], v[168:171], v[32:35]
  TR v[164:165], v2 offset:18432
  MF v[36:39], a[212:215], v[168:171], v[36:39]
  TR v[166:167], v2 offset:18688
  MF v[40:43], a[216:219], v[168:171], v[40:43]
  MF v[44:47], a[220:223], v[168:171], v[44:47]
  s_waitcnt lgkmcnt(6)
  MF v[48:51], a[208:211], v[172:175], v[48:51]
  TR v[168:169], v2 offset:20480
  MF v[52:55], a[212:215], v[172:175], v[52:55]
  TR v[170:171], v2 offset:20736
  MF v[56:59], a[216:219], v[172:175], v[56:59]
  MF v[60:63], a[220:223], v[172:175], v[60:63]
  s_waitcnt lgkmcnt(4)
  MF v[96:99], v[160:163], a[224:227], v[96:99]
  TR v[172:173], v2 offset:22528
  MF v[100:103], v[160:163], a[228:231], v[100:103]
  TR v[174:175], v2 offset:22784
  MF v[104:107], v[160:163], a[232:235], v[104:107]
  s_add_u32 m0, s37, 73728
  s_add_u32 s89, s46, 64
  BL4 v8, s[8:11], s89 offen lds
  MF v[108:111], v[160:163], a[236:239], v[108:111]
  s_add_u32 m0, s37, 77824
  s_add_u32 s89, s47, 64
  BL4 v8, s[8:11], s89 offen lds
  s_waitcnt lgkmcnt(4)
  MF v[112:115], v[164:167], a[224:227], v[112:115]
  TR v[160:161], v2 offset:24576
  MF v[116:119], v[164:167], a[228:231], v[116:119]
  TR v[162:163], v2 offset:24832
  MF v[120:123], v[164:167], a[232:235], v[120:123]
  s_waitcnt vmcnt(17)
  ds_read_b128 v[176:179], v252
  MF v[124:127], v[164:167], a[236:239], v[124:127]
  ds_read_b128 v[192:195], v253
  s_waitcnt vmcnt(14)
  ds_read_b128 v[180:183], v252 offset:2048
  ds_read_b128 v[196:199], v253 offset:2048
  s_waitcnt lgkmcnt(8)
  MF v[96:99], v[168:171], a[240:243], v[96:99]
  TR v[164:165], v2 offset:26624
  MF v[100:103], v[168:171], a[244:247], v[100:103]
  TR v[166:167], v2 offset:26880
  MF v[104:107], v[168:171], a[248:251], v[104:107]
  s_add_u32 m0, s37, 81920
  s_add_u32 s89, s48, 64
  BL4 v8, s[8:11], s89 offen lds
  MF v[108:111], v[168:171], a[252:255], v[108:111]
  s_add_u32 m0, s37, 86016
  s_add_u32 s89, s49, 64
  BL4 v8, s[8:11], s89 offen lds
  s_waitcnt lgkmcnt(8)
  MF v[112:115], v[172:175], a[240:243], v[112:115]
  TR v[168:169], v2 offset:28672
  MF v[116:119], v[172:175], a[244:247], v[116:119]
  TR v[170:171], v2 offset:28928
  MF v[120:123], v[172:175], a[248:251], v[120:123]
  s_waitcnt vmcnt(14)
  ds_read_b128 v[184:187], v252 offset:4096
  MF v[124:127], v[172:175], a[252:255], v[124:127]
  ds_read_b128 v[200:203], v253 offset:4096
  s_waitcnt vmcnt(10)
  ds_read_b128 v[188:191], v252 offset:6144
  ds_read_b128 v[204:207], v253 offset:6144
  s_waitcnt lgkmcnt(11)
  MF v[96:99], v[160:163], v[176:179], v[96:99]
  TR v[172:173], v2 offset:30720
  s_waitcnt lgkmcnt(10)
  MF v[100:103], v[160:163], v[180:183], v[100:103]
  TR v[174:175], v2 offset:30976
  s_waitcnt lgkmcnt(5)
  MF v[104:107], v[160:163], v[184:187], v[104:107]
  s_add_u32 m0, s37, 90112
  s_add_u32 s89, s50, 64
  BL4 v8, s[8:11], s89 offen lds
  s_waitcnt lgkmcnt(3)
  MF v[108:111], v[160:163], v[188:191], v[108:111]
  s_add_u32 m0, s37, 94208
  s_add_u32 s89, s51, 64
  BL4 v8, s[8:11], s89 offen lds
  MF v[112:115], v[164:167], v[176:179], v[112:115]
  TR v[160:161], v4 offset:16384
  MF v[116:119], v[164:167], v[180:183], v[116:119]
  TR v[162:163], v4 offset:16640
  MF v[120:123], v[164:167], v[184:187], v[120:123]
  MF v[124:127], v[164:167], v[188:191], v[124:127]
  MF v[96:99], v[168:171], v[192:195], v[96:99]
  TR v[164:165], v4 offset:18432
  MF v[100:103], v[168:171], v[196:199], v[100:103]
  TR v[166:167], v4 offset:18688
  MF v[104:107], v[168:171], v[200:203], v[104:107]
  s_waitcnt lgkmcnt(6)
  MF v[108:111], v[168:171], v[204:207], v[108:111]
  s_waitcnt lgkmcnt(4)
  MF v[112:115], v[172:175], v[192:195], v[112:115]
  TR v[168:169], v4 offset:20480
  MF v[116:119], v[172:175], v[196:199], v[116:119]
  TR v[170:171], v4 offset:20736
  MF v[120:123], v[172:175], v[200:203], v[120:123]
  MF v[124:127], v[172:175], v[204:207], v[124:127]
  s_waitcnt lgkmcnt(4)
  MF v[128:131], v[160:163], a[224:227], v[128:131]
  TR v[172:173], v4 offset:22528
  MF v[132:135], v[160:163], a[228:231], v[132:135]
  TR v[174:175], v4 offset:22784
  MF v[136:139], v[160:163], a[232:235], v[136:139]
  MF v[140:143], v[160:163], a[236:239], v[140:143]
  s_waitcnt lgkmcnt(4)
  MF v[144:147], v[164:167], a[224:227], v[144:147]
  TR v[160:161], v4 offset:24576
  MF v[148:151], v[164:167], a[228:231], v[148:151]
  TR v[162:163], v4 offset:24832
  MF v[152:155], v[164:167], a[232:235], v[152:155]
  MF v[156:159], v[164:167], a[236:239], v[156:159]
  s_waitcnt lgkmcnt(4)
  MF v[128:131], v[168:171], a[240:243], v[128:131]
  TR v[164:165], v4 offset:26624
  MF v[132:135], v[168:171], a[244:247], v[132:135]
  TR v[166:167], v4 offset:26880
  MF v[136:139], v[168:171], a[248:251], v[136:139]
  v_max_f32 v96, 0, v96
  v_max_f32 v97, 0, v97
  MF v[140:143], v[168:171], a[252:255], v[140:143]
  v_max_f32 v98, 0, v98
  s_waitcnt lgkmcnt(4)
  MF v[144:147], v[172:175], a[240:243], v[144:147]
  TR v[168:169], v4 offset:28672
  v_max_f32 v99, 0, v99
  MF v[148:151], v[172:175], a[244:247], v[148:151]
  TR v[170:171], v4 offset:28928
  v_mul_f32 v96, v96, v112
  MF v[152:155], v[172:175], a[248:251], v[152:155]
  v_mul_f32 v97, v97, v113
  v_mul_f32 v98, v98, v114
  MF v[156:159], v[172:175], a[252:255], v[156:159]
  v_mul_f32 v99, v99, v115
  s_waitcnt lgkmcnt(4)
  MF v[128:131], v[160:163], v[176:179], v[128:131]
  TR v[172:173], v4 offset:30720
  v_cvt_pk_bf16_f32 v248, v96, v97
  MF v[132:135], v[160:163], v[180:183], v[132:135]
  TR v[174:175], v4 offset:30976
  v_cvt_pk_bf16_f32 v249, v98, v99
  MF v[136:139], v[160:163], v[184:187], v[136:139]
  v_max_f32 v100, 0, v100
  v_max_f32 v101, 0, v101
  MF v[140:143], v[160:163], v[188:191], v[140:143]
  v_max_f32 v102, 0, v102
  s_waitcnt lgkmcnt(4)
  MF v[144:147], v[164:167], v[176:179], v[144:147]
  ds_read_b128 v[160:163], v6 offset:32768
  v_max_f32 v103, 0, v103
  MF v[148:151], v[164:167], v[180:183], v[148:151]
  v_mul_f32 v100, v100, v116
  v_mul_f32 v101, v101, v117
  MF v[152:155], v[164:167], v[184:187], v[152:155]
  v_mul_f32 v102, v102, v118
  v_mul_f32 v103, v103, v119
  MF v[156:159], v[164:167], v[188:191], v[156:159]
  v_cvt_pk_bf16_f32 v250, v100, v101
  s_waitcnt lgkmcnt(3)
  MF v[128:131], v[168:171], v[192:195], v[128:131]
  ds_read_b128 v[164:167], v6 offset:34816
  v_cvt_pk_bf16_f32 v251, v102, v103
  MF v[132:135], v[168:171], v[196:199], v[132:135]
  v_max_f32 v104, 0, v104
  v_max_f32 v105, 0, v105
  MF v[136:139], v[168:171], v[200:203], v[136:139]
  v_max_f32 v106, 0, v106
  v_max_f32 v107, 0, v107
  MF v[140:143], v[168:171], v[204:207], v[140:143]
  v_mul_f32 v104, v104, v120
  s_waitcnt lgkmcnt(2)
  MF v[144:147], v[172:175], v[192:195], v[144:147]
  ds_read_b128 v[168:171], v7 offset:32768
  v_mul_f32 v105, v105, v121
  MF v[148:151], v[172:175], v[196:199], v[148:151]
  v_mul_f32 v106, v106, v122
  v_mul_f32 v107, v107, v123
  MF v[152:155], v[172:175], v[200:203], v[152:155]
  v_cvt_pk_bf16_f32 v252, v104, v105
  v_cvt_pk_bf16_f32 v253, v106, v107
  MF v[156:159], v[172:175], v[204:207], v[156:159]
  v_max_f32 v108, 0, v108
  s_waitcnt lgkmcnt(2)
  MF v[32:35], a[224:227], v[160:163], v[32:35]
  ds_read_b128 v[172:175], v7 offset:34816
  v_max_f32 v109, 0, v109
  MF v[36:39], a[228:231], v[160:163], v[36:39]
  v_max_f32 v110, 0, v110
  v_max_f32 v111, 0, v111
  MF v[40:43], a[232:235], v[160:163], v[40:43]
  v_mul_f32 v108, v108, v124
  v_mul_f32 v109, v109, v125
  MF v[44:47], a[236:239], v[160:163], v[44:47]
  v_mul_f32 v110, v110, v126
  s_waitcnt lgkmcnt(2)
  MF v[48:51], a[224:227], v[164:167], v[48:51]
  ds_read_b128 v[160:163], v6 offset:40960
  v_mul_f32 v111, v111, v127
  MF v[52:55], a[228:231], v[164:167], v[52:55]
  v_cvt_pk_bf16_f32 v254, v108, v109
  v_cvt_pk_bf16_f32 v255, v110, v111
  MF v[56:59], a[232:235], v[164:167], v[56:59]
  MF v[60:63], a[236:239], v[164:167], v[60:63]
  s_waitcnt lgkmcnt(2)
  MF v[32:35], a[240:243], v[168:171], v[32:35]
  ds_read_b128 v[164:167], v6 offset:43008
  MF v[36:39], a[244:247], v[168:171], v[36:39]
  MF v[40:43], a[248:251], v[168:171], v[40:43]
  MF v[44:47], a[252:255], v[168:171], v[44:47]
  s_waitcnt lgkmcnt(2)
  MF v[48:51], a[240:243], v[172:175], v[48:51]
  ds_read_b128 v[168:171], v7 offset:40960
  MF v[52:55], a[244:247], v[172:175], v[52:55]
  MF v[56:59], a[248:251], v[172:175], v[56:59]
  MF v[60:63], a[252:255], v[172:175], v[60:63]
  s_waitcnt lgkmcnt(2)
  MF v[32:35], v[176:179], v[160:163], v[32:35]
  ds_read_b128 v[172:175], v7 offset:43008
  MF v[36:39], v[180:183], v[160:163], v[36:39]
  MF v[40:43], v[184:187], v[160:163], v[40:43]
  MF v[44:47], v[188:191], v[160:163], v[44:47]
  s_waitcnt lgkmcnt(2)
  MF v[48:51], v[176:179], v[164:167], v[48:51]
  s_waitcnt vmcnt(7)
  s_barrier
  TR v[160:161], v2 offset:49152
  MF v[52:55], v[180:183], v[164:167], v[52:55]
  TR v[162:163], v2 offset:49408
  MF v[56:59], v[184:187], v[164:167], v[56:59]
  MF v[60:63], v[188:191], v[164:167], v[60:63]
  s_waitcnt lgkmcnt(3)
  MF v[32:35], v[192:195], v[168:171], v[32:35]
  TR v[164:165], v2 offset:51200
  MF v[36:39], v[196:199], v[168:171], v[36:39]
  TR v[166:167], v2 offset:51456
  MF v[40:43], v[200:203], v[168:171], v[40:43]
  MF v[44:47], v[204:207], v[168:171], v[44:47]
  s_waitcnt lgkmcnt(4)
  MF v[48:51], v[192:195], v[172:175], v[48:51]
  TR v[168:169], v2 offset:53248
  MF v[52:55], v[196:199], v[172:175], v[52:55]
  TR v[170:171], v2 offset:53504
  MF v[56:59], v[200:203], v[172:175], v[56:59]
  MF v[60:63], v[204:207], v[172:175], v[60:63]
K1_TA1_G1:
  s_waitcnt lgkmcnt(4)
  MF v[96:99], v[160:163], a[0:3], 0
  TR v[172:173], v2 offset:55296
  MF v[100:103], v[160:163], a[4:7], 0
  TR v[174:175], v2 offset:55552
  MF v[104:107], v[160:163], a[8:11], 0
  s_add_u32 m0, s37, 98304
  s_add_u32 s89, s52, 64
  BL4 v8, s[8:11], s89 offen lds
  MF v[108:111], v[160:163], a[12:15], 0
  s_add_u32 m0, s37, 102400
  s_add_u32 s89, s53, 64
  BL4 v8, s[8:11], s89 offen lds
  s_waitcnt lgkmcnt(4)
  MF v[112:115], v[164:167], a[0:3], 0
  TR v[160:161], v2 offset:57344
  s_cmp_eq_u32 s32, 0
  s_cselect_b32 s84, 1, 0
  MF v[116:119], v[164:167], a[4:7], 0
  TR v[162:163], v2 offset:57600
  MF v[120:123], v[164:167], a[8:11], 0
  s_mov_b32 s82, 262144
POLLR4:
  s_waitcnt vmcnt(8)
  v_cmp_eq_u32 vcc, 1, v245
  s_nop 1
  s_and_b32 s80, vcc_lo, s84
  s_cmp_eq_u32 s80, s84
  s_cbranch_scc1 POLLEDR4
  s_sub_u32 s82, s82, 1
  s_cbranch_scc1 POLLEDR4
  s_sleep 2
  buffer_load_dword v245, v247, s[20:23], 0 offen sc1
  s_waitcnt vmcnt(0)
  s_branch POLLR4
POLLEDR4:
  MF v[124:127], v[164:167], a[12:15], 0
  s_lshl_b32 s80, s2, 2
  s_add_u32 s80, s80, 32636928
  s_waitcnt lgkmcnt(4)
  MF v[96:99], v[168:171], a[16:19], v[96:99]
  TR v[164:165], v2 offset:59392
  s_cmp_eq_u32 s32, 0
  s_cselect_b32 s80, s80, 1073741824
  MF v[100:103], v[168:171], a[20:23], v[100:103]
  TR v[166:167], v2 offset:59648
  v_mov_b32 v30, s80
  MF v[104:107], v[168:171], a[24:27], v[104:107]
  s_add_u32 m0, s37, 106496
  s_add_u32 s89, s54, 64
  BL4 v8, s[8:11], s89 offen lds
  MF v[108:111], v[168:171], a[28:31], v[108:111]
  s_add_u32 m0, s37, 110592
  s_add_u32 s89, s55, 64
  BL4 v8, s[8:11], s89 offen lds
  s_waitcnt lgkmcnt(4)
  MF v[112:115], v[172:175], a[16:19], v[112:115]
  TR v[168:169], v3
  v_mov_b32 v243, 1073741824
  MF v[116:119], v[172:175], a[20:23], v[116:119]
  TR v[170:171], v3 offset:256
  MF v[120:123], v[172:175], a[24:27], v[120:123]
  v_cmp_eq_u32 vcc, 0, v1
  s_nop 1
  v_cndmask_b32 v30, v243, v30, vcc
  MF v[124:127], v[172:175], a[28:31], v[124:127]
  s_add_u32 s88, s36, 0
  s_lshl_b32 s88, s88, 10
  s_waitcnt lgkmcnt(4)
  MF v[96:99], v[160:163], a[32:35], v[96:99]
  TR v[172:173], v3 offset:2048
  v_max_f32 v128, 0, v128
  MF v[100:103], v[160:163], a[36:39], v[100:103]
  TR v[174:175], v3 offset:2304
  v_max_f32 v129, 0, v129
  MF v[104:107], v[160:163], a[40:43], v[104:107]
  s_add_u32 m0, s37, 114688
  s_add_u32 s89, s56, 64
  BL4 v8, s[8:11], s89 offen lds
  MF v[108:111], v[160:163], a[44:47], v[108:111]
  s_add_u32 m0, s37, 118784
  s_add_u32 s89, s57, 64
  BL4 v8, s[8:11], s89 offen lds
  s_waitcnt lgkmcnt(4)
  MF v[112:115], v[164:167], a[32:35], v[112:115]
  TR v[160:161], v3 offset:4096
  v_max_f32 v130, 0, v130
  MF v[116:119], v[164:167], a[36:39], v[116:119]
  TR v[162:163], v3 offset:4352
  v_max_f32 v131, 0, v131
  MF v[120:123], v[164:167], a[40:43], v[120:123]
  v_mul_f32 v128, v128, v144
  v_mul_f32 v129, v129, v145
  MF v[124:127], v[164:167], a[44:47], v[124:127]
  v_mul_f32 v130, v130, v146
  s_waitcnt lgkmcnt(4)
  MF v[96:99], v[168:171], a[48:51], v[96:99]
  TR v[164:165], v3 offset:6144
  v_mul_f32 v131, v131, v147
  MF v[100:103], v[168:171], a[52:55], v[100:103]
  TR v[166:167], v3 offset:6400
  v_mov_b32 v240, v248
  MF v[104:107], v[168:171], a[56:59], v[104:107]
  v_mov_b32 v241, v249
  v_cvt_pk_bf16_f32 v242, v128, v129
  MF v[108:111], v[168:171], a[60:63], v[108:111]
  v_cvt_pk_bf16_f32 v243, v130, v131
  s_waitcnt lgkmcnt(4)
  MF v[112:115], v[172:175], a[48:51], v[112:115]
  TR v[168:169], v3 offset:8192
  s_add_u32 s80, s88, 0
  MF v[116:119], v[172:175], a[52:55], v[116:119]
  TR v[170:171], v3 offset:8448
  MF v[120:123], v[172:175], a[56:59], v[120:123]
  buffer_store_dwordx4 v[240:243], v10, s[16:19], s80 offen sc1
  MF v[124:127], v[172:175], a[60:63], v[124:127]
  v_max_f32 v132, 0, v132
  s_waitcnt lgkmcnt(4)
  MF v[96:99], v[160:163], a[64:67], v[96:99]
  TR v[172:173], v3 offset:10240
  v_max_f32 v133, 0, v133
  MF v[100:103], v[160:163], a[68:71], v[100:103]
  TR v[174:175], v3 offset:10496
  v_max_f32 v134, 0, v134
  MF v[104:107], v[160:163], a[72:75], v[104:107]
  v_max_f32 v135, 0, v135
  v_mul_f32 v132, v132, v148
  MF v[108:111], v[160:163], a[76:79], v[108:111]
  v_mul_f32 v133, v133, v149
  s_waitcnt lgkmcnt(4)
  MF v[112:115], v[164:167], a[64:67], v[112:115]
  TR v[160:161], v4 offset:49152
  v_mul_f32 v134, v134, v150
  MF v[116:119], v[164:167], a[68:71], v[116:119]
  TR v[162:163], v4 offset:49408
  v_mul_f32 v135, v135, v151
  MF v[120:123], v[164:167], a[72:75], v[120:123]
  v_mov_b32 v244, v250
  v_mov_b32 v245, v251
  MF v[124:127], v[164:167], a[76:79], v[124:127]
  v_cvt_pk_bf16_f32 v246, v132, v133
  s_waitcnt lgkmcnt(4)
  MF v[96:99], v[168:171], a[80:83], v[96:99]
  TR v[164:165], v4 offset:51200
  v_cvt_pk_bf16_f32 v247, v134, v135
  MF v[100:103], v[168:171], a[84:87], v[100:103]
  TR v[166:167], v4 offset:51456
  s_add_u32 s80, s88, 185344
  MF v[104:107], v[168:171], a[88:91], v[104:107]
  buffer_store_dwordx4 v[244:247], v10, s[16:19], s80 offen sc1
  MF v[108:111], v[168:171], a[92:95], v[108:111]
  v_max_f32 v136, 0, v136
  s_waitcnt lgkmcnt(4)
  MF v[112:115], v[172:175], a[80:83], v[112:115]
  TR v[168:169], v4 offset:53248
  v_max_f32 v137, 0, v137
  MF v[116:119], v[172:175], a[84:87], v[116:119]
  TR v[170:171], v4 offset:53504
  v_max_f32 v138, 0, v138
  MF v[120:123], v[172:175], a[88:91], v[120:123]
  v_max_f32 v139, 0, v139
  v_mul_f32 v136, v136, v152
  MF v[124:127], v[172:175], a[92:95], v[124:127]
  v_mul_f32 v137, v137, v153
  v_mul_f32 v138, v138, v154
  v_mul_f32 v139, v139, v155
  v_mov_b32 v240, v252
  v_mov_b32 v241, v253
  v_cvt_pk_bf16_f32 v242, v136, v137
  v_cvt_pk_bf16_f32 v243, v138, v139
  s_add_u32 s80, s88, 370688
  buffer_store_dwordx4 v[240:243], v10, s[16:19], s80 offen sc1
  v_max_f32 v140, 0, v140
  v_max_f32 v141, 0, v141
  v_max_f32 v142, 0, v142
  v_max_f32 v143, 0, v143
  v_mul_f32 v140, v140, v156
  v_mul_f32 v141, v141, v157
  v_mul_f32 v142, v142, v158
  v_mul_f32 v143, v143, v159
  v_mov_b32 v244, v254
  v_mov_b32 v245, v255
  v_cvt_pk_bf16_f32 v246, v140, v141
  v_cvt_pk_bf16_f32 v247, v142, v143
  s_add_u32 s80, s88, 556032
  buffer_store_dwordx4 v[244:247], v10, s[16:19], s80 offen sc1
  s_waitcnt lgkmcnt(4)
  MF v[128:131], v[160:163], a[0:3], 0
  TR v[172:173], v4 offset:55296
  s_mov_b32 s84, 256
  MF v[132:135], v[160:163], a[4:7], 0
  TR v[174:175], v4 offset:55552
  MF v[136:139], v[160:163], a[8:11], 0
  buffer_load_dword v27, v25, s[8:11], s84 offen
  MF v[140:143], v[160:163], a[12:15], 0
  v_fma_f32 v226, v210, v32, v33
  s_waitcnt lgkmcnt(4)
  MF v[144:147], v[164:167], a[0:3], 0
  TR v[160:161], v4 offset:57344
  v_fma_f32 v227, v210, v48, v49
  MF v[148:151], v[164:167], a[4:7], 0
  TR v[162:163], v4 offset:57600
  v_fma_f32 v226, -v211, v48, v226
  MF v[152:155], v[164:167], a[8:11], 0
  v_fma_f32 v227, v211, v32, v227
  v_fma_f32 v224, v210, v226, v34
  MF v[156:159], v[164:167], a[12:15], 0
  v_fma_f32 v225, v210, v227, v50
  s_waitcnt lgkmcnt(4)
  MF v[128:131], v[168:171], a[16:19], v[128:131]
  TR v[164:165], v4 offset:59392
  v_fma_f32 v224, -v211, v227, v224
  MF v[132:135], v[168:171], a[20:23], v[132:135]
  TR v[166:167], v4 offset:59648
  v_fma_f32 v225, v211, v226, v225
  MF v[136:139], v[168:171], a[24:27], v[136:139]
  v_fma_f32 v226, v210, v224, v35
  v_fma_f32 v227, v210, v225, v51
  MF v[140:143], v[168:171], a[28:31], v[140:143]
  v_fma_f32 v226, -v211, v225, v226
  s_waitcnt lgkmcnt(4)
  MF v[144:147], v[172:175], a[16:19], v[144:147]
  TR v[168:169], v5
  v_fma_f32 v227, v211, v224, v227
  MF v[148:151], v[172:175], a[20:23], v[148:151]
  TR v[170:171], v5 offset:256
  v_fma_f32 v224, v210, v226, v36
  MF v[152:155], v[172:175], a[24:27], v[152:155]
  v_fma_f32 v225, v210, v227, v52
  v_fma_f32 v224, -v211, v227, v224
  MF v[156:159], v[172:175], a[28:31], v[156:159]
  v_fma_f32 v225, v211, v226, v225
  s_waitcnt lgkmcnt(4)
  MF v[128:131], v[160:163], a[32:35], v[128:131]
  TR v[172:173], v5 offset:2048
  v_fma_f32 v226, v210, v224, v37
  MF v[132:135], v[160:163], a[36:39], v[132:135]
  TR v[174:175], v5 offset:2304
  v_fma_f32 v227, v210, v225, v53
  MF v[136:139], v[160:163], a[40:43], v[136:139]
  v_fma_f32 v226, -v211, v225, v226
  v_fma_f32 v227, v211, v224, v227
  MF v[140:143], v[160:163], a[44:47], v[140:143]
  v_fma_f32 v224, v210, v226, v38
  s_waitcnt lgkmcnt(4)
  MF v[144:147], v[164:167], a[32:35], v[144:147]
  TR v[160:161], v5 offset:4096
  v_fma_f32 v225, v210, v227, v54
  MF v[148:151], v[164:167], a[36:39], v[148:151]
  TR v[162:163], v5 offset:4352
  v_fma_f32 v224, -v211, v227, v224
  MF v[152:155], v[164:167], a[40:43], v[152:155]
  v_fma_f32 v225, v211, v226, v225
  v_fma_f32 v226, v210, v224, v39
  MF v[156:159], v[164:167], a[44:47], v[156:159]
  v_fma_f32 v227, v210, v225, v55
  s_waitcnt lgkmcnt(4)
  MF v[128:131], v[168:171], a[48:51], v[128:131]
  TR v[164:165], v5 offset:6144
  v_fma_f32 v226, -v211, v225, v226
  MF v[132:135], v[168:171], a[52:55], v[132:135]
  TR v[166:167], v5 offset:6400
  v_fma_f32 v227, v211, v224, v227
  MF v[136:139], v[168:171], a[56:59], v[136:139]
  v_fma_f32 v224, v210, v226, v40
  v_fma_f32 v225, v210, v227, v56
  MF v[140:143], v[168:171], a[60:63], v[140:143]
  v_fma_f32 v224, -v211, v227, v224
  s_waitcnt lgkmcnt(4)
  MF v[144:147], v[172:175], a[48:51], v[144:147]
  TR v[168:169], v5 offset:8192
  v_fma_f32 v225, v211, v226, v225
  MF v[148:151], v[172:175], a[52:55], v[148:151]
  TR v[170:171], v5 offset:8448
  v_fma_f32 v226, v210, v224, v41
  MF v[152:155], v[172:175], a[56:59], v[152:155]
  v_fma_f32 v227, v210, v225, v57
  v_fma_f32 v226, -v211, v225, v226
  MF v[156:159], v[172:175], a[60:63], v[156:159]
  v_fma_f32 v227, v211, v224, v227
  s_waitcnt lgkmcnt(4)
  MF v[128:131], v[160:163], a[64:67], v[128:131]
  TR v[172:173], v5 offset:10240
  v_fma_f32 v224, v210, v226, v42
  MF v[132:135], v[160:163], a[68:71], v[132:135]
  TR v[174:175], v5 offset:10496
  v_fma_f32 v225, v210, v227, v58
  MF v[136:139], v[160:163], a[72:75], v[136:139]
  v_fma_f32 v224, -v211, v227, v224
  v_fma_f32 v225, v211, v226, v225
  MF v[140:143], v[160:163], a[76:79], v[140:143]
  v_fma_f32 v226, v210, v224, v43
  s_waitcnt lgkmcnt(4)
  MF v[144:147], v[164:167], a[64:67], v[144:147]
  s_waitcnt vmcnt(11)
  s_barrier
  TR v[160:161], v3 offset:12288
  v_fma_f32 v227, v210, v225, v59
  MF v[148:151], v[164:167], a[68:71], v[148:151]
  TR v[162:163], v3 offset:12544
  v_fma_f32 v226, -v211, v225, v226
  MF v[152:155], v[164:167], a[72:75], v[152:155]
  v_fma_f32 v227, v211, v224, v227
  v_fma_f32 v224, v210, v226, v44
  MF v[156:159], v[164:167], a[76:79], v[156:159]
  v_fma_f32 v225, v210, v227, v60
  s_waitcnt lgkmcnt(4)
  MF v[128:131], v[168:171], a[80:83], v[128:131]
  TR v[164:165], v3 offset:14336
  v_fma_f32 v224, -v211, v227, v224
  MF v[132:135], v[168:171], a[84:87], v[132:135]
  TR v[166:167], v3 offset:14592
  v_fma_f32 v225, v211, v226, v225
  MF v[136:139], v[168:171], a[88:91], v[136:139]
  v_fma_f32 v226, v210, v224, v45
  v_fma_f32 v227, v210, v225, v61
  MF v[140:143], v[168:171], a[92:95], v[140:143]
  v_fma_f32 v226, -v211, v225, v226
  s_waitcnt lgkmcnt(4)
  MF v[144:147], v[172:175], a[80:83], v[144:147]
  TR v[168:169], v5 offset:12288
  v_fma_f32 v227, v211, v224, v227
  MF v[148:151], v[172:175], a[84:87], v[148:151]
  TR v[170:171], v5 offset:12544
  v_fma_f32 v224, v210, v226, v46
  MF v[152:155], v[172:175], a[88:91], v[152:155]
  v_fma_f32 v225, v210, v227, v62
  v_fma_f32 v224, -v211, v227, v224
  MF v[156:159], v[172:175], a[92:95], v[156:159]
  v_fma_f32 v225, v211, v226, v225
  s_waitcnt lgkmcnt(4)
  MF v[96:99], v[160:163], a[96:99], v[96:99]
  TR v[172:173], v5 offset:14336
  v_fma_f32 v226, v210, v224, v47
  MF v[100:103], v[160:163], a[100:103], v[100:103]
  TR v[174:175], v5 offset:14592
  v_fma_f32 v227, v210, v225, v63
  MF v[104:107], v[160:163], a[104:107], v[104:107]
  s_add_u32 m0, s37, 0
  s_add_u32 s89, s40, 128
  BL4 v8, s[8:11], s89 offen lds
  MF v[108:111], v[160:163], a[108:111], v[108:111]
  s_add_u32 m0, s37, 4096
  s_add_u32 s89, s41, 128
  BL4 v8, s[8:11], s89 offen lds
  s_waitcnt lgkmcnt(4)
  MF v[112:115], v[164:167], a[96:99], v[112:115]
  TR v[160:161], v3 offset:16384
  v_fma_f32 v226, -v211, v225, v226
  MF v[116:119], v[164:167], a[100:103], v[116:119]
  TR v[162:163], v3 offset:16640
  v_fma_f32 v227, v211, v224, v227
  MF v[120:123], v[164:167], a[104:107], v[120:123]
  ds_bpermute_b32 v232, v16, v226
  ds_bpermute_b32 v233, v16, v227
  MF v[124:127], v[164:167], a[108:111], v[124:127]
  v_mul_f32 v230, v214, v214
  s_waitcnt lgkmcnt(6)
  MF v[128:131], v[168:171], a[96:99], v[128:131]
  TR v[164:165], v3 offset:18432
  v_mul_f32 v231, v214, v215
  MF v[132:135], v[168:171], a[100:103], v[132:135]
  TR v[166:167], v3 offset:18688
  v_fma_f32 v230, -v215, v215, v230
  MF v[136:139], v[168:171], a[104:107], v[136:139]
  v_add_f32 v231, v231, v231
  v_mul_f32 v230, v230, v19
  MF v[140:143], v[168:171], a[108:111], v[140:143]
  v_mul_f32 v231, v231, v19
  s_waitcnt lgkmcnt(6)
  MF v[144:147], v[172:175], a[96:99], v[144:147]
  TR v[168:169], v5 offset:16384
  MF v[148:151], v[172:175], a[100:103], v[148:151]
  TR v[170:171], v5 offset:16640
  s_waitcnt lgkmcnt(5)
  v_fma_f32 v226, v214, v232, v226
  MF v[152:155], v[172:175], a[104:107], v[152:155]
  s_waitcnt lgkmcnt(4)
  v_fma_f32 v227, v214, v233, v227
  v_fma_f32 v226, -v215, v233, v226
  MF v[156:159], v[172:175], a[108:111], v[156:159]
  v_fma_f32 v227, v215, v232, v227
  MF v[96:99], v[160:163], a[112:115], v[96:99]
  TR v[172:173], v5 offset:18432
  ds_bpermute_b32 v232, v17, v226
  MF v[100:103], v[160:163], a[116:119], v[100:103]
  TR v[174:175], v5 offset:18688
  ds_bpermute_b32 v233, v17, v227
  MF v[104:107], v[160:163], a[120:123], v[104:107]
  s_add_u32 m0, s37, 8192
  s_add_u32 s89, s42, 128
  BL4 v8, s[8:11], s89 offen lds
  MF v[108:111], v[160:163], a[124:127], v[108:111]
  s_add_u32 m0, s37, 12288
  s_add_u32 s89, s43, 128
  BL4 v8, s[8:11], s89 offen lds
  s_waitcnt lgkmcnt(6)
  MF v[112:115], v[164:167], a[112:115], v[112:115]
  TR v[160:161], v3 offset:20480
  MF v[116:119], v[164:167], a[116:119], v[116:119]
  TR v[162:163], v3 offset:20736
  MF v[120:123], v[164:167], a[120:123], v[120:123]
  MF v[124:127], v[164:167], a[124:127], v[124:127]
  s_waitcnt lgkmcnt(4)
  v_fma_f32 v226, v230, v232, v226
  MF v[128:131], v[168:171], a[112:115], v[128:131]
  TR v[164:165], v3 offset:22528
  s_waitcnt lgkmcnt(3)
  v_fma_f32 v227, v230, v233, v227
  MF v[132:135], v[168:171], a[116:119], v[132:135]
  TR v[166:167], v3 offset:22784
  v_fma_f32 v226, -v231, v233, v226
  MF v[136:139], v[168:171], a[120:123], v[136:139]
  v_fma_f32 v227, v231, v232, v227
  ds_write_b64 v11, v[226:227]
  MF v[140:143], v[168:171], a[124:127], v[140:143]
  ds_bpermute_b32 v212, v16, v226
  MF v[144:147], v[172:175], a[112:115], v[144:147]
  TR v[168:169], v5 offset:20480
  ds_bpermute_b32 v213, v16, v227
  MF v[148:151], v[172:175], a[116:119], v[148:151]
  TR v[170:171], v5 offset:20736
  MF v[152:155], v[172:175], a[120:123], v[152:155]
  MF v[156:159], v[172:175], a[124:127], v[156:159]
  s_waitcnt lgkmcnt(7)
  MF v[96:99], v[160:163], a[128:131], v[96:99]
  TR v[172:173], v5 offset:22528
  MF v[100:103], v[160:163], a[132:135], v[100:103]
  TR v[174:175], v5 offset:22784
  MF v[104:107], v[160:163], a[136:139], v[104:107]
  s_add_u32 m0, s37, 16384
  s_add_u32 s89, s44, 128
  BL4 v8, s[8:11], s89 offen lds
  MF v[108:111], v[160:163], a[140:143], v[108:111]
  s_add_u32 m0, s37, 20480
  s_add_u32 s89, s45, 128
  BL4 v8, s[8:11], s89 offen lds
  s_waitcnt lgkmcnt(7)
  MF v[112:115], v[164:167], a[128:131], v[112:115]
  TR v[160:161], v3 offset:24576
  s_waitcnt lgkmcnt(6)
  v_mul_f32 v212, v212, v18
  MF v[116:119], v[164:167], a[132:135], v[116:119]
  TR v[162:163], v3 offset:24832
  s_waitcnt lgkmcnt(5)
  v_mul_f32 v213, v213, v18
  MF v[120:123], v[164:167], a[136:139], v[120:123]
  MF v[124:127], v[164:167], a[140:143], v[124:127]
  s_waitcnt lgkmcnt(4)
  MF v[128:131], v[168:171], a[128:131], v[128:131]
  TR v[164:165], v3 offset:26624
  MF v[132:135], v[168:171], a[132:135], v[132:135]
  TR v[166:167], v3 offset:26880
  MF v[136:139], v[168:171], a[136:139], v[136:139]
  MF v[140:143], v[168:171], a[140:143], v[140:143]
  s_waitcnt lgkmcnt(4)
  MF v[144:147], v[172:175], a[128:131], v[144:147]
  TR v[168:169], v5 offset:24576
  MF v[148:151], v[172:175], a[132:135], v[148:151]
  TR v[170:171], v5 offset:24832
  MF v[152:155], v[172:175], a[136:139], v[152:155]
  MF v[156:159], v[172:175], a[140:143], v[156:159]
  s_waitcnt lgkmcnt(4)
  MF v[96:99], v[160:163], a[144:147], v[96:99]
  TR v[172:173], v5 offset:26624
  MF v[100:103], v[160:163], a[148:151], v[100:103]
  TR v[174:175], v5 offset:26880
  MF v[104:107], v[160:163], a[152:155], v[104:107]
  s_add_u32 m0, s37, 24576
  s_add_u32 s89, s46, 128
  BL4 v8, s[8:11], s89 offen lds
  MF v[108:111], v[160:163], a[156:159], v[108:111]
  s_waitcnt lgkmcnt(4)
  MF v[112:115], v[164:167], a[144:147], v[112:115]
  TR v[160:161], v3 offset:28672
  MF v[116:119], v[164:167], a[148:151], v[116:119]
  TR v[162:163], v3 offset:28928
  MF v[120:123], v[164:167], a[152:155], v[120:123]
  MF v[124:127], v[164:167], a[156:159], v[124:127]
  s_waitcnt lgkmcnt(4)
  MF v[128:131], v[168:171], a[144:147], v[128:131]
  TR v[164:165], v3 offset:30720
  MF v[132:135], v[168:171], a[148:151], v[132:135]
  TR v[166:167], v3 offset:30976
  MF v[136:139], v[168:171], a[152:155], v[136:139]
  MF v[140:143], v[168:171], a[156:159], v[140:143]
  s_waitcnt lgkmcnt(4)
  MF v[144:147], v[172:175], a[144:147], v[144:147]
  TR v[168:169], v5 offset:28672
  MF v[148:151], v[172:175], a[148:151], v[148:151]
  TR v[170:171], v5 offset:28928
  MF v[152:155], v[172:175], a[152:155], v[152:155]
  MF v[156:159], v[172:175], a[156:159], v[156:159]
  s_waitcnt lgkmcnt(4)
  MF v[96:99], v[160:163], a[160:163], v[96:99]
  TR v[172:173], v5 offset:30720
  MF v[100:103], v[160:163], a[164:167], v[100:103]
  TR v[174:175], v5 offset:30976
  MF v[104:107], v[160:163], a[168:171], v[104:107]
  s_add_u32 m0, s37, 28672
  s_add_u32 s89, s47, 128
  BL4 v8, s[8:11], s89 offen lds
  MF v[108:111], v[160:163], a[172:175], v[108:111]
  s_waitcnt lgkmcnt(4)
  MF v[112:115], v[164:167], a[160:163], v[112:115]
  TR v[160:161], v3 offset:32768
  MF v[116:119], v[164:167], a[164:167], v[116:119]
  TR v[162:163], v3 offset:33024
  MF v[120:123], v[164:167], a[168:171], v[120:123]
  MF v[124:127], v[164:167], a[172:175], v[124:127]
  s_waitcnt lgkmcnt(4)
  MF v[128:131], v[168:171], a[160:163], v[128:131]
  TR v[164:165], v3 offset:34816
  MF v[132:135], v[168:171], a[164:167], v[132:135]
  TR v[166:167], v3 offset:35072
  MF v[136:139], v[168:171], a[168:171], v[136:139]
  MF v[140:143], v[168:171], a[172:175], v[140:143]
  s_waitcnt lgkmcnt(4)
  MF v[144:147], v[172:175], a[160:163], v[144:147]
  TR v[168:169], v5 offset:32768
  MF v[148:151], v[172:175], a[164:167], v[148:151]
  TR v[170:171], v5 offset:33024
  MF v[152:155], v[172:175], a[168:171], v[152:155]
  MF v[156:159], v[172:175], a[172:175], v[156:159]
  s_waitcnt lgkmcnt(4)
  MF v[96:99], v[160:163], a[176:179], v[96:99]
  TR v[172:173], v5 offset:34816
  MF v[100:103], v[160:163], a[180:183], v[100:103]
  TR v[174:175], v5 offset:35072
  MF v[104:107], v[160:163], a[184:187], v[104:107]
  s_add_u32 m0, s37, 32768
  s_add_u32 s89, s48, 128
  BL4 v8, s[8:11], s89 offen lds
  MF v[108:111], v[160:163], a[188:191], v[108:111]
  s_waitcnt lgkmcnt(4)
  MF v[112:115], v[164:167], a[176:179], v[112:115]
  s_waitcnt vmcnt(14)
  s_barrier
  TR v[160:161], v3 offset:36864
  MF v[116:119], v[164:167], a[180:183], v[116:119]
  TR v[162:163], v3 offset:37120
  MF v[120:123], v[164:167], a[184:187], v[120:123]
  MF v[124:127], v[164:167], a[188:191], v[124:127]
  s_waitcnt lgkmcnt(4)
  MF v[128:131], v[168:171], a[176:179], v[128:131]
  TR v[164:165], v3 offset:38912
  MF v[132:135], v[168:171], a[180:183], v[132:135]
  TR v[166:167], v3 offset:39168
  MF v[136:139], v[168:171], a[184:187], v[136:139]
  MF v[140:143], v[168:171], a[188:191], v[140:143]
  s_waitcnt lgkmcnt(4)
  MF v[144:147], v[172:175], a[176:179], v[144:147]
  TR v[168:169], v3 offset:40960
  MF v[148:151], v[172:175], a[180:183], v[148:151]
  TR v[170:171], v3 offset:41216
  MF v[152:155], v[172:175], a[184:187], v[152:155]
  MF v[156:159], v[172:175], a[188:191], v[156:159]
  s_waitcnt lgkmcnt(4)
  MF v[96:99], v[160:163], a[192:195], v[96:99]
  TR v[172:173], v3 offset:43008
  MF v[100:103], v[160:163], a[196:199], v[100:103]
  TR v[174:175], v3 offset:43264
  MF v[104:107], v[160:163], a[200:203], v[104:107]
  s_add_u32 m0, s37, 36864
  s_add_u32 s89, s49, 128
  BL4 v8, s[8:11], s89 offen lds
  MF v[108:111], v[160:163], a[204:207], v[108:111]
  s_add_u32 m0, s37, 40960
  s_add_u32 s89, s50, 128
  BL4 v8, s[8:11], s89 offen lds
  s_waitcnt lgkmcnt(4)
  MF v[112:115], v[164:167], a[192:195], v[112:115]
  TR v[160:161], v3 offset:45056
  ds_read_b64 v[224:225], v12
  MF v[116:119], v[164:167], a[196:199], v[116:119]
  TR v[162:163], v3 offset:45312
  ds_read_b64 v[226:227], v12 offset:128
  MF v[120:123], v[164:167], a[200:203], v[120:123]
  ds_read_b64 v[228:229], v12 offset:256
  ds_read_b64 v[230:231], v12 offset:384
  MF v[124:127], v[164:167], a[204:207], v[124:127]
  v_mul_f32 v234, 0x42800000, v208
  s_waitcnt lgkmcnt(8)
  MF v[96:99], v[168:171], a[208:211], v[96:99]
  TR v[164:165], v3 offset:47104
  v_mul_f32 v235, 0x42800000, v209
  MF v[100:103], v[168:171], a[212:215], v[100:103]
  TR v[166:167], v3 offset:47360
  v_exp_f32 v232, v234
  MF v[104:107], v[168:171], a[216:219], v[104:107]
  s_add_u32 m0, s37, 45056
  s_add_u32 s89, s51, 128
  BL4 v8, s[8:11], s89 offen lds
  MF v[108:111], v[168:171], a[220:223], v[108:111]
  v_fract_f32 v235, v235
  s_waitcnt lgkmcnt(8)
  MF v[112:115], v[172:175], a[208:211], v[112:115]
  TR v[168:169], v3 offset:49152
  v_cos_f32 v234, v235
  MF v[116:119], v[172:175], a[212:215], v[116:119]
  TR v[170:171], v3 offset:49408
  v_sin_f32 v235, v235
  MF v[120:123], v[172:175], a[216:219], v[120:123]
  v_mul_f32 v233, v232, v235
  v_mul_f32 v232, v232, v234
  MF v[124:127], v[172:175], a[220:223], v[124:127]
  s_waitcnt lgkmcnt(6)
  v_fma_f32 v226, v232, v224, v226
  MF v[96:99], v[160:163], a[224:227], v[96:99]
  TR v[172:173], v3 offset:51200
  v_fma_f32 v227, v232, v225, v227
  MF v[100:103], v[160:163], a[228:231], v[100:103]
  TR v[174:175], v3 offset:51456
  v_fma_f32 v226, -v233, v225, v226
  MF v[104:107], v[160:163], a[232:235], v[104:107]
  s_add_u32 m0, s37, 49152
  s_add_u32 s89, s52, 128
  BL4 v8, s[8:11], s89 offen lds
  MF v[108:111], v[160:163], a[236:239], v[108:111]
  v_fma_f32 v227, v233, v224, v227
  s_waitcnt lgkmcnt(4)
  MF v[112:115], v[164:167], a[224:227], v[112:115]
  TR v[160:161], v3 offset:53248
  v_fma_f32 v228, v232, v226, v228
  MF v[116:119], v[164:167], a[228:231], v[116:119]
  TR v[162:163], v3 offset:53504
  v_fma_f32 v229, v232, v227, v229
  MF v[120:123], v[164:167], a[232:235], v[120:123]
  v_fma_f32 v228, -v233, v227, v228
  v_fma_f32 v229, v233, v226, v229
  MF v[124:127], v[164:167], a[236:239], v[124:127]
  v_fma_f32 v230, v232, v228, v230
  s_waitcnt lgkmcnt(4)
  MF v[96:99], v[168:171], a[240:243], v[96:99]
  TR v[164:165], v3 offset:55296
  v_fma_f32 v231, v232, v229, v231
  MF v[100:103], v[168:171], a[244:247], v[100:103]
  TR v[166:167], v3 offset:55552
  v_fma_f32 v230, -v233, v229, v230
  MF v[104:107], v[168:171], a[248:251], v[104:107]
  s_add_u32 m0, s37, 53248
  s_add_u32 s89, s53, 128
  BL4 v8, s[8:11], s89 offen lds
  MF v[108:111], v[168:171], a[252:255], v[108:111]
  v_fma_f32 v231, v233, v228, v231
  s_waitcnt lgkmcnt(4)
  MF v[112:115], v[172:175], a[240:243], v[112:115]
  TR v[168:169], v3 offset:57344
  MF v[116:119], v[172:175], a[244:247], v[116:119]
  TR v[170:171], v3 offset:57600
  MF v[120:123], v[172:175], a[248:251], v[120:123]
  buffer_store_dwordx2 v[230:231], v22, s[16:19], 0 offen sc1
  MF v[124:127], v[172:175], a[252:255], v[124:127]
  v_mul_f32 v234, s76, v224
  s_waitcnt lgkmcnt(4)
  MF v[96:99], v[160:163], v[176:179], v[96:99]
  TR v[172:173], v3 offset:59392
  v_mul_f32 v235, s76, v225
  MF v[100:103], v[160:163], v[180:183], v[100:103]
  TR v[174:175], v3 offset:59648
  v_fma_f32 v234, s77, v226, v234
  MF v[104:107], v[160:163], v[184:187], v[104:107]
  s_add_u32 m0, s37, 57344
  s_add_u32 s89, s54, 128
  BL4 v8, s[8:11], s89 offen lds
  MF v[108:111], v[160:163], v[188:191], v[108:111]
  v_fma_f32 v235, s77, v227, v235
  s_waitcnt lgkmcnt(4)
  MF v[112:115], v[164:167], v[176:179], v[112:115]
  TR v[160:161], v5 offset:36864
  v_fma_f32 v234, s78, v228, v234
  MF v[116:119], v[164:167], v[180:183], v[116:119]
  TR v[162:163], v5 offset:37120
  v_fma_f32 v235, s78, v229, v235
  MF v[120:123], v[164:167], v[184:187], v[120:123]
  v_mul_f32 v236, v20, v208
  v_mul_f32 v237, v20, v209
  MF v[124:127], v[164:167], v[188:191], v[124:127]
  v_exp_f32 v232, v236
  s_waitcnt lgkmcnt(4)
  MF v[96:99], v[168:171], v[192:195], v[96:99]
  TR v[164:165], v5 offset:38912
  v_fract_f32 v237, v237
  MF v[100:103], v[168:171], v[196:199], v[100:103]
  TR v[166:167], v5 offset:39168
  v_cos_f32 v236, v237
  MF v[104:107], v[168:171], v[200:203], v[104:107]
  s_add_u32 m0, s37, 61440
  s_add_u32 s89, s55, 128
  BL4 v8, s[8:11], s89 offen lds
  MF v[108:111], v[168:171], v[204:207], v[108:111]
  v_sin_f32 v237, v237
  s_waitcnt lgkmcnt(4)
  MF v[112:115], v[172:175], v[192:195], v[112:115]
  TR v[168:169], v5 offset:40960
  v_mul_f32 v233, v232, v237
  MF v[116:119], v[172:175], v[196:199], v[116:119]
  TR v[170:171], v5 offset:41216
  v_mul_f32 v232, v232, v236
  MF v[120:123], v[172:175], v[200:203], v[120:123]
  v_fma_f32 v212, v232, v234, v212
  v_fma_f32 v213, v232, v235, v213
  MF v[124:127], v[172:175], v[204:207], v[124:127]
  v_fma_f32 v212, -v233, v235, v212
  s_waitcnt lgkmcnt(4)
  MF v[128:131], v[160:163], a[192:195], v[128:131]
  TR v[172:173], v5 offset:43008
  v_fma_f32 v213, v233, v234, v213
  MF v[132:135], v[160:163], a[196:199], v[132:135]
  TR v[174:175], v5 offset:43264
  MF v[136:139], v[160:163], a[200:203], v[136:139]
  MF v[140:143], v[160:163], a[204:207], v[140:143]
  s_waitcnt lgkmcnt(4)
  MF v[144:147], v[164:167], a[192:195], v[144:147]
  TR v[160:161], v5 offset:45056
  MF v[148:151], v[164:167], a[196:199], v[148:151]
  TR v[162:163], v5 offset:45312
  MF v[152:155], v[164:167], a[200:203], v[152:155]
  MF v[156:159], v[164:167], a[204:207], v[156:159]
  s_waitcnt lgkmcnt(4)
  MF v[128:131], v[168:171], a[208:211], v[128:131]
  TR v[164:165], v5 offset:47104
  MF v[132:135], v[168:171], a[212:215], v[132:135]
  TR v[166:167], v5 offset:47360
  MF v[136:139], v[168:171], a[216:219], v[136:139]
  v_max_f32 v96, 0, v96
  v_max_f32 v97, 0, v97
  MF v[140:143], v[168:171], a[220:223], v[140:143]
  v_max_f32 v98, 0, v98
  s_waitcnt lgkmcnt(4)
  MF v[144:147], v[172:175], a[208:211], v[144:147]
  TR v[168:169], v5 offset:49152
  v_max_f32 v99, 0, v99
  MF v[148:151], v[172:175], a[212:215], v[148:151]
  TR v[170:171], v5 offset:49408
  v_mul_f32 v96, v96, v112
  MF v[152:155], v[172:175], a[216:219], v[152:155]
  v_mul_f32 v97, v97, v113
  v_mul_f32 v98, v98, v114
  MF v[156:159], v[172:175], a[220:223], v[156:159]
  v_mul_f32 v99, v99, v115
  s_waitcnt lgkmcnt(4)
  MF v[128:131], v[160:163], a[224:227], v[128:131]
  TR v[172:173], v5 offset:51200
  v_cvt_pk_bf16_f32 v248, v96, v97
  MF v[132:135], v[160:163], a[228:231], v[132:135]
  TR v[174:175], v5 offset:51456
  v_cvt_pk_bf16_f32 v249, v98, v99
  MF v[136:139], v[160:163], a[232:235], v[136:139]
  v_max_f32 v100, 0, v100
  v_max_f32 v101, 0, v101
  MF v[140:143], v[160:163], a[236:239], v[140:143]
  v_max_f32 v102, 0, v102
  s_waitcnt lgkmcnt(4)
  MF v[144:147], v[164:167], a[224:227], v[144:147]
  TR v[160:161], v5 offset:53248
  v_max_f32 v103, 0, v103
  MF v[148:151], v[164:167], a[228:231], v[148:151]
  TR v[162:163], v5 offset:53504
  v_mul_f32 v100, v100, v116
  MF v[152:155], v[164:167], a[232:235], v[152:155]
  v_mul_f32 v101, v101, v117
  v_mul_f32 v102, v102, v118
  MF v[156:159], v[164:167], a[236:239], v[156:159]
  v_mul_f32 v103, v103, v119
  s_waitcnt lgkmcnt(4)
  MF v[128:131], v[168:171], a[240:243], v[128:131]
  TR v[164:165], v5 offset:55296
  v_cvt_pk_bf16_f32 v250, v100, v101
  MF v[132:135], v[168:171], a[244:247], v[132:135]
  TR v[166:167], v5 offset:55552
  v_cvt_pk_bf16_f32 v251, v102, v103
  MF v[136:139], v[168:171], a[248:251], v[136:139]
  v_max_f32 v104, 0, v104
  v_max_f32 v105, 0, v105
  MF v[140:143], v[168:171], a[252:255], v[140:143]
  v_max_f32 v106, 0, v106
  s_waitcnt lgkmcnt(4)
  MF v[144:147], v[172:175], a[240:243], v[144:147]
  TR v[168:169], v5 offset:57344
  v_max_f32 v107, 0, v107
  MF v[148:151], v[172:175], a[244:247], v[148:151]
  TR v[170:171], v5 offset:57600
  v_mul_f32 v104, v104, v120
  MF v[152:155], v[172:175], a[248:251], v[152:155]
  v_mul_f32 v105, v105, v121
  v_mul_f32 v106, v106, v122
  MF v[156:159], v[172:175], a[252:255], v[156:159]
  v_mul_f32 v107, v107, v123
  s_waitcnt lgkmcnt(4)
  MF v[128:131], v[160:163], v[176:179], v[128:131]
  TR v[172:173], v5 offset:59392
  v_cvt_pk_bf16_f32 v252, v104, v105
  MF v[132:135], v[160:163], v[180:183], v[132:135]
  TR v[174:175], v5 offset:59648
  v_cvt_pk_bf16_f32 v253, v106, v107
  MF v[136:139], v[160:163], v[184:187], v[136:139]
  v_max_f32 v108, 0, v108
  v_max_f32 v109, 0, v109
  MF v[140:143], v[160:163], v[188:191], v[140:143]
  v_max_f32 v110, 0, v110
  s_waitcnt lgkmcnt(4)
  MF v[144:147], v[164:167], v[176:179], v[144:147]
  s_waitcnt vmcnt(11)
  s_barrier
  TR v[160:161], v2
  v_max_f32 v111, 0, v111
  MF v[148:151], v[164:167], v[180:183], v[148:151]
  TR v[162:163], v2 offset:256
  v_mul_f32 v108, v108, v124
  MF v[152:155], v[164:167], v[184:187], v[152:155]
  v_mul_f32 v109, v109, v125
  v_mul_f32 v110, v110, v126
  MF v[156:159], v[164:167], v[188:191], v[156:159]
  v_mul_f32 v111, v111, v127
  s_waitcnt lgkmcnt(4)
  MF v[128:131], v[168:171], v[192:195], v[128:131]
  TR v[164:165], v2 offset:2048
  v_cvt_pk_bf16_f32 v254, v108, v109
  MF v[132:135], v[168:171], v[196:199], v[132:135]
  TR v[166:167], v2 offset:2304
  v_cvt_pk_bf16_f32 v255, v110, v111
  MF v[136:139], v[168:171], v[200:203], v[136:139]
  MF v[140:143], v[168:171], v[204:207], v[140:143]
  s_waitcnt lgkmcnt(4)
  MF v[144:147], v[172:175], v[192:195], v[144:147]
  TR v[168:169], v2 offset:4096
  MF v[148:151], v[172:175], v[196:199], v[148:151]
  TR v[170:171], v2 offset:4352
  MF v[152:155], v[172:175], v[200:203], v[152:155]
  MF v[156:159], v[172:175], v[204:207], v[156:159]
K1_TA1_G2:
  s_waitcnt lgkmcnt(4)
  MF v[96:99], v[160:163], a[0:3], 0
  TR v[172:173], v2 offset:6144
  MF v[100:103], v[160:163], a[4:7], 0
  TR v[174:175], v2 offset:6400
  MF v[104:107], v[160:163], a[8:11], 0
  s_add_u32 m0, s37, 65536
  s_add_u32 s89, s56, 128
  BL4 v8, s[8:11], s89 offen lds
  MF v[108:111], v[160:163], a[12:15], 0
  s_add_u32 m0, s37, 69632
  s_add_u32 s89, s57, 128
  BL4 v8, s[8:11], s89 offen lds
  s_waitcnt lgkmcnt(4)
  MF v[112:115], v[164:167], a[0:3], 0
  TR v[160:161], v2 offset:8192
  MF v[116:119], v[164:167], a[4:7], 0
  TR v[162:163], v2 offset:8448
  MF v[120:123], v[164:167], a[8:11], 0
  MF v[124:127], v[164:167], a[12:15], 0
  s_waitcnt lgkmcnt(4)
  MF v[96:99], v[168:171], a[16:19], v[96:99]
  TR v[164:165], v2 offset:10240
  MF v[100:103], v[168:171], a[20:23], v[100:103]
  TR v[166:167], v2 offset:10496
  s_add_u32 s88, s36, 1
  s_lshl_b32 s88, s88, 10
  MF v[104:107], v[168:171], a[24:27], v[104:107]
  s_add_u32 m0, s37, 73728
  s_add_u32 s89, s40, 192
  BL4 v8, s[8:11], s89 offen lds
  MF v[108:111], v[168:171], a[28:31], v[108:111]
  v_max_f32 v128, 0, v128
  s_waitcnt lgkmcnt(4)
  MF v[112:115], v[172:175], a[16:19], v[112:115]
  TR v[168:169], v2 offset:12288
  v_max_f32 v129, 0, v129
  MF v[116:119], v[172:175], a[20:23], v[116:119]
  TR v[170:171], v2 offset:12544
  v_max_f32 v130, 0, v130
  MF v[120:123], v[172:175], a[24:27], v[120:123]
  v_max_f32 v131, 0, v131
  v_mul_f32 v128, v128, v144
  MF v[124:127], v[172:175], a[28:31], v[124:127]
  v_mul_f32 v129, v129, v145
  s_waitcnt lgkmcnt(4)
  MF v[96:99], v[160:163], a[32:35], v[96:99]
  TR v[172:173], v2 offset:14336
  v_mul_f32 v130, v130, v146
  MF v[100:103], v[160:163], a[36:39], v[100:103]
  TR v[174:175], v2 offset:14592
  v_mul_f32 v131, v131, v147
  MF v[104:107], v[160:163], a[40:43], v[104:107]
  s_add_u32 m0, s37, 77824
  s_add_u32 s89, s41, 192
  BL4 v8, s[8:11], s89 offen lds
  MF v[108:111], v[160:163], a[44:47], v[108:111]
  v_mov_b32 v240, v248
  s_waitcnt lgkmcnt(4)
  MF v[112:115], v[164:167], a[32:35], v[112:115]
  TR v[160:161], v2 offset:16384
  v_mov_b32 v241, v249
  MF v[116:119], v[164:167], a[36:39], v[116:119]
  TR v[162:163], v2 offset:16640
  v_cvt_pk_bf16_f32 v242, v128, v129
  MF v[120:123], v[164:167], a[40:43], v[120:123]
  v_cvt_pk_bf16_f32 v243, v130, v131
  s_add_u32 s80, s88, 0
  MF v[124:127], v[164:167], a[44:47], v[124:127]
  s_waitcnt lgkmcnt(4)
  MF v[96:99], v[168:171], a[48:51], v[96:99]
  TR v[164:165], v2 offset:18432
  MF v[100:103], v[168:171], a[52:55], v[100:103]
  TR v[166:167], v2 offset:18688
  MF v[104:107], v[168:171], a[56:59], v[104:107]
  s_add_u32 m0, s37, 81920
  s_add_u32 s89, s42, 192
  BL4 v8, s[8:11], s89 offen lds
  MF v[108:111], v[168:171], a[60:63], v[108:111]
  s_waitcnt lgkmcnt(4)
  MF v[112:115], v[172:175], a[48:51], v[112:115]
  TR v[168:169], v2 offset:20480
  MF v[116:119], v[172:175], a[52:55], v[116:119]
  TR v[170:171], v2 offset:20736
  MF v[120:123], v[172:175], a[56:59], v[120:123]
  buffer_store_dwordx4 v[240:243], v10, s[16:19], s80 offen sc1
  MF v[124:127], v[172:175], a[60:63], v[124:127]
  v_max_f32 v132, 0, v132
  s_waitcnt lgkmcnt(4)
  MF v[96:99], v[160:163], a[64:67], v[96:99]
  TR v[172:173], v2 offset:22528
  v_max_f32 v133, 0, v133
  MF v[100:103], v[160:163], a[68:71], v[100:103]
  TR v[174:175], v2 offset:22784
  v_max_f32 v134, 0, v134
  MF v[104:107], v[160:163], a[72:75], v[104:107]
  s_add_u32 m0, s37, 86016
  s_add_u32 s89, s43, 192
  BL4 v8, s[8:11], s89 offen lds
  MF v[108:111], v[160:163], a[76:79], v[108:111]
  v_max_f32 v135, 0, v135
  s_waitcnt lgkmcnt(4)
  MF v[112:115], v[164:167], a[64:67], v[112:115]
  TR v[160:161], v4
  v_mul_f32 v132, v132, v148
  MF v[116:119], v[164:167], a[68:71], v[116:119]
  TR v[162:163], v4 offset:256
  v_mul_f32 v133, v133, v149
  MF v[120:123], v[164:167], a[72:75], v[120:123]
  v_mul_f32 v134, v134, v150
  v_mul_f32 v135, v135, v151
  MF v[124:127], v[164:167], a[76:79], v[124:127]
  v_mov_b32 v244, v250
  s_waitcnt lgkmcnt(4)
  MF v[96:99], v[168:171], a[80:83], v[96:99]
  TR v[164:165], v4 offset:2048
  v_mov_b32 v245, v251
  MF v[100:103], v[168:171], a[84:87], v[100:103]
  TR v[166:167], v4 offset:2304
  v_cvt_pk_bf16_f32 v246, v132, v133
  MF v[104:107], v[168:171], a[88:91], v[104:107]
  s_add_u32 m0, s37, 90112
  s_add_u32 s89, s44, 192
  BL4 v8, s[8:11], s89 offen lds
  MF v[108:111], v[168:171], a[92:95], v[108:111]
  v_cvt_pk_bf16_f32 v247, v134, v135
  s_waitcnt lgkmcnt(4)
  MF v[112:115], v[172:175], a[80:83], v[112:115]
  TR v[168:169], v4 offset:4096
  s_add_u32 s80, s88, 185344
  MF v[116:119], v[172:175], a[84:87], v[116:119]
  TR v[170:171], v4 offset:4352
  MF v[120:123], v[172:175], a[88:91], v[120:123]
  buffer_store_dwordx4 v[244:247], v10, s[16:19], s80 offen sc1
  MF v[124:127], v[172:175], a[92:95], v[124:127]
  v_max_f32 v136, 0, v136
  v_max_f32 v137, 0, v137
  v_max_f32 v138, 0, v138
  v_max_f32 v139, 0, v139
  v_mul_f32 v136, v136, v152
  v_mul_f32 v137, v137, v153
  v_mul_f32 v138, v138, v154
  v_mul_f32 v139, v139, v155
  v_mov_b32 v240, v252
  v_mov_b32 v241, v253
  v_cvt_pk_bf16_f32 v242, v136, v137
  v_cvt_pk_bf16_f32 v243, v138, v139
  s_add_u32 s80, s88, 370688
  buffer_store_dwordx4 v[240:243], v10, s[16:19], s80 offen sc1
  v_max_f32 v140, 0, v140
  v_max_f32 v141, 0, v141
  v_max_f32 v142, 0, v142
  v_max_f32 v143, 0, v143
  v_mul_f32 v140, v140, v156
  v_mul_f32 v141, v141, v157
  v_mul_f32 v142, v142, v158
  v_mul_f32 v143, v143, v159
  v_mov_b32 v244, v254
  v_mov_b32 v245, v255
  v_cvt_pk_bf16_f32 v246, v140, v141
  v_cvt_pk_bf16_f32 v247, v142, v143
  s_add_u32 s80, s88, 556032
  buffer_store_dwordx4 v[244:247], v10, s[16:19], s80 offen sc1
  s_waitcnt lgkmcnt(4)
  MF v[128:131], v[160:163], a[0:3], 0
  TR v[172:173], v4 offset:6144
  MF v[132:135], v[160:163], a[4:7], 0
  TR v[174:175], v4 offset:6400
  MF v[136:139], v[160:163], a[8:11], 0
  s_lshl_b32 s80, s2, 3
  s_lshl_b32 s81, s32, 1
  s_add_u32 s80, s80, s81
  MF v[140:143], v[160:163], a[12:15], 0
  v_lshrrev_b32 v25, 5, v1
  s_waitcnt lgkmcnt(4)
  MF v[144:147], v[164:167], a[0:3], 0
  TR v[160:161], v4 offset:8192
  v_add_u32 v25, s80, v25
  MF v[148:151], v[164:167], a[4:7], 0
  TR v[162:163], v4 offset:8448
  v_and_b32 v26, 31, v1
  MF v[152:155], v[164:167], a[8:11], 0
  v_lshlrev_b32 v26, 2, v26
  s_mov_b32 s83, 1152
  MF v[156:159], v[164:167], a[12:15], 0
  v_mul_lo_u32 v242, v25, s83
  s_waitcnt lgkmcnt(4)
  MF v[128:131], v[168:171], a[16:19], v[128:131]
  TR v[164:165], v4 offset:10240
  v_add_u32 v242, v242, v26
  MF v[132:135], v[168:171], a[20:23], v[132:135]
  TR v[166:167], v4 offset:10496
  MF v[136:139], v[168:171], a[24:27], v[136:139]
  buffer_load_dword v224, v242, s[4:7], 0 offen
  MF v[140:143], v[168:171], a[28:31], v[140:143]
  s_waitcnt lgkmcnt(4)
  MF v[144:147], v[172:175], a[16:19], v[144:147]
  TR v[168:169], v4 offset:12288
  MF v[148:151], v[172:175], a[20:23], v[148:151]
  TR v[170:171], v4 offset:12544
  MF v[152:155], v[172:175], a[24:27], v[152:155]
  buffer_load_dword v233, v26, s[24:27], 0 offen
  MF v[156:159], v[172:175], a[28:31], v[156:159]
  s_waitcnt lgkmcnt(4)
  MF v[128:131], v[160:163], a[32:35], v[128:131]
  TR v[172:173], v4 offset:14336
  MF v[132:135], v[160:163], a[36:39], v[132:135]
  TR v[174:175], v4 offset:14592
  MF v[136:139], v[160:163], a[40:43], v[136:139]
  buffer_load_dword v225, v242, s[4:7], 0 offen offset:128
  MF v[140:143], v[160:163], a[44:47], v[140:143]
  s_waitcnt lgkmcnt(4)
  MF v[144:147], v[164:167], a[32:35], v[144:147]
  TR v[160:161], v4 offset:16384
  MF v[148:151], v[164:167], a[36:39], v[148:151]
  TR v[162:163], v4 offset:16640
  MF v[152:155], v[164:167], a[40:43], v[152:155]
  buffer_load_dword v234, v26, s[24:27], 0 offen offset:128
  MF v[156:159], v[164:167], a[44:47], v[156:159]
  s_waitcnt lgkmcnt(4)
  MF v[128:131], v[168:171], a[48:51], v[128:131]
  TR v[164:165], v4 offset:18432
  MF v[132:135], v[168:171], a[52:55], v[132:135]
  TR v[166:167], v4 offset:18688
  MF v[136:139], v[168:171], a[56:59], v[136:139]
  buffer_load_dword v226, v242, s[4:7], 0 offen offset:256
  MF v[140:143], v[168:171], a[60:63], v[140:143]
  s_waitcnt lgkmcnt(4)
  MF v[144:147], v[172:175], a[48:51], v[144:147]
  TR v[168:169], v4 offset:20480
  MF v[148:151], v[172:175], a[52:55], v[148:151]
  TR v[170:171], v4 offset:20736
  MF v[152:155], v[172:175], a[56:59], v[152:155]
  buffer_load_dword v235, v26, s[24:27], 0 offen offset:256
  MF v[156:159], v[172:175], a[60:63], v[156:159]
  s_waitcnt lgkmcnt(4)
  MF v[128:131], v[160:163], a[64:67], v[128:131]
  TR v[172:173], v4 offset:22528
  MF v[132:135], v[160:163], a[68:71], v[132:135]
  TR v[174:175], v4 offset:22784
  MF v[136:139], v[160:163], a[72:75], v[136:139]
  buffer_load_dword v227, v242, s[4:7], 0 offen offset:384
  MF v[140:143], v[160:163], a[76:79], v[140:143]
  s_waitcnt lgkmcnt(4)
  MF v[144:147], v[164:167], a[64:67], v[144:147]
  s_waitcnt vmcnt(23)
  s_barrier
  TR v[160:161], v2 offset:24576
  MF v[148:151], v[164:167], a[68:71], v[148:151]
  TR v[162:163], v2 offset:24832
  MF v[152:155], v[164:167], a[72:75], v[152:155]
  buffer_load_dword v236, v26, s[24:27], 0 offen offset:384
  MF v[156:159], v[164:167], a[76:79], v[156:159]
  s_waitcnt lgkmcnt(4)
  MF v[128:131], v[168:171], a[80:83], v[128:131]
  TR v[164:165], v2 offset:26624
  MF v[132:135], v[168:171], a[84:87], v[132:135]
  TR v[166:167], v2 offset:26880
  MF v[136:139], v[168:171], a[88:91], v[136:139]
  buffer_load_dword v228, v242, s[4:7], 0 offen offset:512
  MF v[140:143], v[168:171], a[92:95], v[140:143]
  s_waitcnt lgkmcnt(4)
  MF v[144:147], v[172:175], a[80:83], v[144:147]
  TR v[168:169], v4 offset:24576
  MF v[148:151], v[172:175], a[84:87], v[148:151]
  TR v[170:171], v4 offset:24832
  MF v[152:155], v[172:175], a[88:91], v[152:155]
  buffer_load_dword v237, v26, s[24:27], 0 offen offset:512
  MF v[156:159], v[172:175], a[92:95], v[156:159]
  s_waitcnt lgkmcnt(4)
  MF v[96:99], v[160:163], a[96:99], v[96:99]
  TR v[172:173], v4 offset:26624
  MF v[100:103], v[160:163], a[100:103], v[100:103]
  TR v[174:175], v4 offset:26880
  MF v[104:107], v[160:163], a[104:107], v[104:107]
  s_add_u32 m0, s37, 94208
  s_add_u32 s89, s45, 192
  BL4 v8, s[8:11], s89 offen lds
  MF v[108:111], v[160:163], a[108:111], v[108:111]
  s_waitcnt lgkmcnt(4)
  MF v[112:115], v[164:167], a[96:99], v[112:115]
  TR v[160:161], v2 offset:28672
  MF v[116:119], v[164:167], a[100:103], v[116:119]
  TR v[162:163], v2 offset:28928
  MF v[120:123], v[164:167], a[104:107], v[120:123]
  buffer_load_dword v229, v242, s[4:7], 0 offen offset:640
  MF v[124:127], v[164:167], a[108:111], v[124:127]
  s_waitcnt lgkmcnt(4)
  MF v[128:131], v[168:171], a[96:99], v[128:131]
  TR v[164:165], v2 offset:30720
  MF v[132:135], v[168:171], a[100:103], v[132:135]
  TR v[166:167], v2 offset:30976
  MF v[136:139], v[168:171], a[104:107], v[136:139]
  buffer_load_dword v238, v26, s[24:27], 0 offen offset:640
  MF v[140:143], v[168:171], a[108:111], v[140:143]
  s_waitcnt lgkmcnt(4)
  MF v[144:147], v[172:175], a[96:99], v[144:147]
  TR v[168:169], v4 offset:28672
  MF v[148:151], v[172:175], a[100:103], v[148:151]
  TR v[170:171], v4 offset:28928
  MF v[152:155], v[172:175], a[104:107], v[152:155]
  buffer_load_dword v230, v242, s[4:7], 0 offen offset:768
  MF v[156:159], v[172:175], a[108:111], v[156:159]
  s_waitcnt lgkmcnt(4)
  MF v[96:99], v[160:163], a[112:115], v[96:99]
  TR v[172:173], v4 offset:30720
  MF v[100:103], v[160:163], a[116:119], v[100:103]
  TR v[174:175], v4 offset:30976
  MF v[104:107], v[160:163], a[120:123], v[104:107]
  s_add_u32 m0, s37, 98304
  s_add_u32 s89, s46, 192
  BL4 v8, s[8:11], s89 offen lds
  MF v[108:111], v[160:163], a[124:127], v[108:111]
  s_waitcnt lgkmcnt(4)
  MF v[112:115], v[164:167], a[112:115], v[112:115]
  TR v[160:161], v2 offset:32768
  MF v[116:119], v[164:167], a[116:119], v[116:119]
  TR v[162:163], v2 offset:33024
  MF v[120:123], v[164:167], a[120:123], v[120:123]
  buffer_load_dword v239, v26, s[24:27], 0 offen offset:768
  MF v[124:127], v[164:167], a[124:127], v[124:127]
  s_waitcnt lgkmcnt(4)
  MF v[128:131], v[168:171], a[112:115], v[128:131]
  TR v[164:165], v2 offset:34816
  MF v[132:135], v[168:171], a[116:119], v[132:135]
  TR v[166:167], v2 offset:35072
  MF v[136:139], v[168:171], a[120:123], v[136:139]
  buffer_load_dword v231, v242, s[4:7], 0 offen offset:896
  MF v[140:143], v[168:171], a[124:127], v[140:143]
  s_waitcnt lgkmcnt(4)
  MF v[144:147], v[172:175], a[112:115], v[144:147]
  TR v[168:169], v4 offset:32768
  MF v[148:151], v[172:175], a[116:119], v[148:151]
  TR v[170:171], v4 offset:33024
  MF v[152:155], v[172:175], a[120:123], v[152:155]
  buffer_load_dword v240, v26, s[24:27], 0 offen offset:896
  MF v[156:159], v[172:175], a[124:127], v[156:159]
  s_waitcnt lgkmcnt(4)
  MF v[96:99], v[160:163], a[128:131], v[96:99]
  TR v[172:173], v4 offset:34816
  MF v[100:103], v[160:163], a[132:135], v[100:103]
  TR v[174:175], v4 offset:35072
  MF v[104:107], v[160:163], a[136:139], v[104:107]
  s_add_u32 m0, s37, 102400
  s_add_u32 s89, s47, 192
  BL4 v8, s[8:11], s89 offen lds
  MF v[108:111], v[160:163], a[140:143], v[108:111]
  s_waitcnt lgkmcnt(4)
  MF v[112:115], v[164:167], a[128:131], v[112:115]
  TR v[160:161], v2 offset:36864
  MF v[116:119], v[164:167], a[132:135], v[116:119]
  TR v[162:163], v2 offset:37120
  MF v[120:123], v[164:167], a[136:139], v[120:123]
  buffer_load_dword v232, v242, s[4:7], 0 offen offset:1024
  MF v[124:127], v[164:167], a[140:143], v[124:127]
  s_waitcnt lgkmcnt(4)
  MF v[128:131], v[168:171], a[128:131], v[128:131]
  TR v[164:165], v2 offset:38912
  MF v[132:135], v[168:171], a[132:135], v[132:135]
  TR v[166:167], v2 offset:39168
  MF v[136:139], v[168:171], a[136:139], v[136:139]
  buffer_load_dword v241, v26, s[24:27], 0 offen offset:1024
  MF v[140:143], v[168:171], a[140:143], v[140:143]
  v_mov_b32 v244, 1
  s_waitcnt lgkmcnt(4)
  MF v[144:147], v[172:175], a[128:131], v[144:147]
  TR v[168:169], v4 offset:36864
  MF v[148:151], v[172:175], a[132:135], v[148:151]
  TR v[170:171], v4 offset:37120
  MF v[152:155], v[172:175], a[136:139], v[152:155]
  s_waitcnt vmcnt(34)
  buffer_store_dword v244, v23, s[16:19], 0 offen sc1
  MF v[156:159], v[172:175], a[140:143], v[156:159]
  s_waitcnt lgkmcnt(4)
  MF v[96:99], v[160:163], a[144:147], v[96:99]
  TR v[172:173], v4 offset:38912
  MF v[100:103], v[160:163], a[148:151], v[100:103]
  TR v[174:175], v4 offset:39168
  MF v[104:107], v[160:163], a[152:155], v[104:107]
  s_add_u32 m0, s37, 106496
  s_add_u32 s89, s48, 192
  BL4 v8, s[8:11], s89 offen lds
  MF v[108:111], v[160:163], a[156:159], v[108:111]
  s_waitcnt lgkmcnt(4)
  MF v[112:115], v[164:167], a[144:147], v[112:115]
  TR v[160:161], v2 offset:40960
  MF v[116:119], v[164:167], a[148:151], v[116:119]
  TR v[162:163], v2 offset:41216
  MF v[120:123], v[164:167], a[152:155], v[120:123]
  buffer_load_dword v246, v24, s[16:19], 0 offen sc1
  MF v[124:127], v[164:167], a[156:159], v[124:127]
  v_mov_b32 v248, 0
  s_waitcnt lgkmcnt(4)
  MF v[128:131], v[168:171], a[144:147], v[128:131]
  TR v[164:165], v2 offset:43008
  v_mov_b32 v249, 0
  MF v[132:135], v[168:171], a[148:151], v[132:135]
  TR v[166:167], v2 offset:43264
  s_waitcnt vmcnt(23)
  v_lshlrev_b32 v250, 16, v224
  MF v[136:139], v[168:171], a[152:155], v[136:139]
  v_and_b32 v251, 0xffff0000, v224
  s_waitcnt vmcnt(22)
  v_lshlrev_b32 v252, 16, v233
  MF v[140:143], v[168:171], a[156:159], v[140:143]
  v_and_b32 v253, 0xffff0000, v233
  s_waitcnt lgkmcnt(4)
  MF v[144:147], v[172:175], a[144:147], v[144:147]
  TR v[168:169], v4 offset:40960
  v_mul_f32 v250, v250, v252
  MF v[148:151], v[172:175], a[148:151], v[148:151]
  TR v[170:171], v4 offset:41216
  v_mul_f32 v251, v251, v253
  MF v[152:155], v[172:175], a[152:155], v[152:155]
  v_cvt_pk_bf16_f32 v250, v250, v251
  v_lshlrev_b32 v252, 16, v250
  MF v[156:159], v[172:175], a[156:159], v[156:159]
  v_and_b32 v253, 0xffff0000, v250
  s_waitcnt lgkmcnt(4)
  MF v[96:99], v[160:163], a[160:163], v[96:99]
  TR v[172:173], v4 offset:43008
  v_add_f32 v248, v248, v252
  MF v[100:103], v[160:163], a[164:167], v[100:103]
  TR v[174:175], v4 offset:43264
  v_add_f32 v249, v249, v253
  MF v[104:107], v[160:163], a[168:171], v[104:107]
  s_add_u32 m0, s37, 110592
  s_add_u32 s89, s49, 192
  BL4 v8, s[8:11], s89 offen lds
  MF v[108:111], v[160:163], a[172:175], v[108:111]
  s_waitcnt vmcnt(22)
  v_lshlrev_b32 v250, 16, v225
  s_waitcnt lgkmcnt(4)
  MF v[112:115], v[164:167], a[160:163], v[112:115]
  TR v[160:161], v2 offset:45056
  v_and_b32 v251, 0xffff0000, v225
  MF v[116:119], v[164:167], a[164:167], v[116:119]
  TR v[162:163], v2 offset:45312
  s_waitcnt vmcnt(21)
  v_lshlrev_b32 v252, 16, v234
  MF v[120:123], v[164:167], a[168:171], v[120:123]
  v_and_b32 v253, 0xffff0000, v234
  v_mul_f32 v250, v250, v252
  MF v[124:127], v[164:167], a[172:175], v[124:127]
  v_mul_f32 v251, v251, v253
  s_waitcnt lgkmcnt(4)
  MF v[128:131], v[168:171], a[160:163], v[128:131]
  TR v[164:165], v2 offset:47104
  v_cvt_pk_bf16_f32 v250, v250, v251
  MF v[132:135], v[168:171], a[164:167], v[132:135]
  TR v[166:167], v2 offset:47360
  v_lshlrev_b32 v252, 16, v250
  MF v[136:139], v[168:171], a[168:171], v[136:139]
  v_and_b32 v253, 0xffff0000, v250
  v_add_f32 v248, v248, v252
  MF v[140:143], v[168:171], a[172:175], v[140:143]
  v_add_f32 v249, v249, v253
  s_waitcnt lgkmcnt(4)
  MF v[144:147], v[172:175], a[160:163], v[144:147]
  TR v[168:169], v4 offset:45056
  s_waitcnt vmcnt(20)
  v_lshlrev_b32 v250, 16, v226
  MF v[148:151], v[172:175], a[164:167], v[148:151]
  TR v[170:171], v4 offset:45312
  v_and_b32 v251, 0xffff0000, v226
  MF v[152:155], v[172:175], a[168:171], v[152:155]
  s_waitcnt vmcnt(19)
  v_lshlrev_b32 v252, 16, v235
  v_and_b32 v253, 0xffff0000, v235
  MF v[156:159], v[172:175], a[172:175], v[156:159]
  v_mul_f32 v250, v250, v252
  s_waitcnt lgkmcnt(4)
  MF v[96:99], v[160:163], a[176:179], v[96:99]
  TR v[172:173], v4 offset:47104
  v_mul_f32 v251, v251, v253
  MF v[100:103], v[160:163], a[180:183], v[100:103]
  TR v[174:175], v4 offset:47360
  v_cvt_pk_bf16_f32 v250, v250, v251
  MF v[104:107], v[160:163], a[184:187], v[104:107]
  s_add_u32 m0, s37, 114688
  s_add_u32 s89, s50, 192
  BL4 v8, s[8:11], s89 offen lds
  MF v[108:111], v[160:163], a[188:191], v[108:111]
  v_lshlrev_b32 v252, 16, v250
  s_waitcnt lgkmcnt(4)
  MF v[112:115], v[164:167], a[176:179], v[112:115]
  s_barrier
  TR v[160:161], v2 offset:49152
  v_and_b32 v253, 0xffff0000, v250
  MF v[116:119], v[164:167], a[180:183], v[116:119]
  TR v[162:163], v2 offset:49408
  v_add_f32 v248, v248, v252
  MF v[120:123], v[164:167], a[184:187], v[120:123]
  v_add_f32 v249, v249, v253
  s_waitcnt vmcnt(19)
  v_lshlrev_b32 v250, 16, v227
  MF v[124:127], v[164:167], a[188:191], v[124:127]
  v_and_b32 v251, 0xffff0000, v227
  s_waitcnt lgkmcnt(4)
  MF v[128:131], v[168:171], a[176:179], v[128:131]
  TR v[164:165], v2 offset:51200
  s_waitcnt vmcnt(18)
  v_lshlrev_b32 v252, 16, v236
  MF v[132:135], v[168:171], a[180:183], v[132:135]
  TR v[166:167], v2 offset:51456
  v_and_b32 v253, 0xffff0000, v236
  MF v[136:139], v[168:171], a[184:187], v[136:139]
  v_mul_f32 v250, v250, v252
  v_mul_f32 v251, v251, v253
  MF v[140:143], v[168:171], a[188:191], v[140:143]
  v_cvt_pk_bf16_f32 v250, v250, v251
  s_waitcnt lgkmcnt(4)
  MF v[144:147], v[172:175], a[176:179], v[144:147]
  TR v[168:169], v2 offset:53248
  v_lshlrev_b32 v252, 16, v250
  MF v[148:151], v[172:175], a[180:183], v[148:151]
  TR v[170:171], v2 offset:53504
  v_and_b32 v253, 0xffff0000, v250
  MF v[152:155], v[172:175], a[184:187], v[152:155]
  v_add_f32 v248, v248, v252
  v_add_f32 v249, v249, v253
  MF v[156:159], v[172:175], a[188:191], v[156:159]
  s_waitcnt vmcnt(17)
  v_lshlrev_b32 v250, 16, v228
  s_waitcnt lgkmcnt(4)
  MF v[96:99], v[160:163], a[192:195], v[96:99]
  TR v[172:173], v2 offset:55296
  v_and_b32 v251, 0xffff0000, v228
  MF v[100:103], v[160:163], a[196:199], v[100:103]
  TR v[174:175], v2 offset:55552
  s_waitcnt vmcnt(16)
  v_lshlrev_b32 v252, 16, v237
  MF v[104:107], v[160:163], a[200:203], v[104:107]
  s_add_u32 m0, s37, 118784
  s_add_u32 s89, s51, 192
  BL4 v8, s[8:11], s89 offen lds
  MF v[108:111], v[160:163], a[204:207], v[108:111]
  v_and_b32 v253, 0xffff0000, v237
  s_waitcnt lgkmcnt(4)
  MF v[112:115], v[164:167], a[192:195], v[112:115]
  TR v[160:161], v2 offset:57344
  v_mul_f32 v250, v250, v252
  MF v[116:119], v[164:167], a[196:199], v[116:119]
  TR v[162:163], v2 offset:57600
  v_mul_f32 v251, v251, v253
  MF v[120:123], v[164:167], a[200:203], v[120:123]
  v_cvt_pk_bf16_f32 v250, v250, v251
  v_lshlrev_b32 v252, 16, v250
  MF v[124:127], v[164:167], a[204:207], v[124:127]
  v_and_b32 v253, 0xffff0000, v250
  s_waitcnt lgkmcnt(4)
  MF v[96:99], v[168:171], a[208:211], v[96:99]
  TR v[164:165], v2 offset:59392
  v_add_f32 v248, v248, v252
  MF v[100:103], v[168:171], a[212:215], v[100:103]
  TR v[166:167], v2 offset:59648
  v_add_f32 v249, v249, v253
  MF v[104:107], v[168:171], a[216:219], v[104:107]
  s_add_u32 m0, s37, 0
  s_add_u32 s89, s52, 192
  BL4 v8, s[8:11], s89 offen lds
  MF v[108:111], v[168:171], a[220:223], v[108:111]
  s_waitcnt vmcnt(16)
  v_lshlrev_b32 v250, 16, v229
  s_waitcnt lgkmcnt(4)
  MF v[112:115], v[172:175], a[208:211], v[112:115]
  TR v[168:169], v3
  v_and_b32 v251, 0xffff0000, v229
  MF v[116:119], v[172:175], a[212:215], v[116:119]
  TR v[170:171], v3 offset:256
  s_waitcnt vmcnt(15)
  v_lshlrev_b32 v252, 16, v238
  MF v[120:123], v[172:175], a[216:219], v[120:123]
  v_and_b32 v253, 0xffff0000, v238
  v_mul_f32 v250, v250, v252
  MF v[124:127], v[172:175], a[220:223], v[124:127]
  v_mul_f32 v251, v251, v253
  s_waitcnt lgkmcnt(4)
  MF v[96:99], v[160:163], a[224:227], v[96:99]
  TR v[172:173], v3 offset:2048
  v_cvt_pk_bf16_f32 v250, v250, v251
  MF v[100:103], v[160:163], a[228:231], v[100:103]
  TR v[174:175], v3 offset:2304
  v_lshlrev_b32 v252, 16, v250
  MF v[104:107], v[160:163], a[232:235], v[104:107]
  s_add_u32 m0, s37, 4096
  s_add_u32 s89, s53, 192
  BL4 v8, s[8:11], s89 offen lds
  MF v[108:111], v[160:163], a[236:239], v[108:111]
  v_and_b32 v253, 0xffff0000, v250
  s_waitcnt lgkmcnt(4)
  MF v[112:115], v[164:167], a[224:227], v[112:115]
  TR v[160:161], v3 offset:4096
  v_add_f32 v248, v248, v252
  MF v[116:119], v[164:167], a[228:231], v[116:119]
  TR v[162:163], v3 offset:4352
  v_add_f32 v249, v249, v253
  MF v[120:123], v[164:167], a[232:235], v[120:123]
  s_waitcnt vmcnt(15)
  v_lshlrev_b32 v250, 16, v230
  v_and_b32 v251, 0xffff0000, v230
  MF v[124:127], v[164:167], a[236:239], v[124:127]
  s_waitcnt vmcnt(13)
  v_lshlrev_b32 v252, 16, v239
  s_waitcnt lgkmcnt(4)
  MF v[96:99], v[168:171], a[240:243], v[96:99]
  TR v[164:165], v3 offset:6144
  v_and_b32 v253, 0xffff0000, v239
  MF v[100:103], v[168:171], a[244:247], v[100:103]
  TR v[166:167], v3 offset:6400
  v_mul_f32 v250, v250, v252
  MF v[104:107], v[168:171], a[248:251], v[104:107]
  s_add_u32 m0, s37, 8192
  s_add_u32 s89, s54, 192
  BL4 v8, s[8:11], s89 offen lds
  MF v[108:111], v[168:171], a[252:255], v[108:111]
  v_mul_f32 v251, v251, v253
  s_waitcnt lgkmcnt(4)
  MF v[112:115], v[172:175], a[240:243], v[112:115]
  TR v[168:169], v3 offset:8192
  v_cvt_pk_bf16_f32 v250, v250, v251
  MF v[116:119], v[172:175], a[244:247], v[116:119]
  TR v[170:171], v3 offset:8448
  v_lshlrev_b32 v252, 16, v250
  MF v[120:123], v[172:175], a[248:251], v[120:123]
  v_and_b32 v253, 0xffff0000, v250
  v_add_f32 v248, v248, v252
  MF v[124:127], v[172:175], a[252:255], v[124:127]
  v_add_f32 v249, v249, v253
  s_waitcnt lgkmcnt(4)
  MF v[96:99], v[160:163], v[176:179], v[96:99]
  TR v[172:173], v3 offset:10240
  s_waitcnt vmcnt(13)
  v_lshlrev_b32 v250, 16, v231
  MF v[100:103], v[160:163], v[180:183], v[100:103]
  TR v[174:175], v3 offset:10496
  v_and_b32 v251, 0xffff0000, v231
  MF v[104:107], v[160:163], v[184:187], v[104:107]
  s_add_u32 m0, s37, 12288
  s_add_u32 s89, s55, 192
  BL4 v8, s[8:11], s89 offen lds
  MF v[108:111], v[160:163], v[188:191], v[108:111]
  s_waitcnt vmcnt(13)
  v_lshlrev_b32 v252, 16, v240
  s_waitcnt lgkmcnt(4)
  MF v[112:115], v[164:167], v[176:179], v[112:115]
  TR v[160:161], v4 offset:49152
  v_and_b32 v253, 0xffff0000, v240
  MF v[116:119], v[164:167], v[180:183], v[116:119]
  TR v[162:163], v4 offset:49408
  v_mul_f32 v250, v250, v252
  MF v[120:123], v[164:167], v[184:187], v[120:123]
  v_mul_f32 v251, v251, v253
  v_cvt_pk_bf16_f32 v250, v250, v251
  MF v[124:127], v[164:167], v[188:191], v[124:127]
  v_lshlrev_b32 v252, 16, v250
  s_waitcnt lgkmcnt(4)
  MF v[96:99], v[168:171], v[192:195], v[96:99]
  TR v[164:165], v4 offset:51200
  v_and_b32 v253, 0xffff0000, v250
  MF v[100:103], v[168:171], v[196:199], v[100:103]
  TR v[166:167], v4 offset:51456
  v_add_f32 v248, v248, v252
  MF v[104:107], v[168:171], v[200:203], v[104:107]
  s_add_u32 m0, s37, 16384
  s_add_u32 s89, s56, 192
  BL4 v8, s[8:11], s89 offen lds
  MF v[108:111], v[168:171], v[204:207], v[108:111]
  v_add_f32 v249, v249, v253
  s_waitcnt lgkmcnt(4)
  MF v[112:115], v[172:175], v[192:195], v[112:115]
  TR v[168:169], v4 offset:53248
  s_waitcnt vmcnt(12)
  v_lshlrev_b32 v250, 16, v232
  MF v[116:119], v[172:175], v[196:199], v[116:119]
  TR v[170:171], v4 offset:53504
  v_and_b32 v251, 0xffff0000, v232
  MF v[120:123], v[172:175], v[200:203], v[120:123]
  s_waitcnt vmcnt(11)
  v_lshlrev_b32 v252, 16, v241
  v_and_b32 v253, 0xffff0000, v241
  MF v[124:127], v[172:175], v[204:207], v[124:127]
  v_mul_f32 v250, v250, v252
  s_waitcnt lgkmcnt(4)
  MF v[128:131], v[160:163], a[192:195], v[128:131]
  TR v[172:173], v4 offset:55296
  v_mul_f32 v251, v251, v253
  MF v[132:135], v[160:163], a[196:199], v[132:135]
  TR v[174:175], v4 offset:55552
  v_cvt_pk_bf16_f32 v250, v250, v251
  MF v[136:139], v[160:163], a[200:203], v[136:139]
  v_lshlrev_b32 v252, 16, v250
  v_and_b32 v253, 0xffff0000, v250
  MF v[140:143], v[160:163], a[204:207], v[140:143]
  v_add_f32 v248, v248, v252
  s_waitcnt lgkmcnt(4)
  MF v[144:147], v[164:167], a[192:195], v[144:147]
  TR v[160:161], v4 offset:57344
  v_add_f32 v249, v249, v253
  MF v[148:151], v[164:167], a[196:199], v[148:151]
  TR v[162:163], v4 offset:57600
  v_add_f32 v248, v248, v249
  MF v[152:155], v[164:167], a[200:203], v[152:155]
  s_nop 0
  v_add_f32_dpp v248, v248, v248 row_shr:1 row_mask:0xf bank_mask:0xf bound_ctrl:1
  s_nop 1
  v_add_f32_dpp v248, v248, v248 row_shr:2 row_mask:0xf bank_mask:0xf bound_ctrl:1
  MF v[156:159], v[164:167], a[204:207], v[156:159]
  s_nop 0
  v_add_f32_dpp v248, v248, v248 row_shr:4 row_mask:0xf bank_mask:0xf bound_ctrl:1
  s_waitcnt lgkmcnt(4)
  MF v[128:131], v[168:171], a[208:211], v[128:131]
  TR v[164:165], v4 offset:59392
  v_add_f32_dpp v248, v248, v248 row_shr:8 row_mask:0xf bank_mask:0xf bound_ctrl:1
  MF v[132:135], v[168:171], a[212:215], v[132:135]
  TR v[166:167], v4 offset:59648
  v_add_f32_dpp v248, v248, v248 row_bcast:15 row_mask:0xa bank_mask:0xf
  MF v[136:139], v[168:171], a[216:219], v[136:139]
  v_cvt_pk_bf16_f32 v248, v248, v248
  v_lshlrev_b32 v248, 16, v248
  MF v[140:143], v[168:171], a[220:223], v[140:143]
  v_mul_f32 v248, 0xbfb8aa3b, v248
  s_waitcnt lgkmcnt(4)
  MF v[144:147], v[172:175], a[208:211], v[144:147]
  TR v[168:169], v5
  v_exp_f32 v248, v248
  MF v[148:151], v[172:175], a[212:215], v[148:151]
  TR v[170:171], v5 offset:256
  v_add_f32 v248, 1.0, v248
  MF v[152:155], v[172:175], a[216:219], v[152:155]
  v_rcp_f32 v248, v248
  s_nop 0
  v_cvt_pk_bf16_f32 v248, v248, v248
  MF v[156:159], v[172:175], a[220:223], v[156:159]
  v_lshlrev_b32 v248, 16, v248
  s_waitcnt lgkmcnt(4)
  MF v[128:131], v[160:163], a[224:227], v[128:131]
  TR v[172:173], v5 offset:2048
  v_lshlrev_b32 v250, 2, v25
  MF v[132:135], v[160:163], a[228:231], v[132:135]
  TR v[174:175], v5 offset:2304
  v_add_u32 v250, 32505856, v250
  MF v[136:139], v[160:163], a[232:235], v[136:139]
  v_and_b32 v251, 31, v1
  MF v[140:143], v[160:163], a[236:239], v[140:143]
  s_waitcnt lgkmcnt(4)
  MF v[144:147], v[164:167], a[224:227], v[144:147]
  TR v[160:161], v5 offset:4096
  MF v[148:151], v[164:167], a[228:231], v[148:151]
  TR v[162:163], v5 offset:4352
  MF v[152:155], v[164:167], a[232:235], v[152:155]
  v_cmp_eq_u32 vcc, 31, v251
  v_mov_b32 v251, 1073741824
  s_nop 0
  v_cndmask_b32 v250, v251, v250, vcc
  MF v[156:159], v[164:167], a[236:239], v[156:159]
  s_waitcnt lgkmcnt(4)
  MF v[128:131], v[168:171], a[240:243], v[128:131]
  TR v[164:165], v5 offset:6144
  MF v[132:135], v[168:171], a[244:247], v[132:135]
  TR v[166:167], v5 offset:6400
  MF v[136:139], v[168:171], a[248:251], v[136:139]
  buffer_store_dword v248, v250, s[16:19], 0 offen sc1
  MF v[140:143], v[168:171], a[252:255], v[140:143]
  s_waitcnt lgkmcnt(4)
  MF v[144:147], v[172:175], a[240:243], v[144:147]
  TR v[168:169], v5 offset:8192
  MF v[148:151], v[172:175], a[244:247], v[148:151]
  TR v[170:171], v5 offset:8448
  MF v[152:155], v[172:175], a[248:251], v[152:155]
  s_mov_b32 s82, 262144
POLLE5:
  s_waitcnt vmcnt(9)
  v_cmp_eq_u32 vcc, 1, v246
  s_nop 1
  s_and_b32 s80, vcc_lo, s86
  s_cmp_eq_u32 s80, s86
  s_cbranch_scc1 POLLEDE5
  s_sub_u32 s82, s82, 1
  s_cbranch_scc1 POLLEDE5
  s_sleep 2
  buffer_load_dword v246, v24, s[16:19], 0 offen sc1
  s_waitcnt vmcnt(0)
  s_branch POLLE5
POLLEDE5:
  MF v[156:159], v[172:175], a[252:255], v[156:159]
  s_sub_u32 s80, s33, 7
  s_lshl_b32 s81, s80, 7
  s_waitcnt lgkmcnt(4)
  MF v[128:131], v[160:163], v[176:179], v[128:131]
  TR v[172:173], v5 offset:10240
  s_cmp_ge_u32 s33, 7
  s_cselect_b32 s81, s81, 1073741824
  MF v[132:135], v[160:163], v[180:183], v[132:135]
  TR v[174:175], v5 offset:10496
  MF v[136:139], v[160:163], v[184:187], v[136:139]
  buffer_load_dwordx2 v[224:225], v15, s[16:19], s81 offen sc1
  MF v[140:143], v[160:163], v[188:191], v[140:143]
  s_sub_u32 s80, s33, 6
  s_lshl_b32 s81, s80, 7
  s_waitcnt lgkmcnt(4)
  MF v[144:147], v[164:167], v[176:179], v[144:147]
  s_barrier
  TR v[160:161], v3 offset:12288
  s_cmp_ge_u32 s33, 6
  s_cselect_b32 s81, s81, 1073741824
  MF v[148:151], v[164:167], v[180:183], v[148:151]
  TR v[162:163], v3 offset:12544
  MF v[152:155], v[164:167], v[184:187], v[152:155]
  buffer_load_dwordx2 v[226:227], v15, s[16:19], s81 offen sc1
  MF v[156:159], v[164:167], v[188:191], v[156:159]
  s_sub_u32 s80, s33, 5
  s_lshl_b32 s81, s80, 7
  s_waitcnt lgkmcnt(4)
  MF v[128:131], v[168:171], v[192:195], v[128:131]
  TR v[164:165], v3 offset:14336
  s_cmp_ge_u32 s33, 5
  s_cselect_b32 s81, s81, 1073741824
  MF v[132:135], v[168:171], v[196:199], v[132:135]
  TR v[166:167], v3 offset:14592
  MF v[136:139], v[168:171], v[200:203], v[136:139]
  buffer_load_dwordx2 v[228:229], v15, s[16:19], s81 offen sc1
  MF v[140:143], v[168:171], v[204:207], v[140:143]
  s_sub_u32 s80, s33, 4
  s_lshl_b32 s81, s80, 7
  s_waitcnt lgkmcnt(4)
  MF v[144:147], v[172:175], v[192:195], v[144:147]
  TR v[168:169], v3 offset:16384
  s_cmp_ge_u32 s33, 4
  s_cselect_b32 s81, s81, 1073741824
  MF v[148:151], v[172:175], v[196:199], v[148:151]
  TR v[170:171], v3 offset:16640
  MF v[152:155], v[172:175], v[200:203], v[152:155]
  buffer_load_dwordx2 v[230:231], v15, s[16:19], s81 offen sc1
  MF v[156:159], v[172:175], v[204:207], v[156:159]
  s_sub_u32 s80, s33, 3
  s_lshl_b32 s81, s80, 7
  s_cmp_ge_u32 s33, 3
  s_cselect_b32 s81, s81, 1073741824
  buffer_load_dwordx2 v[232:233], v15, s[16:19], s81 offen sc1
  s_sub_u32 s80, s33, 2
  s_lshl_b32 s81, s80, 7
  s_cmp_ge_u32 s33, 2
  s_cselect_b32 s81, s81, 1073741824
  buffer_load_dwordx2 v[234:235], v15, s[16:19], s81 offen sc1
  s_sub_u32 s80, s33, 1
  s_lshl_b32 s81, s80, 7
  s_cmp_ge_u32 s33, 1
  s_cselect_b32 s81, s81, 1073741824
  buffer_load_dwordx2 v[236:237], v15, s[16:19], s81 offen sc1
  v_max_f32 v96, 0, v96
  v_max_f32 v97, 0, v97
  v_max_f32 v98, 0, v98
  v_max_f32 v99, 0, v99
  v_mul_f32 v96, v96, v112
  v_mul_f32 v97, v97, v113
  v_mul_f32 v98, v98, v114
  v_mul_f32 v99, v99, v115
  v_cvt_pk_bf16_f32 v248, v96, v97
  v_cvt_pk_bf16_f32 v249, v98, v99
  v_max_f32 v100, 0, v100
  v_max_f32 v101, 0, v101
  v_max_f32 v102, 0, v102
  v_max_f32 v103, 0, v103
  v_mul_f32 v100, v100, v116
  v_mul_f32 v101, v101, v117
  v_mul_f32 v102, v102, v118
  v_mul_f32 v103, v103, v119
  v_cvt_pk_bf16_f32 v250, v100, v101
  v_cvt_pk_bf16_f32 v251, v102, v103
  v_max_f32 v104, 0, v104
  v_max_f32 v105, 0, v105
  v_max_f32 v106, 0, v106
  v_max_f32 v107, 0, v107
  v_mul_f32 v104, v104, v120
  v_mul_f32 v105, v105, v121
  v_mul_f32 v106, v106, v122
  v_mul_f32 v107, v107, v123
  v_cvt_pk_bf16_f32 v252, v104, v105
  v_cvt_pk_bf16_f32 v253, v106, v107
  v_max_f32 v108, 0, v108
  v_max_f32 v109, 0, v109
  v_max_f32 v110, 0, v110
  v_max_f32 v111, 0, v111
  v_mul_f32 v108, v108, v124
  v_mul_f32 v109, v109, v125
  v_mul_f32 v110, v110, v126
  v_mul_f32 v111, v111, v127
  v_cvt_pk_bf16_f32 v254, v108, v109
  v_cvt_pk_bf16_f32 v255, v110, v111
K1_TA1_G3:
  s_waitcnt lgkmcnt(4)
  MF v[96:99], v[160:163], a[0:3], 0
  TR v[172:173], v3 offset:18432
  MF v[100:103], v[160:163], a[4:7], 0
  TR v[174:175], v3 offset:18688
  MF v[104:107], v[160:163], a[8:11], 0
  s_add_u32 m0, s37, 20480
  s_add_u32 s89, s57, 192
  BL4 v8, s[8:11], s89 offen lds
  MF v[108:111], v[160:163], a[12:15], 0
  s_waitcnt lgkmcnt(4)
  MF v[112:115], v[164:167], a[0:3], 0
  TR v[160:161], v3 offset:20480
  MF v[116:119], v[164:167], a[4:7], 0
  TR v[162:163], v3 offset:20736
  MF v[120:123], v[164:167], a[8:11], 0
  MF v[124:127], v[164:167], a[12:15], 0
  s_waitcnt lgkmcnt(4)
  MF v[96:99], v[168:171], a[16:19], v[96:99]
  TR v[164:165], v3 offset:22528
  MF v[100:103], v[168:171], a[20:23], v[100:103]
  TR v[166:167], v3 offset:22784
  s_add_u32 s88, s36, 2
  s_lshl_b32 s88, s88, 10
  MF v[104:107], v[168:171], a[24:27], v[104:107]
  s_add_u32 m0, s37, 24576
  s_add_u32 s89, s40, 256
  BL4 v8, s[8:11], s89 offen lds
  MF v[108:111], v[168:171], a[28:31], v[108:111]
  v_max_f32 v128, 0, v128
  s_waitcnt lgkmcnt(4)
  MF v[112:115], v[172:175], a[16:19], v[112:115]
  TR v[168:169], v3 offset:24576
  v_max_f32 v129, 0, v129
  MF v[116:119], v[172:175], a[20:23], v[116:119]
  TR v[170:171], v3 offset:24832
  v_max_f32 v130, 0, v130
  MF v[120:123], v[172:175], a[24:27], v[120:123]
  v_max_f32 v131, 0, v131
  v_mul_f32 v128, v128, v144
  MF v[124:127], v[172:175], a[28:31], v[124:127]
  v_mul_f32 v129, v129, v145
  s_waitcnt lgkmcnt(4)
  MF v[96:99], v[160:163], a[32:35], v[96:99]
  TR v[172:173], v3 offset:26624
  v_mul_f32 v130, v130, v146
  MF v[100:103], v[160:163], a[36:39], v[100:103]
  TR v[174:175], v3 offset:26880
  v_mul_f32 v131, v131, v147
  MF v[104:107], v[160:163], a[40:43], v[104:107]
  s_add_u32 m0, s37, 28672
  s_add_u32 s89, s41, 256
  BL4 v8, s[8:11], s89 offen lds
  MF v[108:111], v[160:163], a[44:47], v[108:111]
  v_mov_b32 v240, v248
  s_waitcnt lgkmcnt(4)
  MF v[112:115], v[164:167], a[32:35], v[112:115]
  TR v[160:161], v3 offset:28672
  v_mov_b32 v241, v249
  MF v[116:119], v[164:167], a[36:39], v[116:119]
  TR v[162:163], v3 offset:28928
  v_cvt_pk_bf16_f32 v242, v128, v129
  MF v[120:123], v[164:167], a[40:43], v[120:123]
  v_cvt_pk_bf16_f32 v243, v130, v131
  s_add_u32 s80, s88, 0
  MF v[124:127], v[164:167], a[44:47], v[124:127]
  s_waitcnt lgkmcnt(4)
  MF v[96:99], v[168:171], a[48:51], v[96:99]
  TR v[164:165], v3 offset:30720
  MF v[100:103], v[168:171], a[52:55], v[100:103]
  TR v[166:167], v3 offset:30976
  MF v[104:107], v[168:171], a[56:59], v[104:107]
  s_add_u32 m0, s37, 32768
  s_add_u32 s89, s42, 256
  BL4 v8, s[8:11], s89 offen lds
  MF v[108:111], v[168:171], a[60:63], v[108:111]
  s_waitcnt lgkmcnt(4)
  MF v[112:115], v[172:175], a[48:51], v[112:115]
  TR v[168:169], v3 offset:32768
  MF v[116:119], v[172:175], a[52:55], v[116:119]
  TR v[170:171], v3 offset:33024
  MF v[120:123], v[172:175], a[56:59], v[120:123]
  buffer_store_dwordx4 v[240:243], v10, s[16:19], s80 offen sc1
  MF v[124:127], v[172:175], a[60:63], v[124:127]
  v_max_f32 v132, 0, v132
  s_waitcnt lgkmcnt(4)
  MF v[96:99], v[160:163], a[64:67], v[96:99]
  TR v[172:173], v3 offset:34816
  v_max_f32 v133, 0, v133
  MF v[100:103], v[160:163], a[68:71], v[100:103]
  TR v[174:175], v3 offset:35072
  v_max_f32 v134, 0, v134
  MF v[104:107], v[160:163], a[72:75], v[104:107]
  s_add_u32 m0, s37, 36864
  s_add_u32 s89, s43, 256
  BL4 v8, s[8:11], s89 offen lds
  MF v[108:111], v[160:163], a[76:79], v[108:111]
  v_max_f32 v135, 0, v135
  s_waitcnt lgkmcnt(4)
  MF v[112:115], v[164:167], a[64:67], v[112:115]
  TR v[160:161], v5 offset:12288
  v_mul_f32 v132, v132, v148
  MF v[116:119], v[164:167], a[68:71], v[116:119]
  TR v[162:163], v5 offset:12544
  v_mul_f32 v133, v133, v149
  MF v[120:123], v[164:167], a[72:75], v[120:123]
  v_mul_f32 v134, v134, v150
  v_mul_f32 v135, v135, v151
  MF v[124:127], v[164:167], a[76:79], v[124:127]
  v_mov_b32 v244, v250
  s_waitcnt lgkmcnt(4)
  MF v[96:99], v[168:171], a[80:83], v[96:99]
  TR v[164:165], v5 offset:14336
  v_mov_b32 v245, v251
  MF v[100:103], v[168:171], a[84:87], v[100:103]
  TR v[166:167], v5 offset:14592
  v_cvt_pk_bf16_f32 v246, v132, v133
  MF v[104:107], v[168:171], a[88:91], v[104:107]
  s_add_u32 m0, s37, 40960
  s_add_u32 s89, s44, 256
  BL4 v8, s[8:11], s89 offen lds
  MF v[108:111], v[168:171], a[92:95], v[108:111]
  v_cvt_pk_bf16_f32 v247, v134, v135
  s_waitcnt lgkmcnt(4)
  MF v[112:115], v[172:175], a[80:83], v[112:115]
  TR v[168:169], v5 offset:16384
  s_add_u32 s80, s88, 185344
  MF v[116:119], v[172:175], a[84:87], v[116:119]
  TR v[170:171], v5 offset:16640
  MF v[120:123], v[172:175], a[88:91], v[120:123]
  buffer_store_dwordx4 v[244:247], v10, s[16:19], s80 offen sc1
  MF v[124:127], v[172:175], a[92:95], v[124:127]
  v_max_f32 v136, 0, v136
  v_max_f32 v137, 0, v137
  v_max_f32 v138, 0, v138
  v_max_f32 v139, 0, v139
  v_mul_f32 v136, v136, v152
  v_mul_f32 v137, v137, v153
  v_mul_f32 v138, v138, v154
  v_mul_f32 v139, v139, v155
  v_mov_b32 v240, v252
  v_mov_b32 v241, v253
  v_cvt_pk_bf16_f32 v242, v136, v137
  v_cvt_pk_bf16_f32 v243, v138, v139
  s_add_u32 s80, s88, 370688
  buffer_store_dwordx4 v[240:243], v10, s[16:19], s80 offen sc1
  v_max_f32 v140, 0, v140
  v_max_f32 v141, 0, v141
  v_max_f32 v142, 0, v142
  v_max_f32 v143, 0, v143
  v_mul_f32 v140, v140, v156
  v_mul_f32 v141, v141, v157
  v_mul_f32 v142, v142, v158
  v_mul_f32 v143, v143, v159
  v_mov_b32 v244, v254
  v_mov_b32 v245, v255
  v_cvt_pk_bf16_f32 v246, v140, v141
  v_cvt_pk_bf16_f32 v247, v142, v143
  s_add_u32 s80, s88, 556032
  buffer_store_dwordx4 v[244:247], v10, s[16:19], s80 offen sc1
  s_waitcnt lgkmcnt(4)
  MF v[128:131], v[160:163], a[0:3], 0
  TR v[172:173], v5 offset:18432
  v_mul_f32 v240, 0x43800000, v208
  MF v[132:135], v[160:163], a[4:7], 0
  TR v[174:175], v5 offset:18688
  v_mul_f32 v241, 0x43800000, v209
  MF v[136:139], v[160:163], a[8:11], 0
  v_exp_f32 v238, v240
  v_fract_f32 v241, v241
  MF v[140:143], v[160:163], a[12:15], 0
  v_cos_f32 v240, v241
  s_waitcnt lgkmcnt(4)
  MF v[144:147], v[164:167], a[0:3], 0
  TR v[160:161], v5 offset:20480
  v_sin_f32 v241, v241
  MF v[148:151], v[164:167], a[4:7], 0
  TR v[162:163], v5 offset:20736
  v_mul_f32 v239, v238, v241
  MF v[152:155], v[164:167], a[8:11], 0
  v_mul_f32 v238, v238, v240
  MF v[156:159], v[164:167], a[12:15], 0
  s_waitcnt lgkmcnt(4)
  MF v[128:131], v[168:171], a[16:19], v[128:131]
  TR v[164:165], v5 offset:22528
  MF v[132:135], v[168:171], a[20:23], v[132:135]
  TR v[166:167], v5 offset:22784
  MF v[136:139], v[168:171], a[24:27], v[136:139]
  MF v[140:143], v[168:171], a[28:31], v[140:143]
  s_waitcnt lgkmcnt(4)
  MF v[144:147], v[172:175], a[16:19], v[144:147]
  TR v[168:169], v5 offset:24576
  s_waitcnt vmcnt(15)
  v_fma_f32 v226, v238, v224, v226
  MF v[148:151], v[172:175], a[20:23], v[148:151]
  TR v[170:171], v5 offset:24832
  v_fma_f32 v227, v238, v225, v227
  MF v[152:155], v[172:175], a[24:27], v[152:155]
  v_fma_f32 v226, -v239, v225, v226
  v_fma_f32 v227, v239, v224, v227
  MF v[156:159], v[172:175], a[28:31], v[156:159]
  s_waitcnt lgkmcnt(4)
  MF v[128:131], v[160:163], a[32:35], v[128:131]
  TR v[172:173], v5 offset:26624
  s_waitcnt vmcnt(14)
  v_fma_f32 v228, v238, v226, v228
  MF v[132:135], v[160:163], a[36:39], v[132:135]
  TR v[174:175], v5 offset:26880
  v_fma_f32 v229, v238, v227, v229
  MF v[136:139], v[160:163], a[40:43], v[136:139]
  v_fma_f32 v228, -v239, v227, v228
  v_fma_f32 v229, v239, v226, v229
  MF v[140:143], v[160:163], a[44:47], v[140:143]
  s_waitcnt lgkmcnt(4)
  MF v[144:147], v[164:167], a[32:35], v[144:147]
  TR v[160:161], v5 offset:28672
  s_waitcnt vmcnt(13)
  v_fma_f32 v230, v238, v228, v230
  MF v[148:151], v[164:167], a[36:39], v[148:151]
  TR v[162:163], v5 offset:28928
  v_fma_f32 v231, v238, v229, v231
  MF v[152:155], v[164:167], a[40:43], v[152:155]
  v_fma_f32 v230, -v239, v229, v230
  v_fma_f32 v231, v239, v228, v231
  MF v[156:159], v[164:167], a[44:47], v[156:159]
  s_waitcnt vmcnt(12)
  v_fma_f32 v232, v238, v230, v232
  s_waitcnt lgkmcnt(4)
  MF v[128:131], v[168:171], a[48:51], v[128:131]
  TR v[164:165], v5 offset:30720
  v_fma_f32 v233, v238, v231, v233
  MF v[132:135], v[168:171], a[52:55], v[132:135]
  TR v[166:167], v5 offset:30976
  v_fma_f32 v232, -v239, v231, v232
  MF v[136:139], v[168:171], a[56:59], v[136:139]
  v_fma_f32 v233, v239, v230, v233
  s_waitcnt vmcnt(11)
  v_fma_f32 v234, v238, v232, v234
  MF v[140:143], v[168:171], a[60:63], v[140:143]
  v_fma_f32 v235, v238, v233, v235
  s_waitcnt lgkmcnt(4)
  MF v[144:147], v[172:175], a[48:51], v[144:147]
  TR v[168:169], v5 offset:32768
  v_fma_f32 v234, -v239, v233, v234
  MF v[148:151], v[172:175], a[52:55], v[148:151]
  TR v[170:171], v5 offset:33024
  v_fma_f32 v235, v239, v232, v235
  MF v[152:155], v[172:175], a[56:59], v[152:155]
  s_waitcnt vmcnt(10)
  v_fma_f32 v236, v238, v234, v236
  v_fma_f32 v237, v238, v235, v237
  MF v[156:159], v[172:175], a[60:63], v[156:159]
  v_fma_f32 v236, -v239, v235, v236
  s_waitcnt lgkmcnt(4)
  MF v[128:131], v[160:163], a[64:67], v[128:131]
  TR v[172:173], v5 offset:34816
  v_fma_f32 v237, v239, v234, v237
  MF v[132:135], v[160:163], a[68:71], v[132:135]
  TR v[174:175], v5 offset:35072
  v_lshlrev_b32 v240, 3, v1
  MF v[136:139], v[160:163], a[72:75], v[136:139]
  v_add_u32 v240, s3, v240
  ds_write_b64 v240, v[236:237]
  MF v[140:143], v[160:163], a[76:79], v[140:143]
  s_waitcnt lgkmcnt(5)
  MF v[144:147], v[164:167], a[64:67], v[144:147]
  s_waitcnt lgkmcnt(0)
  s_barrier
  TR v[160:161], v3 offset:36864
  MF v[148:151], v[164:167], a[68:71], v[148:151]
  TR v[162:163], v3 offset:37120
  MF v[152:155], v[164:167], a[72:75], v[152:155]
  MF v[156:159], v[164:167], a[76:79], v[156:159]
  MF v[128:131], v[168:171], a[80:83], v[128:131]
  TR v[164:165], v3 offset:38912
  MF v[132:135], v[168:171], a[84:87], v[132:135]
  TR v[166:167], v3 offset:39168
  MF v[136:139], v[168:171], a[88:91], v[136:139]
  MF v[140:143], v[168:171], a[92:95], v[140:143]
  MF v[144:147], v[172:175], a[80:83], v[144:147]
  TR v[168:169], v5 offset:36864
  MF v[148:151], v[172:175], a[84:87], v[148:151]
  TR v[170:171], v5 offset:37120
  MF v[152:155], v[172:175], a[88:91], v[152:155]
  MF v[156:159], v[172:175], a[92:95], v[156:159]
  s_waitcnt lgkmcnt(4)
  MF v[96:99], v[160:163], a[96:99], v[96:99]
  TR v[172:173], v5 offset:38912
  MF v[100:103], v[160:163], a[100:103], v[100:103]
  TR v[174:175], v5 offset:39168
  MF v[104:107], v[160:163], a[104:107], v[104:107]
  s_add_u32 m0, s37, 45056
  s_add_u32 s89, s45, 256
  BL4 v8, s[8:11], s89 offen lds
  MF v[108:111], v[160:163], a[108:111], v[108:111]
  s_waitcnt lgkmcnt(4)
  MF v[112:115], v[164:167], a[96:99], v[112:115]
  TR v[160:161], v3 offset:40960
  s_mul_i32 s79, s34, 36
  s_add_u32 s79, s79, 28
  MF v[116:119], v[164:167], a[100:103], v[116:119]
  TR v[162:163], v3 offset:41216
  s_add_u32 s79, s79, s39
  s_lshl_b32 s79, s79, 10
  MF v[120:123], v[164:167], a[104:107], v[120:123]
  v_and_b32 v226, 15, v1
  v_lshlrev_b32 v226, 3, v226
  MF v[124:127], v[164:167], a[108:111], v[124:127]
  v_add_u32 v226, 143360, v226
  s_waitcnt lgkmcnt(4)
  MF v[128:131], v[168:171], a[96:99], v[128:131]
  TR v[164:165], v3 offset:43008
  ds_read_b64 v[228:229], v226
  MF v[132:135], v[168:171], a[100:103], v[132:135]
  TR v[166:167], v3 offset:43264
  v_mul_f32 v226, v21, v208
  MF v[136:139], v[168:171], a[104:107], v[136:139]
  v_mul_f32 v227, v21, v209
  v_exp_f32 v224, v226
  MF v[140:143], v[168:171], a[108:111], v[140:143]
  v_fract_f32 v227, v227
  s_waitcnt lgkmcnt(5)
  MF v[144:147], v[172:175], a[96:99], v[144:147]
  TR v[168:169], v5 offset:40960
  v_cos_f32 v226, v227
  MF v[148:151], v[172:175], a[100:103], v[148:151]
  TR v[170:171], v5 offset:41216
  v_sin_f32 v227, v227
  MF v[152:155], v[172:175], a[104:107], v[152:155]
  v_mul_f32 v225, v224, v227
  v_mul_f32 v224, v224, v226
  MF v[156:159], v[172:175], a[108:111], v[156:159]
  s_waitcnt lgkmcnt(3)
  v_fma_f32 v212, v224, v228, v212
  MF v[96:99], v[160:163], a[112:115], v[96:99]
  TR v[172:173], v5 offset:43008
  v_fma_f32 v213, v224, v229, v213
  MF v[100:103], v[160:163], a[116:119], v[100:103]
  TR v[174:175], v5 offset:43264
  v_fma_f32 v212, -v225, v229, v212
  MF v[104:107], v[160:163], a[120:123], v[104:107]
  s_add_u32 m0, s37, 49152
  s_add_u32 s89, s46, 256
  BL4 v8, s[8:11], s89 offen lds
  MF v[108:111], v[160:163], a[124:127], v[108:111]
  v_fma_f32 v213, v225, v228, v213
  s_waitcnt lgkmcnt(4)
  MF v[112:115], v[164:167], a[112:115], v[112:115]
  TR v[160:161], v3 offset:45056
  v_fma_f32 v32, v210, v212, v32
  MF v[116:119], v[164:167], a[116:119], v[116:119]
  TR v[162:163], v3 offset:45312
  v_fma_f32 v48, v210, v213, v48
  MF v[120:123], v[164:167], a[120:123], v[120:123]
  v_fma_f32 v32, -v211, v213, v32
  v_fma_f32 v48, v211, v212, v48
  MF v[124:127], v[164:167], a[124:127], v[124:127]
  v_fma_f32 v33, v210, v32, v33
  s_waitcnt lgkmcnt(4)
  MF v[128:131], v[168:171], a[112:115], v[128:131]
  TR v[164:165], v3 offset:47104
  v_fma_f32 v49, v210, v48, v49
  MF v[132:135], v[168:171], a[116:119], v[132:135]
  TR v[166:167], v3 offset:47360
  v_fma_f32 v33, -v211, v48, v33
  MF v[136:139], v[168:171], a[120:123], v[136:139]
  v_fma_f32 v49, v211, v32, v49
  v_fma_f32 v34, v210, v33, v34
  MF v[140:143], v[168:171], a[124:127], v[140:143]
  v_fma_f32 v50, v210, v49, v50
  s_waitcnt lgkmcnt(4)
  MF v[144:147], v[172:175], a[112:115], v[144:147]
  TR v[168:169], v5 offset:45056
  v_fma_f32 v34, -v211, v49, v34
  MF v[148:151], v[172:175], a[116:119], v[148:151]
  TR v[170:171], v5 offset:45312
  v_fma_f32 v50, v211, v33, v50
  MF v[152:155], v[172:175], a[120:123], v[152:155]
  v_fma_f32 v35, v210, v34, v35
  v_fma_f32 v51, v210, v50, v51
  MF v[156:159], v[172:175], a[124:127], v[156:159]
  v_fma_f32 v35, -v211, v50, v35
  s_waitcnt lgkmcnt(4)
  MF v[96:99], v[160:163], a[128:131], v[96:99]
  TR v[172:173], v5 offset:47104
  v_fma_f32 v51, v211, v34, v51
  MF v[100:103], v[160:163], a[132:135], v[100:103]
  TR v[174:175], v5 offset:47360
  v_fma_f32 v36, v210, v35, v36
  MF v[104:107], v[160:163], a[136:139], v[104:107]
  s_add_u32 m0, s37, 53248
  s_add_u32 s89, s47, 256
  BL4 v8, s[8:11], s89 offen lds
  MF v[108:111], v[160:163], a[140:143], v[108:111]
  v_fma_f32 v52, v210, v51, v52
  s_waitcnt lgkmcnt(4)
  MF v[112:115], v[164:167], a[128:131], v[112:115]
  TR v[160:161], v3 offset:49152
  v_fma_f32 v36, -v211, v51, v36
  MF v[116:119], v[164:167], a[132:135], v[116:119]
  TR v[162:163], v3 offset:49408
  v_fma_f32 v52, v211, v35, v52
  MF v[120:123], v[164:167], a[136:139], v[120:123]
  v_fma_f32 v37, v210, v36, v37
  v_fma_f32 v53, v210, v52, v53
  MF v[124:127], v[164:167], a[140:143], v[124:127]
  v_fma_f32 v37, -v211, v52, v37
  s_waitcnt lgkmcnt(4)
  MF v[128:131], v[168:171], a[128:131], v[128:131]
  TR v[164:165], v3 offset:51200
  v_fma_f32 v53, v211, v36, v53
  MF v[132:135], v[168:171], a[132:135], v[132:135]
  TR v[166:167], v3 offset:51456
  v_fma_f32 v38, v210, v37, v38
  MF v[136:139], v[168:171], a[136:139], v[136:139]
  v_fma_f32 v54, v210, v53, v54
  v_fma_f32 v38, -v211, v53, v38
  MF v[140:143], v[168:171], a[140:143], v[140:143]
  v_fma_f32 v54, v211, v37, v54
  s_waitcnt lgkmcnt(4)
  MF v[144:147], v[172:175], a[128:131], v[144:147]
  TR v[168:169], v5 offset:49152
  v_fma_f32 v39, v210, v38, v39
  MF v[148:151], v[172:175], a[132:135], v[148:151]
  TR v[170:171], v5 offset:49408
  v_fma_f32 v55, v210, v54, v55
  MF v[152:155], v[172:175], a[136:139], v[152:155]
  v_fma_f32 v39, -v211, v54, v39
  v_fma_f32 v55, v211, v38, v55
  MF v[156:159], v[172:175], a[140:143], v[156:159]
  v_fma_f32 v40, v210, v39, v40
  s_waitcnt lgkmcnt(4)
  MF v[96:99], v[160:163], a[144:147], v[96:99]
  TR v[172:173], v5 offset:51200
  v_fma_f32 v56, v210, v55, v56
  MF v[100:103], v[160:163], a[148:151], v[100:103]
  TR v[174:175], v5 offset:51456
  v_fma_f32 v40, -v211, v55, v40
  MF v[104:107], v[160:163], a[152:155], v[104:107]
  s_add_u32 m0, s37, 57344
  s_add_u32 s89, s48, 256
  BL4 v8, s[8:11], s89 offen lds
  MF v[108:111], v[160:163], a[156:159], v[108:111]
  v_fma_f32 v56, v211, v39, v56
  s_waitcnt lgkmcnt(4)
  MF v[112:115], v[164:167], a[144:147], v[112:115]
  TR v[160:161], v3 offset:53248
  v_fma_f32 v41, v210, v40, v41
  MF v[116:119], v[164:167], a[148:151], v[116:119]
  TR v[162:163], v3 offset:53504
  v_fma_f32 v57, v210, v56, v57
  MF v[120:123], v[164:167], a[152:155], v[120:123]
  v_fma_f32 v41, -v211, v56, v41
  v_fma_f32 v57, v211, v40, v57
  MF v[124:127], v[164:167], a[156:159], v[124:127]
  v_fma_f32 v42, v210, v41, v42
  s_waitcnt lgkmcnt(4)
  MF v[128:131], v[168:171], a[144:147], v[128:131]
  TR v[164:165], v3 offset:55296
  v_fma_f32 v58, v210, v57, v58
  MF v[132:135], v[168:171], a[148:151], v[132:135]
  TR v[166:167], v3 offset:55552
  v_fma_f32 v42, -v211, v57, v42
  MF v[136:139], v[168:171], a[152:155], v[136:139]
  v_fma_f32 v58, v211, v41, v58
  v_fma_f32 v43, v210, v42, v43
  MF v[140:143], v[168:171], a[156:159], v[140:143]
  v_fma_f32 v59, v210, v58, v59
  s_waitcnt lgkmcnt(4)
  MF v[144:147], v[172:175], a[144:147], v[144:147]
  TR v[168:169], v5 offset:53248
  v_fma_f32 v43, -v211, v58, v43
  MF v[148:151], v[172:175], a[148:151], v[148:151]
  TR v[170:171], v5 offset:53504
  v_fma_f32 v59, v211, v42, v59
  MF v[152:155], v[172:175], a[152:155], v[152:155]
  v_fma_f32 v44, v210, v43, v44
  v_fma_f32 v60, v210, v59, v60
  MF v[156:159], v[172:175], a[156:159], v[156:159]
  v_fma_f32 v44, -v211, v59, v44
  s_waitcnt lgkmcnt(4)
  MF v[96:99], v[160:163], a[160:163], v[96:99]
  TR v[172:173], v5 offset:55296
  v_fma_f32 v60, v211, v43, v60
  MF v[100:103], v[160:163], a[164:167], v[100:103]
  TR v[174:175], v5 offset:55552
  v_fma_f32 v45, v210, v44, v45
  MF v[104:107], v[160:163], a[168:171], v[104:107]
  s_add_u32 m0, s37, 61440
  s_add_u32 s89, s49, 256
  BL4 v8, s[8:11], s89 offen lds
  MF v[108:111], v[160:163], a[172:175], v[108:111]
  v_fma_f32 v61, v210, v60, v61
  s_waitcnt lgkmcnt(4)
  MF v[112:115], v[164:167], a[160:163], v[112:115]
  TR v[160:161], v3 offset:57344
  v_fma_f32 v45, -v211, v60, v45
  MF v[116:119], v[164:167], a[164:167], v[116:119]
  TR v[162:163], v3 offset:57600
  v_fma_f32 v61, v211, v44, v61
  MF v[120:123], v[164:167], a[168:171], v[120:123]
  v_fma_f32 v46, v210, v45, v46
  v_fma_f32 v62, v210, v61, v62
  MF v[124:127], v[164:167], a[172:175], v[124:127]
  v_fma_f32 v46, -v211, v61, v46
  s_waitcnt lgkmcnt(4)
  MF v[128:131], v[168:171], a[160:163], v[128:131]
  TR v[164:165], v3 offset:59392
  v_fma_f32 v62, v211, v45, v62
  MF v[132:135], v[168:171], a[164:167], v[132:135]
  TR v[166:167], v3 offset:59648
  v_fma_f32 v47, v210, v46, v47
  MF v[136:139], v[168:171], a[168:171], v[136:139]
  v_fma_f32 v63, v210, v62, v63
  v_fma_f32 v47, -v211, v62, v47
  MF v[140:143], v[168:171], a[172:175], v[140:143]
  v_fma_f32 v63, v211, v46, v63
  s_waitcnt lgkmcnt(4)
  MF v[144:147], v[172:175], a[160:163], v[144:147]
  TR v[168:169], v5 offset:57344
  v_cvt_pk_bf16_f32 v32, v32, v33
  MF v[148:151], v[172:175], a[164:167], v[148:151]
  TR v[170:171], v5 offset:57600
  v_cvt_pk_bf16_f32 v33, v34, v35
  MF v[152:155], v[172:175], a[168:171], v[152:155]
  v_cvt_pk_bf16_f32 v34, v36, v37
  v_cvt_pk_bf16_f32 v35, v38, v39
  MF v[156:159], v[172:175], a[172:175], v[156:159]
  v_cvt_pk_bf16_f32 v36, v40, v41
  s_waitcnt lgkmcnt(4)
  MF v[96:99], v[160:163], a[176:179], v[96:99]
  TR v[172:173], v5 offset:59392
  v_cvt_pk_bf16_f32 v37, v42, v43
  MF v[100:103], v[160:163], a[180:183], v[100:103]
  TR v[174:175], v5 offset:59648
  v_cvt_pk_bf16_f32 v38, v44, v45
  MF v[104:107], v[160:163], a[184:187], v[104:107]
  s_add_u32 m0, s37, 65536
  s_add_u32 s89, s50, 256
  BL4 v8, s[8:11], s89 offen lds
  MF v[108:111], v[160:163], a[188:191], v[108:111]
  v_cvt_pk_bf16_f32 v39, v46, v47
  s_waitcnt lgkmcnt(4)
  MF v[112:115], v[164:167], a[176:179], v[112:115]
  s_waitcnt vmcnt(15)
  s_barrier
  TR v[160:161], v2
  v_cvt_pk_bf16_f32 v48, v48, v49
  MF v[116:119], v[164:167], a[180:183], v[116:119]
  TR v[162:163], v2 offset:256
  v_cvt_pk_bf16_f32 v49, v50, v51
  MF v[120:123], v[164:167], a[184:187], v[120:123]
  v_cvt_pk_bf16_f32 v50, v52, v53
  v_cvt_pk_bf16_f32 v51, v54, v55
  MF v[124:127], v[164:167], a[188:191], v[124:127]
  v_cvt_pk_bf16_f32 v52, v56, v57
  s_waitcnt lgkmcnt(4)
  MF v[128:131], v[168:171], a[176:179], v[128:131]
  TR v[164:165], v2 offset:2048
  v_cvt_pk_bf16_f32 v53, v58, v59
  MF v[132:135], v[168:171], a[180:183], v[132:135]
  TR v[166:167], v2 offset:2304
  v_cvt_pk_bf16_f32 v54, v60, v61
  MF v[136:139], v[168:171], a[184:187], v[136:139]
  v_cvt_pk_bf16_f32 v55, v62, v63
  ds_write_b128 v13, v[32:35]
  MF v[140:143], v[168:171], a[188:191], v[140:143]
  ds_write_b128 v13, v[36:39] offset:16
  s_waitcnt lgkmcnt(6)
  MF v[144:147], v[172:175], a[176:179], v[144:147]
  TR v[168:169], v4
  ds_write_b128 v13, v[48:51] offset:2304
  MF v[148:151], v[172:175], a[180:183], v[148:151]
  TR v[170:171], v4 offset:256
  ds_write_b128 v13, v[52:55] offset:2320
  MF v[152:155], v[172:175], a[184:187], v[152:155]
  TR v[40:41], v14
  TR v[42:43], v14 offset:2304
  MF v[156:159], v[172:175], a[188:191], v[156:159]
  TR v[44:45], v14 offset:8
  s_waitcnt lgkmcnt(11)
  MF v[96:99], v[160:163], a[192:195], v[96:99]
  TR v[172:173], v4 offset:2048
  TR v[46:47], v14 offset:2312
  MF v[100:103], v[160:163], a[196:199], v[100:103]
  TR v[174:175], v4 offset:2304
  TR v[56:57], v14 offset:16
  MF v[104:107], v[160:163], a[200:203], v[104:107]
  s_add_u32 m0, s37, 69632
  s_add_u32 s89, s51, 256
  BL4 v8, s[8:11], s89 offen lds
  MF v[108:111], v[160:163], a[204:207], v[108:111]
  TR v[58:59], v14 offset:2320
  s_waitcnt lgkmcnt(14)
  MF v[112:115], v[164:167], a[192:195], v[112:115]
  TR v[160:161], v2 offset:4096
  TR v[60:61], v14 offset:24
  MF v[116:119], v[164:167], a[196:199], v[116:119]
  TR v[162:163], v2 offset:4352
  TR v[62:63], v14 offset:2328
  MF v[120:123], v[164:167], a[200:203], v[120:123]
  s_add_u32 s80, s79, 0
  MF v[124:127], v[164:167], a[204:207], v[124:127]
  s_waitcnt lgkmcnt(13)
  MF v[128:131], v[168:171], a[192:195], v[128:131]
  TR v[164:165], v2 offset:6144
  MF v[132:135], v[168:171], a[196:199], v[132:135]
  TR v[166:167], v2 offset:6400
  MF v[136:139], v[168:171], a[200:203], v[136:139]
  s_waitcnt lgkmcnt(12)
  buffer_store_dwordx4 v[40:43], v10, s[16:19], s80 offen sc1
  MF v[140:143], v[168:171], a[204:207], v[140:143]
  s_add_u32 s80, s79, 185344
  s_waitcnt lgkmcnt(8)
  MF v[144:147], v[172:175], a[192:195], v[144:147]
  TR v[168:169], v4 offset:4096
  MF v[148:151], v[172:175], a[196:199], v[148:151]
  TR v[170:171], v4 offset:4352
  MF v[152:155], v[172:175], a[200:203], v[152:155]
  buffer_store_dwordx4 v[44:47], v10, s[16:19], s80 offen sc1
  MF v[156:159], v[172:175], a[204:207], v[156:159]
  s_add_u32 s80, s79, 370688
  s_waitcnt lgkmcnt(5)
  MF v[96:99], v[160:163], a[208:211], v[96:99]
  TR v[172:173], v4 offset:6144
  MF v[100:103], v[160:163], a[212:215], v[100:103]
  TR v[174:175], v4 offset:6400
  MF v[104:107], v[160:163], a[216:219], v[104:107]
  s_add_u32 m0, s37, 73728
  s_add_u32 s89, s52, 256
  BL4 v8, s[8:11], s89 offen lds
  MF v[108:111], v[160:163], a[220:223], v[108:111]
  s_waitcnt lgkmcnt(4)
  MF v[112:115], v[164:167], a[208:211], v[112:115]
  TR v[160:161], v2 offset:8192
  MF v[116:119], v[164:167], a[212:215], v[116:119]
  TR v[162:163], v2 offset:8448
  MF v[120:123], v[164:167], a[216:219], v[120:123]
  buffer_store_dwordx4 v[56:59], v10, s[16:19], s80 offen sc1
  MF v[124:127], v[164:167], a[220:223], v[124:127]
  s_add_u32 s80, s79, 556032
  s_waitcnt lgkmcnt(4)
  MF v[128:131], v[168:171], a[208:211], v[128:131]
  TR v[164:165], v2 offset:10240
  MF v[132:135], v[168:171], a[212:215], v[132:135]
  TR v[166:167], v2 offset:10496
  MF v[136:139], v[168:171], a[216:219], v[136:139]
  buffer_store_dwordx4 v[60:63], v10, s[16:19], s80 offen sc1
  MF v[140:143], v[168:171], a[220:223], v[140:143]
  s_waitcnt lgkmcnt(4)
  MF v[144:147], v[172:175], a[208:211], v[144:147]
  TR v[168:169], v4 offset:8192
  MF v[148:151], v[172:175], a[212:215], v[148:151]
  TR v[170:171], v4 offset:8448
  MF v[152:155], v[172:175], a[216:219], v[152:155]
  MF v[156:159], v[172:175], a[220:223], v[156:159]
  s_waitcnt lgkmcnt(4)
  MF v[96:99], v[160:163], a[224:227], v[96:99]
  TR v[172:173], v4 offset:10240
  MF v[100:103], v[160:163], a[228:231], v[100:103]
  TR v[174:175], v4 offset:10496
  MF v[104:107], v[160:163], a[232:235], v[104:107]
  s_add_u32 m0, s37, 77824
  s_add_u32 s89, s53, 256
  BL4 v8, s[8:11], s89 offen lds
  MF v[108:111], v[160:163], a[236:239], v[108:111]
  s_waitcnt lgkmcnt(4)
  MF v[112:115], v[164:167], a[224:227], v[112:115]
  TR v[160:161], v2 offset:12288
  MF v[116:119], v[164:167], a[228:231], v[116:119]
  TR v[162:163], v2 offset:12544
  MF v[120:123], v[164:167], a[232:235], v[120:123]
  MF v[124:127], v[164:167], a[236:239], v[124:127]
  s_waitcnt lgkmcnt(4)
  MF v[128:131], v[168:171], a[224:227], v[128:131]
  TR v[164:165], v2 offset:14336
  MF v[132:135], v[168:171], a[228:231], v[132:135]
  TR v[166:167], v2 offset:14592
  MF v[136:139], v[168:171], a[232:235], v[136:139]
  MF v[140:143], v[168:171], a[236:239], v[140:143]
  s_waitcnt lgkmcnt(4)
  MF v[144:147], v[172:175], a[224:227], v[144:147]
  TR v[168:169], v4 offset:12288
  MF v[148:151], v[172:175], a[228:231], v[148:151]
  TR v[170:171], v4 offset:12544
  MF v[152:155], v[172:175], a[232:235], v[152:155]
  MF v[156:159], v[172:175], a[236:239], v[156:159]
  s_waitcnt lgkmcnt(4)
  MF v[96:99], v[160:163], a[240:243], v[96:99]
  TR v[172:173], v4 offset:14336
  MF v[100:103], v[160:163], a[244:247], v[100:103]
  TR v[174:175], v4 offset:14592
  MF v[104:107], v[160:163], a[248:251], v[104:107]
  s_add_u32 m0, s37, 81920
  s_add_u32 s89, s54, 256
  BL4 v8, s[8:11], s89 offen lds
  MF v[108:111], v[160:163], a[252:255], v[108:111]
  s_waitcnt lgkmcnt(4)
  MF v[112:115], v[164:167], a[240:243], v[112:115]
  TR v[160:161], v2 offset:16384
  MF v[116:119], v[164:167], a[244:247], v[116:119]
  TR v[162:163], v2 offset:16640
  MF v[120:123], v[164:167], a[248:251], v[120:123]
  MF v[124:127], v[164:167], a[252:255], v[124:127]
  s_waitcnt lgkmcnt(4)
  MF v[128:131], v[168:171], a[240:243], v[128:131]
  TR v[164:165], v2 offset:18432
  MF v[132:135], v[168:171], a[244:247], v[132:135]
  TR v[166:167], v2 offset:18688
  MF v[136:139], v[168:171], a[248:251], v[136:139]
  MF v[140:143], v[168:171], a[252:255], v[140:143]
  s_waitcnt lgkmcnt(4)
  MF v[144:147], v[172:175], a[240:243], v[144:147]
  TR v[168:169], v4 offset:16384
  MF v[148:151], v[172:175], a[244:247], v[148:151]
  TR v[170:171], v4 offset:16640
  MF v[152:155], v[172:175], a[248:251], v[152:155]
  MF v[156:159], v[172:175], a[252:255], v[156:159]
  s_waitcnt lgkmcnt(4)
  MF v[96:99], v[160:163], v[176:179], v[96:99]
  TR v[172:173], v4 offset:18432
  MF v[100:103], v[160:163], v[180:183], v[100:103]
  TR v[174:175], v4 offset:18688
  MF v[104:107], v[160:163], v[184:187], v[104:107]
  s_add_u32 m0, s37, 86016
  s_add_u32 s89, s55, 256
  BL4 v8, s[8:11], s89 offen lds
  MF v[108:111], v[160:163], v[188:191], v[108:111]
  s_waitcnt lgkmcnt(4)
  MF v[112:115], v[164:167], v[176:179], v[112:115]
  TR v[160:161], v2 offset:20480
  MF v[116:119], v[164:167], v[180:183], v[116:119]
  TR v[162:163], v2 offset:20736
  MF v[120:123], v[164:167], v[184:187], v[120:123]
  MF v[124:127], v[164:167], v[188:191], v[124:127]
  s_waitcnt lgkmcnt(4)
  MF v[128:131], v[168:171], v[176:179], v[128:131]
  TR v[164:165], v2 offset:22528
  MF v[132:135], v[168:171], v[180:183], v[132:135]
  TR v[166:167], v2 offset:22784
  MF v[136:139], v[168:171], v[184:187], v[136:139]
  MF v[140:143], v[168:171], v[188:191], v[140:143]
  s_waitcnt lgkmcnt(4)
  MF v[144:147], v[172:175], v[176:179], v[144:147]
  TR v[168:169], v4 offset:20480
  MF v[148:151], v[172:175], v[180:183], v[148:151]
  TR v[170:171], v4 offset:20736
  MF v[152:155], v[172:175], v[184:187], v[152:155]
  MF v[156:159], v[172:175], v[188:191], v[156:159]
  s_waitcnt lgkmcnt(4)
  MF v[96:99], v[160:163], v[192:195], v[96:99]
  TR v[172:173], v4 offset:22528
  MF v[100:103], v[160:163], v[196:199], v[100:103]
  TR v[174:175], v4 offset:22784
  MF v[104:107], v[160:163], v[200:203], v[104:107]
  s_add_u32 m0, s37, 90112
  s_add_u32 s89, s56, 256
  BL4 v8, s[8:11], s89 offen lds
  MF v[108:111], v[160:163], v[204:207], v[108:111]
  s_waitcnt lgkmcnt(4)
  MF v[112:115], v[164:167], v[192:195], v[112:115]
  s_waitcnt vmcnt(15)
  s_barrier
  TR v[160:161], v2 offset:24576
  MF v[116:119], v[164:167], v[196:199], v[116:119]
  TR v[162:163], v2 offset:24832
  MF v[120:123], v[164:167], v[200:203], v[120:123]
  MF v[124:127], v[164:167], v[204:207], v[124:127]
  s_waitcnt lgkmcnt(4)
  MF v[128:131], v[168:171], v[192:195], v[128:131]
  TR v[164:165], v2 offset:26624
  MF v[132:135], v[168:171], v[196:199], v[132:135]
  TR v[166:167], v2 offset:26880
  MF v[136:139], v[168:171], v[200:203], v[136:139]
  MF v[140:143], v[168:171], v[204:207], v[140:143]
  s_waitcnt lgkmcnt(4)
  MF v[144:147], v[172:175], v[192:195], v[144:147]
  TR v[168:169], v4 offset:24576
  MF v[148:151], v[172:175], v[196:199], v[148:151]
  TR v[170:171], v4 offset:24832
  MF v[152:155], v[172:175], v[200:203], v[152:155]
  MF v[156:159], v[172:175], v[204:207], v[156:159]
K1_TA1_G4:
  s_waitcnt lgkmcnt(4)
  MF v[32:35], v[160:163], a[0:3], 0
  TR v[172:173], v4 offset:26624
  MF v[36:39], v[160:163], a[4:7], 0
  TR v[174:175], v4 offset:26880
  MF v[40:43], v[160:163], a[8:11], 0
  s_add_u32 m0, s37, 94208
  s_add_u32 s89, s57, 256
  BL4 v8, s[8:11], s89 offen lds
  MF v[44:47], v[160:163], a[12:15], 0
  s_waitcnt lgkmcnt(4)
  MF v[48:51], v[164:167], a[0:3], 0
  TR v[160:161], v2 offset:28672
  MF v[52:55], v[164:167], a[4:7], 0
  TR v[162:163], v2 offset:28928
  MF v[56:59], v[164:167], a[8:11], 0
  MF v[60:63], v[164:167], a[12:15], 0
  s_waitcnt lgkmcnt(4)
  MF v[64:67], v[168:171], a[0:3], 0
  TR v[164:165], v2 offset:30720
  MF v[68:71], v[168:171], a[4:7], 0
  TR v[166:167], v2 offset:30976
  MF v[72:75], v[168:171], a[8:11], 0
  MF v[76:79], v[168:171], a[12:15], 0
  s_waitcnt lgkmcnt(4)
  MF v[80:83], v[172:175], a[0:3], 0
  TR v[168:169], v4 offset:28672
  s_add_u32 s88, s36, 3
  s_lshl_b32 s88, s88, 10
  MF v[84:87], v[172:175], a[4:7], 0
  TR v[170:171], v4 offset:28928
  v_max_f32 v96, 0, v96
  MF v[88:91], v[172:175], a[8:11], 0
  v_max_f32 v97, 0, v97
  v_max_f32 v98, 0, v98
  MF v[92:95], v[172:175], a[12:15], 0
  v_max_f32 v99, 0, v99
  s_waitcnt lgkmcnt(4)
  MF v[32:35], v[160:163], a[16:19], v[32:35]
  TR v[172:173], v4 offset:30720
  v_mul_f32 v96, v96, v112
  MF v[36:39], v[160:163], a[20:23], v[36:39]
  TR v[174:175], v4 offset:30976
  v_mul_f32 v97, v97, v113
  MF v[40:43], v[160:163], a[24:27], v[40:43]
  v_mul_f32 v98, v98, v114
  v_mul_f32 v99, v99, v115
  MF v[44:47], v[160:163], a[28:31], v[44:47]
  v_cvt_pk_bf16_f32 v248, v96, v97
  s_waitcnt lgkmcnt(4)
  MF v[48:51], v[164:167], a[16:19], v[48:51]
  TR v[160:161], v2 offset:32768
  v_cvt_pk_bf16_f32 v249, v98, v99
  MF v[52:55], v[164:167], a[20:23], v[52:55]
  TR v[162:163], v2 offset:33024
  v_max_f32 v128, 0, v128
  MF v[56:59], v[164:167], a[24:27], v[56:59]
  v_max_f32 v129, 0, v129
  v_max_f32 v130, 0, v130
  MF v[60:63], v[164:167], a[28:31], v[60:63]
  v_max_f32 v131, 0, v131
  s_waitcnt lgkmcnt(4)
  MF v[64:67], v[168:171], a[16:19], v[64:67]
  TR v[164:165], v2 offset:34816
  v_mul_f32 v128, v128, v144
  MF v[68:71], v[168:171], a[20:23], v[68:71]
  TR v[166:167], v2 offset:35072
  v_mul_f32 v129, v129, v145
  MF v[72:75], v[168:171], a[24:27], v[72:75]
  v_mul_f32 v130, v130, v146
  v_mul_f32 v131, v131, v147
  MF v[76:79], v[168:171], a[28:31], v[76:79]
  v_cvt_pk_bf16_f32 v250, v128, v129
  s_waitcnt lgkmcnt(4)
  MF v[80:83], v[172:175], a[16:19], v[80:83]
  TR v[168:169], v4 offset:32768
  v_cvt_pk_bf16_f32 v251, v130, v131
  MF v[84:87], v[172:175], a[20:23], v[84:87]
  TR v[170:171], v4 offset:33024
  s_add_u32 s80, s88, 0
  MF v[88:91], v[172:175], a[24:27], v[88:91]
  buffer_store_dwordx4 v[248:251], v10, s[16:19], s80 offen sc1
  MF v[92:95], v[172:175], a[28:31], v[92:95]
  v_max_f32 v100, 0, v100
  s_waitcnt lgkmcnt(4)
  MF v[32:35], v[160:163], a[32:35], v[32:35]
  TR v[172:173], v4 offset:34816
  v_max_f32 v101, 0, v101
  MF v[36:39], v[160:163], a[36:39], v[36:39]
  TR v[174:175], v4 offset:35072
  v_max_f32 v102, 0, v102
  MF v[40:43], v[160:163], a[40:43], v[40:43]
  v_max_f32 v103, 0, v103
  v_mul_f32 v100, v100, v116
  MF v[44:47], v[160:163], a[44:47], v[44:47]
  v_mul_f32 v101, v101, v117
  s_waitcnt lgkmcnt(4)
  MF v[48:51], v[164:167], a[32:35], v[48:51]
  TR v[160:161], v2 offset:36864
  v_mul_f32 v102, v102, v118
  MF v[52:55], v[164:167], a[36:39], v[52:55]
  TR v[162:163], v2 offset:37120
  v_mul_f32 v103, v103, v119
  MF v[56:59], v[164:167], a[40:43], v[56:59]
  v_cvt_pk_bf16_f32 v252, v100, v101
  v_cvt_pk_bf16_f32 v253, v102, v103
  MF v[60:63], v[164:167], a[44:47], v[60:63]
  v_max_f32 v132, 0, v132
  s_waitcnt lgkmcnt(4)
  MF v[64:67], v[168:171], a[32:35], v[64:67]
  TR v[164:165], v2 offset:38912
  v_max_f32 v133, 0, v133
  MF v[68:71], v[168:171], a[36:39], v[68:71]
  TR v[166:167], v2 offset:39168
  v_max_f32 v134, 0, v134
  MF v[72:75], v[168:171], a[40:43], v[72:75]
  v_max_f32 v135, 0, v135
  v_mul_f32 v132, v132, v148
  MF v[76:79], v[168:171], a[44:47], v[76:79]
  v_mul_f32 v133, v133, v149
  s_waitcnt lgkmcnt(4)
  MF v[80:83], v[172:175], a[32:35], v[80:83]
  TR v[168:169], v4 offset:36864
  v_mul_f32 v134, v134, v150
  MF v[84:87], v[172:175], a[36:39], v[84:87]
  TR v[170:171], v4 offset:37120
  v_mul_f32 v135, v135, v151
  MF v[88:91], v[172:175], a[40:43], v[88:91]
  v_cvt_pk_bf16_f32 v254, v132, v133
  v_cvt_pk_bf16_f32 v255, v134, v135
  MF v[92:95], v[172:175], a[44:47], v[92:95]
  s_add_u32 s80, s88, 185344
  s_waitcnt lgkmcnt(4)
  MF v[32:35], v[160:163], a[48:51], v[32:35]
  TR v[172:173], v4 offset:38912
  MF v[36:39], v[160:163], a[52:55], v[36:39]
  TR v[174:175], v4 offset:39168
  MF v[40:43], v[160:163], a[56:59], v[40:43]
  buffer_store_dwordx4 v[252:255], v10, s[16:19], s80 offen sc1
  MF v[44:47], v[160:163], a[60:63], v[44:47]
  v_max_f32 v104, 0, v104
  s_waitcnt lgkmcnt(4)
  MF v[48:51], v[164:167], a[48:51], v[48:51]
  TR v[160:161], v2 offset:40960
  v_max_f32 v105, 0, v105
  MF v[52:55], v[164:167], a[52:55], v[52:55]
  TR v[162:163], v2 offset:41216
  v_max_f32 v106, 0, v106
  MF v[56:59], v[164:167], a[56:59], v[56:59]
  v_max_f32 v107, 0, v107
  v_mul_f32 v104, v104, v120
  MF v[60:63], v[164:167], a[60:63], v[60:63]
  v_mul_f32 v105, v105, v121
  s_waitcnt lgkmcnt(4)
  MF v[64:67], v[168:171], a[48:51], v[64:67]
  TR v[164:165], v2 offset:43008
  v_mul_f32 v106, v106, v122
  MF v[68:71], v[168:171], a[52:55], v[68:71]
  TR v[166:167], v2 offset:43264
  v_mul_f32 v107, v107, v123
  MF v[72:75], v[168:171], a[56:59], v[72:75]
  v_cvt_pk_bf16_f32 v248, v104, v105
  v_cvt_pk_bf16_f32 v249, v106, v107
  MF v[76:79], v[168:171], a[60:63], v[76:79]
  v_max_f32 v136, 0, v136
  s_waitcnt lgkmcnt(4)
  MF v[80:83], v[172:175], a[48:51], v[80:83]
  TR v[168:169], v4 offset:40960
  v_max_f32 v137, 0, v137
  MF v[84:87], v[172:175], a[52:55], v[84:87]
  TR v[170:171], v4 offset:41216
  v_max_f32 v138, 0, v138
  MF v[88:91], v[172:175], a[56:59], v[88:91]
  v_max_f32 v139, 0, v139
  v_mul_f32 v136, v136, v152
  MF v[92:95], v[172:175], a[60:63], v[92:95]
  v_mul_f32 v137, v137, v153
  s_waitcnt lgkmcnt(4)
  MF v[32:35], v[160:163], a[64:67], v[32:35]
  TR v[172:173], v4 offset:43008
  v_mul_f32 v138, v138, v154
  MF v[36:39], v[160:163], a[68:71], v[36:39]
  TR v[174:175], v4 offset:43264
  v_mul_f32 v139, v139, v155
  MF v[40:43], v[160:163], a[72:75], v[40:43]
  v_cvt_pk_bf16_f32 v250, v136, v137
  v_cvt_pk_bf16_f32 v251, v138, v139
  MF v[44:47], v[160:163], a[76:79], v[44:47]
  s_add_u32 s80, s88, 370688
  s_waitcnt lgkmcnt(4)
  MF v[48:51], v[164:167], a[64:67], v[48:51]
  TR v[160:161], v2 offset:45056
  MF v[52:55], v[164:167], a[68:71], v[52:55]
  TR v[162:163], v2 offset:45312
  MF v[56:59], v[164:167], a[72:75], v[56:59]
  buffer_store_dwordx4 v[248:251], v10, s[16:19], s80 offen sc1
  MF v[60:63], v[164:167], a[76:79], v[60:63]
  v_max_f32 v108, 0, v108
  s_waitcnt lgkmcnt(4)
  MF v[64:67], v[168:171], a[64:67], v[64:67]
  TR v[164:165], v2 offset:47104
  v_max_f32 v109, 0, v109
  MF v[68:71], v[168:171], a[68:71], v[68:71]
  TR v[166:167], v2 offset:47360
  v_max_f32 v110, 0, v110
  MF v[72:75], v[168:171], a[72:75], v[72:75]
  v_max_f32 v111, 0, v111
  v_mul_f32 v108, v108, v124
  MF v[76:79], v[168:171], a[76:79], v[76:79]
  v_mul_f32 v109, v109, v125
  s_waitcnt lgkmcnt(4)
  MF v[80:83], v[172:175], a[64:67], v[80:83]
  TR v[168:169], v4 offset:45056
  v_mul_f32 v110, v110, v126
  MF v[84:87], v[172:175], a[68:71], v[84:87]
  TR v[170:171], v4 offset:45312
  v_mul_f32 v111, v111, v127
  MF v[88:91], v[172:175], a[72:75], v[88:91]
  v_cvt_pk_bf16_f32 v252, v108, v109
  v_cvt_pk_bf16_f32 v253, v110, v111
  MF v[92:95], v[172:175], a[76:79], v[92:95]
  v_max_f32 v140, 0, v140
  s_waitcnt lgkmcnt(4)
  MF v[32:35], v[160:163], a[80:83], v[32:35]
  TR v[172:173], v4 offset:47104
  v_max_f32 v141, 0, v141
  MF v[36:39], v[160:163], a[84:87], v[36:39]
  TR v[174:175], v4 offset:47360
  v_max_f32 v142, 0, v142
  MF v[40:43], v[160:163], a[88:91], v[40:43]
  v_max_f32 v143, 0, v143
  v_mul_f32 v140, v140, v156
  MF v[44:47], v[160:163], a[92:95], v[44:47]
  v_mul_f32 v141, v141, v157
  s_waitcnt lgkmcnt(4)
  MF v[48:51], v[164:167], a[80:83], v[48:51]
  s_waitcnt vmcnt(13)
  s_barrier
  TR v[160:161], v2 offset:49152
  v_mul_f32 v142, v142, v158
  MF v[52:55], v[164:167], a[84:87], v[52:55]
  TR v[162:163], v2 offset:49408
  v_mul_f32 v143, v143, v159
  MF v[56:59], v[164:167], a[88:91], v[56:59]
  v_cvt_pk_bf16_f32 v254, v140, v141
  v_cvt_pk_bf16_f32 v255, v142, v143
  MF v[60:63], v[164:167], a[92:95], v[60:63]
  s_add_u32 s80, s88, 556032
  s_waitcnt lgkmcnt(4)
  MF v[64:67], v[168:171], a[80:83], v[64:67]
  TR v[164:165], v2 offset:51200
  MF v[68:71], v[168:171], a[84:87], v[68:71]
  TR v[166:167], v2 offset:51456
  MF v[72:75], v[168:171], a[88:91], v[72:75]
  buffer_store_dwordx4 v[252:255], v10, s[16:19], s80 offen sc1
  MF v[76:79], v[168:171], a[92:95], v[76:79]
  s_waitcnt lgkmcnt(4)
  MF v[80:83], v[172:175], a[80:83], v[80:83]
  TR v[168:169], v4 offset:49152
  MF v[84:87], v[172:175], a[84:87], v[84:87]
  TR v[170:171], v4 offset:49408
  MF v[88:91], v[172:175], a[88:91], v[88:91]
  MF v[92:95], v[172:175], a[92:95], v[92:95]
  s_waitcnt lgkmcnt(4)
  MF v[32:35], v[160:163], a[96:99], v[32:35]
  TR v[172:173], v4 offset:51200
  MF v[36:39], v[160:163], a[100:103], v[36:39]
  TR v[174:175], v4 offset:51456
  MF v[40:43], v[160:163], a[104:107], v[40:43]
  MF v[44:47], v[160:163], a[108:111], v[44:47]
  s_waitcnt lgkmcnt(4)
  MF v[48:51], v[164:167], a[96:99], v[48:51]
  TR v[160:161], v2 offset:53248
  MF v[52:55], v[164:167], a[100:103], v[52:55]
  TR v[162:163], v2 offset:53504
  MF v[56:59], v[164:167], a[104:107], v[56:59]
  MF v[60:63], v[164:167], a[108:111], v[60:63]
  s_waitcnt lgkmcnt(4)
  MF v[64:67], v[168:171], a[96:99], v[64:67]
  TR v[164:165], v2 offset:55296
  MF v[68:71], v[168:171], a[100:103], v[68:71]
  TR v[166:167], v2 offset:55552
  MF v[72:75], v[168:171], a[104:107], v[72:75]
  MF v[76:79], v[168:171], a[108:111], v[76:79]
  s_waitcnt lgkmcnt(4)
  MF v[80:83], v[172:175], a[96:99], v[80:83]
  TR v[168:169], v4 offset:53248
  MF v[84:87], v[172:175], a[100:103], v[84:87]
  TR v[170:171], v4 offset:53504
  MF v[88:91], v[172:175], a[104:107], v[88:91]
  MF v[92:95], v[172:175], a[108:111], v[92:95]
  s_waitcnt lgkmcnt(4)
  MF v[32:35], v[160:163], a[112:115], v[32:35]
  TR v[172:173], v4 offset:55296
  MF v[36:39], v[160:163], a[116:119], v[36:39]
  TR v[174:175], v4 offset:55552
  MF v[40:43], v[160:163], a[120:123], v[40:43]
  MF v[44:47], v[160:163], a[124:127], v[44:47]
  s_waitcnt lgkmcnt(4)
  MF v[48:51], v[164:167], a[112:115], v[48:51]
  TR v[160:161], v2 offset:57344
  MF v[52:55], v[164:167], a[116:119], v[52:55]
  TR v[162:163], v2 offset:57600
  MF v[56:59], v[164:167], a[120:123], v[56:59]
  MF v[60:63], v[164:167], a[124:127], v[60:63]
  s_waitcnt lgkmcnt(4)
  MF v[64:67], v[168:171], a[112:115], v[64:67]
  TR v[164:165], v2 offset:59392
  MF v[68:71], v[168:171], a[116:119], v[68:71]
  TR v[166:167], v2 offset:59648
  MF v[72:75], v[168:171], a[120:123], v[72:75]
  MF v[76:79], v[168:171], a[124:127], v[76:79]
  s_waitcnt lgkmcnt(4)
  MF v[80:83], v[172:175], a[112:115], v[80:83]
  TR v[168:169], v4 offset:57344
  MF v[84:87], v[172:175], a[116:119], v[84:87]
  TR v[170:171], v4 offset:57600
  MF v[88:91], v[172:175], a[120:123], v[88:91]
  MF v[92:95], v[172:175], a[124:127], v[92:95]
  s_waitcnt lgkmcnt(4)
  MF v[32:35], v[160:163], a[128:131], v[32:35]
  TR v[172:173], v4 offset:59392
  MF v[36:39], v[160:163], a[132:135], v[36:39]
  TR v[174:175], v4 offset:59648
  MF v[40:43], v[160:163], a[136:139], v[40:43]
  MF v[44:47], v[160:163], a[140:143], v[44:47]
  s_waitcnt lgkmcnt(4)
  MF v[48:51], v[164:167], a[128:131], v[48:51]
  TR v[160:161], v3
  MF v[52:55], v[164:167], a[132:135], v[52:55]
  TR v[162:163], v3 offset:256
  MF v[56:59], v[164:167], a[136:139], v[56:59]
  MF v[60:63], v[164:167], a[140:143], v[60:63]
  s_waitcnt lgkmcnt(4)
  MF v[64:67], v[168:171], a[128:131], v[64:67]
  TR v[164:165], v3 offset:2048
  MF v[68:71], v[168:171], a[132:135], v[68:71]
  TR v[166:167], v3 offset:2304
  MF v[72:75], v[168:171], a[136:139], v[72:75]
  MF v[76:79], v[168:171], a[140:143], v[76:79]
  s_waitcnt lgkmcnt(4)
  MF v[80:83], v[172:175], a[128:131], v[80:83]
  TR v[168:169], v5
  MF v[84:87], v[172:175], a[132:135], v[84:87]
  TR v[170:171], v5 offset:256
  MF v[88:91], v[172:175], a[136:139], v[88:91]
  MF v[92:95], v[172:175], a[140:143], v[92:95]
  s_waitcnt lgkmcnt(4)
  MF v[32:35], v[160:163], a[144:147], v[32:35]
  TR v[172:173], v5 offset:2048
  MF v[36:39], v[160:163], a[148:151], v[36:39]
  TR v[174:175], v5 offset:2304
  MF v[40:43], v[160:163], a[152:155], v[40:43]
  MF v[44:47], v[160:163], a[156:159], v[44:47]
  s_waitcnt lgkmcnt(4)
  MF v[48:51], v[164:167], a[144:147], v[48:51]
  TR v[160:161], v3 offset:4096
  MF v[52:55], v[164:167], a[148:151], v[52:55]
  TR v[162:163], v3 offset:4352
  MF v[56:59], v[164:167], a[152:155], v[56:59]
  MF v[60:63], v[164:167], a[156:159], v[60:63]
  s_waitcnt lgkmcnt(4)
  MF v[64:67], v[168:171], a[144:147], v[64:67]
  TR v[164:165], v3 offset:6144
  MF v[68:71], v[168:171], a[148:151], v[68:71]
  TR v[166:167], v3 offset:6400
  MF v[72:75], v[168:171], a[152:155], v[72:75]
  MF v[76:79], v[168:171], a[156:159], v[76:79]
  s_waitcnt lgkmcnt(4)
  MF v[80:83], v[172:175], a[144:147], v[80:83]
  TR v[168:169], v5 offset:4096
  MF v[84:87], v[172:175], a[148:151], v[84:87]
  TR v[170:171], v5 offset:4352
  MF v[88:91], v[172:175], a[152:155], v[88:91]
  MF v[92:95], v[172:175], a[156:159], v[92:95]
  s_waitcnt lgkmcnt(4)
  MF v[32:35], v[160:163], a[160:163], v[32:35]
  TR v[172:173], v5 offset:6144
  MF v[36:39], v[160:163], a[164:167], v[36:39]
  TR v[174:175], v5 offset:6400
  MF v[40:43], v[160:163], a[168:171], v[40:43]
  MF v[44:47], v[160:163], a[172:175], v[44:47]
  s_waitcnt lgkmcnt(4)
  MF v[48:51], v[164:167], a[160:163], v[48:51]
  TR v[160:161], v3 offset:8192
  MF v[52:55], v[164:167], a[164:167], v[52:55]
  TR v[162:163], v3 offset:8448
  MF v[56:59], v[164:167], a[168:171], v[56:59]
  MF v[60:63], v[164:167], a[172:175], v[60:63]
  s_waitcnt lgkmcnt(4)
  MF v[64:67], v[168:171], a[160:163], v[64:67]
  TR v[164:165], v3 offset:10240
  MF v[68:71], v[168:171], a[164:167], v[68:71]
  TR v[166:167], v3 offset:10496
  MF v[72:75], v[168:171], a[168:171], v[72:75]
  MF v[76:79], v[168:171], a[172:175], v[76:79]
  s_waitcnt lgkmcnt(4)
  MF v[80:83], v[172:175], a[160:163], v[80:83]
  TR v[168:169], v5 offset:8192
  MF v[84:87], v[172:175], a[164:167], v[84:87]
  TR v[170:171], v5 offset:8448
  MF v[88:91], v[172:175], a[168:171], v[88:91]
  MF v[92:95], v[172:175], a[172:175], v[92:95]
  s_waitcnt lgkmcnt(4)
  MF v[32:35], v[160:163], a[176:179], v[32:35]
  TR v[172:173], v5 offset:10240
  MF v[36:39], v[160:163], a[180:183], v[36:39]
  TR v[174:175], v5 offset:10496
  MF v[40:43], v[160:163], a[184:187], v[40:43]
  MF v[44:47], v[160:163], a[188:191], v[44:47]
  s_waitcnt lgkmcnt(4)
  MF v[48:51], v[164:167], a[176:179], v[48:51]
  s_waitcnt vmcnt(0)
  s_barrier
  v_mov_b32 v243, 1
  buffer_store_dword v243, v30, s[16:19], 0 offen sc1
  TR v[160:161], v3 offset:12288
  MF v[52:55], v[164:167], a[180:183], v[52:55]
  TR v[162:163], v3 offset:12544
  MF v[56:59], v[164:167], a[184:187], v[56:59]
  MF v[60:63], v[164:167], a[188:191], v[60:63]
  s_waitcnt lgkmcnt(4)
  MF v[64:67], v[168:171], a[176:179], v[64:67]
  TR v[164:165], v3 offset:14336
  MF v[68:71], v[168:171], a[180:183], v[68:71]
  TR v[166:167], v3 offset:14592
  MF v[72:75], v[168:171], a[184:187], v[72:75]
  MF v[76:79], v[168:171], a[188:191], v[76:79]
  s_waitcnt lgkmcnt(4)
  MF v[80:83], v[172:175], a[176:179], v[80:83]
  TR v[168:169], v3 offset:16384
  MF v[84:87], v[172:175], a[180:183], v[84:87]
  TR v[170:171], v3 offset:16640
  MF v[88:91], v[172:175], a[184:187], v[88:91]
  MF v[92:95], v[172:175], a[188:191], v[92:95]
  s_waitcnt lgkmcnt(4)
  MF v[32:35], v[160:163], a[192:195], v[32:35]
  TR v[172:173], v3 offset:18432
  MF v[36:39], v[160:163], a[196:199], v[36:39]
  TR v[174:175], v3 offset:18688
  MF v[40:43], v[160:163], a[200:203], v[40:43]
  MF v[44:47], v[160:163], a[204:207], v[44:47]
  s_waitcnt lgkmcnt(4)
  MF v[48:51], v[164:167], a[192:195], v[48:51]
  TR v[160:161], v3 offset:20480
  MF v[52:55], v[164:167], a[196:199], v[52:55]
  TR v[162:163], v3 offset:20736
  MF v[56:59], v[164:167], a[200:203], v[56:59]
  MF v[60:63], v[164:167], a[204:207], v[60:63]
  s_waitcnt lgkmcnt(4)
  MF v[32:35], v[168:171], a[208:211], v[32:35]
  TR v[164:165], v3 offset:22528
  MF v[36:39], v[168:171], a[212:215], v[36:39]
  TR v[166:167], v3 offset:22784
  MF v[40:43], v[168:171], a[216:219], v[40:43]
  MF v[44:47], v[168:171], a[220:223], v[44:47]
  s_waitcnt lgkmcnt(4)
  MF v[48:51], v[172:175], a[208:211], v[48:51]
  TR v[168:169], v3 offset:24576
  MF v[52:55], v[172:175], a[212:215], v[52:55]
  TR v[170:171], v3 offset:24832
  MF v[56:59], v[172:175], a[216:219], v[56:59]
  MF v[60:63], v[172:175], a[220:223], v[60:63]
  s_waitcnt lgkmcnt(4)
  MF v[32:35], v[160:163], a[224:227], v[32:35]
  TR v[172:173], v3 offset:26624
  MF v[36:39], v[160:163], a[228:231], v[36:39]
  TR v[174:175], v3 offset:26880
  MF v[40:43], v[160:163], a[232:235], v[40:43]
  MF v[44:47], v[160:163], a[236:239], v[44:47]
  s_waitcnt lgkmcnt(4)
  MF v[48:51], v[164:167], a[224:227], v[48:51]
  TR v[160:161], v3 offset:28672
  MF v[52:55], v[164:167], a[228:231], v[52:55]
  TR v[162:163], v3 offset:28928
  MF v[56:59], v[164:167], a[232:235], v[56:59]
  MF v[60:63], v[164:167], a[236:239], v[60:63]
  s_waitcnt lgkmcnt(4)
  MF v[32:35], v[168:171], a[240:243], v[32:35]
  TR v[164:165], v3 offset:30720
  MF v[36:39], v[168:171], a[244:247], v[36:39]
  TR v[166:167], v3 offset:30976
  MF v[40:43], v[168:171], a[248:251], v[40:43]
  MF v[44:47], v[168:171], a[252:255], v[44:47]
  s_waitcnt lgkmcnt(4)
  MF v[48:51], v[172:175], a[240:243], v[48:51]
  TR v[168:169], v3 offset:32768
  MF v[52:55], v[172:175], a[244:247], v[52:55]
  TR v[170:171], v3 offset:33024
  MF v[56:59], v[172:175], a[248:251], v[56:59]
  MF v[60:63], v[172:175], a[252:255], v[60:63]
  s_waitcnt lgkmcnt(4)
  MF v[32:35], v[160:163], v[176:179], v[32:35]
  TR v[172:173], v3 offset:34816
  MF v[36:39], v[160:163], v[180:183], v[36:39]
  TR v[174:175], v3 offset:35072
  MF v[40:43], v[160:163], v[184:187], v[40:43]
  MF v[44:47], v[160:163], v[188:191], v[44:47]
  s_waitcnt lgkmcnt(4)
  MF v[48:51], v[164:167], v[176:179], v[48:51]
  TR v[160:161], v5 offset:12288
  MF v[52:55], v[164:167], v[180:183], v[52:55]
  TR v[162:163], v5 offset:12544
  MF v[56:59], v[164:167], v[184:187], v[56:59]
  MF v[60:63], v[164:167], v[188:191], v[60:63]
  s_waitcnt lgkmcnt(4)
  MF v[32:35], v[168:171], v[192:195], v[32:35]
  TR v[164:165], v5 offset:14336
  MF v[36:39], v[168:171], v[196:199], v[36:39]
  TR v[166:167], v5 offset:14592
  MF v[40:43], v[168:171], v[200:203], v[40:43]
  MF v[44:47], v[168:171], v[204:207], v[44:47]
  s_waitcnt lgkmcnt(4)
  MF v[48:51], v[172:175], v[192:195], v[48:51]
  TR v[168:169], v5 offset:16384
  MF v[52:55], v[172:175], v[196:199], v[52:55]
  TR v[170:171], v5 offset:16640
  MF v[56:59], v[172:175], v[200:203], v[56:59]
  MF v[60:63], v[172:175], v[204:207], v[60:63]
  s_waitcnt lgkmcnt(4)
  MF v[64:67], v[160:163], a[192:195], v[64:67]
  TR v[172:173], v5 offset:18432
  MF v[68:71], v[160:163], a[196:199], v[68:71]
  TR v[174:175], v5 offset:18688
  MF v[72:75], v[160:163], a[200:203], v[72:75]
  MF v[76:79], v[160:163], a[204:207], v[76:79]
  s_waitcnt lgkmcnt(4)
  MF v[80:83], v[164:167], a[192:195], v[80:83]
  TR v[160:161], v5 offset:20480
  MF v[84:87], v[164:167], a[196:199], v[84:87]
  TR v[162:163], v5 offset:20736
  MF v[88:91], v[164:167], a[200:203], v[88:91]
  MF v[92:95], v[164:167], a[204:207], v[92:95]
  s_waitcnt lgkmcnt(4)
  MF v[64:67], v[168:171], a[208:211], v[64:67]
  TR v[164:165], v5 offset:22528
  MF v[68:71], v[168:171], a[212:215], v[68:71]
  TR v[166:167], v5 offset:22784
  MF v[72:75], v[168:171], a[216:219], v[72:75]
  v_max_f32 v32, 0, v32
  v_max_f32 v33, 0, v33
  MF v[76:79], v[168:171], a[220:223], v[76:79]
  v_max_f32 v34, 0, v34
  s_waitcnt lgkmcnt(4)
  MF v[80:83], v[172:175], a[208:211], v[80:83]
  TR v[168:169], v5 offset:24576
  v_max_f32 v35, 0, v35
  MF v[84:87], v[172:175], a[212:215], v[84:87]
  TR v[170:171], v5 offset:24832
  v_mul_f32 v32, v32, v48
  MF v[88:91], v[172:175], a[216:219], v[88:91]
  v_mul_f32 v33, v33, v49
  v_mul_f32 v34, v34, v50
  MF v[92:95], v[172:175], a[220:223], v[92:95]
  v_mul_f32 v35, v35, v51
  s_waitcnt lgkmcnt(4)
  MF v[64:67], v[160:163], a[224:227], v[64:67]
  TR v[172:173], v5 offset:26624
  v_cvt_pk_bf16_f32 v248, v32, v33
  MF v[68:71], v[160:163], a[228:231], v[68:71]
  TR v[174:175], v5 offset:26880
  v_cvt_pk_bf16_f32 v249, v34, v35
  MF v[72:75], v[160:163], a[232:235], v[72:75]
  v_max_f32 v36, 0, v36
  v_max_f32 v37, 0, v37
  MF v[76:79], v[160:163], a[236:239], v[76:79]
  v_max_f32 v38, 0, v38
  s_waitcnt lgkmcnt(4)
  MF v[80:83], v[164:167], a[224:227], v[80:83]
  TR v[160:161], v5 offset:28672
  v_max_f32 v39, 0, v39
  MF v[84:87], v[164:167], a[228:231], v[84:87]
  TR v[162:163], v5 offset:28928
  v_mul_f32 v36, v36, v52
  MF v[88:91], v[164:167], a[232:235], v[88:91]
  v_mul_f32 v37, v37, v53
  v_mul_f32 v38, v38, v54
  MF v[92:95], v[164:167], a[236:239], v[92:95]
  v_mul_f32 v39, v39, v55
  s_waitcnt lgkmcnt(4)
  MF v[64:67], v[168:171], a[240:243], v[64:67]
  TR v[164:165], v5 offset:30720
  v_cvt_pk_bf16_f32 v250, v36, v37
  MF v[68:71], v[168:171], a[244:247], v[68:71]
  TR v[166:167], v5 offset:30976
  v_cvt_pk_bf16_f32 v251, v38, v39
  MF v[72:75], v[168:171], a[248:251], v[72:75]
  v_max_f32 v40, 0, v40
  v_max_f32 v41, 0, v41
  MF v[76:79], v[168:171], a[252:255], v[76:79]
  v_max_f32 v42, 0, v42
  s_waitcnt lgkmcnt(4)
  MF v[80:83], v[172:175], a[240:243], v[80:83]
  TR v[168:169], v5 offset:32768
  v_max_f32 v43, 0, v43
  MF v[84:87], v[172:175], a[244:247], v[84:87]
  TR v[170:171], v5 offset:33024
  v_mul_f32 v40, v40, v56
  MF v[88:91], v[172:175], a[248:251], v[88:91]
  v_mul_f32 v41, v41, v57
  v_mul_f32 v42, v42, v58
  MF v[92:95], v[172:175], a[252:255], v[92:95]
  v_mul_f32 v43, v43, v59
  s_waitcnt lgkmcnt(4)
  MF v[64:67], v[160:163], v[176:179], v[64:67]
  TR v[172:173], v5 offset:34816
  v_cvt_pk_bf16_f32 v252, v40, v41
  MF v[68:71], v[160:163], v[180:183], v[68:71]
  TR v[174:175], v5 offset:35072
  v_cvt_pk_bf16_f32 v253, v42, v43
  MF v[72:75], v[160:163], v[184:187], v[72:75]
  v_max_f32 v44, 0, v44
  v_max_f32 v45, 0, v45
  MF v[76:79], v[160:163], v[188:191], v[76:79]
  v_max_f32 v46, 0, v46
  s_waitcnt lgkmcnt(4)
  MF v[80:83], v[164:167], v[176:179], v[80:83]
  v_max_f32 v47, 0, v47
  v_mul_f32 v44, v44, v60
  MF v[84:87], v[164:167], v[180:183], v[84:87]
  v_mul_f32 v45, v45, v61
  v_mul_f32 v46, v46, v62
  MF v[88:91], v[164:167], v[184:187], v[88:91]
  v_mul_f32 v47, v47, v63
  v_cvt_pk_bf16_f32 v254, v44, v45
  MF v[92:95], v[164:167], v[188:191], v[92:95]
  v_cvt_pk_bf16_f32 v255, v46, v47
  s_waitcnt lgkmcnt(2)
  MF v[64:67], v[168:171], v[192:195], v[64:67]
  s_cmp_eq_u32 s32, 0
  s_cselect_b32 s80, 32636928, 1073741824
  v_lshlrev_b32 v31, 4, v1
  MF v[68:71], v[168:171], v[196:199], v[68:71]
  v_add_u32 v31, s80, v31
  MF v[72:75], v[168:171], v[200:203], v[72:75]
  BL4 v[224:227], v31, s[16:19], 0 offen sc1
  MF v[76:79], v[168:171], v[204:207], v[76:79]
  s_waitcnt lgkmcnt(0)
  MF v[80:83], v[172:175], v[192:195], v[80:83]
  MF v[84:87], v[172:175], v[196:199], v[84:87]
  MF v[88:91], v[172:175], v[200:203], v[88:91]
  MF v[92:95], v[172:175], v[204:207], v[92:95]
  s_mul_i32 s88, s34, 45
  s_add_u32 s88, s88, s35
  s_add_u32 s88, s88, 37
  s_lshl_b32 s88, s88, 10
  v_max_f32 v64, 0, v64
  v_max_f32 v65, 0, v65
  v_max_f32 v66, 0, v66
  v_max_f32 v67, 0, v67
  v_mul_f32 v64, v64, v80
  v_mul_f32 v65, v65, v81
  v_mul_f32 v66, v66, v82
  v_mul_f32 v67, v67, v83
  v_mov_b32 v240, v248
  v_mov_b32 v241, v249
  v_cvt_pk_bf16_f32 v242, v64, v65
  v_cvt_pk_bf16_f32 v243, v66, v67
  s_add_u32 s80, s88, 0
  buffer_store_dwordx4 v[240:243], v10, s[16:19], s80 offen sc1
  v_max_f32 v68, 0, v68
  v_max_f32 v69, 0, v69
  v_max_f32 v70, 0, v70
  v_max_f32 v71, 0, v71
  v_mul_f32 v68, v68, v84
  v_mul_f32 v69, v69, v85
  v_mul_f32 v70, v70, v86
  v_mul_f32 v71, v71, v87
  v_mov_b32 v244, v250
  v_mov_b32 v245, v251
  v_cvt_pk_bf16_f32 v246, v68, v69
  v_cvt_pk_bf16_f32 v247, v70, v71
  s_add_u32 s80, s88, 185344
  buffer_store_dwordx4 v[244:247], v10, s[16:19], s80 offen sc1
  v_max_f32 v72, 0, v72
  v_max_f32 v73, 0, v73
  v_max_f32 v74, 0, v74
  v_max_f32 v75, 0, v75
  v_mul_f32 v72, v72, v88
  v_mul_f32 v73, v73, v89
  v_mul_f32 v74, v74, v90
  v_mul_f32 v75, v75, v91
  v_mov_b32 v240, v252
  v_mov_b32 v241, v253
  v_cvt_pk_bf16_f32 v242, v72, v73
  v_cvt_pk_bf16_f32 v243, v74, v75
  s_add_u32 s80, s88, 370688
  buffer_store_dwordx4 v[240:243], v10, s[16:19], s80 offen sc1
  v_max_f32 v76, 0, v76
  v_max_f32 v77, 0, v77
  v_max_f32 v78, 0, v78
  v_max_f32 v79, 0, v79
  v_mul_f32 v76, v76, v92
  v_mul_f32 v77, v77, v93
  v_mul_f32 v78, v78, v94
  v_mul_f32 v79, v79, v95
  v_mov_b32 v244, v254
  v_mov_b32 v245, v255
  v_cvt_pk_bf16_f32 v246, v76, v77
  v_cvt_pk_bf16_f32 v247, v78, v79
  s_add_u32 s80, s88, 556032
  buffer_store_dwordx4 v[244:247], v10, s[16:19], s80 offen sc1
  s_branch P2_START
.globl gated_mix__ssm_conv_s5__glu_gated_reglu__prompt_kernel
.p2align 8
.type gated_mix__ssm_conv_s5__glu_gated_reglu__prompt_kernel,@function
gated_mix__ssm_conv_s5__glu_gated_reglu__prompt_kernel:
  s_cmp_ge_u32 s2, 256
  s_cbranch_scc0 K1_GO
  s_endpgm
K1_GO:
  s_load_dwordx2 s[4:5], s[0:1], 0
  s_load_dwordx4 s[40:43], s[0:1], 80
  s_load_dwordx4 s[44:47], s[0:1], 24
  s_load_dwordx2 s[16:17], s[0:1], 128
  s_load_dwordx2 s[20:21], s[0:1], 120
  s_load_dwordx2 s[24:25], s[0:1], 104
  s_load_dwordx4 s[92:95], s[0:1], 8
  s_load_dwordx2 s[96:97], s[0:1], 56
  s_load_dwordx4 s[76:79], s[0:1], 40
  s_load_dwordx2 s[98:99], s[0:1], 96
  s_getpc_b64 s[84:85]
KPC_T:
  v_and_b32 v242, 15, v0
  v_lshlrev_b32 v242, 7, v242
  v_bfe_u32 v243, v0, 4, 2
  v_mov_b32 v240, K1_TB_MAIN-KERNEL_BEGIN
  v_mov_b32 v241, K1_TA1_MAIN-KERNEL_BEGIN
  v_cmp_eq_u32 vcc, 1, v243
  s_sub_u32 s84, s84, KPC_T-KERNEL_BEGIN
  s_subb_u32 s85, s85, 0
  v_cndmask_b32 v240, v240, v241, vcc
  v_mov_b32 v241, K1_TA_MAIN-KERNEL_BEGIN
  v_cmp_le_u32 vcc, 2, v243
  s_nop 1
  v_cndmask_b32 v240, v240, v241, vcc
  v_add_u32 v240, v240, v242
  v_mov_b32 v241, s85
  v_add_co_u32 v240, vcc, s84, v240
  s_nop 1
  v_addc_co_u32 v241, vcc, 0, v241, vcc
  global_load_dword v233, v[240:241], off
  s_lshr_b32 s91, s2, 3
  s_and_b32 s35, s91, 7
  v_lshrrev_b32 v25, 6, v0
  v_and_b32 v1, 63, v0
  s_and_b32 s90, s2, 7
  v_readfirstlane_b32 s32, v25
  s_lshr_b32 s3, s90, 2
  s_lshr_b32 s89, s91, 3
  s_and_b32 s34, s90, 3
  v_lshrrev_b32 v236, 3, v1
  v_lshrrev_b32 v237, 4, v1
  v_and_b32 v26, 7, v1
  s_lshl_b32 s33, s3, 2
  s_lshl_b32 s59, s89, 1
  s_add_u32 s33, s33, s89
  s_add_u32 s59, s59, s35
  v_xor_b32 v237, v237, v26
  v_and_b32 v26, 4, v236
  v_and_b32 v255, 3, v236
  s_add_u32 s59, s59, s3
  s_lshl_b32 s80, s33, 8
  s_lshl_b32 s81, s32, 6
  v_lshlrev_b32 v237, 4, v237
  v_lshlrev_b32 v26, 2, v26
  s_sub_u32 s88, s59, 9
  s_cmp_ge_u32 s59, 9
  s_cselect_b32 s59, s88, s59
  s_add_u32 s80, s80, s81
  v_add_u32 v26, v26, v255
  s_lshl_b32 s59, s59, 1
  s_mov_b32 s88, 1152
  v_add_u32 v26, s80, v26
  v_xor_b32 v255, 64, v237
  s_lshl_b32 s91, s32, 14
  s_lshl_b32 s58, s59, 6
  v_mul_lo_u32 v26, v26, s88
  s_add_u32 s91, s91, 98304
  v_add_u32 v30, v26, v237
  v_add_u32 v31, v26, v255
  v_add_u32 v31, 36864, v31
  s_waitcnt lgkmcnt(0)
  s_and_b32 s5, s5, 65535
  s_mov_b32 s6, 2359296
  s_mov_b32 s7, 131072
  s_add_u32 s90, s58, 0
  s_add_u32 m0, s91, 0
  s_nop 0
  BL4 v30, s[4:7], s90 offen lds
  s_add_u32 m0, s91, 1024
  s_nop 0
  BL4 v31, s[4:7], s90 offen lds
  s_add_u32 s90, s58, 4608
  s_add_u32 m0, s91, 2048
  s_nop 0
  BL4 v30, s[4:7], s90 offen lds
  s_add_u32 m0, s91, 3072
  s_nop 0
  BL4 v31, s[4:7], s90 offen lds
  s_add_u32 s90, s58, 9216
  s_add_u32 m0, s91, 4096
  s_nop 0
  BL4 v30, s[4:7], s90 offen lds
  s_add_u32 m0, s91, 5120
  s_nop 0
  BL4 v31, s[4:7], s90 offen lds
  s_add_u32 s90, s58, 13824
  s_add_u32 m0, s91, 6144
  s_nop 0
  BL4 v30, s[4:7], s90 offen lds
  s_add_u32 m0, s91, 7168
  s_nop 0
  BL4 v31, s[4:7], s90 offen lds
  s_and_b32 s88, s32, 1
  s_cmp_eq_u32 s88, 0
  s_cselect_b32 s8, s40, s42
  s_cselect_b32 s9, s41, s43
  s_cselect_b32 s12, s44, s46
  s_cselect_b32 s13, s45, s47
  s_and_b32 s9, s9, 65535
  s_mov_b32 s10, 5308416
  s_mov_b32 s11, 131072
  s_and_b32 s13, s13, 65535
  s_mov_b32 s14, 663552
  s_mov_b32 s15, 131072
  s_mul_i32 s40, s59, 294912
  s_add_u32 s59, s59, 1
  s_cmp_ge_u32 s59, 18
  s_cselect_b32 s59, 0, s59
  s_mul_i32 s41, s59, 294912
  s_add_u32 s59, s59, 1
  s_cmp_ge_u32 s59, 18
  s_cselect_b32 s59, 0, s59
  s_lshl_b32 s80, s35, 2
  s_mul_i32 s81, s35, 5
  s_sub_u32 s81, s81, 4
  s_cmp_lt_u32 s35, 4
  s_cselect_b32 s80, s80, s81
  s_mul_i32 s81, s34, 45
  s_add_u32 s36, s81, s80
  s_sub_u32 s36, s36, s35
  s_mul_i32 s81, s34, 36
  s_add_u32 s80, s80, s81
  s_lshl_b32 s80, s80, 6
  v_lshrrev_b32 v26, 2, v1
  v_lshrrev_b32 v255, 5, v1
  v_and_b32 v8, 3, v1
  s_lshr_b32 s81, s32, 1
  v_lshlrev_b32 v255, 1, v255
  s_lshl_b32 s82, s81, 4
  v_xor_b32 v8, v8, v255
  v_add_u32 v26, s82, v26
  s_mov_b32 s88, 9216
  v_lshlrev_b32 v8, 4, v8
  v_mul_lo_u32 v26, v26, s88
  s_and_b32 s82, s32, 1
  s_lshl_b32 s82, s82, 1
  s_add_u32 s82, s82, s81
  v_add_u32 v8, v8, v26
  v_add_u32 v8, s80, v8
  s_lshl_b32 s37, s82, 10
  s_lshl_b32 s38, s32, 11
  s_lshl_b32 s80, s35, 1
  s_cmp_lt_u32 s35, 4
  s_cselect_b32 s80, s80, 8
  s_mul_i32 s81, s34, 9
  s_add_u32 s39, s80, s81
  s_lshr_b32 s80, s32, 1
  s_cmp_lt_u32 s35, 4
  s_cselect_b32 s80, s80, 0
  s_add_u32 s80, s80, s39
  s_lshl_b32 s80, s80, 4
  s_mov_b32 s88, 1152
  v_add_u32 v26, s80, v236
  v_xor_b32 v255, 64, v237
  v_mul_lo_u32 v26, v26, s88
  v_add_u32 v9, v26, v237
  v_add_u32 v27, v26, v255
  v_add_u32 v27, 9216, v27
  s_cmp_lt_u32 s35, 4
  s_cbranch_scc1 K1_TB_D
  s_cmp_eq_u32 s35, 4
  s_cbranch_scc1 K1_TA1_D
  s_add_u32 m0, s37, 0
  s_add_u32 s89, s40, 0
  BL4 v8, s[8:11], s89 offen lds
  s_add_u32 m0, s37, 8192
  s_add_u32 s89, s40, 64
  BL4 v8, s[8:11], s89 offen lds
  s_add_u32 m0, s37, 4096
  s_add_u32 s89, s41, 0
  BL4 v8, s[8:11], s89 offen lds
  s_add_u32 m0, s37, 12288
  s_add_u32 s89, s41, 64
  BL4 v8, s[8:11], s89 offen lds
  s_branch K1_P3
K1_TB_D:
  s_add_u32 m0, s37, 0
  s_add_u32 s89, s40, 0
  BL4 v8, s[8:11], s89 offen lds
  s_add_u32 m0, s38, 8192
  s_nop 0
  BL4 v9, s[12:15], s58 offen lds
  s_add_u32 m0, s37, 4096
  s_add_u32 s89, s41, 0
  BL4 v8, s[8:11], s89 offen lds
  s_add_u32 m0, s38, 9216
  s_nop 0
  BL4 v27, s[12:15], s58 offen lds
  s_branch K1_P3
K1_TA1_D:
  s_add_u32 m0, s37, 0
  s_add_u32 s89, s40, 0
  BL4 v8, s[8:11], s89 offen lds
  s_add_u32 m0, s38, 8192
  s_nop 0
  BL4 v9, s[12:15], s58 offen lds
  s_add_u32 m0, s37, 4096
  s_add_u32 s89, s41, 0
  BL4 v8, s[8:11], s89 offen lds
  s_add_u32 m0, s38, 9216
  s_nop 0
  BL4 v27, s[12:15], s58 offen lds
K1_P3:
  s_mul_i32 s42, s59, 294912
  s_lshl_b32 s60, s59, 6
  s_add_u32 s59, s59, 1
  s_cmp_ge_u32 s59, 18
  s_cselect_b32 s59, 0, s59
  s_mul_i32 s43, s59, 294912
  s_add_u32 s59, s59, 1
  s_cmp_ge_u32 s59, 18
  s_cselect_b32 s59, 0, s59
  s_mul_i32 s44, s59, 294912
  s_lshl_b32 s62, s59, 6
  s_add_u32 s59, s59, 1
  s_cmp_ge_u32 s59, 18
  s_cselect_b32 s59, 0, s59
  s_mul_i32 s45, s59, 294912
  s_add_u32 s59, s59, 1
  s_cmp_ge_u32 s59, 18
  s_cselect_b32 s59, 0, s59
  s_mul_i32 s46, s59, 294912
  s_lshl_b32 s64, s59, 6
  s_add_u32 s59, s59, 1
  s_cmp_ge_u32 s59, 18
  s_cselect_b32 s59, 0, s59
  s_mul_i32 s47, s59, 294912
  s_add_u32 s59, s59, 1
  s_cmp_ge_u32 s59, 18
  s_cselect_b32 s59, 0, s59
  s_mul_i32 s48, s59, 294912
  s_lshl_b32 s66, s59, 6
  s_add_u32 s59, s59, 1
  s_cmp_ge_u32 s59, 18
  s_cselect_b32 s59, 0, s59
  s_mul_i32 s49, s59, 294912
  s_add_u32 s59, s59, 1
  s_cmp_ge_u32 s59, 18
  s_cselect_b32 s59, 0, s59
  s_mul_i32 s50, s59, 294912
  s_lshl_b32 s68, s59, 6
  s_add_u32 s59, s59, 1
  s_cmp_ge_u32 s59, 18
  s_cselect_b32 s59, 0, s59
  s_mul_i32 s51, s59, 294912
  s_add_u32 s59, s59, 1
  s_cmp_ge_u32 s59, 18
  s_cselect_b32 s59, 0, s59
  s_mul_i32 s52, s59, 294912
  s_lshl_b32 s70, s59, 6
  s_add_u32 s59, s59, 1
  s_cmp_ge_u32 s59, 18
  s_cselect_b32 s59, 0, s59
  s_mul_i32 s53, s59, 294912
  s_add_u32 s59, s59, 1
  s_cmp_ge_u32 s59, 18
  s_cselect_b32 s59, 0, s59
  s_mul_i32 s54, s59, 294912
  s_lshl_b32 s72, s59, 6
  s_add_u32 s59, s59, 1
  s_cmp_ge_u32 s59, 18
  s_cselect_b32 s59, 0, s59
  s_mul_i32 s55, s59, 294912
  s_add_u32 s59, s59, 1
  s_cmp_ge_u32 s59, 18
  s_cselect_b32 s59, 0, s59
  s_mul_i32 s56, s59, 294912
  s_lshl_b32 s74, s59, 6
  s_add_u32 s59, s59, 1
  s_cmp_ge_u32 s59, 18
  s_cselect_b32 s59, 0, s59
  s_mul_i32 s57, s59, 294912
  s_add_u32 s59, s59, 1
  s_cmp_ge_u32 s59, 18
  s_cselect_b32 s59, 0, s59
  v_and_b32 v26, 15, v1
  v_lshrrev_b32 v255, 4, v1
  v_lshrrev_b32 v237, 1, v26
  v_xor_b32 v237, v237, v255
  v_lshlrev_b32 v237, 4, v237
  v_lshlrev_b32 v26, 7, v26
  v_add_u32 v6, v26, v237
  v_xor_b32 v7, 64, v6
  v_add_u32 v28, 61440, v6
  v_add_u32 v29, 61440, v7
  v_add_u32 v252, s91, v6
  v_add_u32 v253, s91, v7
  v_lshrrev_b32 v26, 4, v1
  v_and_b32 v255, 15, v1
  v_lshrrev_b32 v238, 1, v26
  v_lshlrev_b32 v2, 10, v238
  v_and_b32 v238, 1, v26
  v_lshlrev_b32 v239, 9, v238
  v_add_u32 v2, v2, v239
  v_lshrrev_b32 v239, 2, v255
  v_lshlrev_b32 v239, 6, v239
  v_add_u32 v2, v2, v239
  v_lshlrev_b32 v238, 1, v238
  v_lshrrev_b32 v239, 1, v255
  v_and_b32 v239, 1, v239
  v_xor_b32 v239, v239, v238
  v_lshlrev_b32 v239, 4, v239
  v_add_u32 v2, v2, v239
  v_and_b32 v239, 1, v255
  v_lshlrev_b32 v239, 3, v239
  v_add_u32 v2, v2, v239
  v_xor_b32 v4, 32, v2
  v_add_u32 v3, 61440, v2
  v_add_u32 v5, 61440, v4
  s_getpc_b64 s[84:85]
KPC_C:
  s_lshr_b32 s80, s2, 3
  s_lshl_b32 s80, s80, 2
  s_add_u32 s80, s80, s32
  s_lshl_b32 s80, s80, 13
  v_lshlrev_b32 v242, 7, v1
  v_add_u32 v242, s80, v242
  s_mov_b32 s81, KERNEL_END-KERNEL_BEGIN-128
  v_min_u32 v242, s81, v242
  s_sub_u32 s80, s84, KPC_C-KERNEL_BEGIN
  s_subb_u32 s85, s85, 0
  v_mov_b32 v241, s85
  v_add_co_u32 v240, vcc, s80, v242
  s_nop 1
  v_addc_co_u32 v241, vcc, 0, v241, vcc
  global_load_dword v233, v[240:241], off
  s_and_b32 s17, s17, 65535
  s_mov_b32 s18, 67108864
  s_mov_b32 s19, 131072
  s_cmp_lt_u32 s35, 4
  s_cbranch_scc1 K1_TB_MAIN
  s_cmp_eq_u32 s35, 4
  s_cbranch_scc1 K1_TA1_MAIN
K1_TA_MAIN:
  s_add_u32 m0, s37, 16384
  s_add_u32 s89, s42, 0
  BL4 v8, s[8:11], s89 offen lds
  s_add_u32 m0, s37, 24576
  s_add_u32 s89, s42, 64
  BL4 v8, s[8:11], s89 offen lds
  s_add_u32 m0, s37, 20480
  s_add_u32 s89, s43, 0
  BL4 v8, s[8:11], s89 offen lds
  s_add_u32 m0, s37, 28672
  s_add_u32 s89, s43, 64
  BL4 v8, s[8:11], s89 offen lds
  s_add_u32 s90, s60, 0
  s_add_u32 m0, s91, 8192
  s_nop 0
  BL4 v30, s[4:7], s90 offen lds
  s_add_u32 m0, s91, 9216
  s_nop 0
  BL4 v31, s[4:7], s90 offen lds
  s_add_u32 s90, s60, 4608
  s_add_u32 m0, s91, 10240
  s_nop 0
  BL4 v30, s[4:7], s90 offen lds
  s_add_u32 m0, s91, 11264
  s_nop 0
  BL4 v31, s[4:7], s90 offen lds
  s_add_u32 s90, s60, 9216
  s_add_u32 m0, s91, 12288
  s_nop 0
  BL4 v30, s[4:7], s90 offen lds
  s_add_u32 m0, s91, 13312
  s_nop 0
  BL4 v31, s[4:7], s90 offen lds
  s_and_b32 s17, s17, 65535
  s_mov_b32 s18, 67108864
  s_mov_b32 s19, 131072
  s_and_b32 s21, s21, 65535
  s_mov_b32 s22, 256
  s_mov_b32 s23, 131072
  s_and_b32 s25, s25, 65535
  s_mov_b32 s26, 1152
  s_mov_b32 s27, 131072
  s_lshl_b32 s80, s33, 4
  s_lshl_b32 s81, s32, 2
  s_add_u32 s80, s80, s81
  s_mul_i32 s80, s80, 185344
  v_lshlrev_b32 v10, 4, v1
  v_add_u32 v10, s80, v10
  s_lshl_b32 s80, s2, 3
  s_lshl_b32 s81, s32, 1
  s_add_u32 s80, s80, s81
  v_lshrrev_b32 v25, 5, v1
  v_add_u32 v25, s80, v25
  v_and_b32 v26, 31, v1
  v_lshlrev_b32 v26, 2, v26
  s_mov_b32 s83, 1152
  v_mul_lo_u32 v255, v25, s83
  v_add_u32 v255, v255, v26
  buffer_load_dword v208, v255, s[4:7], 0 offen
  buffer_load_dword v217, v26, s[24:27], 0 offen
  buffer_load_dword v209, v255, s[4:7], 0 offen offset:128
  buffer_load_dword v218, v26, s[24:27], 0 offen offset:128
  buffer_load_dword v210, v255, s[4:7], 0 offen offset:256
  buffer_load_dword v219, v26, s[24:27], 0 offen offset:256
  buffer_load_dword v211, v255, s[4:7], 0 offen offset:384
  buffer_load_dword v220, v26, s[24:27], 0 offen offset:384
  buffer_load_dword v212, v255, s[4:7], 0 offen offset:512
  buffer_load_dword v221, v26, s[24:27], 0 offen offset:512
  buffer_load_dword v213, v255, s[4:7], 0 offen offset:640
  buffer_load_dword v222, v26, s[24:27], 0 offen offset:640
  buffer_load_dword v214, v255, s[4:7], 0 offen offset:768
  buffer_load_dword v223, v26, s[24:27], 0 offen offset:768
  buffer_load_dword v215, v255, s[4:7], 0 offen offset:896
  buffer_load_dword v224, v26, s[24:27], 0 offen offset:896
  buffer_load_dword v216, v255, s[4:7], 0 offen offset:1024
  buffer_load_dword v225, v26, s[24:27], 0 offen offset:1024
  s_mul_i32 s80, s33, 72
  s_lshr_b32 s81, s32, 1
  s_mul_i32 s81, s81, 36
  s_add_u32 s80, s80, s81
  v_add_u32 v11, s80, v1
  s_mov_b32 s81, 9216
  v_mul_lo_u32 v11, v11, s81
  s_lshl_b32 s80, s35, 2
  s_mul_i32 s81, s35, 5
  s_sub_u32 s81, s81, 4
  s_cmp_lt_u32 s35, 4
  s_cselect_b32 s80, s80, s81
  s_mul_i32 s81, s34, 36
  s_add_u32 s80, s80, s81
  s_lshl_b32 s80, s80, 6
  v_add_u32 v11, s80, v11
  v_mov_b32 v232, 1073741824
  v_cmp_gt_u32 vcc, 36, v1
  s_nop 1
  v_cndmask_b32 v11, v232, v11, vcc
  s_waitcnt vmcnt(39)
  ds_read_b128 a[0:3], v252
  ds_read_b128 a[16:19], v253
  s_add_u32 s90, s60, 13824
  s_add_u32 m0, s91, 14336
  s_nop 0
  BL4 v30, s[4:7], s90 offen lds
  s_add_u32 m0, s91, 15360
  s_nop 0
  BL4 v31, s[4:7], s90 offen lds
  s_waitcnt vmcnt(39)
  ds_read_b128 a[4:7], v252 offset:2048
  ds_read_b128 a[20:23], v253 offset:2048
  s_add_u32 s90, s62, 0
  s_add_u32 m0, s91, 0
  s_nop 0
  s_waitcnt lgkmcnt(2)
  BL4 v30, s[4:7], s90 offen lds
  s_add_u32 m0, s91, 1024
  s_nop 0
  BL4 v31, s[4:7], s90 offen lds
  s_waitcnt vmcnt(39)
  ds_read_b128 a[8:11], v252 offset:4096
  ds_read_b128 a[24:27], v253 offset:4096
  s_add_u32 s90, s62, 4608
  s_add_u32 m0, s91, 2048
  s_nop 0
  s_waitcnt lgkmcnt(2)
  BL4 v30, s[4:7], s90 offen lds
  s_add_u32 m0, s91, 3072
  s_nop 0
  BL4 v31, s[4:7], s90 offen lds
  s_waitcnt vmcnt(39)
  ds_read_b128 a[12:15], v252 offset:6144
  ds_read_b128 a[28:31], v253 offset:6144
  s_add_u32 s90, s62, 9216
  s_add_u32 m0, s91, 4096
  s_nop 0
  s_waitcnt lgkmcnt(2)
  BL4 v30, s[4:7], s90 offen lds
  s_add_u32 m0, s91, 5120
  s_nop 0
  BL4 v31, s[4:7], s90 offen lds
  s_waitcnt vmcnt(37)
  s_barrier
  TR v[160:161], v2
  TR v[162:163], v2 offset:256
  TR v[164:165], v2 offset:2048
  TR v[166:167], v2 offset:2304
  TR v[168:169], v4
  TR v[170:171], v4 offset:256
  s_waitcnt lgkmcnt(4)
  MF v[32:35], v[160:163], a[0:3], 0
  TR v[172:173], v4 offset:2048
  MF v[36:39], v[160:163], a[4:7], 0
  TR v[174:175], v4 offset:2304
  MF v[40:43], v[160:163], a[8:11], 0
  s_add_u32 m0, s37, 32768
  s_add_u32 s89, s44, 0
  BL4 v8, s[8:11], s89 offen lds
  MF v[44:47], v[160:163], a[12:15], 0
  s_add_u32 m0, s37, 40960
  s_add_u32 s89, s44, 64
  BL4 v8, s[8:11], s89 offen lds
  s_waitcnt lgkmcnt(4)
  MF v[48:51], v[164:167], a[0:3], 0
  TR v[160:161], v2 offset:8192
  MF v[52:55], v[164:167], a[4:7], 0
  TR v[162:163], v2 offset:8448
  MF v[56:59], v[164:167], a[8:11], 0
  s_waitcnt vmcnt(32)
  ds_read_b128 a[32:35], v252 offset:8192
  MF v[60:63], v[164:167], a[12:15], 0
  ds_read_b128 a[48:51], v253 offset:8192
  s_waitcnt lgkmcnt(6)
  MF v[64:67], v[168:171], a[0:3], 0
  TR v[164:165], v2 offset:10240
  MF v[68:71], v[168:171], a[4:7], 0
  TR v[166:167], v2 offset:10496
  MF v[72:75], v[168:171], a[8:11], 0
  s_add_u32 s90, s62, 13824
  s_add_u32 m0, s91, 6144
  s_nop 0
  BL4 v30, s[4:7], s90 offen lds
  MF v[76:79], v[168:171], a[12:15], 0
  s_add_u32 m0, s91, 7168
  s_nop 0
  BL4 v31, s[4:7], s90 offen lds
  s_waitcnt lgkmcnt(6)
  MF v[80:83], v[172:175], a[0:3], 0
  TR v[168:169], v4 offset:8192
  MF v[84:87], v[172:175], a[4:7], 0
  TR v[170:171], v4 offset:8448
  MF v[88:91], v[172:175], a[8:11], 0
  s_waitcnt vmcnt(32)
  ds_read_b128 a[36:39], v252 offset:10240
  MF v[92:95], v[172:175], a[12:15], 0
  ds_read_b128 a[52:55], v253 offset:10240
  s_add_u32 s90, s64, 0
  s_add_u32 m0, s91, 8192
  s_nop 0
  s_waitcnt lgkmcnt(6)
  BL4 v30, s[4:7], s90 offen lds
  s_add_u32 m0, s91, 9216
  s_nop 0
  BL4 v31, s[4:7], s90 offen lds
  MF v[96:99], v[160:163], a[0:3], 0
  TR v[172:173], v4 offset:10240
  MF v[100:103], v[160:163], a[4:7], 0
  TR v[174:175], v4 offset:10496
  MF v[104:107], v[160:163], a[8:11], 0
  s_add_u32 m0, s37, 36864
  s_add_u32 s89, s45, 0
  BL4 v8, s[8:11], s89 offen lds
  MF v[108:111], v[160:163], a[12:15], 0
  s_add_u32 m0, s37, 45056
  s_add_u32 s89, s45, 64
  BL4 v8, s[8:11], s89 offen lds
  s_waitcnt lgkmcnt(6)
  MF v[112:115], v[164:167], a[0:3], 0
  TR v[160:161], v2 offset:4096
  MF v[116:119], v[164:167], a[4:7], 0
  TR v[162:163], v2 offset:4352
  MF v[120:123], v[164:167], a[8:11], 0
  s_cmp_eq_u32 s2, 0
  s_cbranch_scc0 ZSKIP1
  v_mov_b32 v244, 0
  v_mov_b32 v245, 0
  v_mov_b32 v246, 0
  v_mov_b32 v247, 0
  v_lshlrev_b32 v243, 4, v1
  s_add_u32 s80, s32, 0
  s_lshl_b32 s81, s80, 10
  s_add_u32 s81, s81, 32636928
  s_cmp_lt_u32 s80, 14
  s_cselect_b32 s81, s81, 1073741824
  buffer_store_dwordx4 v[244:247], v243, s[16:19], s81 offen sc1
  s_add_u32 s80, s32, 4
  s_lshl_b32 s81, s80, 10
  s_add_u32 s81, s81, 32636928
  s_cmp_lt_u32 s80, 14
  s_cselect_b32 s81, s81, 1073741824
  buffer_store_dwordx4 v[244:247], v243, s[16:19], s81 offen sc1
  s_add_u32 s80, s32, 8
  s_lshl_b32 s81, s80, 10
  s_add_u32 s81, s81, 32636928
  s_cmp_lt_u32 s80, 14
  s_cselect_b32 s81, s81, 1073741824
  buffer_store_dwordx4 v[244:247], v243, s[16:19], s81 offen sc1
  s_add_u32 s80, s32, 12
  s_lshl_b32 s81, s80, 10
  s_add_u32 s81, s81, 32636928
  s_cmp_lt_u32 s80, 14
  s_cselect_b32 s81, s81, 1073741824
  buffer_store_dwordx4 v[244:247], v243, s[16:19], s81 offen sc1
  s_waitcnt vmcnt(0)
ZSKIP1:
  MF v[124:127], v[164:167], a[12:15], 0
  s_waitcnt lgkmcnt(6)
  MF v[128:131], v[168:171], a[0:3], 0
  TR v[164:165], v2 offset:6144
  MF v[132:135], v[168:171], a[4:7], 0
  TR v[166:167], v2 offset:6400
  MF v[136:139], v[168:171], a[8:11], 0
  MF v[140:143], v[168:171], a[12:15], 0
  s_waitcnt lgkmcnt(4)
  MF v[144:147], v[172:175], a[0:3], 0
  TR v[168:169], v4 offset:4096
  MF v[148:151], v[172:175], a[4:7], 0
  TR v[170:171], v4 offset:4352
  MF v[152:155], v[172:175], a[8:11], 0
  MF v[156:159], v[172:175], a[12:15], 0
  s_waitcnt lgkmcnt(4)
  MF v[32:35], v[160:163], a[16:19], v[32:35]
  TR v[172:173], v4 offset:6144
  MF v[36:39], v[160:163], a[20:23], v[36:39]
  TR v[174:175], v4 offset:6400
  MF v[40:43], v[160:163], a[24:27], v[40:43]
  s_add_u32 m0, s37, 49152
  s_add_u32 s89, s46, 0
  BL4 v8, s[8:11], s89 offen lds
  MF v[44:47], v[160:163], a[28:31], v[44:47]
  s_add_u32 m0, s37, 57344
  s_add_u32 s89, s46, 64
  BL4 v8, s[8:11], s89 offen lds
  s_waitcnt lgkmcnt(4)
  MF v[48:51], v[164:167], a[16:19], v[48:51]
  TR v[160:161], v2 offset:12288
  MF v[52:55], v[164:167], a[20:23], v[52:55]
  TR v[162:163], v2 offset:12544
  MF v[56:59], v[164:167], a[24:27], v[56:59]
  s_waitcnt vmcnt(36)
  ds_read_b128 a[40:43], v252 offset:12288
  MF v[60:63], v[164:167], a[28:31], v[60:63]
  ds_read_b128 a[56:59], v253 offset:12288
  s_waitcnt lgkmcnt(6)
  MF v[64:67], v[168:171], a[16:19], v[64:67]
  TR v[164:165], v2 offset:14336
  s_mov_b32 s84, 128
  MF v[68:71], v[168:171], a[20:23], v[68:71]
  TR v[166:167], v2 offset:14592
  MF v[72:75], v[168:171], a[24:27], v[72:75]
  s_add_u32 s90, s64, 4608
  s_add_u32 m0, s91, 10240
  s_nop 0
  BL4 v30, s[4:7], s90 offen lds
  MF v[76:79], v[168:171], a[28:31], v[76:79]
  s_add_u32 m0, s91, 11264
  s_nop 0
  BL4 v31, s[4:7], s90 offen lds
  s_waitcnt lgkmcnt(6)
  MF v[80:83], v[172:175], a[16:19], v[80:83]
  TR v[168:169], v4 offset:12288
  MF v[84:87], v[172:175], a[20:23], v[84:87]
  TR v[170:171], v4 offset:12544
  MF v[88:91], v[172:175], a[24:27], v[88:91]
  s_waitcnt vmcnt(18)
  ds_read_b128 a[44:47], v252 offset:14336
  MF v[92:95], v[172:175], a[28:31], v[92:95]
  ds_read_b128 a[60:63], v253 offset:14336
  s_add_u32 s90, s64, 9216
  s_add_u32 m0, s91, 12288
  s_nop 0
  s_waitcnt lgkmcnt(6)
  BL4 v30, s[4:7], s90 offen lds
  s_add_u32 m0, s91, 13312
  s_nop 0
  BL4 v31, s[4:7], s90 offen lds
  MF v[96:99], v[160:163], a[16:19], v[96:99]
  TR v[172:173], v4 offset:14336
  MF v[100:103], v[160:163], a[20:23], v[100:103]
  TR v[174:175], v4 offset:14592
  MF v[104:107], v[160:163], a[24:27], v[104:107]
  s_add_u32 m0, s37, 53248
  s_add_u32 s89, s47, 0
  BL4 v8, s[8:11], s89 offen lds
  MF v[108:111], v[160:163], a[28:31], v[108:111]
  s_add_u32 m0, s37, 61440
  s_add_u32 s89, s47, 64
  BL4 v8, s[8:11], s89 offen lds
  s_waitcnt lgkmcnt(6)
  MF v[112:115], v[164:167], a[16:19], v[112:115]
  s_barrier
  TR v[160:161], v2 offset:16384
  MF v[116:119], v[164:167], a[20:23], v[116:119]
  TR v[162:163], v2 offset:16640
  MF v[120:123], v[164:167], a[24:27], v[120:123]
  buffer_load_dword v233, v11, s[8:11], s84 offen
  MF v[124:127], v[164:167], a[28:31], v[124:127]
  s_waitcnt lgkmcnt(6)
  MF v[128:131], v[168:171], a[16:19], v[128:131]
  TR v[164:165], v2 offset:18432
  MF v[132:135], v[168:171], a[20:23], v[132:135]
  TR v[166:167], v2 offset:18688
  MF v[136:139], v[168:171], a[24:27], v[136:139]
  MF v[140:143], v[168:171], a[28:31], v[140:143]
  s_waitcnt lgkmcnt(4)
  MF v[144:147], v[172:175], a[16:19], v[144:147]
  TR v[168:169], v4 offset:16384
  MF v[148:151], v[172:175], a[20:23], v[148:151]
  TR v[170:171], v4 offset:16640
  MF v[152:155], v[172:175], a[24:27], v[152:155]
  MF v[156:159], v[172:175], a[28:31], v[156:159]
  s_waitcnt lgkmcnt(4)
  MF v[32:35], v[160:163], a[32:35], v[32:35]
  TR v[172:173], v4 offset:18432
  MF v[36:39], v[160:163], a[36:39], v[36:39]
  TR v[174:175], v4 offset:18688
  MF v[40:43], v[160:163], a[40:43], v[40:43]
  s_add_u32 m0, s37, 65536
  s_add_u32 s89, s48, 0
  BL4 v8, s[8:11], s89 offen lds
  MF v[44:47], v[160:163], a[44:47], v[44:47]
  s_add_u32 m0, s37, 73728
  s_add_u32 s89, s48, 64
  BL4 v8, s[8:11], s89 offen lds
  s_waitcnt lgkmcnt(4)
  MF v[48:51], v[164:167], a[32:35], v[48:51]
  TR v[160:161], v2 offset:24576
  MF v[52:55], v[164:167], a[36:39], v[52:55]
  TR v[162:163], v2 offset:24832
  MF v[56:59], v[164:167], a[40:43], v[56:59]
  s_waitcnt vmcnt(23)
  ds_read_b128 a[64:67], v252
  MF v[60:63], v[164:167], a[44:47], v[60:63]
  ds_read_b128 a[80:83], v253
  s_waitcnt lgkmcnt(6)
  MF v[64:67], v[168:171], a[32:35], v[64:67]
  TR v[164:165], v2 offset:26624
  MF v[68:71], v[168:171], a[36:39], v[68:71]
  TR v[166:167], v2 offset:26880
  MF v[72:75], v[168:171], a[40:43], v[72:75]
  s_add_u32 s90, s64, 13824
  s_add_u32 m0, s91, 14336
  s_nop 0
  BL4 v30, s[4:7], s90 offen lds
  MF v[76:79], v[168:171], a[44:47], v[76:79]
  s_add_u32 m0, s91, 15360
  s_nop 0
  BL4 v31, s[4:7], s90 offen lds
  s_waitcnt lgkmcnt(6)
  MF v[80:83], v[172:175], a[32:35], v[80:83]
  TR v[168:169], v4 offset:24576
  MF v[84:87], v[172:175], a[36:39], v[84:87]
  TR v[170:171], v4 offset:24832
  MF v[88:91], v[172:175], a[40:43], v[88:91]
  s_waitcnt vmcnt(23)
  ds_read_b128 a[68:71], v252 offset:2048
  MF v[92:95], v[172:175], a[44:47], v[92:95]
  ds_read_b128 a[84:87], v253 offset:2048
  s_add_u32 s90, s66, 0
  s_add_u32 m0, s91, 0
  s_nop 0
  s_waitcnt lgkmcnt(6)
  BL4 v30, s[4:7], s90 offen lds
  s_add_u32 m0, s91, 1024
  s_nop 0
  BL4 v31, s[4:7], s90 offen lds
  MF v[96:99], v[160:163], a[32:35], v[96:99]
  TR v[172:173], v4 offset:26624
  MF v[100:103], v[160:163], a[36:39], v[100:103]
  TR v[174:175], v4 offset:26880
  MF v[104:107], v[160:163], a[40:43], v[104:107]
  s_add_u32 m0, s37, 69632
  s_add_u32 s89, s49, 0
  BL4 v8, s[8:11], s89 offen lds
  MF v[108:111], v[160:163], a[44:47], v[108:111]
  s_add_u32 m0, s37, 77824
  s_add_u32 s89, s49, 64
  BL4 v8, s[8:11], s89 offen lds
  s_waitcnt lgkmcnt(6)
  MF v[112:115], v[164:167], a[32:35], v[112:115]
  TR v[160:161], v2 offset:20480
  MF v[116:119], v[164:167], a[36:39], v[116:119]
  TR v[162:163], v2 offset:20736
  MF v[120:123], v[164:167], a[40:43], v[120:123]
  MF v[124:127], v[164:167], a[44:47], v[124:127]
  s_waitcnt lgkmcnt(6)
  MF v[128:131], v[168:171], a[32:35], v[128:131]
  TR v[164:165], v2 offset:22528
  MF v[132:135], v[168:171], a[36:39], v[132:135]
  TR v[166:167], v2 offset:22784
  MF v[136:139], v[168:171], a[40:43], v[136:139]
  MF v[140:143], v[168:171], a[44:47], v[140:143]
  s_waitcnt lgkmcnt(4)
  MF v[144:147], v[172:175], a[32:35], v[144:147]
  TR v[168:169], v4 offset:20480
  MF v[148:151], v[172:175], a[36:39], v[148:151]
  TR v[170:171], v4 offset:20736
  MF v[152:155], v[172:175], a[40:43], v[152:155]
  MF v[156:159], v[172:175], a[44:47], v[156:159]
  s_waitcnt lgkmcnt(4)
  MF v[32:35], v[160:163], a[48:51], v[32:35]
  TR v[172:173], v4 offset:22528
  MF v[36:39], v[160:163], a[52:55], v[36:39]
  TR v[174:175], v4 offset:22784
  MF v[40:43], v[160:163], a[56:59], v[40:43]
  s_add_u32 m0, s37, 81920
  s_add_u32 s89, s50, 0
  BL4 v8, s[8:11], s89 offen lds
  MF v[44:47], v[160:163], a[60:63], v[44:47]
  s_waitcnt vmcnt(26)
  ds_read_b128 a[72:75], v252 offset:4096
  s_waitcnt lgkmcnt(5)
  MF v[48:51], v[164:167], a[48:51], v[48:51]
  TR v[160:161], v2 offset:28672
  MF v[52:55], v[164:167], a[52:55], v[52:55]
  TR v[162:163], v2 offset:28928
  MF v[56:59], v[164:167], a[56:59], v[56:59]
  ds_read_b128 a[88:91], v253 offset:4096
  MF v[60:63], v[164:167], a[60:63], v[60:63]
  s_add_u32 s90, s66, 4608
  s_add_u32 m0, s91, 2048
  s_nop 0
  BL4 v30, s[4:7], s90 offen lds
  s_waitcnt lgkmcnt(6)
  MF v[64:67], v[168:171], a[48:51], v[64:67]
  TR v[164:165], v2 offset:30720
  MF v[68:71], v[168:171], a[52:55], v[68:71]
  TR v[166:167], v2 offset:30976
  MF v[72:75], v[168:171], a[56:59], v[72:75]
  s_add_u32 m0, s91, 3072
  s_nop 0
  BL4 v31, s[4:7], s90 offen lds
  MF v[76:79], v[168:171], a[60:63], v[76:79]
  s_waitcnt vmcnt(24)
  ds_read_b128 a[76:79], v252 offset:6144
  s_waitcnt lgkmcnt(7)
  MF v[80:83], v[172:175], a[48:51], v[80:83]
  TR v[168:169], v4 offset:28672
  MF v[84:87], v[172:175], a[52:55], v[84:87]
  TR v[170:171], v4 offset:28928
  MF v[88:91], v[172:175], a[56:59], v[88:91]
  ds_read_b128 a[92:95], v253 offset:6144
  MF v[92:95], v[172:175], a[60:63], v[92:95]
  s_add_u32 s90, s66, 9216
  s_add_u32 m0, s91, 4096
  s_nop 0
  s_waitcnt lgkmcnt(6)
  BL4 v30, s[4:7], s90 offen lds
  s_add_u32 m0, s91, 5120
  s_nop 0
  BL4 v31, s[4:7], s90 offen lds
  MF v[96:99], v[160:163], a[48:51], v[96:99]
  TR v[172:173], v4 offset:30720
  MF v[100:103], v[160:163], a[52:55], v[100:103]
  TR v[174:175], v4 offset:30976
  MF v[104:107], v[160:163], a[56:59], v[104:107]
  s_add_u32 m0, s37, 90112
  s_add_u32 s89, s50, 64
  BL4 v8, s[8:11], s89 offen lds
  MF v[108:111], v[160:163], a[60:63], v[108:111]
  s_waitcnt lgkmcnt(6)
  MF v[112:115], v[164:167], a[48:51], v[112:115]
  s_waitcnt vmcnt(23)
  s_barrier
  TR v[160:161], v2 offset:32768
  MF v[116:119], v[164:167], a[52:55], v[116:119]
  TR v[162:163], v2 offset:33024
  MF v[120:123], v[164:167], a[56:59], v[120:123]
  MF v[124:127], v[164:167], a[60:63], v[124:127]
  s_waitcnt lgkmcnt(5)
  MF v[128:131], v[168:171], a[48:51], v[128:131]
  TR v[164:165], v2 offset:34816
  MF v[132:135], v[168:171], a[52:55], v[132:135]
  TR v[166:167], v2 offset:35072
  MF v[136:139], v[168:171], a[56:59], v[136:139]
  MF v[140:143], v[168:171], a[60:63], v[140:143]
  s_waitcnt lgkmcnt(4)
  MF v[144:147], v[172:175], a[48:51], v[144:147]
  TR v[168:169], v4 offset:32768
  MF v[148:151], v[172:175], a[52:55], v[148:151]
  TR v[170:171], v4 offset:33024
  MF v[152:155], v[172:175], a[56:59], v[152:155]
  MF v[156:159], v[172:175], a[60:63], v[156:159]
  s_waitcnt lgkmcnt(4)
  MF v[32:35], v[160:163], a[64:67], v[32:35]
  TR v[172:173], v4 offset:34816
  MF v[36:39], v[160:163], a[68:71], v[36:39]
  TR v[174:175], v4 offset:35072
  MF v[40:43], v[160:163], a[72:75], v[40:43]
  s_add_u32 m0, s37, 86016
  s_add_u32 s89, s51, 0
  BL4 v8, s[8:11], s89 offen lds
  MF v[44:47], v[160:163], a[76:79], v[44:47]
  s_add_u32 m0, s37, 94208
  s_add_u32 s89, s51, 64
  BL4 v8, s[8:11], s89 offen lds
  s_waitcnt lgkmcnt(4)
  MF v[48:51], v[164:167], a[64:67], v[48:51]
  TR v[160:161], v2 offset:40960
  MF v[52:55], v[164:167], a[68:71], v[52:55]
  TR v[162:163], v2 offset:41216
  MF v[56:59], v[164:167], a[72:75], v[56:59]
  ds_read_b128 a[96:99], v252 offset:8192
  MF v[60:63], v[164:167], a[76:79], v[60:63]
  ds_read_b128 a[112:115], v253 offset:8192
  s_waitcnt lgkmcnt(6)
  MF v[64:67], v[168:171], a[64:67], v[64:67]
  TR v[164:165], v2 offset:43008
  MF v[68:71], v[168:171], a[68:71], v[68:71]
  TR v[166:167], v2 offset:43264
  MF v[72:75], v[168:171], a[72:75], v[72:75]
  s_add_u32 s90, s66, 13824
  s_add_u32 m0, s91, 6144
  s_nop 0
  BL4 v30, s[4:7], s90 offen lds
  MF v[76:79], v[168:171], a[76:79], v[76:79]
  s_add_u32 m0, s91, 7168
  s_nop 0
  BL4 v31, s[4:7], s90 offen lds
  s_waitcnt lgkmcnt(6)
  MF v[80:83], v[172:175], a[64:67], v[80:83]
  TR v[168:169], v4 offset:40960
  s_or_b32 s80, s2, s32
  MF v[84:87], v[172:175], a[68:71], v[84:87]
  TR v[170:171], v4 offset:41216
  s_cmp_eq_u32 s80, 0
  s_cselect_b32 s80, 0, 1073741824
  MF v[88:91], v[172:175], a[72:75], v[88:91]
  s_waitcnt vmcnt(23)
  ds_read_b128 a[100:103], v252 offset:10240
  MF v[92:95], v[172:175], a[76:79], v[92:95]
  ds_read_b128 a[116:119], v253 offset:10240
  s_add_u32 s90, s68, 0
  s_add_u32 m0, s91, 8192
  s_nop 0
  s_waitcnt lgkmcnt(6)
  BL4 v30, s[4:7], s90 offen lds
  s_add_u32 m0, s91, 9216
  s_nop 0
  BL4 v31, s[4:7], s90 offen lds
  MF v[96:99], v[160:163], a[64:67], v[96:99]
  TR v[172:173], v4 offset:43008
  v_mov_b32 v229, s80
  MF v[100:103], v[160:163], a[68:71], v[100:103]
  TR v[174:175], v4 offset:43264
  v_mov_b32 v230, 1073741824
  MF v[104:107], v[160:163], a[72:75], v[104:107]
  s_add_u32 m0, s37, 0
  s_add_u32 s89, s52, 0
  BL4 v8, s[8:11], s89 offen lds
  MF v[108:111], v[160:163], a[76:79], v[108:111]
  s_waitcnt lgkmcnt(6)
  MF v[112:115], v[164:167], a[64:67], v[112:115]
  TR v[160:161], v2 offset:36864
  MF v[116:119], v[164:167], a[68:71], v[116:119]
  TR v[162:163], v2 offset:37120
  MF v[120:123], v[164:167], a[72:75], v[120:123]
  v_cmp_eq_u32 vcc, 0, v1
  s_nop 1
  v_cndmask_b32 v229, v230, v229, vcc
  MF v[124:127], v[164:167], a[76:79], v[124:127]
  v_mov_b32 v230, 1
  s_waitcnt lgkmcnt(6)
  MF v[128:131], v[168:171], a[64:67], v[128:131]
  TR v[164:165], v2 offset:38912
  MF v[132:135], v[168:171], a[68:71], v[132:135]
  TR v[166:167], v2 offset:39168
  MF v[136:139], v[168:171], a[72:75], v[136:139]
  buffer_store_dword v230, v229, s[20:23], 0 offen sc1
  MF v[140:143], v[168:171], a[76:79], v[140:143]
  v_mov_b32 v226, 0
  s_waitcnt lgkmcnt(4)
  MF v[144:147], v[172:175], a[64:67], v[144:147]
  TR v[168:169], v4 offset:36864
  v_mov_b32 v227, 0
  MF v[148:151], v[172:175], a[68:71], v[148:151]
  TR v[170:171], v4 offset:37120
  v_lshlrev_b32 v228, 16, v208
  MF v[152:155], v[172:175], a[72:75], v[152:155]
  v_and_b32 v229, 0xffff0000, v208
  v_lshlrev_b32 v230, 16, v217
  MF v[156:159], v[172:175], a[76:79], v[156:159]
  v_and_b32 v231, 0xffff0000, v217
  s_waitcnt lgkmcnt(4)
  MF v[32:35], v[160:163], a[80:83], v[32:35]
  TR v[172:173], v4 offset:38912
  v_mul_f32 v228, v228, v230
  MF v[36:39], v[160:163], a[84:87], v[36:39]
  TR v[174:175], v4 offset:39168
  v_mul_f32 v229, v229, v231
  MF v[40:43], v[160:163], a[88:91], v[40:43]
  s_add_u32 m0, s37, 8192
  s_add_u32 s89, s52, 64
  BL4 v8, s[8:11], s89 offen lds
  MF v[44:47], v[160:163], a[92:95], v[44:47]
  s_waitcnt vmcnt(26)
  ds_read_b128 a[104:107], v252 offset:12288
  s_waitcnt lgkmcnt(5)
  MF v[48:51], v[164:167], a[80:83], v[48:51]
  TR v[160:161], v2 offset:45056
  v_cvt_pk_bf16_f32 v228, v228, v229
  MF v[52:55], v[164:167], a[84:87], v[52:55]
  TR v[162:163], v2 offset:45312
  v_lshlrev_b32 v230, 16, v228
  MF v[56:59], v[164:167], a[88:91], v[56:59]
  ds_read_b128 a[120:123], v253 offset:12288
  MF v[60:63], v[164:167], a[92:95], v[60:63]
  s_add_u32 s90, s68, 4608
  s_add_u32 m0, s91, 10240
  s_nop 0
  BL4 v30, s[4:7], s90 offen lds
  s_waitcnt lgkmcnt(6)
  MF v[64:67], v[168:171], a[80:83], v[64:67]
  TR v[164:165], v2 offset:47104
  v_and_b32 v231, 0xffff0000, v228
  MF v[68:71], v[168:171], a[84:87], v[68:71]
  TR v[166:167], v2 offset:47360
  v_add_f32 v226, v226, v230
  MF v[72:75], v[168:171], a[88:91], v[72:75]
  s_add_u32 m0, s91, 11264
  s_nop 0
  BL4 v31, s[4:7], s90 offen lds
  MF v[76:79], v[168:171], a[92:95], v[76:79]
  s_waitcnt vmcnt(21)
  ds_read_b128 a[108:111], v252 offset:14336
  s_waitcnt lgkmcnt(7)
  MF v[80:83], v[172:175], a[80:83], v[80:83]
  TR v[168:169], v4 offset:45056
  v_add_f32 v227, v227, v231
  MF v[84:87], v[172:175], a[84:87], v[84:87]
  TR v[170:171], v4 offset:45312
  v_lshlrev_b32 v228, 16, v209
  MF v[88:91], v[172:175], a[88:91], v[88:91]
  ds_read_b128 a[124:127], v253 offset:14336
  MF v[92:95], v[172:175], a[92:95], v[92:95]
  s_add_u32 s90, s68, 9216
  s_add_u32 m0, s91, 12288
  s_nop 0
  s_waitcnt lgkmcnt(6)
  BL4 v30, s[4:7], s90 offen lds
  s_add_u32 m0, s91, 13312
  s_nop 0
  BL4 v31, s[4:7], s90 offen lds
  MF v[96:99], v[160:163], a[80:83], v[96:99]
  TR v[172:173], v4 offset:47104
  v_and_b32 v229, 0xffff0000, v209
  MF v[100:103], v[160:163], a[84:87], v[100:103]
  TR v[174:175], v4 offset:47360
  v_lshlrev_b32 v230, 16, v218
  MF v[104:107], v[160:163], a[88:91], v[104:107]
  s_add_u32 m0, s37, 4096
  s_add_u32 s89, s53, 0
  BL4 v8, s[8:11], s89 offen lds
  MF v[108:111], v[160:163], a[92:95], v[108:111]
  v_and_b32 v231, 0xffff0000, v218
  s_waitcnt lgkmcnt(6)
  MF v[112:115], v[164:167], a[80:83], v[112:115]
  s_barrier
  TR v[160:161], v2 offset:49152
  v_mul_f32 v228, v228, v230
  MF v[116:119], v[164:167], a[84:87], v[116:119]
  TR v[162:163], v2 offset:49408
  v_mul_f32 v229, v229, v231
  MF v[120:123], v[164:167], a[88:91], v[120:123]
  v_cvt_pk_bf16_f32 v228, v228, v229
  v_lshlrev_b32 v230, 16, v228
  MF v[124:127], v[164:167], a[92:95], v[124:127]
  v_and_b32 v231, 0xffff0000, v228
  s_waitcnt lgkmcnt(5)
  MF v[128:131], v[168:171], a[80:83], v[128:131]
  TR v[164:165], v2 offset:51200
  v_add_f32 v226, v226, v230
  MF v[132:135], v[168:171], a[84:87], v[132:135]
  TR v[166:167], v2 offset:51456
  v_add_f32 v227, v227, v231
  MF v[136:139], v[168:171], a[88:91], v[136:139]
  v_lshlrev_b32 v228, 16, v210
  v_and_b32 v229, 0xffff0000, v210
  MF v[140:143], v[168:171], a[92:95], v[140:143]
  v_lshlrev_b32 v230, 16, v219
  s_waitcnt lgkmcnt(4)
  MF v[144:147], v[172:175], a[80:83], v[144:147]
  TR v[168:169], v4 offset:49152
  v_and_b32 v231, 0xffff0000, v219
  MF v[148:151], v[172:175], a[84:87], v[148:151]
  TR v[170:171], v4 offset:49408
  v_mul_f32 v228, v228, v230
  MF v[152:155], v[172:175], a[88:91], v[152:155]
  v_mul_f32 v229, v229, v231
  v_cvt_pk_bf16_f32 v228, v228, v229
  MF v[156:159], v[172:175], a[92:95], v[156:159]
  v_lshlrev_b32 v230, 16, v228
  s_waitcnt lgkmcnt(4)
  MF v[32:35], v[160:163], a[96:99], v[32:35]
  TR v[172:173], v4 offset:51200
  v_and_b32 v231, 0xffff0000, v228
  MF v[36:39], v[160:163], a[100:103], v[36:39]
  TR v[174:175], v4 offset:51456
  v_add_f32 v226, v226, v230
  MF v[40:43], v[160:163], a[104:107], v[40:43]
  s_add_u32 m0, s37, 12288
  s_add_u32 s89, s53, 64
  BL4 v8, s[8:11], s89 offen lds
  MF v[44:47], v[160:163], a[108:111], v[44:47]
  s_waitcnt vmcnt(23)
  ds_read_b128 a[128:131], v252
  s_waitcnt lgkmcnt(5)
  MF v[48:51], v[164:167], a[96:99], v[48:51]
  TR v[160:161], v2 offset:57344
  v_add_f32 v227, v227, v231
  MF v[52:55], v[164:167], a[100:103], v[52:55]
  TR v[162:163], v2 offset:57600
  v_lshlrev_b32 v228, 16, v211
  MF v[56:59], v[164:167], a[104:107], v[56:59]
  ds_read_b128 a[144:147], v253
  MF v[60:63], v[164:167], a[108:111], v[60:63]
  s_add_u32 s90, s68, 13824
  s_add_u32 m0, s91, 14336
  s_nop 0
  BL4 v30, s[4:7], s90 offen lds
  s_waitcnt lgkmcnt(6)
  MF v[64:67], v[168:171], a[96:99], v[64:67]
  TR v[164:165], v2 offset:59392
  v_and_b32 v229, 0xffff0000, v211
  MF v[68:71], v[168:171], a[100:103], v[68:71]
  TR v[166:167], v2 offset:59648
  v_lshlrev_b32 v230, 16, v220
  MF v[72:75], v[168:171], a[104:107], v[72:75]
  s_add_u32 m0, s91, 15360
  s_nop 0
  BL4 v31, s[4:7], s90 offen lds
  MF v[76:79], v[168:171], a[108:111], v[76:79]
  s_waitcnt vmcnt(20)
  ds_read_b128 a[132:135], v252 offset:2048
  s_waitcnt lgkmcnt(7)
  MF v[80:83], v[172:175], a[96:99], v[80:83]
  TR v[168:169], v4 offset:57344
  v_and_b32 v231, 0xffff0000, v220
  MF v[84:87], v[172:175], a[100:103], v[84:87]
  TR v[170:171], v4 offset:57600
  v_mul_f32 v228, v228, v230
  MF v[88:91], v[172:175], a[104:107], v[88:91]
  ds_read_b128 a[148:151], v253 offset:2048
  MF v[92:95], v[172:175], a[108:111], v[92:95]
  s_add_u32 s90, s70, 0
  s_add_u32 m0, s91, 0
  s_nop 0
  s_waitcnt lgkmcnt(6)
  BL4 v30, s[4:7], s90 offen lds
  s_add_u32 m0, s91, 1024
  s_nop 0
  BL4 v31, s[4:7], s90 offen lds
  MF v[96:99], v[160:163], a[96:99], v[96:99]
  TR v[172:173], v4 offset:59392
  v_mul_f32 v229, v229, v231
  MF v[100:103], v[160:163], a[100:103], v[100:103]
  TR v[174:175], v4 offset:59648
  v_cvt_pk_bf16_f32 v228, v228, v229
  MF v[104:107], v[160:163], a[104:107], v[104:107]
  v_lshlrev_b32 v230, 16, v228
  v_and_b32 v231, 0xffff0000, v228
  MF v[108:111], v[160:163], a[108:111], v[108:111]
  v_add_f32 v226, v226, v230
  s_waitcnt lgkmcnt(6)
  MF v[112:115], v[164:167], a[96:99], v[112:115]
  TR v[160:161], v2 offset:53248
  v_add_f32 v227, v227, v231
  MF v[116:119], v[164:167], a[100:103], v[116:119]
  TR v[162:163], v2 offset:53504
  v_lshlrev_b32 v228, 16, v212
  MF v[120:123], v[164:167], a[104:107], v[120:123]
  v_and_b32 v229, 0xffff0000, v212
  v_lshlrev_b32 v230, 16, v221
  MF v[124:127], v[164:167], a[108:111], v[124:127]
  v_and_b32 v231, 0xffff0000, v221
  s_waitcnt lgkmcnt(5)
  MF v[128:131], v[168:171], a[96:99], v[128:131]
  TR v[164:165], v2 offset:55296
  v_mul_f32 v228, v228, v230
  MF v[132:135], v[168:171], a[100:103], v[132:135]
  TR v[166:167], v2 offset:55552
  v_mul_f32 v229, v229, v231
  MF v[136:139], v[168:171], a[104:107], v[136:139]
  v_cvt_pk_bf16_f32 v228, v228, v229
  v_lshlrev_b32 v230, 16, v228
  MF v[140:143], v[168:171], a[108:111], v[140:143]
  v_and_b32 v231, 0xffff0000, v228
  s_waitcnt lgkmcnt(4)
  MF v[144:147], v[172:175], a[96:99], v[144:147]
  TR v[168:169], v4 offset:53248
  v_add_f32 v226, v226, v230
  MF v[148:151], v[172:175], a[100:103], v[148:151]
  TR v[170:171], v4 offset:53504
  v_add_f32 v227, v227, v231
  MF v[152:155], v[172:175], a[104:107], v[152:155]
  v_lshlrev_b32 v228, 16, v213
  v_and_b32 v229, 0xffff0000, v213
  MF v[156:159], v[172:175], a[108:111], v[156:159]
  v_lshlrev_b32 v230, 16, v222
  s_waitcnt lgkmcnt(4)
  MF v[32:35], v[160:163], a[112:115], v[32:35]
  TR v[172:173], v4 offset:55296
  v_and_b32 v231, 0xffff0000, v222
  MF v[36:39], v[160:163], a[116:119], v[36:39]
  TR v[174:175], v4 offset:55552
  v_mul_f32 v228, v228, v230
  MF v[40:43], v[160:163], a[120:123], v[40:43]
  s_waitcnt vmcnt(20)
  ds_read_b128 a[136:139], v252 offset:4096
  MF v[44:47], v[160:163], a[124:127], v[44:47]
  ds_read_b128 a[152:155], v253 offset:4096
  s_waitcnt lgkmcnt(6)
  MF v[48:51], v[164:167], a[112:115], v[48:51]
  TR v[160:161], v3
  v_mul_f32 v229, v229, v231
  MF v[52:55], v[164:167], a[116:119], v[52:55]
  TR v[162:163], v3 offset:256
  v_cvt_pk_bf16_f32 v228, v228, v229
  MF v[56:59], v[164:167], a[120:123], v[56:59]
  s_add_u32 s90, s70, 4608
  s_add_u32 m0, s91, 2048
  s_nop 0
  BL4 v30, s[4:7], s90 offen lds
  MF v[60:63], v[164:167], a[124:127], v[60:63]
  s_add_u32 m0, s91, 3072
  s_nop 0
  BL4 v31, s[4:7], s90 offen lds
  s_waitcnt lgkmcnt(6)
  MF v[64:67], v[168:171], a[112:115], v[64:67]
  TR v[164:165], v3 offset:2048
  v_lshlrev_b32 v230, 16, v228
  MF v[68:71], v[168:171], a[116:119], v[68:71]
  TR v[166:167], v3 offset:2304
  v_and_b32 v231, 0xffff0000, v228
  MF v[72:75], v[168:171], a[120:123], v[72:75]
  s_waitcnt vmcnt(17)
  ds_read_b128 a[140:143], v252 offset:6144
  MF v[76:79], v[168:171], a[124:127], v[76:79]
  ds_read_b128 a[156:159], v253 offset:6144
  s_waitcnt lgkmcnt(8)
  MF v[80:83], v[172:175], a[112:115], v[80:83]
  TR v[168:169], v5
  v_add_f32 v226, v226, v230
  MF v[84:87], v[172:175], a[116:119], v[84:87]
  TR v[170:171], v5 offset:256
  v_add_f32 v227, v227, v231
  MF v[88:91], v[172:175], a[120:123], v[88:91]
  s_add_u32 s90, s70, 9216
  s_add_u32 m0, s91, 4096
  s_nop 0
  s_waitcnt lgkmcnt(8)
  BL4 v30, s[4:7], s90 offen lds
  MF v[92:95], v[172:175], a[124:127], v[92:95]
  s_add_u32 m0, s91, 5120
  s_nop 0
  BL4 v31, s[4:7], s90 offen lds
  s_waitcnt lgkmcnt(6)
  MF v[96:99], v[160:163], a[112:115], v[96:99]
  TR v[172:173], v5 offset:2048
  v_lshlrev_b32 v228, 16, v214
  MF v[100:103], v[160:163], a[116:119], v[100:103]
  TR v[174:175], v5 offset:2304
  v_and_b32 v229, 0xffff0000, v214
  MF v[104:107], v[160:163], a[120:123], v[104:107]
  v_lshlrev_b32 v230, 16, v223
  v_and_b32 v231, 0xffff0000, v223
  MF v[108:111], v[160:163], a[124:127], v[108:111]
  v_mul_f32 v228, v228, v230
  s_waitcnt lgkmcnt(6)
  MF v[112:115], v[164:167], a[112:115], v[112:115]
  s_barrier
  TR v[160:161], v3 offset:4096
  v_mul_f32 v229, v229, v231
  MF v[116:119], v[164:167], a[116:119], v[116:119]
  TR v[162:163], v3 offset:4352
  v_cvt_pk_bf16_f32 v228, v228, v229
  MF v[120:123], v[164:167], a[120:123], v[120:123]
  v_lshlrev_b32 v230, 16, v228
  v_and_b32 v231, 0xffff0000, v228
  MF v[124:127], v[164:167], a[124:127], v[124:127]
  v_add_f32 v226, v226, v230
  s_waitcnt lgkmcnt(4)
  MF v[128:131], v[168:171], a[112:115], v[128:131]
  TR v[164:165], v3 offset:6144
  v_add_f32 v227, v227, v231
  MF v[132:135], v[168:171], a[116:119], v[132:135]
  TR v[166:167], v3 offset:6400
  v_lshlrev_b32 v228, 16, v215
  MF v[136:139], v[168:171], a[120:123], v[136:139]
  v_and_b32 v229, 0xffff0000, v215
  v_lshlrev_b32 v230, 16, v224
  MF v[140:143], v[168:171], a[124:127], v[140:143]
  v_and_b32 v231, 0xffff0000, v224
  s_waitcnt lgkmcnt(4)
  MF v[144:147], v[172:175], a[112:115], v[144:147]
  TR v[168:169], v5 offset:4096
  v_mul_f32 v228, v228, v230
  MF v[148:151], v[172:175], a[116:119], v[148:151]
  TR v[170:171], v5 offset:4352
  v_mul_f32 v229, v229, v231
  MF v[152:155], v[172:175], a[120:123], v[152:155]
  v_cvt_pk_bf16_f32 v228, v228, v229
  v_lshlrev_b32 v230, 16, v228
  MF v[156:159], v[172:175], a[124:127], v[156:159]
  v_and_b32 v231, 0xffff0000, v228
  s_waitcnt lgkmcnt(4)
  MF v[32:35], v[160:163], a[128:131], v[32:35]
  TR v[172:173], v5 offset:6144
  v_add_f32 v226, v226, v230
  MF v[36:39], v[160:163], a[132:135], v[36:39]
  TR v[174:175], v5 offset:6400
  v_add_f32 v227, v227, v231
  MF v[40:43], v[160:163], a[136:139], v[40:43]
  s_add_u32 m0, s37, 16384
  s_add_u32 s89, s54, 0
  BL4 v8, s[8:11], s89 offen lds
  MF v[44:47], v[160:163], a[140:143], v[44:47]
  s_add_u32 m0, s37, 32768
  s_add_u32 s89, s54, 64
  BL4 v8, s[8:11], s89 offen lds
  s_waitcnt lgkmcnt(4)
  MF v[48:51], v[164:167], a[128:131], v[48:51]
  TR v[160:161], v3 offset:12288
  v_lshlrev_b32 v228, 16, v216
  MF v[52:55], v[164:167], a[132:135], v[52:55]
  TR v[162:163], v3 offset:12544
  v_and_b32 v229, 0xffff0000, v216
  MF v[56:59], v[164:167], a[136:139], v[56:59]
  s_waitcnt vmcnt(19)
  ds_read_b128 a[160:163], v252 offset:8192
  MF v[60:63], v[164:167], a[140:143], v[60:63]
  ds_read_b128 a[176:179], v253 offset:8192
  s_waitcnt lgkmcnt(6)
  MF v[64:67], v[168:171], a[128:131], v[64:67]
  TR v[164:165], v3 offset:14336
  v_lshlrev_b32 v230, 16, v225
  MF v[68:71], v[168:171], a[132:135], v[68:71]
  TR v[166:167], v3 offset:14592
  v_and_b32 v231, 0xffff0000, v225
  MF v[72:75], v[168:171], a[136:139], v[72:75]
  s_add_u32 s90, s70, 13824
  s_add_u32 m0, s91, 6144
  s_nop 0
  BL4 v30, s[4:7], s90 offen lds
  MF v[76:79], v[168:171], a[140:143], v[76:79]
  s_add_u32 m0, s91, 7168
  s_nop 0
  BL4 v31, s[4:7], s90 offen lds
  s_waitcnt lgkmcnt(6)
  MF v[80:83], v[172:175], a[128:131], v[80:83]
  TR v[168:169], v5 offset:12288
  v_mul_f32 v228, v228, v230
  MF v[84:87], v[172:175], a[132:135], v[84:87]
  TR v[170:171], v5 offset:12544
  v_mul_f32 v229, v229, v231
  MF v[88:91], v[172:175], a[136:139], v[88:91]
  s_waitcnt vmcnt(16)
  ds_read_b128 a[164:167], v252 offset:10240
  MF v[92:95], v[172:175], a[140:143], v[92:95]
  ds_read_b128 a[180:183], v253 offset:10240
  s_add_u32 s90, s72, 0
  s_add_u32 m0, s91, 8192
  s_nop 0
  s_waitcnt lgkmcnt(6)
  BL4 v30, s[4:7], s90 offen lds
  s_add_u32 m0, s91, 9216
  s_nop 0
  BL4 v31, s[4:7], s90 offen lds
  MF v[96:99], v[160:163], a[128:131], v[96:99]
  TR v[172:173], v5 offset:14336
  v_cvt_pk_bf16_f32 v228, v228, v229
  MF v[100:103], v[160:163], a[132:135], v[100:103]
  TR v[174:175], v5 offset:14592
  v_lshlrev_b32 v230, 16, v228
  MF v[104:107], v[160:163], a[136:139], v[104:107]
  s_add_u32 m0, s37, 20480
  s_add_u32 s89, s55, 0
  BL4 v8, s[8:11], s89 offen lds
  MF v[108:111], v[160:163], a[140:143], v[108:111]
  s_add_u32 m0, s37, 36864
  s_add_u32 s89, s55, 64
  BL4 v8, s[8:11], s89 offen lds
  s_waitcnt lgkmcnt(6)
  MF v[112:115], v[164:167], a[128:131], v[112:115]
  TR v[160:161], v3 offset:8192
  v_and_b32 v231, 0xffff0000, v228
  MF v[116:119], v[164:167], a[132:135], v[116:119]
  TR v[162:163], v3 offset:8448
  v_add_f32 v226, v226, v230
  MF v[120:123], v[164:167], a[136:139], v[120:123]
  v_add_f32 v227, v227, v231
  v_add_f32 v226, v226, v227
  MF v[124:127], v[164:167], a[140:143], v[124:127]
  s_nop 0
  v_add_f32_dpp v226, v226, v226 row_shr:1 row_mask:0xf bank_mask:0xf bound_ctrl:1
  s_waitcnt lgkmcnt(6)
  MF v[128:131], v[168:171], a[128:131], v[128:131]
  TR v[164:165], v3 offset:10240
  v_add_f32_dpp v226, v226, v226 row_shr:2 row_mask:0xf bank_mask:0xf bound_ctrl:1
  MF v[132:135], v[168:171], a[132:135], v[132:135]
  TR v[166:167], v3 offset:10496
  v_add_f32_dpp v226, v226, v226 row_shr:4 row_mask:0xf bank_mask:0xf bound_ctrl:1
  MF v[136:139], v[168:171], a[136:139], v[136:139]
  s_nop 0
  v_add_f32_dpp v226, v226, v226 row_shr:8 row_mask:0xf bank_mask:0xf bound_ctrl:1
  s_nop 1
  v_add_f32_dpp v226, v226, v226 row_bcast:15 row_mask:0xa bank_mask:0xf
  MF v[140:143], v[168:171], a[140:143], v[140:143]
  v_cvt_pk_bf16_f32 v226, v226, v226
  s_waitcnt lgkmcnt(4)
  MF v[144:147], v[172:175], a[128:131], v[144:147]
  TR v[168:169], v5 offset:8192
  v_lshlrev_b32 v226, 16, v226
  MF v[148:151], v[172:175], a[132:135], v[148:151]
  TR v[170:171], v5 offset:8448
  v_mul_f32 v226, 0xbfb8aa3b, v226
  MF v[152:155], v[172:175], a[136:139], v[152:155]
  v_exp_f32 v226, v226
  s_nop 0
  v_add_f32 v226, 1.0, v226
  MF v[156:159], v[172:175], a[140:143], v[156:159]
  v_rcp_f32 v226, v226
  s_waitcnt lgkmcnt(4)
  MF v[32:35], v[160:163], a[144:147], v[32:35]
  TR v[172:173], v5 offset:10240
  v_cvt_pk_bf16_f32 v226, v226, v226
  MF v[36:39], v[160:163], a[148:151], v[36:39]
  TR v[174:175], v5 offset:10496
  v_lshlrev_b32 v226, 16, v226
  MF v[40:43], v[160:163], a[152:155], v[40:43]
  s_add_u32 m0, s37, 24576
  s_add_u32 s89, s56, 0
  BL4 v8, s[8:11], s89 offen lds
  MF v[44:47], v[160:163], a[156:159], v[44:47]
  s_add_u32 m0, s37, 40960
  s_add_u32 s89, s56, 64
  BL4 v8, s[8:11], s89 offen lds
  s_waitcnt lgkmcnt(4)
  MF v[48:51], v[164:167], a[144:147], v[48:51]
  TR v[160:161], v3 offset:16384
  v_lshlrev_b32 v228, 2, v25
  MF v[52:55], v[164:167], a[148:151], v[52:55]
  TR v[162:163], v3 offset:16640
  v_add_u32 v228, 32505856, v228
  MF v[56:59], v[164:167], a[152:155], v[56:59]
  s_waitcnt vmcnt(20)
  ds_read_b128 a[168:171], v252 offset:12288
  MF v[60:63], v[164:167], a[156:159], v[60:63]
  ds_read_b128 a[184:187], v253 offset:12288
  s_waitcnt lgkmcnt(6)
  MF v[64:67], v[168:171], a[144:147], v[64:67]
  TR v[164:165], v3 offset:18432
  v_and_b32 v229, 31, v1
  MF v[68:71], v[168:171], a[148:151], v[68:71]
  TR v[166:167], v3 offset:18688
  MF v[72:75], v[168:171], a[152:155], v[72:75]
  s_add_u32 s90, s72, 4608
  s_add_u32 m0, s91, 10240
  s_nop 0
  BL4 v30, s[4:7], s90 offen lds
  MF v[76:79], v[168:171], a[156:159], v[76:79]
  s_add_u32 m0, s91, 11264
  s_nop 0
  BL4 v31, s[4:7], s90 offen lds
  s_waitcnt lgkmcnt(6)
  MF v[80:83], v[172:175], a[144:147], v[80:83]
  TR v[168:169], v5 offset:16384
  MF v[84:87], v[172:175], a[148:151], v[84:87]
  TR v[170:171], v5 offset:16640
  MF v[88:91], v[172:175], a[152:155], v[88:91]
  s_waitcnt vmcnt(18)
  ds_read_b128 a[172:175], v252 offset:14336
  MF v[92:95], v[172:175], a[156:159], v[92:95]
  ds_read_b128 a[188:191], v253 offset:14336
  s_add_u32 s90, s72, 9216
  s_add_u32 m0, s91, 12288
  s_nop 0
  s_waitcnt lgkmcnt(6)
  BL4 v30, s[4:7], s90 offen lds
  s_add_u32 m0, s91, 13312
  s_nop 0
  BL4 v31, s[4:7], s90 offen lds
  MF v[96:99], v[160:163], a[144:147], v[96:99]
  TR v[172:173], v5 offset:18432
  MF v[100:103], v[160:163], a[148:151], v[100:103]
  TR v[174:175], v5 offset:18688
  MF v[104:107], v[160:163], a[152:155], v[104:107]
  s_add_u32 m0, s37, 28672
  s_add_u32 s89, s57, 0
  BL4 v8, s[8:11], s89 offen lds
  MF v[108:111], v[160:163], a[156:159], v[108:111]
  s_add_u32 m0, s37, 45056
  s_add_u32 s89, s57, 64
  BL4 v8, s[8:11], s89 offen lds
  s_waitcnt lgkmcnt(6)
  MF v[112:115], v[164:167], a[144:147], v[112:115]
  s_barrier
  TR v[160:161], v3 offset:20480
  MF v[116:119], v[164:167], a[148:151], v[116:119]
  TR v[162:163], v3 offset:20736
  MF v[120:123], v[164:167], a[152:155], v[120:123]
  v_cmp_eq_u32 vcc, 31, v229
  v_mov_b32 v229, 1073741824
  s_nop 0
  v_cndmask_b32 v228, v229, v228, vcc
  MF v[124:127], v[164:167], a[156:159], v[124:127]
  s_waitcnt lgkmcnt(6)
  MF v[128:131], v[168:171], a[144:147], v[128:131]
  TR v[164:165], v3 offset:22528
  MF v[132:135], v[168:171], a[148:151], v[132:135]
  TR v[166:167], v3 offset:22784
  MF v[136:139], v[168:171], a[152:155], v[136:139]
  buffer_store_dword v226, v228, s[16:19], 0 offen sc1
  MF v[140:143], v[168:171], a[156:159], v[140:143]
  s_mov_b32 s84, 192
  s_waitcnt lgkmcnt(4)
  MF v[144:147], v[172:175], a[144:147], v[144:147]
  TR v[168:169], v5 offset:20480
  MF v[148:151], v[172:175], a[148:151], v[148:151]
  TR v[170:171], v5 offset:20736
  MF v[152:155], v[172:175], a[152:155], v[152:155]
  buffer_load_dword v233, v11, s[8:11], s84 offen
  MF v[156:159], v[172:175], a[156:159], v[156:159]
  s_cmp_eq_u32 s32, 0
  s_cselect_b32 s80, 0, 1073741824
  s_waitcnt lgkmcnt(4)
  MF v[32:35], v[160:163], a[160:163], v[32:35]
  TR v[172:173], v5 offset:22528
  v_mov_b32 v247, s80
  MF v[36:39], v[160:163], a[164:167], v[36:39]
  TR v[174:175], v5 offset:22784
  MF v[40:43], v[160:163], a[168:171], v[40:43]
  s_waitcnt vmcnt(22)
  ds_read_b128 a[192:195], v252
  MF v[44:47], v[160:163], a[172:175], v[44:47]
  ds_read_b128 a[208:211], v253
  s_waitcnt lgkmcnt(6)
  MF v[48:51], v[164:167], a[160:163], v[48:51]
  TR v[160:161], v3 offset:28672
  MF v[52:55], v[164:167], a[164:167], v[52:55]
  TR v[162:163], v3 offset:28928
  MF v[56:59], v[164:167], a[168:171], v[56:59]
  s_add_u32 s90, s72, 13824
  s_add_u32 m0, s91, 14336
  s_nop 0
  BL4 v30, s[4:7], s90 offen lds
  MF v[60:63], v[164:167], a[172:175], v[60:63]
  s_add_u32 m0, s91, 15360
  s_nop 0
  BL4 v31, s[4:7], s90 offen lds
  s_waitcnt lgkmcnt(6)
  MF v[64:67], v[168:171], a[160:163], v[64:67]
  TR v[164:165], v3 offset:30720
  MF v[68:71], v[168:171], a[164:167], v[68:71]
  TR v[166:167], v3 offset:30976
  MF v[72:75], v[168:171], a[168:171], v[72:75]
  s_waitcnt vmcnt(22)
  ds_read_b128 a[196:199], v252 offset:2048
  MF v[76:79], v[168:171], a[172:175], v[76:79]
  ds_read_b128 a[212:215], v253 offset:2048
  s_waitcnt lgkmcnt(8)
  MF v[80:83], v[172:175], a[160:163], v[80:83]
  TR v[168:169], v5 offset:28672
  MF v[84:87], v[172:175], a[164:167], v[84:87]
  TR v[170:171], v5 offset:28928
  MF v[88:91], v[172:175], a[168:171], v[88:91]
  s_add_u32 s90, s74, 0
  s_add_u32 m0, s91, 0
  s_nop 0
  s_waitcnt lgkmcnt(8)
  BL4 v30, s[4:7], s90 offen lds
  MF v[92:95], v[172:175], a[172:175], v[92:95]
  s_add_u32 m0, s91, 1024
  s_nop 0
  BL4 v31, s[4:7], s90 offen lds
  s_waitcnt lgkmcnt(6)
  MF v[96:99], v[160:163], a[160:163], v[96:99]
  TR v[172:173], v5 offset:30720
  MF v[100:103], v[160:163], a[164:167], v[100:103]
  TR v[174:175], v5 offset:30976
  MF v[104:107], v[160:163], a[168:171], v[104:107]
  buffer_load_dword v245, v247, s[20:23], 0 offen sc1
  MF v[108:111], v[160:163], a[172:175], v[108:111]
  s_waitcnt lgkmcnt(6)
  MF v[112:115], v[164:167], a[160:163], v[112:115]
  TR v[160:161], v3 offset:24576
  MF v[116:119], v[164:167], a[164:167], v[116:119]
  TR v[162:163], v3 offset:24832
  MF v[120:123], v[164:167], a[168:171], v[120:123]
  MF v[124:127], v[164:167], a[172:175], v[124:127]
  s_waitcnt lgkmcnt(4)
  MF v[128:131], v[168:171], a[160:163], v[128:131]
  TR v[164:165], v3 offset:26624
  MF v[132:135], v[168:171], a[164:167], v[132:135]
  TR v[166:167], v3 offset:26880
  MF v[136:139], v[168:171], a[168:171], v[136:139]
  MF v[140:143], v[168:171], a[172:175], v[140:143]
  s_waitcnt lgkmcnt(4)
  MF v[144:147], v[172:175], a[160:163], v[144:147]
  TR v[168:169], v5 offset:24576
  MF v[148:151], v[172:175], a[164:167], v[148:151]
  TR v[170:171], v5 offset:24832
  MF v[152:155], v[172:175], a[168:171], v[152:155]
  MF v[156:159], v[172:175], a[172:175], v[156:159]
  s_waitcnt lgkmcnt(4)
  MF v[32:35], v[160:163], a[176:179], v[32:35]
  TR v[172:173], v5 offset:26624
  MF v[36:39], v[160:163], a[180:183], v[36:39]
  TR v[174:175], v5 offset:26880
  MF v[40:43], v[160:163], a[184:187], v[40:43]
  s_waitcnt vmcnt(23)
  ds_read_b128 a[200:203], v252 offset:4096
  MF v[44:47], v[160:163], a[188:191], v[44:47]
  ds_read_b128 a[216:219], v253 offset:4096
  s_waitcnt lgkmcnt(6)
  MF v[48:51], v[164:167], a[176:179], v[48:51]
  TR v[160:161], v3 offset:32768
  MF v[52:55], v[164:167], a[180:183], v[52:55]
  TR v[162:163], v3 offset:33024
  MF v[56:59], v[164:167], a[184:187], v[56:59]
  s_add_u32 s90, s74, 4608
  s_add_u32 m0, s91, 2048
  s_nop 0
  BL4 v30, s[4:7], s90 offen lds
  MF v[60:63], v[164:167], a[188:191], v[60:63]
  s_add_u32 m0, s91, 3072
  s_nop 0
  BL4 v31, s[4:7], s90 offen lds
  s_waitcnt lgkmcnt(6)
  MF v[64:67], v[168:171], a[176:179], v[64:67]
  TR v[164:165], v3 offset:34816
  MF v[68:71], v[168:171], a[180:183], v[68:71]
  TR v[166:167], v3 offset:35072
  MF v[72:75], v[168:171], a[184:187], v[72:75]
  s_waitcnt vmcnt(21)
  ds_read_b128 a[204:207], v252 offset:6144
  MF v[76:79], v[168:171], a[188:191], v[76:79]
  ds_read_b128 a[220:223], v253 offset:6144
  s_waitcnt lgkmcnt(8)
  MF v[80:83], v[172:175], a[176:179], v[80:83]
  TR v[168:169], v5 offset:32768
  MF v[84:87], v[172:175], a[180:183], v[84:87]
  TR v[170:171], v5 offset:33024
  MF v[88:91], v[172:175], a[184:187], v[88:91]
  s_add_u32 s90, s74, 9216
  s_add_u32 m0, s91, 4096
  s_nop 0
  s_waitcnt lgkmcnt(8)
  BL4 v30, s[4:7], s90 offen lds
  MF v[92:95], v[172:175], a[188:191], v[92:95]
  s_add_u32 m0, s91, 5120
  s_nop 0
  BL4 v31, s[4:7], s90 offen lds
  s_waitcnt lgkmcnt(6)
  MF v[96:99], v[160:163], a[176:179], v[96:99]
  TR v[172:173], v5 offset:34816
  MF v[100:103], v[160:163], a[180:183], v[100:103]
  TR v[174:175], v5 offset:35072
  MF v[104:107], v[160:163], a[184:187], v[104:107]
  MF v[108:111], v[160:163], a[188:191], v[108:111]
  s_waitcnt lgkmcnt(6)
  MF v[112:115], v[164:167], a[176:179], v[112:115]
  s_barrier
  TR v[160:161], v2
  MF v[116:119], v[164:167], a[180:183], v[116:119]
  TR v[162:163], v2 offset:256
  MF v[120:123], v[164:167], a[184:187], v[120:123]
  MF v[124:127], v[164:167], a[188:191], v[124:127]
  s_waitcnt lgkmcnt(4)
  MF v[128:131], v[168:171], a[176:179], v[128:131]
  TR v[164:165], v2 offset:2048
  MF v[132:135], v[168:171], a[180:183], v[132:135]
  TR v[166:167], v2 offset:2304
  MF v[136:139], v[168:171], a[184:187], v[136:139]
  MF v[140:143], v[168:171], a[188:191], v[140:143]
  s_waitcnt lgkmcnt(4)
  MF v[144:147], v[172:175], a[176:179], v[144:147]
  TR v[168:169], v4
  MF v[148:151], v[172:175], a[180:183], v[148:151]
  TR v[170:171], v4 offset:256
  MF v[152:155], v[172:175], a[184:187], v[152:155]
  MF v[156:159], v[172:175], a[188:191], v[156:159]
  s_waitcnt lgkmcnt(4)
  MF v[32:35], v[160:163], a[192:195], v[32:35]
  TR v[172:173], v4 offset:2048
  MF v[36:39], v[160:163], a[196:199], v[36:39]
  TR v[174:175], v4 offset:2304
  MF v[40:43], v[160:163], a[200:203], v[40:43]
  s_add_u32 m0, s37, 49152
  s_add_u32 s89, s40, 128
  BL4 v8, s[8:11], s89 offen lds
  MF v[44:47], v[160:163], a[204:207], v[44:47]
  s_add_u32 m0, s37, 53248
  s_add_u32 s89, s41, 128
  BL4 v8, s[8:11], s89 offen lds
  s_waitcnt lgkmcnt(4)
  MF v[48:51], v[164:167], a[192:195], v[48:51]
  TR v[160:161], v2 offset:8192
  MF v[52:55], v[164:167], a[196:199], v[52:55]
  TR v[162:163], v2 offset:8448
  MF v[56:59], v[164:167], a[200:203], v[56:59]
  s_waitcnt vmcnt(23)
  ds_read_b128 a[224:227], v252 offset:8192
  MF v[60:63], v[164:167], a[204:207], v[60:63]
  ds_read_b128 a[240:243], v253 offset:8192
  s_waitcnt lgkmcnt(6)
  MF v[64:67], v[168:171], a[192:195], v[64:67]
  TR v[164:165], v2 offset:10240
  MF v[68:71], v[168:171], a[196:199], v[68:71]
  TR v[166:167], v2 offset:10496
  MF v[72:75], v[168:171], a[200:203], v[72:75]
  s_add_u32 s90, s74, 13824
  s_add_u32 m0, s91, 6144
  s_nop 0
  BL4 v30, s[4:7], s90 offen lds
  MF v[76:79], v[168:171], a[204:207], v[76:79]
  s_add_u32 m0, s91, 7168
  s_nop 0
  BL4 v31, s[4:7], s90 offen lds
  s_waitcnt lgkmcnt(6)
  MF v[80:83], v[172:175], a[192:195], v[80:83]
  TR v[168:169], v4 offset:8192
  MF v[84:87], v[172:175], a[196:199], v[84:87]
  TR v[170:171], v4 offset:8448
  MF v[88:91], v[172:175], a[200:203], v[88:91]
  s_waitcnt vmcnt(19)
  ds_read_b128 a[228:231], v252 offset:10240
  MF v[92:95], v[172:175], a[204:207], v[92:95]
  ds_read_b128 a[244:247], v253 offset:10240
  s_waitcnt lgkmcnt(8)
  MF v[96:99], v[160:163], a[192:195], v[96:99]
  TR v[172:173], v4 offset:10240
  MF v[100:103], v[160:163], a[196:199], v[100:103]
  TR v[174:175], v4 offset:10496
  MF v[104:107], v[160:163], a[200:203], v[104:107]
  s_add_u32 m0, s37, 57344
  s_add_u32 s89, s42, 128
  BL4 v8, s[8:11], s89 offen lds
  MF v[108:111], v[160:163], a[204:207], v[108:111]
  s_add_u32 m0, s37, 61440
  s_add_u32 s89, s43, 128
  BL4 v8, s[8:11], s89 offen lds
  s_waitcnt lgkmcnt(6)
  MF v[112:115], v[164:167], a[192:195], v[112:115]
  TR v[160:161], v2 offset:4096
  MF v[116:119], v[164:167], a[196:199], v[116:119]
  TR v[162:163], v2 offset:4352
  MF v[120:123], v[164:167], a[200:203], v[120:123]
  MF v[124:127], v[164:167], a[204:207], v[124:127]
  s_waitcnt lgkmcnt(6)
  MF v[128:131], v[168:171], a[192:195], v[128:131]
  TR v[164:165], v2 offset:6144
  MF v[132:135], v[168:171], a[196:199], v[132:135]
  TR v[166:167], v2 offset:6400
  MF v[136:139], v[168:171], a[200:203], v[136:139]
  MF v[140:143], v[168:171], a[204:207], v[140:143]
  s_waitcnt lgkmcnt(4)
  MF v[144:147], v[172:175], a[192:195], v[144:147]
  TR v[168:169], v4 offset:4096
  MF v[148:151], v[172:175], a[196:199], v[148:151]
  TR v[170:171], v4 offset:4352
  MF v[152:155], v[172:175], a[200:203], v[152:155]
  MF v[156:159], v[172:175], a[204:207], v[156:159]
  s_waitcnt lgkmcnt(4)
  MF v[32:35], v[160:163], a[208:211], v[32:35]
  TR v[172:173], v4 offset:6144
  MF v[36:39], v[160:163], a[212:215], v[36:39]
  TR v[174:175], v4 offset:6400
  MF v[40:43], v[160:163], a[216:219], v[40:43]
  s_add_u32 m0, s37, 65536
  s_add_u32 s89, s44, 128
  BL4 v8, s[8:11], s89 offen lds
  MF v[44:47], v[160:163], a[220:223], v[44:47]
  s_add_u32 m0, s37, 69632
  s_add_u32 s89, s45, 128
  BL4 v8, s[8:11], s89 offen lds
  s_waitcnt lgkmcnt(4)
  MF v[48:51], v[164:167], a[208:211], v[48:51]
  TR v[160:161], v2 offset:12288
  MF v[52:55], v[164:167], a[212:215], v[52:55]
  TR v[162:163], v2 offset:12544
  MF v[56:59], v[164:167], a[216:219], v[56:59]
  s_waitcnt vmcnt(21)
  ds_read_b128 a[232:235], v252 offset:12288
  MF v[60:63], v[164:167], a[220:223], v[60:63]
  ds_read_b128 a[248:251], v253 offset:12288
  s_waitcnt lgkmcnt(6)
  MF v[64:67], v[168:171], a[208:211], v[64:67]
  TR v[164:165], v2 offset:14336
  MF v[68:71], v[168:171], a[212:215], v[68:71]
  TR v[166:167], v2 offset:14592
  MF v[72:75], v[168:171], a[216:219], v[72:75]
  s_waitcnt vmcnt(15)
  ds_read_b128 a[236:239], v252 offset:14336
  MF v[76:79], v[168:171], a[220:223], v[76:79]
  ds_read_b128 a[252:255], v253 offset:14336
  s_waitcnt lgkmcnt(8)
  MF v[80:83], v[172:175], a[208:211], v[80:83]
  TR v[168:169], v4 offset:12288
  MF v[84:87], v[172:175], a[212:215], v[84:87]
  TR v[170:171], v4 offset:12544
  MF v[88:91], v[172:175], a[216:219], v[88:91]
  MF v[92:95], v[172:175], a[220:223], v[92:95]
  s_waitcnt lgkmcnt(8)
  MF v[96:99], v[160:163], a[208:211], v[96:99]
  TR v[172:173], v4 offset:14336
  MF v[100:103], v[160:163], a[212:215], v[100:103]
  TR v[174:175], v4 offset:14592
  MF v[104:107], v[160:163], a[216:219], v[104:107]
  MF v[108:111], v[160:163], a[220:223], v[108:111]
  s_waitcnt lgkmcnt(6)
  MF v[112:115], v[164:167], a[208:211], v[112:115]
  s_barrier
  TR v[160:161], v2 offset:16384
  MF v[116:119], v[164:167], a[212:215], v[116:119]
  TR v[162:163], v2 offset:16640
  MF v[120:123], v[164:167], a[216:219], v[120:123]
  MF v[124:127], v[164:167], a[220:223], v[124:127]
  s_waitcnt lgkmcnt(4)
  MF v[128:131], v[168:171], a[208:211], v[128:131]
  TR v[164:165], v2 offset:18432
  MF v[132:135], v[168:171], a[212:215], v[132:135]
  TR v[166:167], v2 offset:18688
  MF v[136:139], v[168:171], a[216:219], v[136:139]
  MF v[140:143], v[168:171], a[220:223], v[140:143]
  s_waitcnt lgkmcnt(4)
  MF v[144:147], v[172:175], a[208:211], v[144:147]
  TR v[168:169], v2 offset:20480
  MF v[148:151], v[172:175], a[212:215], v[148:151]
  TR v[170:171], v2 offset:20736
  MF v[152:155], v[172:175], a[216:219], v[152:155]
  s_mov_b32 s84, 256
  MF v[156:159], v[172:175], a[220:223], v[156:159]
  s_waitcnt lgkmcnt(4)
  MF v[32:35], v[160:163], a[224:227], v[32:35]
  TR v[172:173], v2 offset:22528
  MF v[36:39], v[160:163], a[228:231], v[36:39]
  TR v[174:175], v2 offset:22784
  MF v[40:43], v[160:163], a[232:235], v[40:43]
  s_add_u32 m0, s37, 73728
  s_add_u32 s89, s46, 128
  BL4 v8, s[8:11], s89 offen lds
  MF v[44:47], v[160:163], a[236:239], v[44:47]
  s_add_u32 m0, s37, 77824
  s_add_u32 s89, s47, 128
  BL4 v8, s[8:11], s89 offen lds
  s_waitcnt lgkmcnt(4)
  MF v[48:51], v[164:167], a[224:227], v[48:51]
  TR v[160:161], v2 offset:24576
  MF v[52:55], v[164:167], a[228:231], v[52:55]
  TR v[162:163], v2 offset:24832
  MF v[56:59], v[164:167], a[232:235], v[56:59]
  s_waitcnt vmcnt(15)
  ds_read_b128 v[176:179], v252
  MF v[60:63], v[164:167], a[236:239], v[60:63]
  ds_read_b128 v[192:195], v253
  s_waitcnt vmcnt(12)
  ds_read_b128 v[180:183], v252 offset:2048
  ds_read_b128 v[196:199], v253 offset:2048
  s_waitcnt lgkmcnt(8)
  MF v[32:35], v[168:171], a[240:243], v[32:35]
  TR v[164:165], v2 offset:26624
  MF v[36:39], v[168:171], a[244:247], v[36:39]
  TR v[166:167], v2 offset:26880
  MF v[40:43], v[168:171], a[248:251], v[40:43]
  s_add_u32 m0, s37, 81920
  s_add_u32 s89, s48, 128
  BL4 v8, s[8:11], s89 offen lds
  MF v[44:47], v[168:171], a[252:255], v[44:47]
  s_add_u32 m0, s37, 86016
  s_add_u32 s89, s49, 128
  BL4 v8, s[8:11], s89 offen lds
  s_waitcnt lgkmcnt(8)
  MF v[48:51], v[172:175], a[240:243], v[48:51]
  TR v[168:169], v2 offset:28672
  MF v[52:55], v[172:175], a[244:247], v[52:55]
  TR v[170:171], v2 offset:28928
  MF v[56:59], v[172:175], a[248:251], v[56:59]
  s_waitcnt vmcnt(12)
  ds_read_b128 v[184:187], v252 offset:4096
  MF v[60:63], v[172:175], a[252:255], v[60:63]
  ds_read_b128 v[200:203], v253 offset:4096
  s_waitcnt vmcnt(8)
  ds_read_b128 v[188:191], v252 offset:6144
  ds_read_b128 v[204:207], v253 offset:6144
  s_waitcnt lgkmcnt(11)
  MF v[32:35], v[160:163], v[176:179], v[32:35]
  TR v[172:173], v2 offset:30720
  s_waitcnt lgkmcnt(10)
  MF v[36:39], v[160:163], v[180:183], v[36:39]
  TR v[174:175], v2 offset:30976
  s_waitcnt lgkmcnt(5)
  MF v[40:43], v[160:163], v[184:187], v[40:43]
  s_add_u32 m0, s37, 90112
  s_add_u32 s89, s50, 128
  BL4 v8, s[8:11], s89 offen lds
  s_waitcnt lgkmcnt(3)
  MF v[44:47], v[160:163], v[188:191], v[44:47]
  s_add_u32 m0, s37, 94208
  s_add_u32 s89, s51, 128
  BL4 v8, s[8:11], s89 offen lds
  MF v[48:51], v[164:167], v[176:179], v[48:51]
  TR v[160:161], v4 offset:16384
  MF v[52:55], v[164:167], v[180:183], v[52:55]
  TR v[162:163], v4 offset:16640
  MF v[56:59], v[164:167], v[184:187], v[56:59]
  buffer_load_dword v233, v11, s[8:11], s84 offen
  MF v[60:63], v[164:167], v[188:191], v[60:63]
  s_lshl_b32 s84, s34, 3
  s_add_u32 s84, s84, s33
  MF v[32:35], v[168:171], v[192:195], v[32:35]
  TR v[164:165], v4 offset:18432
  s_mul_i32 s84, s84, 3
  s_add_u32 s84, s84, s35
  MF v[36:39], v[168:171], v[196:199], v[36:39]
  TR v[166:167], v4 offset:18688
  s_sub_u32 s84, s84, 5
  s_lshl_b32 s84, s84, 2
  MF v[40:43], v[168:171], v[200:203], v[40:43]
  s_add_u32 s84, s84, s32
  s_lshl_b32 s85, s34, 3
  s_add_u32 s85, s85, s33
  s_mul_i32 s85, s85, 7
  s_waitcnt lgkmcnt(6)
  MF v[44:47], v[168:171], v[204:207], v[44:47]
  s_sub_u32 s83, s35, 1
  s_waitcnt lgkmcnt(4)
  MF v[48:51], v[172:175], v[192:195], v[48:51]
  TR v[168:169], v4 offset:20480
  s_cmp_lt_u32 s35, 4
  s_cselect_b32 s83, s35, s83
  MF v[52:55], v[172:175], v[196:199], v[52:55]
  TR v[170:171], v4 offset:20736
  s_add_u32 s85, s85, s83
  s_lshl_b32 s85, s85, 2
  MF v[56:59], v[172:175], v[200:203], v[56:59]
  s_add_u32 s82, s85, s32
  s_mov_b32 s28, s98
  s_and_b32 s29, s99, 65535
  s_mov_b32 s30, 5308416
  MF v[60:63], v[172:175], v[204:207], v[60:63]
  s_mov_b32 s31, 131072
  s_waitcnt lgkmcnt(4)
  MF v[64:67], v[160:163], a[224:227], v[64:67]
  TR v[172:173], v4 offset:22528
  v_lshrrev_b32 v231, 5, v1
  MF v[68:71], v[160:163], a[228:231], v[68:71]
  TR v[174:175], v4 offset:22784
  v_mul_u32_u24 v231, 896, v231
  MF v[72:75], v[160:163], a[232:235], v[72:75]
  s_add_u32 s85, s82, 0
  v_add_u32 v231, s85, v231
  MF v[76:79], v[160:163], a[236:239], v[76:79]
  v_mul_u32_u24 v230, 7282, v231
  s_waitcnt lgkmcnt(4)
  MF v[80:83], v[164:167], a[224:227], v[80:83]
  TR v[160:161], v4 offset:24576
  v_lshrrev_b32 v230, 16, v230
  MF v[84:87], v[164:167], a[228:231], v[84:87]
  TR v[162:163], v4 offset:24832
  v_mul_u32_u24 v229, 9, v230
  MF v[88:91], v[164:167], a[232:235], v[88:91]
  v_sub_u32 v231, v231, v229
  v_lshlrev_b32 v231, 7, v231
  MF v[92:95], v[164:167], a[236:239], v[92:95]
  v_lshlrev_b32 v230, 5, v230
  s_waitcnt lgkmcnt(4)
  MF v[64:67], v[168:171], a[240:243], v[64:67]
  TR v[164:165], v4 offset:26624
  v_and_b32 v229, 31, v1
  MF v[68:71], v[168:171], a[244:247], v[68:71]
  TR v[166:167], v4 offset:26880
  v_add_u32 v230, v230, v229
  MF v[72:75], v[168:171], a[248:251], v[72:75]
  v_mul_u32_u24 v230, 1152, v230
  v_add_u32 v231, v231, v230
  MF v[76:79], v[168:171], a[252:255], v[76:79]
  s_waitcnt lgkmcnt(4)
  MF v[80:83], v[172:175], a[240:243], v[80:83]
  TR v[168:169], v4 offset:28672
  MF v[84:87], v[172:175], a[244:247], v[84:87]
  TR v[170:171], v4 offset:28928
  MF v[88:91], v[172:175], a[248:251], v[88:91]
  buffer_load_dword v233, v231, s[28:31], 0 offen
  MF v[92:95], v[172:175], a[252:255], v[92:95]
  s_mul_i32 s85, s84, 7282
  s_lshr_b32 s85, s85, 16
  s_waitcnt lgkmcnt(4)
  MF v[64:67], v[160:163], v[176:179], v[64:67]
  TR v[172:173], v4 offset:30720
  s_mul_i32 s83, s85, 9
  s_sub_u32 s83, s84, s83
  MF v[68:71], v[160:163], v[180:183], v[68:71]
  TR v[174:175], v4 offset:30976
  s_lshl_b32 s83, s83, 6
  MF v[72:75], v[160:163], v[184:187], v[72:75]
  v_add_u32 v231, s83, v1
  v_mul_u32_u24 v231, 1152, v231
  MF v[76:79], v[160:163], v[188:191], v[76:79]
  s_lshl_b32 s85, s85, 5
  s_waitcnt lgkmcnt(4)
  MF v[80:83], v[164:167], v[176:179], v[80:83]
  TR v[160:161], v2 offset:32768
  v_add_u32 v231, s85, v231
  MF v[84:87], v[164:167], v[180:183], v[84:87]
  TR v[162:163], v2 offset:33024
  s_mov_b32 s28, s76
  s_and_b32 s29, s77, 65535
  MF v[88:91], v[164:167], v[184:187], v[88:91]
  s_mov_b32 s30, 663552
  s_mov_b32 s31, 131072
  MF v[92:95], v[164:167], v[188:191], v[92:95]
  s_waitcnt lgkmcnt(4)
  MF v[64:67], v[168:171], v[192:195], v[64:67]
  TR v[164:165], v2 offset:34816
  MF v[68:71], v[168:171], v[196:199], v[68:71]
  TR v[166:167], v2 offset:35072
  MF v[72:75], v[168:171], v[200:203], v[72:75]
  buffer_load_dword v233, v231, s[28:31], 0 offen
  MF v[76:79], v[168:171], v[204:207], v[76:79]
  s_mov_b32 s28, s78
  s_and_b32 s29, s79, 65535
  s_waitcnt lgkmcnt(4)
  MF v[80:83], v[172:175], v[192:195], v[80:83]
  TR v[168:169], v4 offset:32768
  s_mov_b32 s30, 663552
  s_mov_b32 s31, 131072
  MF v[84:87], v[172:175], v[196:199], v[84:87]
  TR v[170:171], v4 offset:33024
  MF v[88:91], v[172:175], v[200:203], v[88:91]
  buffer_load_dword v233, v231, s[28:31], 0 offen
  MF v[92:95], v[172:175], v[204:207], v[92:95]
  v_max_f32 v32, 0, v32
  s_waitcnt lgkmcnt(4)
  MF v[96:99], v[160:163], a[224:227], v[96:99]
  TR v[172:173], v4 offset:34816
  v_max_f32 v33, 0, v33
  MF v[100:103], v[160:163], a[228:231], v[100:103]
  TR v[174:175], v4 offset:35072
  v_max_f32 v34, 0, v34
  MF v[104:107], v[160:163], a[232:235], v[104:107]
  v_max_f32 v35, 0, v35
  v_mul_f32 v32, v32, v48
  MF v[108:111], v[160:163], a[236:239], v[108:111]
  v_mul_f32 v33, v33, v49
  s_waitcnt lgkmcnt(4)
  MF v[112:115], v[164:167], a[224:227], v[112:115]
  TR v[160:161], v2 offset:36864
  v_mul_f32 v34, v34, v50
  MF v[116:119], v[164:167], a[228:231], v[116:119]
  TR v[162:163], v2 offset:37120
  v_mul_f32 v35, v35, v51
  MF v[120:123], v[164:167], a[232:235], v[120:123]
  v_cvt_pk_bf16_f32 v248, v32, v33
  v_cvt_pk_bf16_f32 v249, v34, v35
  MF v[124:127], v[164:167], a[236:239], v[124:127]
  v_max_f32 v36, 0, v36
  s_waitcnt lgkmcnt(4)
  MF v[128:131], v[168:171], a[224:227], v[128:131]
  TR v[164:165], v2 offset:38912
  v_max_f32 v37, 0, v37
  MF v[132:135], v[168:171], a[228:231], v[132:135]
  TR v[166:167], v2 offset:39168
  v_max_f32 v38, 0, v38
  MF v[136:139], v[168:171], a[232:235], v[136:139]
  v_max_f32 v39, 0, v39
  v_mul_f32 v36, v36, v52
  MF v[140:143], v[168:171], a[236:239], v[140:143]
  v_mul_f32 v37, v37, v53
  s_waitcnt lgkmcnt(4)
  MF v[144:147], v[172:175], a[224:227], v[144:147]
  TR v[168:169], v4 offset:36864
  v_mul_f32 v38, v38, v54
  MF v[148:151], v[172:175], a[228:231], v[148:151]
  TR v[170:171], v4 offset:37120
  v_mul_f32 v39, v39, v55
  MF v[152:155], v[172:175], a[232:235], v[152:155]
  v_cvt_pk_bf16_f32 v250, v36, v37
  v_cvt_pk_bf16_f32 v251, v38, v39
  MF v[156:159], v[172:175], a[236:239], v[156:159]
  v_max_f32 v40, 0, v40
  s_waitcnt lgkmcnt(4)
  MF v[96:99], v[160:163], a[240:243], v[96:99]
  TR v[172:173], v4 offset:38912
  v_max_f32 v41, 0, v41
  MF v[100:103], v[160:163], a[244:247], v[100:103]
  TR v[174:175], v4 offset:39168
  v_max_f32 v42, 0, v42
  MF v[104:107], v[160:163], a[248:251], v[104:107]
  v_max_f32 v43, 0, v43
  v_mul_f32 v40, v40, v56
  MF v[108:111], v[160:163], a[252:255], v[108:111]
  v_mul_f32 v41, v41, v57
  s_waitcnt lgkmcnt(4)
  MF v[112:115], v[164:167], a[240:243], v[112:115]
  TR v[160:161], v2 offset:40960
  v_mul_f32 v42, v42, v58
  MF v[116:119], v[164:167], a[244:247], v[116:119]
  TR v[162:163], v2 offset:41216
  v_mul_f32 v43, v43, v59
  MF v[120:123], v[164:167], a[248:251], v[120:123]
  v_cvt_pk_bf16_f32 v252, v40, v41
  v_cvt_pk_bf16_f32 v253, v42, v43
  MF v[124:127], v[164:167], a[252:255], v[124:127]
  v_max_f32 v44, 0, v44
  s_waitcnt lgkmcnt(4)
  MF v[128:131], v[168:171], a[240:243], v[128:131]
  TR v[164:165], v2 offset:43008
  v_max_f32 v45, 0, v45
  MF v[132:135], v[168:171], a[244:247], v[132:135]
  TR v[166:167], v2 offset:43264
  v_max_f32 v46, 0, v46
  MF v[136:139], v[168:171], a[248:251], v[136:139]
  v_max_f32 v47, 0, v47
  v_mul_f32 v44, v44, v60
  MF v[140:143], v[168:171], a[252:255], v[140:143]
  v_mul_f32 v45, v45, v61
  s_waitcnt lgkmcnt(4)
  MF v[144:147], v[172:175], a[240:243], v[144:147]
  TR v[168:169], v4 offset:40960
  v_mul_f32 v46, v46, v62
  MF v[148:151], v[172:175], a[244:247], v[148:151]
  TR v[170:171], v4 offset:41216
  v_mul_f32 v47, v47, v63
  MF v[152:155], v[172:175], a[248:251], v[152:155]
  v_cvt_pk_bf16_f32 v254, v44, v45
  v_cvt_pk_bf16_f32 v255, v46, v47
  MF v[156:159], v[172:175], a[252:255], v[156:159]
  s_waitcnt lgkmcnt(4)
  MF v[96:99], v[160:163], v[176:179], v[96:99]
  TR v[172:173], v4 offset:43008
  MF v[100:103], v[160:163], v[180:183], v[100:103]
  TR v[174:175], v4 offset:43264
  MF v[104:107], v[160:163], v[184:187], v[104:107]
  MF v[108:111], v[160:163], v[188:191], v[108:111]
  s_waitcnt lgkmcnt(4)
  MF v[112:115], v[164:167], v[176:179], v[112:115]
  TR v[160:161], v2 offset:45056
  MF v[116:119], v[164:167], v[180:183], v[116:119]
  TR v[162:163], v2 offset:45312
  MF v[120:123], v[164:167], v[184:187], v[120:123]
  MF v[124:127], v[164:167], v[188:191], v[124:127]
  s_waitcnt lgkmcnt(4)
  MF v[128:131], v[168:171], v[176:179], v[128:131]
  TR v[164:165], v2 offset:47104
  MF v[132:135], v[168:171], v[180:183], v[132:135]
  TR v[166:167], v2 offset:47360
  MF v[136:139], v[168:171], v[184:187], v[136:139]
  MF v[140:143], v[168:171], v[188:191], v[140:143]
  s_waitcnt lgkmcnt(4)
  MF v[144:147], v[172:175], v[176:179], v[144:147]
  TR v[168:169], v4 offset:45056
  MF v[148:151], v[172:175], v[180:183], v[148:151]
  TR v[170:171], v4 offset:45312
  MF v[152:155], v[172:175], v[184:187], v[152:155]
  MF v[156:159], v[172:175], v[188:191], v[156:159]
  s_waitcnt lgkmcnt(4)
  MF v[96:99], v[160:163], v[192:195], v[96:99]
  TR v[172:173], v4 offset:47104
  MF v[100:103], v[160:163], v[196:199], v[100:103]
  TR v[174:175], v4 offset:47360
  MF v[104:107], v[160:163], v[200:203], v[104:107]
  MF v[108:111], v[160:163], v[204:207], v[108:111]
  s_waitcnt lgkmcnt(4)
  MF v[112:115], v[164:167], v[192:195], v[112:115]
  s_waitcnt vmcnt(10)
  s_barrier
  TR v[160:161], v2 offset:49152
  MF v[116:119], v[164:167], v[196:199], v[116:119]
  TR v[162:163], v2 offset:49408
  MF v[120:123], v[164:167], v[200:203], v[120:123]
  MF v[124:127], v[164:167], v[204:207], v[124:127]
  s_waitcnt lgkmcnt(4)
  MF v[128:131], v[168:171], v[192:195], v[128:131]
  TR v[164:165], v2 offset:51200
  MF v[132:135], v[168:171], v[196:199], v[132:135]
  TR v[166:167], v2 offset:51456
  MF v[136:139], v[168:171], v[200:203], v[136:139]
  MF v[140:143], v[168:171], v[204:207], v[140:143]
  s_waitcnt lgkmcnt(4)
  MF v[144:147], v[172:175], v[192:195], v[144:147]
  TR v[168:169], v2 offset:53248
  MF v[148:151], v[172:175], v[196:199], v[148:151]
  TR v[170:171], v2 offset:53504
  MF v[152:155], v[172:175], v[200:203], v[152:155]
  MF v[156:159], v[172:175], v[204:207], v[156:159]
K1_TA_G1:
  s_waitcnt lgkmcnt(4)
  MF v[32:35], v[160:163], a[0:3], 0
  TR v[172:173], v2 offset:55296
  MF v[36:39], v[160:163], a[4:7], 0
  TR v[174:175], v2 offset:55552
  MF v[40:43], v[160:163], a[8:11], 0
  s_add_u32 m0, s37, 98304
  s_add_u32 s89, s52, 128
  BL4 v8, s[8:11], s89 offen lds
  MF v[44:47], v[160:163], a[12:15], 0
  s_add_u32 m0, s37, 102400
  s_add_u32 s89, s53, 128
  BL4 v8, s[8:11], s89 offen lds
  s_waitcnt lgkmcnt(4)
  MF v[48:51], v[164:167], a[0:3], 0
  TR v[160:161], v2 offset:57344
  s_cmp_eq_u32 s32, 0
  s_cselect_b32 s84, 1, 0
  MF v[52:55], v[164:167], a[4:7], 0
  TR v[162:163], v2 offset:57600
  MF v[56:59], v[164:167], a[8:11], 0
  s_mov_b32 s82, 262144
POLLR1:
  v_cmp_eq_u32 vcc, 1, v245
  s_nop 1
  s_and_b32 s80, vcc_lo, s84
  s_cmp_eq_u32 s80, s84
  s_cbranch_scc1 POLLEDR1
  s_sub_u32 s82, s82, 1
  s_cbranch_scc1 POLLEDR1
  s_sleep 2
  buffer_load_dword v245, v247, s[20:23], 0 offen sc1
  s_waitcnt vmcnt(0)
  s_branch POLLR1
POLLEDR1:
  MF v[60:63], v[164:167], a[12:15], 0
  s_lshl_b32 s80, s2, 2
  s_add_u32 s80, s80, 32636928
  s_waitcnt lgkmcnt(4)
  MF v[32:35], v[168:171], a[16:19], v[32:35]
  TR v[164:165], v2 offset:59392
  s_cmp_eq_u32 s32, 0
  s_cselect_b32 s80, s80, 1073741824
  MF v[36:39], v[168:171], a[20:23], v[36:39]
  TR v[166:167], v2 offset:59648
  v_mov_b32 v30, s80
  MF v[40:43], v[168:171], a[24:27], v[40:43]
  s_add_u32 m0, s37, 106496
  s_add_u32 s89, s54, 128
  BL4 v8, s[8:11], s89 offen lds
  MF v[44:47], v[168:171], a[28:31], v[44:47]
  s_add_u32 m0, s37, 110592
  s_add_u32 s89, s55, 128
  BL4 v8, s[8:11], s89 offen lds
  s_waitcnt lgkmcnt(4)
  MF v[48:51], v[172:175], a[16:19], v[48:51]
  TR v[168:169], v3
  v_mov_b32 v243, 1073741824
  MF v[52:55], v[172:175], a[20:23], v[52:55]
  TR v[170:171], v3 offset:256
  MF v[56:59], v[172:175], a[24:27], v[56:59]
  v_cmp_eq_u32 vcc, 0, v1
  s_nop 1
  v_cndmask_b32 v30, v243, v30, vcc
  MF v[60:63], v[172:175], a[28:31], v[60:63]
  s_add_u32 s88, s36, 0
  s_lshl_b32 s88, s88, 10
  s_waitcnt lgkmcnt(4)
  MF v[32:35], v[160:163], a[32:35], v[32:35]
  TR v[172:173], v3 offset:2048
  v_max_f32 v64, 0, v64
  MF v[36:39], v[160:163], a[36:39], v[36:39]
  TR v[174:175], v3 offset:2304
  v_max_f32 v65, 0, v65
  MF v[40:43], v[160:163], a[40:43], v[40:43]
  s_add_u32 m0, s37, 114688
  s_add_u32 s89, s56, 128
  BL4 v8, s[8:11], s89 offen lds
  MF v[44:47], v[160:163], a[44:47], v[44:47]
  s_add_u32 m0, s37, 118784
  s_add_u32 s89, s57, 128
  BL4 v8, s[8:11], s89 offen lds
  s_waitcnt lgkmcnt(4)
  MF v[48:51], v[164:167], a[32:35], v[48:51]
  TR v[160:161], v3 offset:4096
  v_max_f32 v66, 0, v66
  MF v[52:55], v[164:167], a[36:39], v[52:55]
  TR v[162:163], v3 offset:4352
  v_max_f32 v67, 0, v67
  MF v[56:59], v[164:167], a[40:43], v[56:59]
  v_mul_f32 v64, v64, v80
  v_mul_f32 v65, v65, v81
  MF v[60:63], v[164:167], a[44:47], v[60:63]
  v_mul_f32 v66, v66, v82
  s_waitcnt lgkmcnt(4)
  MF v[32:35], v[168:171], a[48:51], v[32:35]
  TR v[164:165], v3 offset:6144
  v_mul_f32 v67, v67, v83
  MF v[36:39], v[168:171], a[52:55], v[36:39]
  TR v[166:167], v3 offset:6400
  v_mov_b32 v240, v248
  MF v[40:43], v[168:171], a[56:59], v[40:43]
  v_mov_b32 v241, v249
  v_cvt_pk_bf16_f32 v242, v64, v65
  MF v[44:47], v[168:171], a[60:63], v[44:47]
  v_cvt_pk_bf16_f32 v243, v66, v67
  s_waitcnt lgkmcnt(4)
  MF v[48:51], v[172:175], a[48:51], v[48:51]
  TR v[168:169], v3 offset:8192
  s_add_u32 s80, s88, 0
  MF v[52:55], v[172:175], a[52:55], v[52:55]
  TR v[170:171], v3 offset:8448
  MF v[56:59], v[172:175], a[56:59], v[56:59]
  buffer_store_dwordx4 v[240:243], v10, s[16:19], s80 offen sc1
  MF v[60:63], v[172:175], a[60:63], v[60:63]
  v_max_f32 v68, 0, v68
  s_waitcnt lgkmcnt(4)
  MF v[32:35], v[160:163], a[64:67], v[32:35]
  TR v[172:173], v3 offset:10240
  v_max_f32 v69, 0, v69
  MF v[36:39], v[160:163], a[68:71], v[36:39]
  TR v[174:175], v3 offset:10496
  v_max_f32 v70, 0, v70
  MF v[40:43], v[160:163], a[72:75], v[40:43]
  v_max_f32 v71, 0, v71
  v_mul_f32 v68, v68, v84
  MF v[44:47], v[160:163], a[76:79], v[44:47]
  v_mul_f32 v69, v69, v85
  s_waitcnt lgkmcnt(4)
  MF v[48:51], v[164:167], a[64:67], v[48:51]
  TR v[160:161], v4 offset:49152
  v_mul_f32 v70, v70, v86
  MF v[52:55], v[164:167], a[68:71], v[52:55]
  TR v[162:163], v4 offset:49408
  v_mul_f32 v71, v71, v87
  MF v[56:59], v[164:167], a[72:75], v[56:59]
  v_mov_b32 v244, v250
  v_mov_b32 v245, v251
  MF v[60:63], v[164:167], a[76:79], v[60:63]
  v_cvt_pk_bf16_f32 v246, v68, v69
  s_waitcnt lgkmcnt(4)
  MF v[32:35], v[168:171], a[80:83], v[32:35]
  TR v[164:165], v4 offset:51200
  v_cvt_pk_bf16_f32 v247, v70, v71
  MF v[36:39], v[168:171], a[84:87], v[36:39]
  TR v[166:167], v4 offset:51456
  s_add_u32 s80, s88, 185344
  MF v[40:43], v[168:171], a[88:91], v[40:43]
  buffer_store_dwordx4 v[244:247], v10, s[16:19], s80 offen sc1
  MF v[44:47], v[168:171], a[92:95], v[44:47]
  v_max_f32 v72, 0, v72
  s_waitcnt lgkmcnt(4)
  MF v[48:51], v[172:175], a[80:83], v[48:51]
  TR v[168:169], v4 offset:53248
  v_max_f32 v73, 0, v73
  MF v[52:55], v[172:175], a[84:87], v[52:55]
  TR v[170:171], v4 offset:53504
  v_max_f32 v74, 0, v74
  MF v[56:59], v[172:175], a[88:91], v[56:59]
  v_max_f32 v75, 0, v75
  v_mul_f32 v72, v72, v88
  MF v[60:63], v[172:175], a[92:95], v[60:63]
  v_mul_f32 v73, v73, v89
  v_mul_f32 v74, v74, v90
  v_mul_f32 v75, v75, v91
  v_mov_b32 v240, v252
  v_mov_b32 v241, v253
  v_cvt_pk_bf16_f32 v242, v72, v73
  v_cvt_pk_bf16_f32 v243, v74, v75
  s_add_u32 s80, s88, 370688
  buffer_store_dwordx4 v[240:243], v10, s[16:19], s80 offen sc1
  v_max_f32 v76, 0, v76
  v_max_f32 v77, 0, v77
  v_max_f32 v78, 0, v78
  v_max_f32 v79, 0, v79
  v_mul_f32 v76, v76, v92
  v_mul_f32 v77, v77, v93
  v_mul_f32 v78, v78, v94
  v_mul_f32 v79, v79, v95
  v_mov_b32 v244, v254
  v_mov_b32 v245, v255
  v_cvt_pk_bf16_f32 v246, v76, v77
  v_cvt_pk_bf16_f32 v247, v78, v79
  s_add_u32 s80, s88, 556032
  buffer_store_dwordx4 v[244:247], v10, s[16:19], s80 offen sc1
  s_waitcnt lgkmcnt(4)
  MF v[64:67], v[160:163], a[0:3], 0
  TR v[172:173], v4 offset:55296
  s_add_u32 s88, s36, 1
  s_lshl_b32 s88, s88, 10
  MF v[68:71], v[160:163], a[4:7], 0
  TR v[174:175], v4 offset:55552
  v_max_f32 v96, 0, v96
  MF v[72:75], v[160:163], a[8:11], 0
  v_max_f32 v97, 0, v97
  v_max_f32 v98, 0, v98
  MF v[76:79], v[160:163], a[12:15], 0
  v_max_f32 v99, 0, v99
  s_waitcnt lgkmcnt(4)
  MF v[80:83], v[164:167], a[0:3], 0
  TR v[160:161], v4 offset:57344
  v_mul_f32 v96, v96, v112
  MF v[84:87], v[164:167], a[4:7], 0
  TR v[162:163], v4 offset:57600
  v_mul_f32 v97, v97, v113
  MF v[88:91], v[164:167], a[8:11], 0
  v_mul_f32 v98, v98, v114
  v_mul_f32 v99, v99, v115
  MF v[92:95], v[164:167], a[12:15], 0
  v_cvt_pk_bf16_f32 v248, v96, v97
  s_waitcnt lgkmcnt(4)
  MF v[64:67], v[168:171], a[16:19], v[64:67]
  TR v[164:165], v4 offset:59392
  v_cvt_pk_bf16_f32 v249, v98, v99
  MF v[68:71], v[168:171], a[20:23], v[68:71]
  TR v[166:167], v4 offset:59648
  v_max_f32 v128, 0, v128
  MF v[72:75], v[168:171], a[24:27], v[72:75]
  v_max_f32 v129, 0, v129
  v_max_f32 v130, 0, v130
  MF v[76:79], v[168:171], a[28:31], v[76:79]
  v_max_f32 v131, 0, v131
  s_waitcnt lgkmcnt(4)
  MF v[80:83], v[172:175], a[16:19], v[80:83]
  TR v[168:169], v5
  v_mul_f32 v128, v128, v144
  MF v[84:87], v[172:175], a[20:23], v[84:87]
  TR v[170:171], v5 offset:256
  v_mul_f32 v129, v129, v145
  MF v[88:91], v[172:175], a[24:27], v[88:91]
  v_mul_f32 v130, v130, v146
  v_mul_f32 v131, v131, v147
  MF v[92:95], v[172:175], a[28:31], v[92:95]
  v_cvt_pk_bf16_f32 v250, v128, v129
  s_waitcnt lgkmcnt(4)
  MF v[64:67], v[160:163], a[32:35], v[64:67]
  TR v[172:173], v5 offset:2048
  v_cvt_pk_bf16_f32 v251, v130, v131
  MF v[68:71], v[160:163], a[36:39], v[68:71]
  TR v[174:175], v5 offset:2304
  s_add_u32 s80, s88, 0
  MF v[72:75], v[160:163], a[40:43], v[72:75]
  buffer_store_dwordx4 v[248:251], v10, s[16:19], s80 offen sc1
  MF v[76:79], v[160:163], a[44:47], v[76:79]
  v_max_f32 v100, 0, v100
  s_waitcnt lgkmcnt(4)
  MF v[80:83], v[164:167], a[32:35], v[80:83]
  TR v[160:161], v5 offset:4096
  v_max_f32 v101, 0, v101
  MF v[84:87], v[164:167], a[36:39], v[84:87]
  TR v[162:163], v5 offset:4352
  v_max_f32 v102, 0, v102
  MF v[88:91], v[164:167], a[40:43], v[88:91]
  v_max_f32 v103, 0, v103
  v_mul_f32 v100, v100, v116
  MF v[92:95], v[164:167], a[44:47], v[92:95]
  v_mul_f32 v101, v101, v117
  s_waitcnt lgkmcnt(4)
  MF v[64:67], v[168:171], a[48:51], v[64:67]
  TR v[164:165], v5 offset:6144
  v_mul_f32 v102, v102, v118
  MF v[68:71], v[168:171], a[52:55], v[68:71]
  TR v[166:167], v5 offset:6400
  v_mul_f32 v103, v103, v119
  MF v[72:75], v[168:171], a[56:59], v[72:75]
  v_cvt_pk_bf16_f32 v252, v100, v101
  v_cvt_pk_bf16_f32 v253, v102, v103
  MF v[76:79], v[168:171], a[60:63], v[76:79]
  v_max_f32 v132, 0, v132
  s_waitcnt lgkmcnt(4)
  MF v[80:83], v[172:175], a[48:51], v[80:83]
  TR v[168:169], v5 offset:8192
  v_max_f32 v133, 0, v133
  MF v[84:87], v[172:175], a[52:55], v[84:87]
  TR v[170:171], v5 offset:8448
  v_max_f32 v134, 0, v134
  MF v[88:91], v[172:175], a[56:59], v[88:91]
  v_max_f32 v135, 0, v135
  v_mul_f32 v132, v132, v148
  MF v[92:95], v[172:175], a[60:63], v[92:95]
  v_mul_f32 v133, v133, v149
  s_waitcnt lgkmcnt(4)
  MF v[64:67], v[160:163], a[64:67], v[64:67]
  TR v[172:173], v5 offset:10240
  v_mul_f32 v134, v134, v150
  MF v[68:71], v[160:163], a[68:71], v[68:71]
  TR v[174:175], v5 offset:10496
  v_mul_f32 v135, v135, v151
  MF v[72:75], v[160:163], a[72:75], v[72:75]
  v_cvt_pk_bf16_f32 v254, v132, v133
  v_cvt_pk_bf16_f32 v255, v134, v135
  MF v[76:79], v[160:163], a[76:79], v[76:79]
  s_add_u32 s80, s88, 185344
  s_waitcnt lgkmcnt(4)
  MF v[80:83], v[164:167], a[64:67], v[80:83]
  s_waitcnt vmcnt(15)
  s_barrier
  TR v[160:161], v3 offset:12288
  MF v[84:87], v[164:167], a[68:71], v[84:87]
  TR v[162:163], v3 offset:12544
  MF v[88:91], v[164:167], a[72:75], v[88:91]
  buffer_store_dwordx4 v[252:255], v10, s[16:19], s80 offen sc1
  MF v[92:95], v[164:167], a[76:79], v[92:95]
  v_max_f32 v104, 0, v104
  s_waitcnt lgkmcnt(4)
  MF v[64:67], v[168:171], a[80:83], v[64:67]
  TR v[164:165], v3 offset:14336
  v_max_f32 v105, 0, v105
  MF v[68:71], v[168:171], a[84:87], v[68:71]
  TR v[166:167], v3 offset:14592
  v_max_f32 v106, 0, v106
  MF v[72:75], v[168:171], a[88:91], v[72:75]
  v_max_f32 v107, 0, v107
  v_mul_f32 v104, v104, v120
  MF v[76:79], v[168:171], a[92:95], v[76:79]
  v_mul_f32 v105, v105, v121
  s_waitcnt lgkmcnt(4)
  MF v[80:83], v[172:175], a[80:83], v[80:83]
  TR v[168:169], v5 offset:12288
  v_mul_f32 v106, v106, v122
  MF v[84:87], v[172:175], a[84:87], v[84:87]
  TR v[170:171], v5 offset:12544
  v_mul_f32 v107, v107, v123
  MF v[88:91], v[172:175], a[88:91], v[88:91]
  v_cvt_pk_bf16_f32 v248, v104, v105
  v_cvt_pk_bf16_f32 v249, v106, v107
  MF v[92:95], v[172:175], a[92:95], v[92:95]
  v_max_f32 v136, 0, v136
  s_waitcnt lgkmcnt(4)
  MF v[32:35], v[160:163], a[96:99], v[32:35]
  TR v[172:173], v5 offset:14336
  v_max_f32 v137, 0, v137
  MF v[36:39], v[160:163], a[100:103], v[36:39]
  TR v[174:175], v5 offset:14592
  v_max_f32 v138, 0, v138
  MF v[40:43], v[160:163], a[104:107], v[40:43]
  s_add_u32 m0, s37, 0
  s_add_u32 s89, s40, 192
  BL4 v8, s[8:11], s89 offen lds
  MF v[44:47], v[160:163], a[108:111], v[44:47]
  s_add_u32 m0, s37, 4096
  s_add_u32 s89, s41, 192
  BL4 v8, s[8:11], s89 offen lds
  s_waitcnt lgkmcnt(4)
  MF v[48:51], v[164:167], a[96:99], v[48:51]
  TR v[160:161], v3 offset:16384
  v_max_f32 v139, 0, v139
  MF v[52:55], v[164:167], a[100:103], v[52:55]
  TR v[162:163], v3 offset:16640
  v_mul_f32 v136, v136, v152
  MF v[56:59], v[164:167], a[104:107], v[56:59]
  v_mul_f32 v137, v137, v153
  v_mul_f32 v138, v138, v154
  MF v[60:63], v[164:167], a[108:111], v[60:63]
  v_mul_f32 v139, v139, v155
  s_waitcnt lgkmcnt(4)
  MF v[64:67], v[168:171], a[96:99], v[64:67]
  TR v[164:165], v3 offset:18432
  v_cvt_pk_bf16_f32 v250, v136, v137
  MF v[68:71], v[168:171], a[100:103], v[68:71]
  TR v[166:167], v3 offset:18688
  v_cvt_pk_bf16_f32 v251, v138, v139
  MF v[72:75], v[168:171], a[104:107], v[72:75]
  s_add_u32 s80, s88, 370688
  MF v[76:79], v[168:171], a[108:111], v[76:79]
  s_waitcnt lgkmcnt(4)
  MF v[80:83], v[172:175], a[96:99], v[80:83]
  TR v[168:169], v5 offset:16384
  MF v[84:87], v[172:175], a[100:103], v[84:87]
  TR v[170:171], v5 offset:16640
  MF v[88:91], v[172:175], a[104:107], v[88:91]
  buffer_store_dwordx4 v[248:251], v10, s[16:19], s80 offen sc1
  MF v[92:95], v[172:175], a[108:111], v[92:95]
  v_max_f32 v108, 0, v108
  s_waitcnt lgkmcnt(4)
  MF v[32:35], v[160:163], a[112:115], v[32:35]
  TR v[172:173], v5 offset:18432
  v_max_f32 v109, 0, v109
  MF v[36:39], v[160:163], a[116:119], v[36:39]
  TR v[174:175], v5 offset:18688
  v_max_f32 v110, 0, v110
  MF v[40:43], v[160:163], a[120:123], v[40:43]
  s_add_u32 m0, s37, 8192
  s_add_u32 s89, s42, 192
  BL4 v8, s[8:11], s89 offen lds
  MF v[44:47], v[160:163], a[124:127], v[44:47]
  s_add_u32 m0, s37, 12288
  s_add_u32 s89, s43, 192
  BL4 v8, s[8:11], s89 offen lds
  s_waitcnt lgkmcnt(4)
  MF v[48:51], v[164:167], a[112:115], v[48:51]
  TR v[160:161], v3 offset:20480
  v_max_f32 v111, 0, v111
  MF v[52:55], v[164:167], a[116:119], v[52:55]
  TR v[162:163], v3 offset:20736
  v_mul_f32 v108, v108, v124
  MF v[56:59], v[164:167], a[120:123], v[56:59]
  v_mul_f32 v109, v109, v125
  v_mul_f32 v110, v110, v126
  MF v[60:63], v[164:167], a[124:127], v[60:63]
  v_mul_f32 v111, v111, v127
  s_waitcnt lgkmcnt(4)
  MF v[64:67], v[168:171], a[112:115], v[64:67]
  TR v[164:165], v3 offset:22528
  v_cvt_pk_bf16_f32 v252, v108, v109
  MF v[68:71], v[168:171], a[116:119], v[68:71]
  TR v[166:167], v3 offset:22784
  v_cvt_pk_bf16_f32 v253, v110, v111
  MF v[72:75], v[168:171], a[120:123], v[72:75]
  v_max_f32 v140, 0, v140
  v_max_f32 v141, 0, v141
  MF v[76:79], v[168:171], a[124:127], v[76:79]
  v_max_f32 v142, 0, v142
  s_waitcnt lgkmcnt(4)
  MF v[80:83], v[172:175], a[112:115], v[80:83]
  TR v[168:169], v5 offset:20480
  v_max_f32 v143, 0, v143
  MF v[84:87], v[172:175], a[116:119], v[84:87]
  TR v[170:171], v5 offset:20736
  v_mul_f32 v140, v140, v156
  MF v[88:91], v[172:175], a[120:123], v[88:91]
  v_mul_f32 v141, v141, v157
  v_mul_f32 v142, v142, v158
  MF v[92:95], v[172:175], a[124:127], v[92:95]
  v_mul_f32 v143, v143, v159
  s_waitcnt lgkmcnt(4)
  MF v[32:35], v[160:163], a[128:131], v[32:35]
  TR v[172:173], v5 offset:22528
  v_cvt_pk_bf16_f32 v254, v140, v141
  MF v[36:39], v[160:163], a[132:135], v[36:39]
  TR v[174:175], v5 offset:22784
  v_cvt_pk_bf16_f32 v255, v142, v143
  MF v[40:43], v[160:163], a[136:139], v[40:43]
  s_add_u32 m0, s37, 16384
  s_add_u32 s89, s44, 192
  BL4 v8, s[8:11], s89 offen lds
  MF v[44:47], v[160:163], a[140:143], v[44:47]
  s_add_u32 m0, s37, 20480
  s_add_u32 s89, s45, 192
  BL4 v8, s[8:11], s89 offen lds
  s_waitcnt lgkmcnt(4)
  MF v[48:51], v[164:167], a[128:131], v[48:51]
  TR v[160:161], v3 offset:24576
  s_add_u32 s80, s88, 556032
  MF v[52:55], v[164:167], a[132:135], v[52:55]
  TR v[162:163], v3 offset:24832
  MF v[56:59], v[164:167], a[136:139], v[56:59]
  buffer_store_dwordx4 v[252:255], v10, s[16:19], s80 offen sc1
  MF v[60:63], v[164:167], a[140:143], v[60:63]
  s_lshl_b32 s58, s34, 3
  s_add_u32 s58, s58, s33
  s_waitcnt lgkmcnt(4)
  MF v[64:67], v[168:171], a[128:131], v[64:67]
  TR v[164:165], v3 offset:26624
  s_mul_i32 s58, s58, 3
  s_add_u32 s58, s58, s35
  MF v[68:71], v[168:171], a[132:135], v[68:71]
  TR v[166:167], v3 offset:26880
  s_sub_u32 s58, s58, 5
  s_lshl_b32 s58, s58, 2
  MF v[72:75], v[168:171], a[136:139], v[72:75]
  s_add_u32 s58, s58, s32
  s_mul_i32 s59, s58, 7282
  s_lshr_b32 s59, s59, 16
  s_mul_i32 s61, s59, 9
  MF v[76:79], v[168:171], a[140:143], v[76:79]
  s_sub_u32 s60, s58, s61
  s_mov_b32 s24, s76
  s_waitcnt lgkmcnt(4)
  MF v[80:83], v[172:175], a[128:131], v[80:83]
  TR v[168:169], v5 offset:24576
  s_and_b32 s25, s77, 65535
  s_mov_b32 s26, 663552
  MF v[84:87], v[172:175], a[132:135], v[84:87]
  TR v[170:171], v5 offset:24832
  s_mov_b32 s27, 131072
  s_mov_b32 s28, s78
  MF v[88:91], v[172:175], a[136:139], v[88:91]
  s_and_b32 s29, s79, 65535
  s_mov_b32 s30, 663552
  s_mov_b32 s31, 131072
  s_lshl_b32 s61, s60, 6
  MF v[92:95], v[172:175], a[140:143], v[92:95]
  v_lshrrev_b32 v240, 1, v1
  s_waitcnt lgkmcnt(4)
  MF v[32:35], v[160:163], a[144:147], v[32:35]
  TR v[172:173], v5 offset:26624
  v_add_u32 v240, s61, v240
  MF v[36:39], v[160:163], a[148:151], v[36:39]
  TR v[174:175], v5 offset:26880
  v_mul_u32_u24 v240, 1152, v240
  MF v[40:43], v[160:163], a[152:155], v[40:43]
  s_add_u32 m0, s37, 24576
  s_add_u32 s89, s46, 192
  BL4 v8, s[8:11], s89 offen lds
  MF v[44:47], v[160:163], a[156:159], v[44:47]
  v_and_b32 v241, 1, v1
  s_waitcnt lgkmcnt(4)
  MF v[48:51], v[164:167], a[144:147], v[48:51]
  TR v[160:161], v3 offset:28672
  v_lshlrev_b32 v241, 4, v241
  MF v[52:55], v[164:167], a[148:151], v[52:55]
  TR v[162:163], v3 offset:28928
  v_add_u32 v240, v240, v241
  MF v[56:59], v[164:167], a[152:155], v[56:59]
  s_lshl_b32 s61, s59, 5
  v_add_u32 v240, s61, v240
  s_mov_b32 s62, 36864
  MF v[60:63], v[164:167], a[156:159], v[60:63]
  s_waitcnt lgkmcnt(4)
  MF v[64:67], v[168:171], a[144:147], v[64:67]
  TR v[164:165], v3 offset:30720
  MF v[68:71], v[168:171], a[148:151], v[68:71]
  TR v[166:167], v3 offset:30976
  MF v[72:75], v[168:171], a[152:155], v[72:75]
  BL4 v[208:211], v240, s[24:27], 0 offen
  MF v[76:79], v[168:171], a[156:159], v[76:79]
  s_waitcnt lgkmcnt(4)
  MF v[80:83], v[172:175], a[144:147], v[80:83]
  TR v[168:169], v5 offset:28672
  MF v[84:87], v[172:175], a[148:151], v[84:87]
  TR v[170:171], v5 offset:28928
  MF v[88:91], v[172:175], a[152:155], v[88:91]
  BL4 v[212:215], v240, s[28:31], 0 offen
  MF v[92:95], v[172:175], a[156:159], v[92:95]
  s_waitcnt lgkmcnt(4)
  MF v[32:35], v[160:163], a[160:163], v[32:35]
  TR v[172:173], v5 offset:30720
  MF v[36:39], v[160:163], a[164:167], v[36:39]
  TR v[174:175], v5 offset:30976
  MF v[40:43], v[160:163], a[168:171], v[40:43]
  s_add_u32 m0, s37, 28672
  s_add_u32 s89, s47, 192
  BL4 v8, s[8:11], s89 offen lds
  MF v[44:47], v[160:163], a[172:175], v[44:47]
  s_waitcnt lgkmcnt(4)
  MF v[48:51], v[164:167], a[160:163], v[48:51]
  TR v[160:161], v3 offset:32768
  MF v[52:55], v[164:167], a[164:167], v[52:55]
  TR v[162:163], v3 offset:33024
  MF v[56:59], v[164:167], a[168:171], v[56:59]
  BL4 v[216:219], v240, s[24:27], s62 offen
  MF v[60:63], v[164:167], a[172:175], v[60:63]
  s_waitcnt lgkmcnt(4)
  MF v[64:67], v[168:171], a[160:163], v[64:67]
  TR v[164:165], v3 offset:34816
  MF v[68:71], v[168:171], a[164:167], v[68:71]
  TR v[166:167], v3 offset:35072
  MF v[72:75], v[168:171], a[168:171], v[72:75]
  BL4 v[220:223], v240, s[28:31], s62 offen
  MF v[76:79], v[168:171], a[172:175], v[76:79]
  v_and_b32 v241, 15, v1
  s_waitcnt lgkmcnt(4)
  MF v[80:83], v[172:175], a[160:163], v[80:83]
  TR v[168:169], v5 offset:32768
  v_lshlrev_b32 v241, 1, v241
  MF v[84:87], v[172:175], a[164:167], v[84:87]
  TR v[170:171], v5 offset:33024
  s_lshl_b32 s61, s59, 5
  MF v[88:91], v[172:175], a[168:171], v[88:91]
  v_add_u32 v241, s61, v241
  s_mov_b32 s12, s92
  s_and_b32 s13, s93, 65535
  MF v[92:95], v[172:175], a[172:175], v[92:95]
  s_mov_b32 s14, 1152
  s_mov_b32 s15, 131072
  s_waitcnt lgkmcnt(4)
  MF v[32:35], v[160:163], a[176:179], v[32:35]
  TR v[172:173], v5 offset:34816
  MF v[36:39], v[160:163], a[180:183], v[36:39]
  TR v[174:175], v5 offset:35072
  MF v[40:43], v[160:163], a[184:187], v[40:43]
  s_add_u32 m0, s37, 32768
  s_add_u32 s89, s48, 192
  BL4 v8, s[8:11], s89 offen lds
  MF v[44:47], v[160:163], a[188:191], v[44:47]
  s_waitcnt lgkmcnt(4)
  MF v[48:51], v[164:167], a[176:179], v[48:51]
  s_waitcnt vmcnt(21)
  s_barrier
  TR v[160:161], v3 offset:36864
  MF v[52:55], v[164:167], a[180:183], v[52:55]
  TR v[162:163], v3 offset:37120
  MF v[56:59], v[164:167], a[184:187], v[56:59]
  buffer_load_ushort v224, v241, s[12:15], 0 offen
  MF v[60:63], v[164:167], a[188:191], v[60:63]
  s_mov_b32 s12, s94
  s_and_b32 s13, s95, 65535
  s_waitcnt lgkmcnt(4)
  MF v[64:67], v[168:171], a[176:179], v[64:67]
  TR v[164:165], v3 offset:38912
  s_mov_b32 s14, 1152
  s_mov_b32 s15, 131072
  MF v[68:71], v[168:171], a[180:183], v[68:71]
  TR v[166:167], v3 offset:39168
  MF v[72:75], v[168:171], a[184:187], v[72:75]
  buffer_load_ushort v225, v241, s[12:15], 0 offen
  MF v[76:79], v[168:171], a[188:191], v[76:79]
  s_mov_b32 s12, s96
  s_and_b32 s13, s97, 65535
  s_waitcnt lgkmcnt(4)
  MF v[80:83], v[172:175], a[176:179], v[80:83]
  TR v[168:169], v5 offset:36864
  s_mov_b32 s14, 1152
  s_mov_b32 s15, 131072
  MF v[84:87], v[172:175], a[180:183], v[84:87]
  TR v[170:171], v5 offset:37120
  MF v[88:91], v[172:175], a[184:187], v[88:91]
  buffer_load_ushort v226, v241, s[12:15], 0 offen
  MF v[92:95], v[172:175], a[188:191], v[92:95]
  s_waitcnt lgkmcnt(4)
  MF v[32:35], v[160:163], a[192:195], v[32:35]
  TR v[172:173], v5 offset:38912
  MF v[36:39], v[160:163], a[196:199], v[36:39]
  TR v[174:175], v5 offset:39168
  MF v[40:43], v[160:163], a[200:203], v[40:43]
  s_add_u32 m0, s37, 36864
  s_add_u32 s89, s49, 192
  BL4 v8, s[8:11], s89 offen lds
  MF v[44:47], v[160:163], a[204:207], v[44:47]
  s_add_u32 m0, s37, 40960
  s_add_u32 s89, s50, 192
  BL4 v8, s[8:11], s89 offen lds
  s_waitcnt lgkmcnt(4)
  MF v[48:51], v[164:167], a[192:195], v[48:51]
  TR v[160:161], v3 offset:40960
  MF v[52:55], v[164:167], a[196:199], v[52:55]
  TR v[162:163], v3 offset:41216
  MF v[56:59], v[164:167], a[200:203], v[56:59]
  MF v[60:63], v[164:167], a[204:207], v[60:63]
  s_waitcnt lgkmcnt(4)
  MF v[64:67], v[168:171], a[192:195], v[64:67]
  TR v[164:165], v3 offset:43008
  MF v[68:71], v[168:171], a[196:199], v[68:71]
  TR v[166:167], v3 offset:43264
  MF v[72:75], v[168:171], a[200:203], v[72:75]
  MF v[76:79], v[168:171], a[204:207], v[76:79]
  s_waitcnt lgkmcnt(4)
  MF v[80:83], v[172:175], a[192:195], v[80:83]
  TR v[168:169], v5 offset:40960
  MF v[84:87], v[172:175], a[196:199], v[84:87]
  TR v[170:171], v5 offset:41216
  MF v[88:91], v[172:175], a[200:203], v[88:91]
  MF v[92:95], v[172:175], a[204:207], v[92:95]
  s_waitcnt lgkmcnt(4)
  MF v[32:35], v[160:163], a[208:211], v[32:35]
  TR v[172:173], v5 offset:43008
  MF v[36:39], v[160:163], a[212:215], v[36:39]
  TR v[174:175], v5 offset:43264
  MF v[40:43], v[160:163], a[216:219], v[40:43]
  s_add_u32 m0, s37, 45056
  s_add_u32 s89, s51, 192
  BL4 v8, s[8:11], s89 offen lds
  MF v[44:47], v[160:163], a[220:223], v[44:47]
  s_waitcnt lgkmcnt(4)
  MF v[48:51], v[164:167], a[208:211], v[48:51]
  TR v[160:161], v3 offset:45056
  MF v[52:55], v[164:167], a[212:215], v[52:55]
  TR v[162:163], v3 offset:45312
  MF v[56:59], v[164:167], a[216:219], v[56:59]
  MF v[60:63], v[164:167], a[220:223], v[60:63]
  s_waitcnt lgkmcnt(4)
  MF v[64:67], v[168:171], a[208:211], v[64:67]
  TR v[164:165], v3 offset:47104
  MF v[68:71], v[168:171], a[212:215], v[68:71]
  TR v[166:167], v3 offset:47360
  MF v[72:75], v[168:171], a[216:219], v[72:75]
  MF v[76:79], v[168:171], a[220:223], v[76:79]
  s_waitcnt lgkmcnt(4)
  MF v[80:83], v[172:175], a[208:211], v[80:83]
  TR v[168:169], v5 offset:45056
  MF v[84:87], v[172:175], a[212:215], v[84:87]
  TR v[170:171], v5 offset:45312
  MF v[88:91], v[172:175], a[216:219], v[88:91]
  MF v[92:95], v[172:175], a[220:223], v[92:95]
  s_waitcnt lgkmcnt(4)
  MF v[32:35], v[160:163], a[224:227], v[32:35]
  TR v[172:173], v5 offset:47104
  MF v[36:39], v[160:163], a[228:231], v[36:39]
  TR v[174:175], v5 offset:47360
  MF v[40:43], v[160:163], a[232:235], v[40:43]
  s_add_u32 m0, s37, 49152
  s_add_u32 s89, s52, 192
  BL4 v8, s[8:11], s89 offen lds
  MF v[44:47], v[160:163], a[236:239], v[44:47]
  s_waitcnt lgkmcnt(4)
  MF v[48:51], v[164:167], a[224:227], v[48:51]
  TR v[160:161], v3 offset:49152
  MF v[52:55], v[164:167], a[228:231], v[52:55]
  TR v[162:163], v3 offset:49408
  MF v[56:59], v[164:167], a[232:235], v[56:59]
  MF v[60:63], v[164:167], a[236:239], v[60:63]
  s_waitcnt lgkmcnt(4)
  MF v[64:67], v[168:171], a[224:227], v[64:67]
  TR v[164:165], v3 offset:51200
  MF v[68:71], v[168:171], a[228:231], v[68:71]
  TR v[166:167], v3 offset:51456
  MF v[72:75], v[168:171], a[232:235], v[72:75]
  MF v[76:79], v[168:171], a[236:239], v[76:79]
  s_waitcnt lgkmcnt(4)
  MF v[80:83], v[172:175], a[224:227], v[80:83]
  TR v[168:169], v5 offset:49152
  MF v[84:87], v[172:175], a[228:231], v[84:87]
  TR v[170:171], v5 offset:49408
  MF v[88:91], v[172:175], a[232:235], v[88:91]
  MF v[92:95], v[172:175], a[236:239], v[92:95]
  s_waitcnt lgkmcnt(4)
  MF v[32:35], v[160:163], a[240:243], v[32:35]
  TR v[172:173], v5 offset:51200
  MF v[36:39], v[160:163], a[244:247], v[36:39]
  TR v[174:175], v5 offset:51456
  MF v[40:43], v[160:163], a[248:251], v[40:43]
  s_add_u32 m0, s37, 53248
  s_add_u32 s89, s53, 192
  BL4 v8, s[8:11], s89 offen lds
  MF v[44:47], v[160:163], a[252:255], v[44:47]
  s_waitcnt lgkmcnt(4)
  MF v[48:51], v[164:167], a[240:243], v[48:51]
  TR v[160:161], v3 offset:53248
  MF v[52:55], v[164:167], a[244:247], v[52:55]
  TR v[162:163], v3 offset:53504
  MF v[56:59], v[164:167], a[248:251], v[56:59]
  MF v[60:63], v[164:167], a[252:255], v[60:63]
  s_waitcnt lgkmcnt(4)
  MF v[64:67], v[168:171], a[240:243], v[64:67]
  TR v[164:165], v3 offset:55296
  MF v[68:71], v[168:171], a[244:247], v[68:71]
  TR v[166:167], v3 offset:55552
  MF v[72:75], v[168:171], a[248:251], v[72:75]
  MF v[76:79], v[168:171], a[252:255], v[76:79]
  s_waitcnt lgkmcnt(4)
  MF v[80:83], v[172:175], a[240:243], v[80:83]
  TR v[168:169], v5 offset:53248
  MF v[84:87], v[172:175], a[244:247], v[84:87]
  TR v[170:171], v5 offset:53504
  MF v[88:91], v[172:175], a[248:251], v[88:91]
  MF v[92:95], v[172:175], a[252:255], v[92:95]
  s_waitcnt lgkmcnt(4)
  MF v[32:35], v[160:163], v[176:179], v[32:35]
  TR v[172:173], v5 offset:55296
  MF v[36:39], v[160:163], v[180:183], v[36:39]
  TR v[174:175], v5 offset:55552
  MF v[40:43], v[160:163], v[184:187], v[40:43]
  s_add_u32 m0, s37, 57344
  s_add_u32 s89, s54, 192
  BL4 v8, s[8:11], s89 offen lds
  MF v[44:47], v[160:163], v[188:191], v[44:47]
  s_waitcnt lgkmcnt(4)
  MF v[48:51], v[164:167], v[176:179], v[48:51]
  TR v[160:161], v3 offset:57344
  MF v[52:55], v[164:167], v[180:183], v[52:55]
  TR v[162:163], v3 offset:57600
  MF v[56:59], v[164:167], v[184:187], v[56:59]
  MF v[60:63], v[164:167], v[188:191], v[60:63]
  s_waitcnt lgkmcnt(4)
  MF v[64:67], v[168:171], v[176:179], v[64:67]
  TR v[164:165], v3 offset:59392
  MF v[68:71], v[168:171], v[180:183], v[68:71]
  TR v[166:167], v3 offset:59648
  MF v[72:75], v[168:171], v[184:187], v[72:75]
  MF v[76:79], v[168:171], v[188:191], v[76:79]
  s_waitcnt lgkmcnt(4)
  MF v[80:83], v[172:175], v[176:179], v[80:83]
  TR v[168:169], v5 offset:57344
  MF v[84:87], v[172:175], v[180:183], v[84:87]
  TR v[170:171], v5 offset:57600
  MF v[88:91], v[172:175], v[184:187], v[88:91]
  MF v[92:95], v[172:175], v[188:191], v[92:95]
  s_waitcnt lgkmcnt(4)
  MF v[32:35], v[160:163], v[192:195], v[32:35]
  TR v[172:173], v5 offset:59392
  MF v[36:39], v[160:163], v[196:199], v[36:39]
  TR v[174:175], v5 offset:59648
  MF v[40:43], v[160:163], v[200:203], v[40:43]
  s_add_u32 m0, s37, 61440
  s_add_u32 s89, s55, 192
  BL4 v8, s[8:11], s89 offen lds
  MF v[44:47], v[160:163], v[204:207], v[44:47]
  s_waitcnt lgkmcnt(4)
  MF v[48:51], v[164:167], v[192:195], v[48:51]
  s_waitcnt vmcnt(18)
  s_barrier
  TR v[160:161], v2
  MF v[52:55], v[164:167], v[196:199], v[52:55]
  TR v[162:163], v2 offset:256
  MF v[56:59], v[164:167], v[200:203], v[56:59]
  MF v[60:63], v[164:167], v[204:207], v[60:63]
  s_waitcnt lgkmcnt(4)
  MF v[64:67], v[168:171], v[192:195], v[64:67]
  TR v[164:165], v2 offset:2048
  MF v[68:71], v[168:171], v[196:199], v[68:71]
  TR v[166:167], v2 offset:2304
  MF v[72:75], v[168:171], v[200:203], v[72:75]
  MF v[76:79], v[168:171], v[204:207], v[76:79]
  s_waitcnt lgkmcnt(4)
  MF v[80:83], v[172:175], v[192:195], v[80:83]
  TR v[168:169], v4
  MF v[84:87], v[172:175], v[196:199], v[84:87]
  TR v[170:171], v4 offset:256
  MF v[88:91], v[172:175], v[200:203], v[88:91]
  MF v[92:95], v[172:175], v[204:207], v[92:95]
K1_TA_G2:
  s_waitcnt lgkmcnt(4)
  MF v[96:99], v[160:163], a[0:3], 0
  TR v[172:173], v4 offset:2048
  MF v[100:103], v[160:163], a[4:7], 0
  TR v[174:175], v4 offset:2304
  MF v[104:107], v[160:163], a[8:11], 0
  s_add_u32 m0, s37, 65536
  s_add_u32 s89, s56, 192
  BL4 v8, s[8:11], s89 offen lds
  MF v[108:111], v[160:163], a[12:15], 0
  s_add_u32 m0, s37, 69632
  s_add_u32 s89, s57, 192
  BL4 v8, s[8:11], s89 offen lds
  s_waitcnt lgkmcnt(4)
  MF v[112:115], v[164:167], a[0:3], 0
  TR v[160:161], v2 offset:4096
  MF v[116:119], v[164:167], a[4:7], 0
  TR v[162:163], v2 offset:4352
  MF v[120:123], v[164:167], a[8:11], 0
  MF v[124:127], v[164:167], a[12:15], 0
  s_waitcnt lgkmcnt(4)
  MF v[128:131], v[168:171], a[0:3], 0
  TR v[164:165], v2 offset:6144
  MF v[132:135], v[168:171], a[4:7], 0
  TR v[166:167], v2 offset:6400
  MF v[136:139], v[168:171], a[8:11], 0
  MF v[140:143], v[168:171], a[12:15], 0
  s_waitcnt lgkmcnt(4)
  MF v[144:147], v[172:175], a[0:3], 0
  TR v[168:169], v4 offset:4096
  s_add_u32 s88, s36, 2
  s_lshl_b32 s88, s88, 10
  MF v[148:151], v[172:175], a[4:7], 0
  TR v[170:171], v4 offset:4352
  v_max_f32 v32, 0, v32
  MF v[152:155], v[172:175], a[8:11], 0
  v_max_f32 v33, 0, v33
  v_max_f32 v34, 0, v34
  MF v[156:159], v[172:175], a[12:15], 0
  v_max_f32 v35, 0, v35
  s_waitcnt lgkmcnt(4)
  MF v[96:99], v[160:163], a[16:19], v[96:99]
  TR v[172:173], v4 offset:6144
  v_mul_f32 v32, v32, v48
  MF v[100:103], v[160:163], a[20:23], v[100:103]
  TR v[174:175], v4 offset:6400
  v_mul_f32 v33, v33, v49
  MF v[104:107], v[160:163], a[24:27], v[104:107]
  s_add_u32 m0, s37, 73728
  s_add_u32 s89, s40, 256
  BL4 v8, s[8:11], s89 offen lds
  MF v[108:111], v[160:163], a[28:31], v[108:111]
  v_mul_f32 v34, v34, v50
  s_waitcnt lgkmcnt(4)
  MF v[112:115], v[164:167], a[16:19], v[112:115]
  TR v[160:161], v2 offset:8192
  v_mul_f32 v35, v35, v51
  MF v[116:119], v[164:167], a[20:23], v[116:119]
  TR v[162:163], v2 offset:8448
  v_cvt_pk_bf16_f32 v248, v32, v33
  MF v[120:123], v[164:167], a[24:27], v[120:123]
  v_cvt_pk_bf16_f32 v249, v34, v35
  v_max_f32 v64, 0, v64
  MF v[124:127], v[164:167], a[28:31], v[124:127]
  v_max_f32 v65, 0, v65
  s_waitcnt lgkmcnt(4)
  MF v[128:131], v[168:171], a[16:19], v[128:131]
  TR v[164:165], v2 offset:10240
  v_max_f32 v66, 0, v66
  MF v[132:135], v[168:171], a[20:23], v[132:135]
  TR v[166:167], v2 offset:10496
  v_max_f32 v67, 0, v67
  MF v[136:139], v[168:171], a[24:27], v[136:139]
  v_mul_f32 v64, v64, v80
  v_mul_f32 v65, v65, v81
  MF v[140:143], v[168:171], a[28:31], v[140:143]
  v_mul_f32 v66, v66, v82
  s_waitcnt lgkmcnt(4)
  MF v[144:147], v[172:175], a[16:19], v[144:147]
  TR v[168:169], v4 offset:8192
  v_mul_f32 v67, v67, v83
  MF v[148:151], v[172:175], a[20:23], v[148:151]
  TR v[170:171], v4 offset:8448
  v_cvt_pk_bf16_f32 v250, v64, v65
  MF v[152:155], v[172:175], a[24:27], v[152:155]
  v_cvt_pk_bf16_f32 v251, v66, v67
  s_add_u32 s80, s88, 0
  MF v[156:159], v[172:175], a[28:31], v[156:159]
  s_waitcnt lgkmcnt(4)
  MF v[96:99], v[160:163], a[32:35], v[96:99]
  TR v[172:173], v4 offset:10240
  MF v[100:103], v[160:163], a[36:39], v[100:103]
  TR v[174:175], v4 offset:10496
  MF v[104:107], v[160:163], a[40:43], v[104:107]
  s_add_u32 m0, s37, 77824
  s_add_u32 s89, s41, 256
  BL4 v8, s[8:11], s89 offen lds
  MF v[108:111], v[160:163], a[44:47], v[108:111]
  s_waitcnt lgkmcnt(4)
  MF v[112:115], v[164:167], a[32:35], v[112:115]
  TR v[160:161], v2 offset:12288
  MF v[116:119], v[164:167], a[36:39], v[116:119]
  TR v[162:163], v2 offset:12544
  MF v[120:123], v[164:167], a[40:43], v[120:123]
  buffer_store_dwordx4 v[248:251], v10, s[16:19], s80 offen sc1
  MF v[124:127], v[164:167], a[44:47], v[124:127]
  v_max_f32 v36, 0, v36
  s_waitcnt lgkmcnt(4)
  MF v[128:131], v[168:171], a[32:35], v[128:131]
  TR v[164:165], v2 offset:14336
  v_max_f32 v37, 0, v37
  MF v[132:135], v[168:171], a[36:39], v[132:135]
  TR v[166:167], v2 offset:14592
  v_max_f32 v38, 0, v38
  MF v[136:139], v[168:171], a[40:43], v[136:139]
  v_max_f32 v39, 0, v39
  v_mul_f32 v36, v36, v52
  MF v[140:143], v[168:171], a[44:47], v[140:143]
  v_mul_f32 v37, v37, v53
  s_waitcnt lgkmcnt(4)
  MF v[144:147], v[172:175], a[32:35], v[144:147]
  TR v[168:169], v4 offset:12288
  v_mul_f32 v38, v38, v54
  MF v[148:151], v[172:175], a[36:39], v[148:151]
  TR v[170:171], v4 offset:12544
  v_mul_f32 v39, v39, v55
  MF v[152:155], v[172:175], a[40:43], v[152:155]
  v_cvt_pk_bf16_f32 v252, v36, v37
  v_cvt_pk_bf16_f32 v253, v38, v39
  MF v[156:159], v[172:175], a[44:47], v[156:159]
  v_max_f32 v68, 0, v68
  s_waitcnt lgkmcnt(4)
  MF v[96:99], v[160:163], a[48:51], v[96:99]
  TR v[172:173], v4 offset:14336
  v_max_f32 v69, 0, v69
  MF v[100:103], v[160:163], a[52:55], v[100:103]
  TR v[174:175], v4 offset:14592
  v_max_f32 v70, 0, v70
  MF v[104:107], v[160:163], a[56:59], v[104:107]
  s_add_u32 m0, s37, 81920
  s_add_u32 s89, s42, 256
  BL4 v8, s[8:11], s89 offen lds
  MF v[108:111], v[160:163], a[60:63], v[108:111]
  v_max_f32 v71, 0, v71
  s_waitcnt lgkmcnt(4)
  MF v[112:115], v[164:167], a[48:51], v[112:115]
  TR v[160:161], v2 offset:16384
  v_mul_f32 v68, v68, v84
  MF v[116:119], v[164:167], a[52:55], v[116:119]
  TR v[162:163], v2 offset:16640
  v_mul_f32 v69, v69, v85
  MF v[120:123], v[164:167], a[56:59], v[120:123]
  v_mul_f32 v70, v70, v86
  v_mul_f32 v71, v71, v87
  MF v[124:127], v[164:167], a[60:63], v[124:127]
  v_cvt_pk_bf16_f32 v254, v68, v69
  s_waitcnt lgkmcnt(4)
  MF v[128:131], v[168:171], a[48:51], v[128:131]
  TR v[164:165], v2 offset:18432
  v_cvt_pk_bf16_f32 v255, v70, v71
  MF v[132:135], v[168:171], a[52:55], v[132:135]
  TR v[166:167], v2 offset:18688
  s_add_u32 s80, s88, 185344
  MF v[136:139], v[168:171], a[56:59], v[136:139]
  buffer_store_dwordx4 v[252:255], v10, s[16:19], s80 offen sc1
  MF v[140:143], v[168:171], a[60:63], v[140:143]
  v_max_f32 v40, 0, v40
  s_waitcnt lgkmcnt(4)
  MF v[144:147], v[172:175], a[48:51], v[144:147]
  TR v[168:169], v4 offset:16384
  v_max_f32 v41, 0, v41
  MF v[148:151], v[172:175], a[52:55], v[148:151]
  TR v[170:171], v4 offset:16640
  v_max_f32 v42, 0, v42
  MF v[152:155], v[172:175], a[56:59], v[152:155]
  v_max_f32 v43, 0, v43
  v_mul_f32 v40, v40, v56
  MF v[156:159], v[172:175], a[60:63], v[156:159]
  v_mul_f32 v41, v41, v57
  s_waitcnt lgkmcnt(4)
  MF v[96:99], v[160:163], a[64:67], v[96:99]
  TR v[172:173], v4 offset:18432
  v_mul_f32 v42, v42, v58
  MF v[100:103], v[160:163], a[68:71], v[100:103]
  TR v[174:175], v4 offset:18688
  v_mul_f32 v43, v43, v59
  MF v[104:107], v[160:163], a[72:75], v[104:107]
  s_add_u32 m0, s37, 86016
  s_add_u32 s89, s43, 256
  BL4 v8, s[8:11], s89 offen lds
  MF v[108:111], v[160:163], a[76:79], v[108:111]
  v_cvt_pk_bf16_f32 v248, v40, v41
  s_waitcnt lgkmcnt(4)
  MF v[112:115], v[164:167], a[64:67], v[112:115]
  TR v[160:161], v2 offset:20480
  v_cvt_pk_bf16_f32 v249, v42, v43
  MF v[116:119], v[164:167], a[68:71], v[116:119]
  TR v[162:163], v2 offset:20736
  v_max_f32 v72, 0, v72
  MF v[120:123], v[164:167], a[72:75], v[120:123]
  v_max_f32 v73, 0, v73
  v_max_f32 v74, 0, v74
  MF v[124:127], v[164:167], a[76:79], v[124:127]
  v_max_f32 v75, 0, v75
  s_waitcnt lgkmcnt(4)
  MF v[128:131], v[168:171], a[64:67], v[128:131]
  TR v[164:165], v2 offset:22528
  v_mul_f32 v72, v72, v88
  MF v[132:135], v[168:171], a[68:71], v[132:135]
  TR v[166:167], v2 offset:22784
  v_mul_f32 v73, v73, v89
  MF v[136:139], v[168:171], a[72:75], v[136:139]
  v_mul_f32 v74, v74, v90
  v_mul_f32 v75, v75, v91
  MF v[140:143], v[168:171], a[76:79], v[140:143]
  v_cvt_pk_bf16_f32 v250, v72, v73
  s_waitcnt lgkmcnt(4)
  MF v[144:147], v[172:175], a[64:67], v[144:147]
  TR v[168:169], v4 offset:20480
  v_cvt_pk_bf16_f32 v251, v74, v75
  MF v[148:151], v[172:175], a[68:71], v[148:151]
  TR v[170:171], v4 offset:20736
  s_add_u32 s80, s88, 370688
  MF v[152:155], v[172:175], a[72:75], v[152:155]
  buffer_store_dwordx4 v[248:251], v10, s[16:19], s80 offen sc1
  MF v[156:159], v[172:175], a[76:79], v[156:159]
  v_max_f32 v44, 0, v44
  s_waitcnt lgkmcnt(4)
  MF v[96:99], v[160:163], a[80:83], v[96:99]
  TR v[172:173], v4 offset:22528
  v_max_f32 v45, 0, v45
  MF v[100:103], v[160:163], a[84:87], v[100:103]
  TR v[174:175], v4 offset:22784
  v_max_f32 v46, 0, v46
  MF v[104:107], v[160:163], a[88:91], v[104:107]
  s_add_u32 m0, s37, 90112
  s_add_u32 s89, s44, 256
  BL4 v8, s[8:11], s89 offen lds
  MF v[108:111], v[160:163], a[92:95], v[108:111]
  v_max_f32 v47, 0, v47
  s_waitcnt lgkmcnt(4)
  MF v[112:115], v[164:167], a[80:83], v[112:115]
  s_waitcnt vmcnt(14)
  s_barrier
  TR v[160:161], v2 offset:24576
  v_mul_f32 v44, v44, v60
  MF v[116:119], v[164:167], a[84:87], v[116:119]
  TR v[162:163], v2 offset:24832
  v_mul_f32 v45, v45, v61
  MF v[120:123], v[164:167], a[88:91], v[120:123]
  v_mul_f32 v46, v46, v62
  v_mul_f32 v47, v47, v63
  MF v[124:127], v[164:167], a[92:95], v[124:127]
  v_cvt_pk_bf16_f32 v252, v44, v45
  s_waitcnt lgkmcnt(4)
  MF v[128:131], v[168:171], a[80:83], v[128:131]
  TR v[164:165], v2 offset:26624
  v_cvt_pk_bf16_f32 v253, v46, v47
  MF v[132:135], v[168:171], a[84:87], v[132:135]
  TR v[166:167], v2 offset:26880
  v_max_f32 v76, 0, v76
  MF v[136:139], v[168:171], a[88:91], v[136:139]
  v_max_f32 v77, 0, v77
  v_max_f32 v78, 0, v78
  MF v[140:143], v[168:171], a[92:95], v[140:143]
  v_max_f32 v79, 0, v79
  s_waitcnt lgkmcnt(4)
  MF v[144:147], v[172:175], a[80:83], v[144:147]
  TR v[168:169], v4 offset:24576
  v_mul_f32 v76, v76, v92
  MF v[148:151], v[172:175], a[84:87], v[148:151]
  TR v[170:171], v4 offset:24832
  v_mul_f32 v77, v77, v93
  MF v[152:155], v[172:175], a[88:91], v[152:155]
  v_mul_f32 v78, v78, v94
  v_mul_f32 v79, v79, v95
  MF v[156:159], v[172:175], a[92:95], v[156:159]
  v_cvt_pk_bf16_f32 v254, v76, v77
  s_waitcnt lgkmcnt(4)
  MF v[96:99], v[160:163], a[96:99], v[96:99]
  TR v[172:173], v4 offset:26624
  v_cvt_pk_bf16_f32 v255, v78, v79
  MF v[100:103], v[160:163], a[100:103], v[100:103]
  TR v[174:175], v4 offset:26880
  s_add_u32 s80, s88, 556032
  MF v[104:107], v[160:163], a[104:107], v[104:107]
  s_add_u32 m0, s37, 94208
  s_add_u32 s89, s45, 256
  BL4 v8, s[8:11], s89 offen lds
  MF v[108:111], v[160:163], a[108:111], v[108:111]
  s_waitcnt lgkmcnt(4)
  MF v[112:115], v[164:167], a[96:99], v[112:115]
  TR v[160:161], v2 offset:28672
  MF v[116:119], v[164:167], a[100:103], v[116:119]
  TR v[162:163], v2 offset:28928
  MF v[120:123], v[164:167], a[104:107], v[120:123]
  buffer_store_dwordx4 v[252:255], v10, s[16:19], s80 offen sc1
  MF v[124:127], v[164:167], a[108:111], v[124:127]
  v_lshlrev_b32 v224, 16, v224
  s_waitcnt lgkmcnt(4)
  MF v[128:131], v[168:171], a[96:99], v[128:131]
  TR v[164:165], v2 offset:30720
  v_lshlrev_b32 v225, 16, v225
  MF v[132:135], v[168:171], a[100:103], v[132:135]
  TR v[166:167], v2 offset:30976
  v_lshlrev_b32 v226, 16, v226
  MF v[136:139], v[168:171], a[104:107], v[136:139]
  v_mul_f32 v226, 0x3fb8aa3b, v226
  v_exp_f32 v226, v226
  MF v[140:143], v[168:171], a[108:111], v[140:143]
  v_cvt_pk_bf16_f32 v226, v226, v226
  s_waitcnt lgkmcnt(4)
  MF v[144:147], v[172:175], a[96:99], v[144:147]
  TR v[168:169], v4 offset:28672
  v_lshlrev_b32 v226, 16, v226
  MF v[148:151], v[172:175], a[100:103], v[148:151]
  TR v[170:171], v4 offset:28928
  v_mul_f32 v228, v226, v224
  MF v[152:155], v[172:175], a[104:107], v[152:155]
  v_mul_f32 v229, v226, v225
  v_mul_f32 v228, 0x3fb8aa3b, v228
  MF v[156:159], v[172:175], a[108:111], v[156:159]
  v_mul_f32 v229, 0x3e22f983, v229
  s_waitcnt lgkmcnt(4)
  MF v[96:99], v[160:163], a[112:115], v[96:99]
  TR v[172:173], v4 offset:30720
  v_exp_f32 v230, v228
  MF v[100:103], v[160:163], a[116:119], v[100:103]
  TR v[174:175], v4 offset:30976
  v_fract_f32 v233, v229
  MF v[104:107], v[160:163], a[120:123], v[104:107]
  s_add_u32 m0, s37, 98304
  s_add_u32 s89, s46, 256
  BL4 v8, s[8:11], s89 offen lds
  MF v[108:111], v[160:163], a[124:127], v[108:111]
  v_cos_f32 v232, v233
  s_waitcnt lgkmcnt(4)
  MF v[112:115], v[164:167], a[112:115], v[112:115]
  TR v[160:161], v2 offset:32768
  v_sin_f32 v233, v233
  MF v[116:119], v[164:167], a[116:119], v[116:119]
  TR v[162:163], v2 offset:33024
  v_mul_f32 v231, v230, v233
  MF v[120:123], v[164:167], a[120:123], v[120:123]
  v_mul_f32 v230, v230, v232
  v_add_f32 v230, -1.0, v230
  MF v[124:127], v[164:167], a[124:127], v[124:127]
  v_mul_f32 v232, v224, v224
  s_waitcnt lgkmcnt(4)
  MF v[128:131], v[168:171], a[112:115], v[128:131]
  TR v[164:165], v2 offset:34816
  v_fma_f32 v232, v225, v225, v232
  MF v[132:135], v[168:171], a[116:119], v[132:135]
  TR v[166:167], v2 offset:35072
  v_rcp_f32 v232, v232
  MF v[136:139], v[168:171], a[120:123], v[136:139]
  v_add_f32 v232, v232, v232
  v_mul_f32 v228, v230, v224
  MF v[140:143], v[168:171], a[124:127], v[140:143]
  v_fma_f32 v228, v231, v225, v228
  s_waitcnt lgkmcnt(4)
  MF v[144:147], v[172:175], a[112:115], v[144:147]
  TR v[168:169], v4 offset:32768
  v_mul_f32 v229, v231, v224
  MF v[148:151], v[172:175], a[116:119], v[148:151]
  TR v[170:171], v4 offset:33024
  v_fma_f32 v229, -v230, v225, v229
  MF v[152:155], v[172:175], a[120:123], v[152:155]
  v_mul_f32 v228, v228, v232
  v_mul_f32 v229, v229, v232
  MF v[156:159], v[172:175], a[124:127], v[156:159]
  s_lshl_b32 s61, s32, 7
  s_add_u32 s61, s61, 142336
  s_waitcnt lgkmcnt(4)
  MF v[96:99], v[160:163], a[128:131], v[96:99]
  TR v[172:173], v4 offset:34816
  v_and_b32 v242, 15, v1
  MF v[100:103], v[160:163], a[132:135], v[100:103]
  TR v[174:175], v4 offset:35072
  v_lshlrev_b32 v242, 3, v242
  MF v[104:107], v[160:163], a[136:139], v[104:107]
  s_add_u32 m0, s37, 102400
  s_add_u32 s89, s47, 256
  BL4 v8, s[8:11], s89 offen lds
  MF v[108:111], v[160:163], a[140:143], v[108:111]
  v_add_u32 v242, s61, v242
  s_waitcnt lgkmcnt(4)
  MF v[112:115], v[164:167], a[128:131], v[112:115]
  TR v[160:161], v2 offset:36864
  ds_write_b64 v242, v[228:229]
  MF v[116:119], v[164:167], a[132:135], v[116:119]
  TR v[162:163], v2 offset:37120
  v_and_b32 v242, 1, v1
  MF v[120:123], v[164:167], a[136:139], v[120:123]
  v_lshlrev_b32 v242, 6, v242
  v_add_u32 v242, s61, v242
  MF v[124:127], v[164:167], a[140:143], v[124:127]
  ds_read_b128 v[224:227], v242
  s_waitcnt lgkmcnt(6)
  MF v[128:131], v[168:171], a[128:131], v[128:131]
  TR v[164:165], v2 offset:38912
  ds_read_b128 v[228:231], v242 offset:16
  MF v[132:135], v[168:171], a[132:135], v[132:135]
  TR v[166:167], v2 offset:39168
  ds_read_b128 v[232:235], v242 offset:32
  MF v[136:139], v[168:171], a[136:139], v[136:139]
  ds_read_b128 v[236:239], v242 offset:48
  v_lshrrev_b32 v244, 5, v1
  MF v[140:143], v[168:171], a[140:143], v[140:143]
  s_lshl_b32 s61, s60, 2
  s_add_u32 s61, s61, 0
  s_waitcnt lgkmcnt(9)
  MF v[144:147], v[172:175], a[128:131], v[144:147]
  TR v[168:169], v4 offset:36864
  v_add_u32 v244, s61, v244
  MF v[148:151], v[172:175], a[132:135], v[148:151]
  TR v[170:171], v4 offset:37120
  v_mul_u32_u24 v245, 7282, v244
  MF v[152:155], v[172:175], a[136:139], v[152:155]
  v_lshrrev_b32 v245, 16, v245
  v_mul_u32_u24 v246, 9, v245
  MF v[156:159], v[172:175], a[140:143], v[156:159]
  v_sub_u32 v244, v244, v246
  s_waitcnt lgkmcnt(8)
  MF v[96:99], v[160:163], a[144:147], v[96:99]
  TR v[172:173], v4 offset:38912
  v_lshlrev_b32 v244, 10, v244
  MF v[100:103], v[160:163], a[148:151], v[100:103]
  TR v[174:175], v4 offset:39168
  v_mul_u32_u24 v245, 405, v245
  MF v[104:107], v[160:163], a[152:155], v[104:107]
  s_add_u32 m0, s37, 106496
  s_add_u32 s89, s48, 256
  BL4 v8, s[8:11], s89 offen lds
  MF v[108:111], v[160:163], a[156:159], v[108:111]
  v_lshlrev_b32 v245, 10, v245
  s_waitcnt lgkmcnt(6)
  MF v[112:115], v[164:167], a[144:147], v[112:115]
  TR v[160:161], v2 offset:40960
  v_add_u32 v244, v244, v245
  MF v[116:119], v[164:167], a[148:151], v[116:119]
  TR v[162:163], v2 offset:41216
  v_lshrrev_b32 v246, 1, v1
  MF v[120:123], v[164:167], a[152:155], v[120:123]
  v_and_b32 v246, 15, v246
  v_lshlrev_b32 v246, 4, v246
  MF v[124:127], v[164:167], a[156:159], v[124:127]
  v_add_u32 v244, v244, v246
  s_waitcnt lgkmcnt(4)
  MF v[128:131], v[168:171], a[144:147], v[128:131]
  TR v[164:165], v2 offset:43008
  v_and_b32 v246, 1, v1
  MF v[132:135], v[168:171], a[148:151], v[132:135]
  TR v[166:167], v2 offset:43264
  v_lshlrev_b32 v246, 9, v246
  MF v[136:139], v[168:171], a[152:155], v[136:139]
  v_add_u32 v246, v246, v244
  s_mul_i32 s61, s59, 7282
  s_lshr_b32 s61, s61, 16
  MF v[140:143], v[168:171], a[156:159], v[140:143]
  s_mul_i32 s62, s61, 9
  s_sub_u32 s62, s59, s62
  s_waitcnt lgkmcnt(4)
  MF v[144:147], v[172:175], a[144:147], v[144:147]
  TR v[168:169], v4 offset:40960
  s_mul_i32 s61, s61, 180
  s_add_u32 s61, s61, s62
  MF v[148:151], v[172:175], a[148:151], v[148:151]
  TR v[170:171], v4 offset:41216
  s_add_u32 s61, s61, 28
  s_mul_i32 s61, s61, 9216
  MF v[152:155], v[172:175], a[152:155], v[152:155]
  s_add_u32 s61, s61, 25165824
  s_cmp_lt_u32 s58, 324
  s_cselect_b32 s61, s61, 1073741824
  MF v[156:159], v[172:175], a[156:159], v[156:159]
  v_add_u32 v246, s61, v246
  s_waitcnt lgkmcnt(4)
  MF v[96:99], v[160:163], a[160:163], v[96:99]
  TR v[172:173], v4 offset:43008
  v_lshlrev_b32 v247, 16, v208
  MF v[100:103], v[160:163], a[164:167], v[100:103]
  TR v[174:175], v4 offset:43264
  v_lshlrev_b32 v243, 16, v212
  MF v[104:107], v[160:163], a[168:171], v[104:107]
  s_add_u32 m0, s37, 110592
  s_add_u32 s89, s49, 256
  BL4 v8, s[8:11], s89 offen lds
  MF v[108:111], v[160:163], a[172:175], v[108:111]
  v_mul_f32 v240, v224, v247
  s_waitcnt lgkmcnt(4)
  MF v[112:115], v[164:167], a[160:163], v[112:115]
  TR v[160:161], v2 offset:45056
  v_mul_f32 v248, v224, v243
  MF v[116:119], v[164:167], a[164:167], v[116:119]
  TR v[162:163], v2 offset:45312
  v_fma_f32 v240, -v225, v243, v240
  MF v[120:123], v[164:167], a[168:171], v[120:123]
  v_fma_f32 v248, v225, v247, v248
  v_and_b32 v247, 0xffff0000, v208
  MF v[124:127], v[164:167], a[172:175], v[124:127]
  v_and_b32 v243, 0xffff0000, v212
  s_waitcnt lgkmcnt(4)
  MF v[128:131], v[168:171], a[160:163], v[128:131]
  TR v[164:165], v2 offset:47104
  v_mul_f32 v241, v226, v247
  MF v[132:135], v[168:171], a[164:167], v[132:135]
  TR v[166:167], v2 offset:47360
  v_mul_f32 v249, v226, v243
  MF v[136:139], v[168:171], a[168:171], v[136:139]
  v_fma_f32 v241, -v227, v243, v241
  v_fma_f32 v249, v227, v247, v249
  MF v[140:143], v[168:171], a[172:175], v[140:143]
  v_lshlrev_b32 v247, 16, v209
  s_waitcnt lgkmcnt(4)
  MF v[144:147], v[172:175], a[160:163], v[144:147]
  TR v[168:169], v4 offset:45056
  v_lshlrev_b32 v243, 16, v213
  MF v[148:151], v[172:175], a[164:167], v[148:151]
  TR v[170:171], v4 offset:45312
  v_mul_f32 v242, v228, v247
  MF v[152:155], v[172:175], a[168:171], v[152:155]
  v_mul_f32 v250, v228, v243
  v_fma_f32 v242, -v229, v243, v242
  MF v[156:159], v[172:175], a[172:175], v[156:159]
  v_fma_f32 v250, v229, v247, v250
  s_waitcnt lgkmcnt(4)
  MF v[96:99], v[160:163], a[176:179], v[96:99]
  TR v[172:173], v4 offset:47104
  v_and_b32 v247, 0xffff0000, v209
  MF v[100:103], v[160:163], a[180:183], v[100:103]
  TR v[174:175], v4 offset:47360
  v_and_b32 v243, 0xffff0000, v213
  MF v[104:107], v[160:163], a[184:187], v[104:107]
  s_add_u32 m0, s37, 114688
  s_add_u32 s89, s50, 256
  BL4 v8, s[8:11], s89 offen lds
  MF v[108:111], v[160:163], a[188:191], v[108:111]
  v_mul_f32 v244, v230, v247
  s_waitcnt lgkmcnt(4)
  MF v[112:115], v[164:167], a[176:179], v[112:115]
  s_waitcnt vmcnt(15)
  s_barrier
  TR v[160:161], v2 offset:49152
  v_mul_f32 v251, v230, v243
  MF v[116:119], v[164:167], a[180:183], v[116:119]
  TR v[162:163], v2 offset:49408
  v_fma_f32 v244, -v231, v243, v244
  MF v[120:123], v[164:167], a[184:187], v[120:123]
  v_fma_f32 v251, v231, v247, v251
  v_cvt_pk_bf16_f32 v252, v240, v241
  MF v[124:127], v[164:167], a[188:191], v[124:127]
  v_cvt_pk_bf16_f32 v253, v242, v244
  s_waitcnt lgkmcnt(4)
  MF v[128:131], v[168:171], a[176:179], v[128:131]
  TR v[164:165], v2 offset:51200
  v_cvt_pk_bf16_f32 v254, -v248, -v249
  MF v[132:135], v[168:171], a[180:183], v[132:135]
  TR v[166:167], v2 offset:51456
  v_cvt_pk_bf16_f32 v255, -v250, -v251
  MF v[136:139], v[168:171], a[184:187], v[136:139]
  buffer_store_dwordx4 v[252:255], v246, s[16:19], 0 offen sc1
  MF v[140:143], v[168:171], a[188:191], v[140:143]
  v_lshlrev_b32 v247, 16, v210
  s_waitcnt lgkmcnt(4)
  MF v[144:147], v[172:175], a[176:179], v[144:147]
  TR v[168:169], v4 offset:49152
  v_lshlrev_b32 v243, 16, v214
  MF v[148:151], v[172:175], a[180:183], v[148:151]
  TR v[170:171], v4 offset:49408
  v_mul_f32 v240, v232, v247
  MF v[152:155], v[172:175], a[184:187], v[152:155]
  v_mul_f32 v248, v232, v243
  v_fma_f32 v240, -v233, v243, v240
  MF v[156:159], v[172:175], a[188:191], v[156:159]
  v_fma_f32 v248, v233, v247, v248
  s_waitcnt lgkmcnt(4)
  MF v[96:99], v[160:163], a[192:195], v[96:99]
  TR v[172:173], v4 offset:51200
  v_and_b32 v247, 0xffff0000, v210
  MF v[100:103], v[160:163], a[196:199], v[100:103]
  TR v[174:175], v4 offset:51456
  v_and_b32 v243, 0xffff0000, v214
  MF v[104:107], v[160:163], a[200:203], v[104:107]
  s_add_u32 m0, s37, 118784
  s_add_u32 s89, s51, 256
  BL4 v8, s[8:11], s89 offen lds
  MF v[108:111], v[160:163], a[204:207], v[108:111]
  v_mul_f32 v241, v234, v247
  s_waitcnt lgkmcnt(4)
  MF v[112:115], v[164:167], a[192:195], v[112:115]
  TR v[160:161], v2 offset:53248
  v_mul_f32 v249, v234, v243
  MF v[116:119], v[164:167], a[196:199], v[116:119]
  TR v[162:163], v2 offset:53504
  v_fma_f32 v241, -v235, v243, v241
  MF v[120:123], v[164:167], a[200:203], v[120:123]
  v_fma_f32 v249, v235, v247, v249
  v_lshlrev_b32 v247, 16, v211
  MF v[124:127], v[164:167], a[204:207], v[124:127]
  v_lshlrev_b32 v243, 16, v215
  s_waitcnt lgkmcnt(4)
  MF v[128:131], v[168:171], a[192:195], v[128:131]
  TR v[164:165], v2 offset:55296
  v_mul_f32 v242, v236, v247
  MF v[132:135], v[168:171], a[196:199], v[132:135]
  TR v[166:167], v2 offset:55552
  v_mul_f32 v250, v236, v243
  MF v[136:139], v[168:171], a[200:203], v[136:139]
  v_fma_f32 v242, -v237, v243, v242
  v_fma_f32 v250, v237, v247, v250
  MF v[140:143], v[168:171], a[204:207], v[140:143]
  v_and_b32 v247, 0xffff0000, v211
  s_waitcnt lgkmcnt(4)
  MF v[144:147], v[172:175], a[192:195], v[144:147]
  TR v[168:169], v4 offset:53248
  v_and_b32 v243, 0xffff0000, v215
  MF v[148:151], v[172:175], a[196:199], v[148:151]
  TR v[170:171], v4 offset:53504
  v_mul_f32 v244, v238, v247
  MF v[152:155], v[172:175], a[200:203], v[152:155]
  v_mul_f32 v251, v238, v243
  v_fma_f32 v244, -v239, v243, v244
  MF v[156:159], v[172:175], a[204:207], v[156:159]
  v_fma_f32 v251, v239, v247, v251
  s_waitcnt lgkmcnt(4)
  MF v[96:99], v[160:163], a[208:211], v[96:99]
  TR v[172:173], v4 offset:55296
  v_cvt_pk_bf16_f32 v252, v240, v241
  MF v[100:103], v[160:163], a[212:215], v[100:103]
  TR v[174:175], v4 offset:55552
  v_cvt_pk_bf16_f32 v253, v242, v244
  MF v[104:107], v[160:163], a[216:219], v[104:107]
  s_add_u32 m0, s37, 0
  s_add_u32 s89, s52, 256
  BL4 v8, s[8:11], s89 offen lds
  MF v[108:111], v[160:163], a[220:223], v[108:111]
  v_cvt_pk_bf16_f32 v254, -v248, -v249
  s_waitcnt lgkmcnt(4)
  MF v[112:115], v[164:167], a[208:211], v[112:115]
  TR v[160:161], v2 offset:57344
  v_cvt_pk_bf16_f32 v255, -v250, -v251
  MF v[116:119], v[164:167], a[212:215], v[116:119]
  TR v[162:163], v2 offset:57600
  MF v[120:123], v[164:167], a[216:219], v[120:123]
  buffer_store_dwordx4 v[252:255], v246, s[16:19], 0 offen offset:256 sc1
  MF v[124:127], v[164:167], a[220:223], v[124:127]
  v_lshrrev_b32 v244, 5, v1
  s_waitcnt lgkmcnt(4)
  MF v[128:131], v[168:171], a[208:211], v[128:131]
  TR v[164:165], v2 offset:59392
  s_lshl_b32 s61, s60, 2
  s_add_u32 s61, s61, 2
  MF v[132:135], v[168:171], a[212:215], v[132:135]
  TR v[166:167], v2 offset:59648
  v_add_u32 v244, s61, v244
  MF v[136:139], v[168:171], a[216:219], v[136:139]
  v_mul_u32_u24 v245, 7282, v244
  v_lshrrev_b32 v245, 16, v245
  MF v[140:143], v[168:171], a[220:223], v[140:143]
  v_mul_u32_u24 v246, 9, v245
  s_waitcnt lgkmcnt(4)
  MF v[144:147], v[172:175], a[208:211], v[144:147]
  TR v[168:169], v4 offset:57344
  v_sub_u32 v244, v244, v246
  MF v[148:151], v[172:175], a[212:215], v[148:151]
  TR v[170:171], v4 offset:57600
  v_lshlrev_b32 v244, 10, v244
  MF v[152:155], v[172:175], a[216:219], v[152:155]
  v_mul_u32_u24 v245, 405, v245
  v_lshlrev_b32 v245, 10, v245
  MF v[156:159], v[172:175], a[220:223], v[156:159]
  v_add_u32 v244, v244, v245
  s_waitcnt lgkmcnt(4)
  MF v[96:99], v[160:163], a[224:227], v[96:99]
  TR v[172:173], v4 offset:59392
  v_lshrrev_b32 v246, 1, v1
  MF v[100:103], v[160:163], a[228:231], v[100:103]
  TR v[174:175], v4 offset:59648
  v_and_b32 v246, 15, v246
  MF v[104:107], v[160:163], a[232:235], v[104:107]
  s_add_u32 m0, s37, 4096
  s_add_u32 s89, s53, 256
  BL4 v8, s[8:11], s89 offen lds
  MF v[108:111], v[160:163], a[236:239], v[108:111]
  v_lshlrev_b32 v246, 4, v246
  s_waitcnt lgkmcnt(4)
  MF v[112:115], v[164:167], a[224:227], v[112:115]
  TR v[160:161], v3
  v_add_u32 v244, v244, v246
  MF v[116:119], v[164:167], a[228:231], v[116:119]
  TR v[162:163], v3 offset:256
  v_and_b32 v246, 1, v1
  MF v[120:123], v[164:167], a[232:235], v[120:123]
  v_lshlrev_b32 v246, 9, v246
  v_add_u32 v246, v246, v244
  MF v[124:127], v[164:167], a[236:239], v[124:127]
  s_mul_i32 s61, s59, 7282
  s_lshr_b32 s61, s61, 16
  s_waitcnt lgkmcnt(4)
  MF v[128:131], v[168:171], a[224:227], v[128:131]
  TR v[164:165], v3 offset:2048
  s_mul_i32 s62, s61, 9
  s_sub_u32 s62, s59, s62
  MF v[132:135], v[168:171], a[228:231], v[132:135]
  TR v[166:167], v3 offset:2304
  s_mul_i32 s61, s61, 180
  s_add_u32 s61, s61, s62
  MF v[136:139], v[168:171], a[232:235], v[136:139]
  s_add_u32 s61, s61, 28
  s_mul_i32 s61, s61, 9216
  s_add_u32 s61, s61, 25165824
  MF v[140:143], v[168:171], a[236:239], v[140:143]
  s_cmp_lt_u32 s58, 324
  s_cselect_b32 s61, s61, 1073741824
  s_waitcnt lgkmcnt(4)
  MF v[144:147], v[172:175], a[224:227], v[144:147]
  TR v[168:169], v5
  v_add_u32 v246, s61, v246
  MF v[148:151], v[172:175], a[228:231], v[148:151]
  TR v[170:171], v5 offset:256
  v_lshlrev_b32 v247, 16, v216
  MF v[152:155], v[172:175], a[232:235], v[152:155]
  v_lshlrev_b32 v243, 16, v220
  v_mul_f32 v240, v224, v247
  MF v[156:159], v[172:175], a[236:239], v[156:159]
  v_mul_f32 v248, v224, v243
  s_waitcnt lgkmcnt(4)
  MF v[96:99], v[160:163], a[240:243], v[96:99]
  TR v[172:173], v5 offset:2048
  v_fma_f32 v240, -v225, v243, v240
  MF v[100:103], v[160:163], a[244:247], v[100:103]
  TR v[174:175], v5 offset:2304
  v_fma_f32 v248, v225, v247, v248
  MF v[104:107], v[160:163], a[248:251], v[104:107]
  s_add_u32 m0, s37, 8192
  s_add_u32 s89, s54, 256
  BL4 v8, s[8:11], s89 offen lds
  MF v[108:111], v[160:163], a[252:255], v[108:111]
  v_and_b32 v247, 0xffff0000, v216
  s_waitcnt lgkmcnt(4)
  MF v[112:115], v[164:167], a[240:243], v[112:115]
  TR v[160:161], v3 offset:4096
  v_and_b32 v243, 0xffff0000, v220
  MF v[116:119], v[164:167], a[244:247], v[116:119]
  TR v[162:163], v3 offset:4352
  v_mul_f32 v241, v226, v247
  MF v[120:123], v[164:167], a[248:251], v[120:123]
  v_mul_f32 v249, v226, v243
  v_fma_f32 v241, -v227, v243, v241
  MF v[124:127], v[164:167], a[252:255], v[124:127]
  v_fma_f32 v249, v227, v247, v249
  s_waitcnt lgkmcnt(4)
  MF v[128:131], v[168:171], a[240:243], v[128:131]
  TR v[164:165], v3 offset:6144
  v_lshlrev_b32 v247, 16, v217
  MF v[132:135], v[168:171], a[244:247], v[132:135]
  TR v[166:167], v3 offset:6400
  v_lshlrev_b32 v243, 16, v221
  MF v[136:139], v[168:171], a[248:251], v[136:139]
  v_mul_f32 v242, v228, v247
  v_mul_f32 v250, v228, v243
  MF v[140:143], v[168:171], a[252:255], v[140:143]
  v_fma_f32 v242, -v229, v243, v242
  s_waitcnt lgkmcnt(4)
  MF v[144:147], v[172:175], a[240:243], v[144:147]
  TR v[168:169], v5 offset:4096
  v_fma_f32 v250, v229, v247, v250
  MF v[148:151], v[172:175], a[244:247], v[148:151]
  TR v[170:171], v5 offset:4352
  v_and_b32 v247, 0xffff0000, v217
  MF v[152:155], v[172:175], a[248:251], v[152:155]
  v_and_b32 v243, 0xffff0000, v221
  v_mul_f32 v244, v230, v247
  MF v[156:159], v[172:175], a[252:255], v[156:159]
  v_mul_f32 v251, v230, v243
  s_waitcnt lgkmcnt(4)
  MF v[96:99], v[160:163], v[176:179], v[96:99]
  TR v[172:173], v5 offset:6144
  v_fma_f32 v244, -v231, v243, v244
  MF v[100:103], v[160:163], v[180:183], v[100:103]
  TR v[174:175], v5 offset:6400
  v_fma_f32 v251, v231, v247, v251
  MF v[104:107], v[160:163], v[184:187], v[104:107]
  s_add_u32 m0, s37, 12288
  s_add_u32 s89, s55, 256
  BL4 v8, s[8:11], s89 offen lds
  MF v[108:111], v[160:163], v[188:191], v[108:111]
  v_cvt_pk_bf16_f32 v252, v240, v241
  s_waitcnt lgkmcnt(4)
  MF v[112:115], v[164:167], v[176:179], v[112:115]
  TR v[160:161], v3 offset:8192
  v_cvt_pk_bf16_f32 v253, v242, v244
  MF v[116:119], v[164:167], v[180:183], v[116:119]
  TR v[162:163], v3 offset:8448
  v_cvt_pk_bf16_f32 v254, -v248, -v249
  MF v[120:123], v[164:167], v[184:187], v[120:123]
  v_cvt_pk_bf16_f32 v255, -v250, -v251
  MF v[124:127], v[164:167], v[188:191], v[124:127]
  s_waitcnt lgkmcnt(4)
  MF v[128:131], v[168:171], v[176:179], v[128:131]
  TR v[164:165], v3 offset:10240
  MF v[132:135], v[168:171], v[180:183], v[132:135]
  TR v[166:167], v3 offset:10496
  MF v[136:139], v[168:171], v[184:187], v[136:139]
  buffer_store_dwordx4 v[252:255], v246, s[16:19], 0 offen sc1
  MF v[140:143], v[168:171], v[188:191], v[140:143]
  v_lshlrev_b32 v247, 16, v218
  s_waitcnt lgkmcnt(4)
  MF v[144:147], v[172:175], v[176:179], v[144:147]
  TR v[168:169], v5 offset:8192
  v_lshlrev_b32 v243, 16, v222
  MF v[148:151], v[172:175], v[180:183], v[148:151]
  TR v[170:171], v5 offset:8448
  v_mul_f32 v240, v232, v247
  MF v[152:155], v[172:175], v[184:187], v[152:155]
  v_mul_f32 v248, v232, v243
  v_fma_f32 v240, -v233, v243, v240
  MF v[156:159], v[172:175], v[188:191], v[156:159]
  v_fma_f32 v248, v233, v247, v248
  s_waitcnt lgkmcnt(4)
  MF v[96:99], v[160:163], v[192:195], v[96:99]
  TR v[172:173], v5 offset:10240
  v_and_b32 v247, 0xffff0000, v218
  MF v[100:103], v[160:163], v[196:199], v[100:103]
  TR v[174:175], v5 offset:10496
  v_and_b32 v243, 0xffff0000, v222
  MF v[104:107], v[160:163], v[200:203], v[104:107]
  s_add_u32 m0, s37, 16384
  s_add_u32 s89, s56, 256
  BL4 v8, s[8:11], s89 offen lds
  MF v[108:111], v[160:163], v[204:207], v[108:111]
  v_mul_f32 v241, v234, v247
  s_waitcnt lgkmcnt(4)
  MF v[112:115], v[164:167], v[192:195], v[112:115]
  s_waitcnt vmcnt(15)
  s_barrier
  TR v[160:161], v3 offset:12288
  v_mul_f32 v249, v234, v243
  MF v[116:119], v[164:167], v[196:199], v[116:119]
  TR v[162:163], v3 offset:12544
  v_fma_f32 v241, -v235, v243, v241
  MF v[120:123], v[164:167], v[200:203], v[120:123]
  v_fma_f32 v249, v235, v247, v249
  v_lshlrev_b32 v247, 16, v219
  MF v[124:127], v[164:167], v[204:207], v[124:127]
  v_lshlrev_b32 v243, 16, v223
  s_waitcnt lgkmcnt(4)
  MF v[128:131], v[168:171], v[192:195], v[128:131]
  TR v[164:165], v3 offset:14336
  v_mul_f32 v242, v236, v247
  MF v[132:135], v[168:171], v[196:199], v[132:135]
  TR v[166:167], v3 offset:14592
  v_mul_f32 v250, v236, v243
  MF v[136:139], v[168:171], v[200:203], v[136:139]
  v_fma_f32 v242, -v237, v243, v242
  v_fma_f32 v250, v237, v247, v250
  MF v[140:143], v[168:171], v[204:207], v[140:143]
  v_and_b32 v247, 0xffff0000, v219
  s_waitcnt lgkmcnt(4)
  MF v[144:147], v[172:175], v[192:195], v[144:147]
  TR v[168:169], v5 offset:12288
  v_and_b32 v243, 0xffff0000, v223
  MF v[148:151], v[172:175], v[196:199], v[148:151]
  TR v[170:171], v5 offset:12544
  v_mul_f32 v244, v238, v247
  MF v[152:155], v[172:175], v[200:203], v[152:155]
  v_mul_f32 v251, v238, v243
  v_fma_f32 v244, -v239, v243, v244
  MF v[156:159], v[172:175], v[204:207], v[156:159]
  v_fma_f32 v251, v239, v247, v251
  v_cvt_pk_bf16_f32 v252, v240, v241
  v_cvt_pk_bf16_f32 v253, v242, v244
  v_cvt_pk_bf16_f32 v254, -v248, -v249
  v_cvt_pk_bf16_f32 v255, -v250, -v251
  buffer_store_dwordx4 v[252:255], v246, s[16:19], 0 offen offset:256 sc1
  s_mov_b32 s24, s98
  s_and_b32 s25, s99, 65535
  s_mov_b32 s26, 5308416
  s_mov_b32 s27, 131072
  v_lshrrev_b32 v240, 3, v1
  v_mul_u32_u24 v240, 1152, v240
  v_and_b32 v241, 7, v1
  v_lshlrev_b32 v241, 4, v241
  v_add_u32 v240, v240, v241
  s_lshl_b32 s62, s32, 13
  s_add_u32 s62, s62, 122880
  s_lshl_b32 s63, s34, 3
  s_add_u32 s63, s63, s33
  s_mul_i32 s63, s63, 7
  s_sub_u32 s68, s35, 1
  s_cmp_lt_u32 s35, 4
  s_cselect_b32 s68, s35, s68
  s_add_u32 s63, s63, s68
  s_lshl_b32 s63, s63, 2
  s_add_u32 s63, s63, s32
  s_add_u32 s63, s63, 0
  s_mul_i32 s64, s63, 7282
  s_lshr_b32 s64, s64, 16
  s_mul_i32 s68, s64, 9
  s_sub_u32 s60, s63, s68
  s_mul_i32 s65, s64, 1821
  s_lshr_b32 s65, s65, 16
  s_mul_i32 s68, s65, 36
  s_sub_u32 s66, s64, s68
  s_lshr_b32 s68, s66, 2
  s_sub_u32 s69, s66, 16
  s_mul_i32 s70, s69, 52
  s_lshr_b32 s70, s70, 8
  s_mul_i32 s67, s70, 5
  s_sub_u32 s69, s69, s67
  s_add_u32 s70, s70, 4
  s_cmp_lt_u32 s66, 16
  s_cselect_b32 s68, s68, s70
  s_and_b32 s70, s66, 3
  s_add_u32 s70, s70, 1
  s_cmp_lt_u32 s66, 16
  s_cselect_b32 s69, s70, s69
  s_sub_u32 s67, s66, s68
  s_add_u32 s70, s68, 37
  s_cmp_eq_u32 s69, 4
  s_cselect_b32 s67, s70, s67
  s_mul_i32 s68, s65, 180
  s_add_u32 s68, s68, s67
  s_mul_i32 s68, s68, 9216
  s_add_u32 s68, s68, 25165824
  s_cmp_lt_u32 s63, 1296
  s_cselect_b32 s58, s68, 1073741824
  s_mul_i32 s68, s64, 36864
  s_lshl_b32 s69, s60, 7
  s_add_u32 s68, s68, s69
  s_cmp_lt_u32 s63, 1296
  s_cselect_b32 s71, s68, 1073741824
  s_add_u32 s73, s71, 0
  s_add_u32 m0, s62, 0
  s_nop 0
  BL4 v240, s[24:27], s73 offen lds
  s_add_u32 s73, s71, 9216
  s_add_u32 m0, s62, 1024
  s_nop 0
  BL4 v240, s[24:27], s73 offen lds
  s_add_u32 s73, s71, 18432
  s_add_u32 m0, s62, 2048
  s_nop 0
  BL4 v240, s[24:27], s73 offen lds
  s_add_u32 s73, s71, 27648
  s_add_u32 m0, s62, 3072
  s_nop 0
  BL4 v240, s[24:27], s73 offen lds
  s_lshl_b32 s63, s34, 3
  s_add_u32 s63, s63, s33
  s_mul_i32 s63, s63, 7
  s_sub_u32 s68, s35, 1
  s_cmp_lt_u32 s35, 4
  s_cselect_b32 s68, s35, s68
  s_add_u32 s63, s63, s68
  s_lshl_b32 s63, s63, 2
  s_add_u32 s63, s63, s32
  s_add_u32 s63, s63, 896
  s_mul_i32 s64, s63, 7282
  s_lshr_b32 s64, s64, 16
  s_mul_i32 s68, s64, 9
  s_sub_u32 s61, s63, s68
  s_mul_i32 s65, s64, 1821
  s_lshr_b32 s65, s65, 16
  s_mul_i32 s68, s65, 36
  s_sub_u32 s66, s64, s68
  s_lshr_b32 s68, s66, 2
  s_sub_u32 s69, s66, 16
  s_mul_i32 s70, s69, 52
  s_lshr_b32 s70, s70, 8
  s_mul_i32 s67, s70, 5
  s_sub_u32 s69, s69, s67
  s_add_u32 s70, s70, 4
  s_cmp_lt_u32 s66, 16
  s_cselect_b32 s68, s68, s70
  s_and_b32 s70, s66, 3
  s_add_u32 s70, s70, 1
  s_cmp_lt_u32 s66, 16
  s_cselect_b32 s69, s70, s69
  s_sub_u32 s67, s66, s68
  s_add_u32 s70, s68, 37
  s_cmp_eq_u32 s69, 4
  s_cselect_b32 s67, s70, s67
  s_mul_i32 s68, s65, 180
  s_add_u32 s68, s68, s67
  s_mul_i32 s68, s68, 9216
  s_add_u32 s68, s68, 25165824
  s_cmp_lt_u32 s63, 1296
  s_cselect_b32 s59, s68, 1073741824
  s_mul_i32 s68, s64, 36864
  s_lshl_b32 s69, s61, 7
  s_add_u32 s68, s68, s69
  s_cmp_lt_u32 s63, 1296
  s_cselect_b32 s72, s68, 1073741824
  s_add_u32 s73, s72, 0
  s_add_u32 m0, s62, 4096
  s_nop 0
  BL4 v240, s[24:27], s73 offen lds
  s_add_u32 s73, s72, 9216
  s_add_u32 m0, s62, 5120
  s_nop 0
  BL4 v240, s[24:27], s73 offen lds
  s_add_u32 s73, s72, 18432
  s_add_u32 m0, s62, 6144
  s_nop 0
  BL4 v240, s[24:27], s73 offen lds
  s_add_u32 s73, s72, 27648
  s_add_u32 m0, s62, 7168
  s_nop 0
  BL4 v240, s[24:27], s73 offen lds
K1_TA_G3:
  s_waitcnt lgkmcnt(4)
  MF v[32:35], v[160:163], a[0:3], 0
  TR v[172:173], v5 offset:14336
  MF v[36:39], v[160:163], a[4:7], 0
  TR v[174:175], v5 offset:14592
  MF v[40:43], v[160:163], a[8:11], 0
  s_add_u32 m0, s37, 20480
  s_add_u32 s89, s57, 256
  BL4 v8, s[8:11], s89 offen lds
  MF v[44:47], v[160:163], a[12:15], 0
  s_waitcnt lgkmcnt(4)
  MF v[48:51], v[164:167], a[0:3], 0
  TR v[160:161], v3 offset:16384
  MF v[52:55], v[164:167], a[4:7], 0
  TR v[162:163], v3 offset:16640
  MF v[56:59], v[164:167], a[8:11], 0
  MF v[60:63], v[164:167], a[12:15], 0
  s_waitcnt lgkmcnt(4)
  MF v[64:67], v[168:171], a[0:3], 0
  TR v[164:165], v3 offset:18432
  MF v[68:71], v[168:171], a[4:7], 0
  TR v[166:167], v3 offset:18688
  MF v[72:75], v[168:171], a[8:11], 0
  MF v[76:79], v[168:171], a[12:15], 0
  s_waitcnt lgkmcnt(4)
  MF v[80:83], v[172:175], a[0:3], 0
  TR v[168:169], v5 offset:16384
  s_add_u32 s88, s36, 3
  s_lshl_b32 s88, s88, 10
  MF v[84:87], v[172:175], a[4:7], 0
  TR v[170:171], v5 offset:16640
  v_max_f32 v96, 0, v96
  MF v[88:91], v[172:175], a[8:11], 0
  v_max_f32 v97, 0, v97
  v_max_f32 v98, 0, v98
  MF v[92:95], v[172:175], a[12:15], 0
  v_max_f32 v99, 0, v99
  s_waitcnt lgkmcnt(4)
  MF v[32:35], v[160:163], a[16:19], v[32:35]
  TR v[172:173], v5 offset:18432
  v_mul_f32 v96, v96, v112
  MF v[36:39], v[160:163], a[20:23], v[36:39]
  TR v[174:175], v5 offset:18688
  v_mul_f32 v97, v97, v113
  MF v[40:43], v[160:163], a[24:27], v[40:43]
  v_mul_f32 v98, v98, v114
  v_mul_f32 v99, v99, v115
  MF v[44:47], v[160:163], a[28:31], v[44:47]
  v_cvt_pk_bf16_f32 v248, v96, v97
  s_waitcnt lgkmcnt(4)
  MF v[48:51], v[164:167], a[16:19], v[48:51]
  TR v[160:161], v3 offset:20480
  v_cvt_pk_bf16_f32 v249, v98, v99
  MF v[52:55], v[164:167], a[20:23], v[52:55]
  TR v[162:163], v3 offset:20736
  v_max_f32 v128, 0, v128
  MF v[56:59], v[164:167], a[24:27], v[56:59]
  v_max_f32 v129, 0, v129
  v_max_f32 v130, 0, v130
  MF v[60:63], v[164:167], a[28:31], v[60:63]
  v_max_f32 v131, 0, v131
  s_waitcnt lgkmcnt(4)
  MF v[64:67], v[168:171], a[16:19], v[64:67]
  TR v[164:165], v3 offset:22528
  v_mul_f32 v128, v128, v144
  MF v[68:71], v[168:171], a[20:23], v[68:71]
  TR v[166:167], v3 offset:22784
  v_mul_f32 v129, v129, v145
  MF v[72:75], v[168:171], a[24:27], v[72:75]
  v_mul_f32 v130, v130, v146
  v_mul_f32 v131, v131, v147
  MF v[76:79], v[168:171], a[28:31], v[76:79]
  v_cvt_pk_bf16_f32 v250, v128, v129
  s_waitcnt lgkmcnt(4)
  MF v[80:83], v[172:175], a[16:19], v[80:83]
  TR v[168:169], v5 offset:20480
  v_cvt_pk_bf16_f32 v251, v130, v131
  MF v[84:87], v[172:175], a[20:23], v[84:87]
  TR v[170:171], v5 offset:20736
  s_add_u32 s80, s88, 0
  MF v[88:91], v[172:175], a[24:27], v[88:91]
  buffer_store_dwordx4 v[248:251], v10, s[16:19], s80 offen sc1
  MF v[92:95], v[172:175], a[28:31], v[92:95]
  v_max_f32 v100, 0, v100
  s_waitcnt lgkmcnt(4)
  MF v[32:35], v[160:163], a[32:35], v[32:35]
  TR v[172:173], v5 offset:22528
  v_max_f32 v101, 0, v101
  MF v[36:39], v[160:163], a[36:39], v[36:39]
  TR v[174:175], v5 offset:22784
  v_max_f32 v102, 0, v102
  MF v[40:43], v[160:163], a[40:43], v[40:43]
  v_max_f32 v103, 0, v103
  v_mul_f32 v100, v100, v116
  MF v[44:47], v[160:163], a[44:47], v[44:47]
  v_mul_f32 v101, v101, v117
  s_waitcnt lgkmcnt(4)
  MF v[48:51], v[164:167], a[32:35], v[48:51]
  TR v[160:161], v3 offset:24576
  v_mul_f32 v102, v102, v118
  MF v[52:55], v[164:167], a[36:39], v[52:55]
  TR v[162:163], v3 offset:24832
  v_mul_f32 v103, v103, v119
  MF v[56:59], v[164:167], a[40:43], v[56:59]
  v_cvt_pk_bf16_f32 v252, v100, v101
  v_cvt_pk_bf16_f32 v253, v102, v103
  MF v[60:63], v[164:167], a[44:47], v[60:63]
  v_max_f32 v132, 0, v132
  s_waitcnt lgkmcnt(4)
  MF v[64:67], v[168:171], a[32:35], v[64:67]
  TR v[164:165], v3 offset:26624
  v_max_f32 v133, 0, v133
  MF v[68:71], v[168:171], a[36:39], v[68:71]
  TR v[166:167], v3 offset:26880
  v_max_f32 v134, 0, v134
  MF v[72:75], v[168:171], a[40:43], v[72:75]
  v_max_f32 v135, 0, v135
  v_mul_f32 v132, v132, v148
  MF v[76:79], v[168:171], a[44:47], v[76:79]
  v_mul_f32 v133, v133, v149
  s_waitcnt lgkmcnt(4)
  MF v[80:83], v[172:175], a[32:35], v[80:83]
  TR v[168:169], v5 offset:24576
  v_mul_f32 v134, v134, v150
  MF v[84:87], v[172:175], a[36:39], v[84:87]
  TR v[170:171], v5 offset:24832
  v_mul_f32 v135, v135, v151
  MF v[88:91], v[172:175], a[40:43], v[88:91]
  v_cvt_pk_bf16_f32 v254, v132, v133
  v_cvt_pk_bf16_f32 v255, v134, v135
  MF v[92:95], v[172:175], a[44:47], v[92:95]
  s_add_u32 s80, s88, 185344
  s_waitcnt lgkmcnt(4)
  MF v[32:35], v[160:163], a[48:51], v[32:35]
  TR v[172:173], v5 offset:26624
  MF v[36:39], v[160:163], a[52:55], v[36:39]
  TR v[174:175], v5 offset:26880
  MF v[40:43], v[160:163], a[56:59], v[40:43]
  buffer_store_dwordx4 v[252:255], v10, s[16:19], s80 offen sc1
  MF v[44:47], v[160:163], a[60:63], v[44:47]
  v_max_f32 v104, 0, v104
  s_waitcnt lgkmcnt(4)
  MF v[48:51], v[164:167], a[48:51], v[48:51]
  TR v[160:161], v3 offset:28672
  v_max_f32 v105, 0, v105
  MF v[52:55], v[164:167], a[52:55], v[52:55]
  TR v[162:163], v3 offset:28928
  v_max_f32 v106, 0, v106
  MF v[56:59], v[164:167], a[56:59], v[56:59]
  v_max_f32 v107, 0, v107
  v_mul_f32 v104, v104, v120
  MF v[60:63], v[164:167], a[60:63], v[60:63]
  v_mul_f32 v105, v105, v121
  s_waitcnt lgkmcnt(4)
  MF v[64:67], v[168:171], a[48:51], v[64:67]
  TR v[164:165], v3 offset:30720
  v_mul_f32 v106, v106, v122
  MF v[68:71], v[168:171], a[52:55], v[68:71]
  TR v[166:167], v3 offset:30976
  v_mul_f32 v107, v107, v123
  MF v[72:75], v[168:171], a[56:59], v[72:75]
  v_cvt_pk_bf16_f32 v248, v104, v105
  v_cvt_pk_bf16_f32 v249, v106, v107
  MF v[76:79], v[168:171], a[60:63], v[76:79]
  v_max_f32 v136, 0, v136
  s_waitcnt lgkmcnt(4)
  MF v[80:83], v[172:175], a[48:51], v[80:83]
  TR v[168:169], v5 offset:28672
  v_max_f32 v137, 0, v137
  MF v[84:87], v[172:175], a[52:55], v[84:87]
  TR v[170:171], v5 offset:28928
  v_max_f32 v138, 0, v138
  MF v[88:91], v[172:175], a[56:59], v[88:91]
  v_max_f32 v139, 0, v139
  v_mul_f32 v136, v136, v152
  MF v[92:95], v[172:175], a[60:63], v[92:95]
  v_mul_f32 v137, v137, v153
  s_waitcnt lgkmcnt(4)
  MF v[32:35], v[160:163], a[64:67], v[32:35]
  TR v[172:173], v5 offset:30720
  v_mul_f32 v138, v138, v154
  MF v[36:39], v[160:163], a[68:71], v[36:39]
  TR v[174:175], v5 offset:30976
  v_mul_f32 v139, v139, v155
  MF v[40:43], v[160:163], a[72:75], v[40:43]
  v_cvt_pk_bf16_f32 v250, v136, v137
  v_cvt_pk_bf16_f32 v251, v138, v139
  MF v[44:47], v[160:163], a[76:79], v[44:47]
  s_add_u32 s80, s88, 370688
  s_waitcnt lgkmcnt(4)
  MF v[48:51], v[164:167], a[64:67], v[48:51]
  TR v[160:161], v3 offset:32768
  MF v[52:55], v[164:167], a[68:71], v[52:55]
  TR v[162:163], v3 offset:33024
  MF v[56:59], v[164:167], a[72:75], v[56:59]
  buffer_store_dwordx4 v[248:251], v10, s[16:19], s80 offen sc1
  MF v[60:63], v[164:167], a[76:79], v[60:63]
  v_max_f32 v108, 0, v108
  s_waitcnt lgkmcnt(4)
  MF v[64:67], v[168:171], a[64:67], v[64:67]
  TR v[164:165], v3 offset:34816
  v_max_f32 v109, 0, v109
  MF v[68:71], v[168:171], a[68:71], v[68:71]
  TR v[166:167], v3 offset:35072
  v_max_f32 v110, 0, v110
  MF v[72:75], v[168:171], a[72:75], v[72:75]
  v_max_f32 v111, 0, v111
  v_mul_f32 v108, v108, v124
  MF v[76:79], v[168:171], a[76:79], v[76:79]
  v_mul_f32 v109, v109, v125
  s_waitcnt lgkmcnt(4)
  MF v[80:83], v[172:175], a[64:67], v[80:83]
  TR v[168:169], v5 offset:32768
  v_mul_f32 v110, v110, v126
  MF v[84:87], v[172:175], a[68:71], v[84:87]
  TR v[170:171], v5 offset:33024
  v_mul_f32 v111, v111, v127
  MF v[88:91], v[172:175], a[72:75], v[88:91]
  v_cvt_pk_bf16_f32 v252, v108, v109
  v_cvt_pk_bf16_f32 v253, v110, v111
  MF v[92:95], v[172:175], a[76:79], v[92:95]
  v_max_f32 v140, 0, v140
  s_waitcnt lgkmcnt(4)
  MF v[32:35], v[160:163], a[80:83], v[32:35]
  TR v[172:173], v5 offset:34816
  v_max_f32 v141, 0, v141
  MF v[36:39], v[160:163], a[84:87], v[36:39]
  TR v[174:175], v5 offset:35072
  v_max_f32 v142, 0, v142
  MF v[40:43], v[160:163], a[88:91], v[40:43]
  v_max_f32 v143, 0, v143
  v_mul_f32 v140, v140, v156
  MF v[44:47], v[160:163], a[92:95], v[44:47]
  v_mul_f32 v141, v141, v157
  s_waitcnt lgkmcnt(4)
  MF v[48:51], v[164:167], a[80:83], v[48:51]
  s_waitcnt vmcnt(20)
  s_barrier
  TR v[160:161], v3 offset:36864
  v_mul_f32 v142, v142, v158
  MF v[52:55], v[164:167], a[84:87], v[52:55]
  TR v[162:163], v3 offset:37120
  v_mul_f32 v143, v143, v159
  MF v[56:59], v[164:167], a[88:91], v[56:59]
  v_cvt_pk_bf16_f32 v254, v140, v141
  v_cvt_pk_bf16_f32 v255, v142, v143
  MF v[60:63], v[164:167], a[92:95], v[60:63]
  s_add_u32 s80, s88, 556032
  s_waitcnt lgkmcnt(4)
  MF v[64:67], v[168:171], a[80:83], v[64:67]
  TR v[164:165], v3 offset:38912
  MF v[68:71], v[168:171], a[84:87], v[68:71]
  TR v[166:167], v3 offset:39168
  MF v[72:75], v[168:171], a[88:91], v[72:75]
  buffer_store_dwordx4 v[252:255], v10, s[16:19], s80 offen sc1
  MF v[76:79], v[168:171], a[92:95], v[76:79]
  v_lshrrev_b32 v241, 4, v1
  s_waitcnt lgkmcnt(4)
  MF v[80:83], v[172:175], a[80:83], v[80:83]
  TR v[168:169], v5 offset:36864
  v_lshlrev_b32 v241, 2, v241
  MF v[84:87], v[172:175], a[84:87], v[84:87]
  TR v[170:171], v5 offset:37120
  v_and_b32 v242, 15, v1
  MF v[88:91], v[172:175], a[88:91], v[88:91]
  v_lshrrev_b32 v242, 2, v242
  v_add_u32 v241, v241, v242
  MF v[92:95], v[172:175], a[92:95], v[92:95]
  v_lshlrev_b32 v241, 7, v241
  s_waitcnt lgkmcnt(4)
  MF v[32:35], v[160:163], a[96:99], v[32:35]
  TR v[172:173], v5 offset:38912
  v_and_b32 v242, 3, v1
  MF v[36:39], v[160:163], a[100:103], v[36:39]
  TR v[174:175], v5 offset:39168
  v_lshlrev_b32 v242, 3, v242
  MF v[40:43], v[160:163], a[104:107], v[40:43]
  v_add_u32 v241, v241, v242
  v_add_u32 v241, s62, v241
  MF v[44:47], v[160:163], a[108:111], v[44:47]
  v_lshlrev_b32 v242, 4, v1
  s_waitcnt lgkmcnt(4)
  MF v[48:51], v[164:167], a[96:99], v[48:51]
  TR v[160:161], v3 offset:40960
  s_waitcnt vmcnt(9)
  TR v[224:225], v241
  MF v[52:55], v[164:167], a[100:103], v[52:55]
  TR v[162:163], v3 offset:41216
  TR v[226:227], v241 offset:2048
  MF v[56:59], v[164:167], a[104:107], v[56:59]
  TR v[228:229], v241 offset:32
  TR v[230:231], v241 offset:2080
  MF v[60:63], v[164:167], a[108:111], v[60:63]
  TR v[232:233], v241 offset:64
  s_waitcnt lgkmcnt(9)
  MF v[64:67], v[168:171], a[96:99], v[64:67]
  TR v[164:165], v3 offset:43008
  TR v[234:235], v241 offset:2112
  MF v[68:71], v[168:171], a[100:103], v[68:71]
  TR v[166:167], v3 offset:43264
  TR v[236:237], v241 offset:96
  MF v[72:75], v[168:171], a[104:107], v[72:75]
  TR v[238:239], v241 offset:2144
  s_lshl_b32 s68, s60, 2
  s_add_u32 s68, s68, 0
  MF v[76:79], v[168:171], a[108:111], v[76:79]
  s_mul_i32 s69, s68, 7282
  s_lshr_b32 s69, s69, 16
  s_waitcnt lgkmcnt(12)
  MF v[80:83], v[172:175], a[96:99], v[80:83]
  TR v[168:169], v5 offset:40960
  s_mul_i32 s70, s69, 9
  s_sub_u32 s68, s68, s70
  MF v[84:87], v[172:175], a[100:103], v[84:87]
  TR v[170:171], v5 offset:41216
  s_mul_i32 s69, s69, 414720
  s_lshl_b32 s68, s68, 10
  MF v[88:91], v[172:175], a[104:107], v[88:91]
  s_add_u32 s68, s68, s69
  s_add_u32 s68, s68, s58
  MF v[92:95], v[172:175], a[108:111], v[92:95]
  s_waitcnt lgkmcnt(11)
  MF v[32:35], v[160:163], a[112:115], v[32:35]
  TR v[172:173], v5 offset:43008
  MF v[36:39], v[160:163], a[116:119], v[36:39]
  TR v[174:175], v5 offset:43264
  MF v[40:43], v[160:163], a[120:123], v[40:43]
  s_waitcnt lgkmcnt(12)
  buffer_store_dwordx4 v[224:227], v242, s[16:19], s68 offen sc1
  MF v[44:47], v[160:163], a[124:127], v[44:47]
  s_lshl_b32 s68, s60, 2
  s_add_u32 s68, s68, 1
  s_waitcnt lgkmcnt(6)
  MF v[48:51], v[164:167], a[112:115], v[48:51]
  TR v[160:161], v3 offset:45056
  s_mul_i32 s69, s68, 7282
  s_lshr_b32 s69, s69, 16
  MF v[52:55], v[164:167], a[116:119], v[52:55]
  TR v[162:163], v3 offset:45312
  s_mul_i32 s70, s69, 9
  s_sub_u32 s68, s68, s70
  MF v[56:59], v[164:167], a[120:123], v[56:59]
  s_mul_i32 s69, s69, 414720
  s_lshl_b32 s68, s68, 10
  s_add_u32 s68, s68, s69
  s_add_u32 s68, s68, s58
  MF v[60:63], v[164:167], a[124:127], v[60:63]
  s_waitcnt lgkmcnt(4)
  MF v[64:67], v[168:171], a[112:115], v[64:67]
  TR v[164:165], v3 offset:47104
  MF v[68:71], v[168:171], a[116:119], v[68:71]
  TR v[166:167], v3 offset:47360
  MF v[72:75], v[168:171], a[120:123], v[72:75]
  buffer_store_dwordx4 v[228:231], v242, s[16:19], s68 offen sc1
  MF v[76:79], v[168:171], a[124:127], v[76:79]
  s_lshl_b32 s68, s60, 2
  s_add_u32 s68, s68, 2
  s_waitcnt lgkmcnt(4)
  MF v[80:83], v[172:175], a[112:115], v[80:83]
  TR v[168:169], v5 offset:45056
  s_mul_i32 s69, s68, 7282
  s_lshr_b32 s69, s69, 16
  MF v[84:87], v[172:175], a[116:119], v[84:87]
  TR v[170:171], v5 offset:45312
  s_mul_i32 s70, s69, 9
  s_sub_u32 s68, s68, s70
  MF v[88:91], v[172:175], a[120:123], v[88:91]
  s_mul_i32 s69, s69, 414720
  s_lshl_b32 s68, s68, 10
  s_add_u32 s68, s68, s69
  s_add_u32 s68, s68, s58
  MF v[92:95], v[172:175], a[124:127], v[92:95]
  s_waitcnt lgkmcnt(4)
  MF v[32:35], v[160:163], a[128:131], v[32:35]
  TR v[172:173], v5 offset:47104
  MF v[36:39], v[160:163], a[132:135], v[36:39]
  TR v[174:175], v5 offset:47360
  MF v[40:43], v[160:163], a[136:139], v[40:43]
  buffer_store_dwordx4 v[232:235], v242, s[16:19], s68 offen sc1
  MF v[44:47], v[160:163], a[140:143], v[44:47]
  s_lshl_b32 s68, s60, 2
  s_add_u32 s68, s68, 3
  s_waitcnt lgkmcnt(4)
  MF v[48:51], v[164:167], a[128:131], v[48:51]
  TR v[160:161], v3 offset:49152
  s_mul_i32 s69, s68, 7282
  s_lshr_b32 s69, s69, 16
  MF v[52:55], v[164:167], a[132:135], v[52:55]
  TR v[162:163], v3 offset:49408
  s_mul_i32 s70, s69, 9
  s_sub_u32 s68, s68, s70
  MF v[56:59], v[164:167], a[136:139], v[56:59]
  s_mul_i32 s69, s69, 414720
  s_lshl_b32 s68, s68, 10
  s_add_u32 s68, s68, s69
  s_add_u32 s68, s68, s58
  MF v[60:63], v[164:167], a[140:143], v[60:63]
  s_waitcnt lgkmcnt(4)
  MF v[64:67], v[168:171], a[128:131], v[64:67]
  TR v[164:165], v3 offset:51200
  MF v[68:71], v[168:171], a[132:135], v[68:71]
  TR v[166:167], v3 offset:51456
  MF v[72:75], v[168:171], a[136:139], v[72:75]
  buffer_store_dwordx4 v[236:239], v242, s[16:19], s68 offen sc1
  MF v[76:79], v[168:171], a[140:143], v[76:79]
  s_waitcnt vmcnt(9)
  TR v[224:225], v241 offset:4096
  s_waitcnt lgkmcnt(5)
  MF v[80:83], v[172:175], a[128:131], v[80:83]
  TR v[168:169], v5 offset:49152
  TR v[226:227], v241 offset:6144
  MF v[84:87], v[172:175], a[132:135], v[84:87]
  TR v[170:171], v5 offset:49408
  TR v[228:229], v241 offset:4128
  MF v[88:91], v[172:175], a[136:139], v[88:91]
  TR v[230:231], v241 offset:6176
  TR v[232:233], v241 offset:4160
  MF v[92:95], v[172:175], a[140:143], v[92:95]
  TR v[234:235], v241 offset:6208
  s_waitcnt lgkmcnt(10)
  MF v[32:35], v[160:163], a[144:147], v[32:35]
  TR v[172:173], v5 offset:51200
  TR v[236:237], v241 offset:4192
  MF v[36:39], v[160:163], a[148:151], v[36:39]
  TR v[174:175], v5 offset:51456
  TR v[238:239], v241 offset:6240
  MF v[40:43], v[160:163], a[152:155], v[40:43]
  s_lshl_b32 s68, s61, 2
  s_add_u32 s68, s68, 0
  s_mul_i32 s69, s68, 7282
  s_lshr_b32 s69, s69, 16
  MF v[44:47], v[160:163], a[156:159], v[44:47]
  s_mul_i32 s70, s69, 9
  s_sub_u32 s68, s68, s70
  s_waitcnt lgkmcnt(12)
  MF v[48:51], v[164:167], a[144:147], v[48:51]
  TR v[160:161], v3 offset:53248
  s_mul_i32 s69, s69, 414720
  s_lshl_b32 s68, s68, 10
  MF v[52:55], v[164:167], a[148:151], v[52:55]
  TR v[162:163], v3 offset:53504
  s_add_u32 s68, s68, s69
  s_add_u32 s68, s68, s59
  MF v[56:59], v[164:167], a[152:155], v[56:59]
  s_waitcnt lgkmcnt(11)
  buffer_store_dwordx4 v[224:227], v242, s[16:19], s68 offen sc1
  MF v[60:63], v[164:167], a[156:159], v[60:63]
  s_lshl_b32 s68, s61, 2
  s_add_u32 s68, s68, 1
  s_waitcnt lgkmcnt(10)
  MF v[64:67], v[168:171], a[144:147], v[64:67]
  TR v[164:165], v3 offset:55296
  s_mul_i32 s69, s68, 7282
  s_lshr_b32 s69, s69, 16
  MF v[68:71], v[168:171], a[148:151], v[68:71]
  TR v[166:167], v3 offset:55552
  s_mul_i32 s70, s69, 9
  s_sub_u32 s68, s68, s70
  MF v[72:75], v[168:171], a[152:155], v[72:75]
  s_mul_i32 s69, s69, 414720
  s_lshl_b32 s68, s68, 10
  s_add_u32 s68, s68, s69
  s_add_u32 s68, s68, s59
  MF v[76:79], v[168:171], a[156:159], v[76:79]
  s_waitcnt lgkmcnt(5)
  MF v[80:83], v[172:175], a[144:147], v[80:83]
  TR v[168:169], v5 offset:53248
  MF v[84:87], v[172:175], a[148:151], v[84:87]
  TR v[170:171], v5 offset:53504
  MF v[88:91], v[172:175], a[152:155], v[88:91]
  buffer_store_dwordx4 v[228:231], v242, s[16:19], s68 offen sc1
  MF v[92:95], v[172:175], a[156:159], v[92:95]
  s_lshl_b32 s68, s61, 2
  s_add_u32 s68, s68, 2
  s_waitcnt lgkmcnt(4)
  MF v[32:35], v[160:163], a[160:163], v[32:35]
  TR v[172:173], v5 offset:55296
  s_mul_i32 s69, s68, 7282
  s_lshr_b32 s69, s69, 16
  MF v[36:39], v[160:163], a[164:167], v[36:39]
  TR v[174:175], v5 offset:55552
  s_mul_i32 s70, s69, 9
  s_sub_u32 s68, s68, s70
  MF v[40:43], v[160:163], a[168:171], v[40:43]
  s_mul_i32 s69, s69, 414720
  s_lshl_b32 s68, s68, 10
  s_add_u32 s68, s68, s69
  s_add_u32 s68, s68, s59
  MF v[44:47], v[160:163], a[172:175], v[44:47]
  s_waitcnt lgkmcnt(4)
  MF v[48:51], v[164:167], a[160:163], v[48:51]
  TR v[160:161], v3 offset:57344
  MF v[52:55], v[164:167], a[164:167], v[52:55]
  TR v[162:163], v3 offset:57600
  MF v[56:59], v[164:167], a[168:171], v[56:59]
  buffer_store_dwordx4 v[232:235], v242, s[16:19], s68 offen sc1
  MF v[60:63], v[164:167], a[172:175], v[60:63]
  s_lshl_b32 s68, s61, 2
  s_add_u32 s68, s68, 3
  s_waitcnt lgkmcnt(4)
  MF v[64:67], v[168:171], a[160:163], v[64:67]
  TR v[164:165], v3 offset:59392
  s_mul_i32 s69, s68, 7282
  s_lshr_b32 s69, s69, 16
  MF v[68:71], v[168:171], a[164:167], v[68:71]
  TR v[166:167], v3 offset:59648
  s_mul_i32 s70, s69, 9
  s_sub_u32 s68, s68, s70
  MF v[72:75], v[168:171], a[168:171], v[72:75]
  s_mul_i32 s69, s69, 414720
  s_lshl_b32 s68, s68, 10
  s_add_u32 s68, s68, s69
  s_add_u32 s68, s68, s59
  MF v[76:79], v[168:171], a[172:175], v[76:79]
  s_waitcnt lgkmcnt(4)
  MF v[80:83], v[172:175], a[160:163], v[80:83]
  TR v[168:169], v5 offset:57344
  MF v[84:87], v[172:175], a[164:167], v[84:87]
  TR v[170:171], v5 offset:57600
  MF v[88:91], v[172:175], a[168:171], v[88:91]
  buffer_store_dwordx4 v[236:239], v242, s[16:19], s68 offen sc1
  MF v[92:95], v[172:175], a[172:175], v[92:95]
  s_waitcnt lgkmcnt(4)
  MF v[32:35], v[160:163], a[176:179], v[32:35]
  TR v[172:173], v5 offset:59392
  MF v[36:39], v[160:163], a[180:183], v[36:39]
  TR v[174:175], v5 offset:59648
  MF v[40:43], v[160:163], a[184:187], v[40:43]
  MF v[44:47], v[160:163], a[188:191], v[44:47]
  s_waitcnt lgkmcnt(4)
  MF v[48:51], v[164:167], a[176:179], v[48:51]
  s_waitcnt vmcnt(0)
  s_barrier
  v_mov_b32 v243, 1
  buffer_store_dword v243, v30, s[16:19], 0 offen sc1
  TR v[160:161], v2
  MF v[52:55], v[164:167], a[180:183], v[52:55]
  TR v[162:163], v2 offset:256
  MF v[56:59], v[164:167], a[184:187], v[56:59]
  MF v[60:63], v[164:167], a[188:191], v[60:63]
  s_waitcnt lgkmcnt(4)
  MF v[64:67], v[168:171], a[176:179], v[64:67]
  TR v[164:165], v2 offset:2048
  MF v[68:71], v[168:171], a[180:183], v[68:71]
  TR v[166:167], v2 offset:2304
  MF v[72:75], v[168:171], a[184:187], v[72:75]
  MF v[76:79], v[168:171], a[188:191], v[76:79]
  s_waitcnt lgkmcnt(4)
  MF v[80:83], v[172:175], a[176:179], v[80:83]
  TR v[168:169], v2 offset:4096
  MF v[84:87], v[172:175], a[180:183], v[84:87]
  TR v[170:171], v2 offset:4352
  MF v[88:91], v[172:175], a[184:187], v[88:91]
  MF v[92:95], v[172:175], a[188:191], v[92:95]
  s_waitcnt lgkmcnt(4)
  MF v[32:35], v[160:163], a[192:195], v[32:35]
  TR v[172:173], v2 offset:6144
  MF v[36:39], v[160:163], a[196:199], v[36:39]
  TR v[174:175], v2 offset:6400
  MF v[40:43], v[160:163], a[200:203], v[40:43]
  MF v[44:47], v[160:163], a[204:207], v[44:47]
  s_waitcnt lgkmcnt(4)
  MF v[48:51], v[164:167], a[192:195], v[48:51]
  TR v[160:161], v2 offset:8192
  MF v[52:55], v[164:167], a[196:199], v[52:55]
  TR v[162:163], v2 offset:8448
  MF v[56:59], v[164:167], a[200:203], v[56:59]
  MF v[60:63], v[164:167], a[204:207], v[60:63]
  s_waitcnt lgkmcnt(4)
  MF v[32:35], v[168:171], a[208:211], v[32:35]
  TR v[164:165], v2 offset:10240
  MF v[36:39], v[168:171], a[212:215], v[36:39]
  TR v[166:167], v2 offset:10496
  MF v[40:43], v[168:171], a[216:219], v[40:43]
  MF v[44:47], v[168:171], a[220:223], v[44:47]
  s_waitcnt lgkmcnt(4)
  MF v[48:51], v[172:175], a[208:211], v[48:51]
  TR v[168:169], v2 offset:12288
  MF v[52:55], v[172:175], a[212:215], v[52:55]
  TR v[170:171], v2 offset:12544
  MF v[56:59], v[172:175], a[216:219], v[56:59]
  MF v[60:63], v[172:175], a[220:223], v[60:63]
  s_waitcnt lgkmcnt(4)
  MF v[32:35], v[160:163], a[224:227], v[32:35]
  TR v[172:173], v2 offset:14336
  MF v[36:39], v[160:163], a[228:231], v[36:39]
  TR v[174:175], v2 offset:14592
  MF v[40:43], v[160:163], a[232:235], v[40:43]
  MF v[44:47], v[160:163], a[236:239], v[44:47]
  s_waitcnt lgkmcnt(4)
  MF v[48:51], v[164:167], a[224:227], v[48:51]
  TR v[160:161], v2 offset:16384
  MF v[52:55], v[164:167], a[228:231], v[52:55]
  TR v[162:163], v2 offset:16640
  MF v[56:59], v[164:167], a[232:235], v[56:59]
  MF v[60:63], v[164:167], a[236:239], v[60:63]
  s_waitcnt lgkmcnt(4)
  MF v[32:35], v[168:171], a[240:243], v[32:35]
  TR v[164:165], v2 offset:18432
  MF v[36:39], v[168:171], a[244:247], v[36:39]
  TR v[166:167], v2 offset:18688
  MF v[40:43], v[168:171], a[248:251], v[40:43]
  MF v[44:47], v[168:171], a[252:255], v[44:47]
  s_waitcnt lgkmcnt(4)
  MF v[48:51], v[172:175], a[240:243], v[48:51]
  TR v[168:169], v2 offset:20480
  MF v[52:55], v[172:175], a[244:247], v[52:55]
  TR v[170:171], v2 offset:20736
  MF v[56:59], v[172:175], a[248:251], v[56:59]
  MF v[60:63], v[172:175], a[252:255], v[60:63]
  s_waitcnt lgkmcnt(4)
  MF v[32:35], v[160:163], v[176:179], v[32:35]
  TR v[172:173], v2 offset:22528
  MF v[36:39], v[160:163], v[180:183], v[36:39]
  TR v[174:175], v2 offset:22784
  MF v[40:43], v[160:163], v[184:187], v[40:43]
  MF v[44:47], v[160:163], v[188:191], v[44:47]
  s_waitcnt lgkmcnt(4)
  MF v[48:51], v[164:167], v[176:179], v[48:51]
  TR v[160:161], v4
  MF v[52:55], v[164:167], v[180:183], v[52:55]
  TR v[162:163], v4 offset:256
  MF v[56:59], v[164:167], v[184:187], v[56:59]
  MF v[60:63], v[164:167], v[188:191], v[60:63]
  s_waitcnt lgkmcnt(4)
  MF v[32:35], v[168:171], v[192:195], v[32:35]
  TR v[164:165], v4 offset:2048
  MF v[36:39], v[168:171], v[196:199], v[36:39]
  TR v[166:167], v4 offset:2304
  MF v[40:43], v[168:171], v[200:203], v[40:43]
  MF v[44:47], v[168:171], v[204:207], v[44:47]
  s_waitcnt lgkmcnt(4)
  MF v[48:51], v[172:175], v[192:195], v[48:51]
  TR v[168:169], v4 offset:4096
  MF v[52:55], v[172:175], v[196:199], v[52:55]
  TR v[170:171], v4 offset:4352
  MF v[56:59], v[172:175], v[200:203], v[56:59]
  MF v[60:63], v[172:175], v[204:207], v[60:63]
  s_waitcnt lgkmcnt(4)
  MF v[64:67], v[160:163], a[192:195], v[64:67]
  TR v[172:173], v4 offset:6144
  MF v[68:71], v[160:163], a[196:199], v[68:71]
  TR v[174:175], v4 offset:6400
  MF v[72:75], v[160:163], a[200:203], v[72:75]
  MF v[76:79], v[160:163], a[204:207], v[76:79]
  s_waitcnt lgkmcnt(4)
  MF v[80:83], v[164:167], a[192:195], v[80:83]
  TR v[160:161], v4 offset:8192
  MF v[84:87], v[164:167], a[196:199], v[84:87]
  TR v[162:163], v4 offset:8448
  MF v[88:91], v[164:167], a[200:203], v[88:91]
  MF v[92:95], v[164:167], a[204:207], v[92:95]
  s_waitcnt lgkmcnt(4)
  MF v[64:67], v[168:171], a[208:211], v[64:67]
  TR v[164:165], v4 offset:10240
  MF v[68:71], v[168:171], a[212:215], v[68:71]
  TR v[166:167], v4 offset:10496
  MF v[72:75], v[168:171], a[216:219], v[72:75]
  v_max_f32 v32, 0, v32
  v_max_f32 v33, 0, v33
  MF v[76:79], v[168:171], a[220:223], v[76:79]
  v_max_f32 v34, 0, v34
  s_waitcnt lgkmcnt(4)
  MF v[80:83], v[172:175], a[208:211], v[80:83]
  TR v[168:169], v4 offset:12288
  v_max_f32 v35, 0, v35
  MF v[84:87], v[172:175], a[212:215], v[84:87]
  TR v[170:171], v4 offset:12544
  v_mul_f32 v32, v32, v48
  MF v[88:91], v[172:175], a[216:219], v[88:91]
  v_mul_f32 v33, v33, v49
  v_mul_f32 v34, v34, v50
  MF v[92:95], v[172:175], a[220:223], v[92:95]
  v_mul_f32 v35, v35, v51
  s_waitcnt lgkmcnt(4)
  MF v[64:67], v[160:163], a[224:227], v[64:67]
  TR v[172:173], v4 offset:14336
  v_cvt_pk_bf16_f32 v248, v32, v33
  MF v[68:71], v[160:163], a[228:231], v[68:71]
  TR v[174:175], v4 offset:14592
  v_cvt_pk_bf16_f32 v249, v34, v35
  MF v[72:75], v[160:163], a[232:235], v[72:75]
  v_max_f32 v36, 0, v36
  v_max_f32 v37, 0, v37
  MF v[76:79], v[160:163], a[236:239], v[76:79]
  v_max_f32 v38, 0, v38
  s_waitcnt lgkmcnt(4)
  MF v[80:83], v[164:167], a[224:227], v[80:83]
  TR v[160:161], v4 offset:16384
  v_max_f32 v39, 0, v39
  MF v[84:87], v[164:167], a[228:231], v[84:87]
  TR v[162:163], v4 offset:16640
  v_mul_f32 v36, v36, v52
  MF v[88:91], v[164:167], a[232:235], v[88:91]
  v_mul_f32 v37, v37, v53
  v_mul_f32 v38, v38, v54
  MF v[92:95], v[164:167], a[236:239], v[92:95]
  v_mul_f32 v39, v39, v55
  s_waitcnt lgkmcnt(4)
  MF v[64:67], v[168:171], a[240:243], v[64:67]
  TR v[164:165], v4 offset:18432
  v_cvt_pk_bf16_f32 v250, v36, v37
  MF v[68:71], v[168:171], a[244:247], v[68:71]
  TR v[166:167], v4 offset:18688
  v_cvt_pk_bf16_f32 v251, v38, v39
  MF v[72:75], v[168:171], a[248:251], v[72:75]
  v_max_f32 v40, 0, v40
  v_max_f32 v41, 0, v41
  MF v[76:79], v[168:171], a[252:255], v[76:79]
  v_max_f32 v42, 0, v42
  s_waitcnt lgkmcnt(4)
  MF v[80:83], v[172:175], a[240:243], v[80:83]
  TR v[168:169], v4 offset:20480
  v_max_f32 v43, 0, v43
  MF v[84:87], v[172:175], a[244:247], v[84:87]
  TR v[170:171], v4 offset:20736
  v_mul_f32 v40, v40, v56
  MF v[88:91], v[172:175], a[248:251], v[88:91]
  v_mul_f32 v41, v41, v57
  v_mul_f32 v42, v42, v58
  MF v[92:95], v[172:175], a[252:255], v[92:95]
  v_mul_f32 v43, v43, v59
  s_waitcnt lgkmcnt(4)
  MF v[64:67], v[160:163], v[176:179], v[64:67]
  TR v[172:173], v4 offset:22528
  v_cvt_pk_bf16_f32 v252, v40, v41
  MF v[68:71], v[160:163], v[180:183], v[68:71]
  TR v[174:175], v4 offset:22784
  v_cvt_pk_bf16_f32 v253, v42, v43
  MF v[72:75], v[160:163], v[184:187], v[72:75]
  v_max_f32 v44, 0, v44
  v_max_f32 v45, 0, v45
  MF v[76:79], v[160:163], v[188:191], v[76:79]
  v_max_f32 v46, 0, v46
  s_waitcnt lgkmcnt(4)
  MF v[80:83], v[164:167], v[176:179], v[80:83]
  v_max_f32 v47, 0, v47
  v_mul_f32 v44, v44, v60
  MF v[84:87], v[164:167], v[180:183], v[84:87]
  v_mul_f32 v45, v45, v61
  v_mul_f32 v46, v46, v62
  MF v[88:91], v[164:167], v[184:187], v[88:91]
  v_mul_f32 v47, v47, v63
  v_cvt_pk_bf16_f32 v254, v44, v45
  MF v[92:95], v[164:167], v[188:191], v[92:95]
  v_cvt_pk_bf16_f32 v255, v46, v47
  s_waitcnt lgkmcnt(2)
  MF v[64:67], v[168:171], v[192:195], v[64:67]
  s_cmp_eq_u32 s32, 0
  s_cselect_b32 s80, 32636928, 1073741824
  v_lshlrev_b32 v31, 4, v1
  MF v[68:71], v[168:171], v[196:199], v[68:71]
  v_add_u32 v31, s80, v31
  MF v[72:75], v[168:171], v[200:203], v[72:75]
  BL4 v[224:227], v31, s[16:19], 0 offen sc1
  MF v[76:79], v[168:171], v[204:207], v[76:79]
  s_waitcnt lgkmcnt(0)
  MF v[80:83], v[172:175], v[192:195], v[80:83]
  MF v[84:87], v[172:175], v[196:199], v[84:87]
  MF v[88:91], v[172:175], v[200:203], v[88:91]
  MF v[92:95], v[172:175], v[204:207], v[92:95]
  s_mul_i32 s88, s34, 45
  s_add_u32 s88, s88, s35
  s_add_u32 s88, s88, 37
  s_lshl_b32 s88, s88, 10
  v_max_f32 v64, 0, v64
  v_max_f32 v65, 0, v65
  v_max_f32 v66, 0, v66
  v_max_f32 v67, 0, v67
  v_mul_f32 v64, v64, v80
  v_mul_f32 v65, v65, v81
  v_mul_f32 v66, v66, v82
  v_mul_f32 v67, v67, v83
  v_mov_b32 v240, v248
  v_mov_b32 v241, v249
  v_cvt_pk_bf16_f32 v242, v64, v65
  v_cvt_pk_bf16_f32 v243, v66, v67
  s_add_u32 s80, s88, 0
  buffer_store_dwordx4 v[240:243], v10, s[16:19], s80 offen sc1
  v_max_f32 v68, 0, v68
  v_max_f32 v69, 0, v69
  v_max_f32 v70, 0, v70
  v_max_f32 v71, 0, v71
  v_mul_f32 v68, v68, v84
  v_mul_f32 v69, v69, v85
  v_mul_f32 v70, v70, v86
  v_mul_f32 v71, v71, v87
  v_mov_b32 v244, v250
  v_mov_b32 v245, v251
  v_cvt_pk_bf16_f32 v246, v68, v69
  v_cvt_pk_bf16_f32 v247, v70, v71
  s_add_u32 s80, s88, 185344
  buffer_store_dwordx4 v[244:247], v10, s[16:19], s80 offen sc1
  v_max_f32 v72, 0, v72
  v_max_f32 v73, 0, v73
  v_max_f32 v74, 0, v74
  v_max_f32 v75, 0, v75
  v_mul_f32 v72, v72, v88
  v_mul_f32 v73, v73, v89
  v_mul_f32 v74, v74, v90
  v_mul_f32 v75, v75, v91
  v_mov_b32 v240, v252
  v_mov_b32 v241, v253
  v_cvt_pk_bf16_f32 v242, v72, v73
  v_cvt_pk_bf16_f32 v243, v74, v75
  s_add_u32 s80, s88, 370688
  buffer_store_dwordx4 v[240:243], v10, s[16:19], s80 offen sc1
  v_max_f32 v76, 0, v76
  v_max_f32 v77, 0, v77
  v_max_f32 v78, 0, v78
  v_max_f32 v79, 0, v79
  v_mul_f32 v76, v76, v92
  v_mul_f32 v77, v77, v93
  v_mul_f32 v78, v78, v94
  v_mul_f32 v79, v79, v95
  v_mov_b32 v244, v254
  v_mov_b32 v245, v255
  v_cvt_pk_bf16_f32 v246, v76, v77
  v_cvt_pk_bf16_f32 v247, v78, v79
  s_add_u32 s80, s88, 556032
  buffer_store_dwordx4 v[244:247], v10, s[16:19], s80 offen sc1
  s_branch P2_START
P2_START:
  s_and_b32 s38, s2, 7
  s_lshr_b32 s39, s2, 3
  v_lshlrev_b32 v2, 4, v1
  s_and_b32 s33, s38, 3
  s_lshr_b32 s38, s38, 2
  s_lshl_b32 s38, s38, 3
  s_lshr_b32 s40, s39, 2
  s_add_u32 s34, s38, s40
  s_and_b32 s35, s39, 3
  s_lshl_b32 s38, s33, 2
  s_add_u32 s38, s38, s35
  s_mul_i32 s43, s38, 414720
  s_add_u32 s43, s43, 25165824
  s_mul_i32 s42, s32, 9216
  s_lshl_b32 s38, s34, 3
  s_lshl_b32 s39, s32, 1
  s_add_u32 s38, s38, s39
  s_mul_i32 s39, s38, 185344
  s_mul_i32 s44, s33, 46080
  v_add_u32 v6, s39, v2
  v_add_u32 v7, 185344, v6
  s_lshr_b32 s39, s38, 2
  s_lshl_b32 s39, s39, 6
  s_and_b32 s40, s38, 3
  s_lshl_b32 s40, s40, 2
  s_add_u32 s39, s39, s40
  v_and_b32 v18, 12, v1
  v_lshlrev_b32 v18, 2, v18
  v_and_b32 v19, 3, v1
  v_add_u32 v20, v18, v19
  v_add_u32 v18, s39, v20
  v_lshlrev_b32 v18, 2, v18
  v_add_u32 v18, 32505856, v18
  s_mov_b32 s61, 0
  s_cmp_eq_u32 s32, 0
  s_cbranch_scc0 P2_FAOK
  s_mov_b32 s40, 262144
POLLA6:
  s_waitcnt vmcnt(4)
  v_and_b32 v224, v224, v225
  v_and_b32 v224, v224, v226
  v_and_b32 v224, v224, v227
  v_cmp_eq_u32 vcc, 1, v224
  s_nop 1
  s_cmp_eq_u64 vcc, -1
  s_cbranch_scc1 POLLEDA6
  s_sub_u32 s40, s40, 1
  s_cbranch_scc1 POLLEDA6
  s_sleep 12
  BL4 v[224:227], v31, s[16:19], 0 offen sc1
  s_waitcnt vmcnt(0)
  s_branch POLLA6
POLLEDA6:
P2_FAOK:
  s_barrier
  s_add_u32 s38, s61, 0
  s_sub_u32 s39, s38, 7
  s_cmp_ge_u32 s38, 7
  s_cselect_b32 s38, s39, s38
  s_lshl_b32 s62, s38, 2
  s_mul_i32 s66, s62, 9216
  s_add_u32 s66, s66, s43
  s_add_u32 s66, s66, s42
  s_add_u32 m0, s42, 0
  s_add_u32 s37, s66, 0
  BL4 v2, s[16:19], s37 offen sc1 lds
  BL4 v2, s[16:19], s37 offen offset:1024 sc1 lds
  BL4 v2, s[16:19], s37 offen offset:2048 sc1 lds
  BL4 v2, s[16:19], s37 offen offset:3072 sc1 lds
  s_add_u32 m0, s42, 4096
  s_add_u32 s37, s66, 4096
  BL4 v2, s[16:19], s37 offen sc1 lds
  BL4 v2, s[16:19], s37 offen offset:1024 sc1 lds
  BL4 v2, s[16:19], s37 offen offset:2048 sc1 lds
  BL4 v2, s[16:19], s37 offen offset:3072 sc1 lds
  s_add_u32 m0, s42, 8192
  s_add_u32 s37, s66, 8192
  BL4 v2, s[16:19], s37 offen sc1 lds
  s_add_u32 s36, s44, 0
  BL4 a[0:3], v6, s[16:19], s36 offen sc1
  BL4 a[4:7], v7, s[16:19], s36 offen sc1
  s_add_u32 s36, s44, 1024
  BL4 a[8:11], v6, s[16:19], s36 offen sc1
  BL4 a[12:15], v7, s[16:19], s36 offen sc1
  buffer_load_dword v8, v18, s[16:19], 0 offen sc1
  buffer_load_dword v9, v18, s[16:19], 0 offen offset:16 sc1
  s_add_u32 s36, s44, 2048
  BL4 a[16:19], v6, s[16:19], s36 offen sc1
  BL4 a[20:23], v7, s[16:19], s36 offen sc1
  s_add_u32 s36, s44, 3072
  BL4 a[24:27], v6, s[16:19], s36 offen sc1
  BL4 a[28:31], v7, s[16:19], s36 offen sc1
  s_add_u32 s38, s61, 1
  s_sub_u32 s39, s38, 7
  s_cmp_ge_u32 s38, 7
  s_cselect_b32 s38, s39, s38
  s_lshl_b32 s63, s38, 2
  s_mul_i32 s66, s63, 9216
  s_add_u32 s66, s66, s43
  s_add_u32 s66, s66, s42
  s_add_u32 m0, s42, 36864
  s_add_u32 s37, s66, 0
  BL4 v2, s[16:19], s37 offen sc1 lds
  BL4 v2, s[16:19], s37 offen offset:1024 sc1 lds
  BL4 v2, s[16:19], s37 offen offset:2048 sc1 lds
  BL4 v2, s[16:19], s37 offen offset:3072 sc1 lds
  s_add_u32 m0, s42, 40960
  s_add_u32 s37, s66, 4096
  BL4 v2, s[16:19], s37 offen sc1 lds
  BL4 v2, s[16:19], s37 offen offset:1024 sc1 lds
  BL4 v2, s[16:19], s37 offen offset:2048 sc1 lds
  BL4 v2, s[16:19], s37 offen offset:3072 sc1 lds
  s_add_u32 m0, s42, 45056
  s_add_u32 s37, s66, 8192
  BL4 v2, s[16:19], s37 offen sc1 lds
  s_add_u32 s36, s44, 4096
  BL4 a[32:35], v6, s[16:19], s36 offen sc1
  BL4 a[36:39], v7, s[16:19], s36 offen sc1
  s_add_u32 s36, s44, 5120
  BL4 a[40:43], v6, s[16:19], s36 offen sc1
  BL4 a[44:47], v7, s[16:19], s36 offen sc1
  s_add_u32 s36, s44, 6144
  BL4 a[48:51], v6, s[16:19], s36 offen sc1
  BL4 a[52:55], v7, s[16:19], s36 offen sc1
  s_load_dwordx2 s[24:25], s[0:1], 64
  s_load_dwordx2 s[28:29], s[0:1], 112
  v_mov_b32 v3, v2
  v_add_u32 v4, 49152, v2
  v_add_u32 v5, 98304, v2
  s_lshl_b32 s38, s2, 2
  s_add_u32 s38, s38, 32637952
  s_cmp_eq_u32 s32, 0
  s_cselect_b32 s38, s38, 1073741824
  v_mov_b32 v12, s38
  v_mov_b32 v19, 1073741824
  v_cmp_eq_u32 vcc, 0, v1
  s_nop 1
  v_cndmask_b32 v12, v19, v12, vcc
  s_and_b32 s38, s2, 7
  s_lshr_b32 s39, s34, 1
  s_and_b32 s39, s39, 3
  s_lshl_b32 s39, s39, 6
  s_add_u32 s38, s38, s39
  s_lshl_b32 s38, s38, 2
  s_add_u32 s38, s38, 32637952
  v_lshlrev_b32 v13, 5, v1
  v_add_u32 v13, s38, v13
  s_cmp_eq_u32 s32, 0
  s_cselect_b32 s38, 8, 0
  v_cmp_gt_u32 vcc, s38, v1
  s_nop 1
  v_cndmask_b32 v13, v19, v13, vcc
  s_lshl_b32 s45, s34, 2
  s_add_u32 s45, s45, s35
  s_lshl_b32 s38, s45, 2
  s_add_u32 s38, s38, s32
  s_lshl_b32 s38, s38, 2
  s_add_u32 s38, s38, s33
  s_mul_i32 s39, s38, 18432
  s_add_u32 s39, s39, 33554432
  v_add_u32 v16, s39, v2
  s_lshl_b32 s38, s45, 2
  s_add_u32 s38, s38, s32
  s_lshl_b32 s38, s38, 3
  s_add_u32 s38, s38, s33
  s_lshl_b32 s38, s38, 2
  s_add_u32 s38, s38, 32643072
  v_mov_b32 v14, s38
  v_cmp_eq_u32 vcc, 0, v1
  s_nop 1
  v_cndmask_b32 v14, v19, v14, vcc
  s_lshl_b32 s38, s45, 2
  s_add_u32 s38, s38, s33
  s_mul_i32 s39, s38, 73728
  s_add_u32 s39, s39, 33554432
  v_add_u32 v21, s39, v2
  s_lshl_b32 s38, s38, 5
  s_add_u32 s38, s38, 32643072
  v_lshlrev_b32 v15, 2, v1
  v_add_u32 v15, s38, v15
  v_cmp_gt_u32 vcc, 4, v1
  s_nop 1
  v_cndmask_b32 v15, v19, v15, vcc
  s_lshl_b32 s46, 1, s33
  s_xor_b32 s46, s46, 15
  s_waitcnt lgkmcnt(0)
  s_and_b32 s25, s25, 65535
  s_mov_b32 s26, 1152
  s_mov_b32 s27, 131072
  s_and_b32 s29, s29, 65535
  s_mov_b32 s30, 4718592
  s_mov_b32 s31, 131072
  s_waitcnt vmcnt(25)
  s_barrier
  v_mov_b32 v17, 1
  buffer_store_dword v17, v12, s[16:19], 0 offen sc1
  ds_read_b128 v[176:179], v3
  ds_read_b128 v[180:183], v3 offset:1024
  ds_read_b128 v[184:187], v3 offset:2048
  ds_read_b128 v[188:191], v3 offset:3072
  ds_read_b128 v[192:195], v3 offset:4096
  ds_read_b128 v[196:199], v3 offset:5120
  s_waitcnt vmcnt(25) lgkmcnt(5)
  MF v[32:35], v[176:179], a[0:3], 0
  ds_read_b128 v[200:203], v3 offset:6144
  s_waitcnt vmcnt(24)
  MF v[68:71], v[176:179], a[4:7], 0
  s_add_u32 s38, s61, 2
  s_sub_u32 s39, s38, 7
  s_cmp_ge_u32 s38, 7
  s_cselect_b32 s38, s39, s38
  s_lshl_b32 s64, s38, 2
  s_waitcnt lgkmcnt(5)
  MF v[36:39], v[180:183], a[0:3], 0
  ds_read_b128 v[204:207], v3 offset:7168
  MF v[72:75], v[180:183], a[4:7], 0
  s_mul_i32 s66, s64, 9216
  s_add_u32 s66, s66, s43
  s_add_u32 s66, s66, s42
  s_add_u32 m0, s42, 73728
  s_add_u32 s37, s66, 0
  BL4 v2, s[16:19], s37 offen sc1 lds
  s_waitcnt lgkmcnt(5)
  MF v[40:43], v[184:187], a[0:3], 0
  ds_read_b128 v[176:179], v3 offset:8192
  MF v[76:79], v[184:187], a[4:7], 0
  BL4 v2, s[16:19], s37 offen offset:1024 sc1 lds
  s_waitcnt lgkmcnt(5)
  MF v[44:47], v[188:191], a[0:3], 0
  ds_read_b128 v[180:183], v3 offset:9216
  MF v[80:83], v[188:191], a[4:7], 0
  s_add_u32 s36, s44, 7168
  BL4 a[56:59], v6, s[16:19], s36 offen sc1
  s_waitcnt lgkmcnt(5)
  MF v[48:51], v[192:195], a[0:3], 0
  ds_read_b128 v[184:187], v3 offset:10240
  MF v[84:87], v[192:195], a[4:7], 0
  BL4 a[60:63], v7, s[16:19], s36 offen sc1
  s_waitcnt lgkmcnt(5)
  MF v[52:55], v[196:199], a[0:3], 0
  ds_read_b128 v[188:191], v3 offset:11264
  MF v[88:91], v[196:199], a[4:7], 0
  s_waitcnt lgkmcnt(5)
  MF v[56:59], v[200:203], a[0:3], 0
  ds_read_b128 v[192:195], v3 offset:12288
  MF v[92:95], v[200:203], a[4:7], 0
  s_waitcnt lgkmcnt(5)
  MF v[60:63], v[204:207], a[0:3], 0
  ds_read_b128 v[196:199], v3 offset:13312
  MF v[96:99], v[204:207], a[4:7], 0
  s_waitcnt lgkmcnt(5)
  MF v[64:67], v[176:179], a[0:3], 0
  ds_read_b128 v[200:203], v3 offset:14336
  MF v[100:103], v[176:179], a[4:7], 0
  s_waitcnt vmcnt(27) lgkmcnt(5)
  MF v[32:35], v[180:183], a[8:11], v[32:35]
  ds_read_b128 v[204:207], v3 offset:15360
  s_waitcnt vmcnt(26)
  MF v[68:71], v[180:183], a[12:15], v[68:71]
  BL4 v2, s[16:19], s37 offen offset:2048 sc1 lds
  s_waitcnt lgkmcnt(5)
  MF v[36:39], v[184:187], a[8:11], v[36:39]
  ds_read_b128 v[176:179], v3 offset:16384
  MF v[72:75], v[184:187], a[12:15], v[72:75]
  BL4 v2, s[16:19], s37 offen offset:3072 sc1 lds
  s_waitcnt lgkmcnt(5)
  MF v[40:43], v[188:191], a[8:11], v[40:43]
  ds_read_b128 v[180:183], v3 offset:17408
  MF v[76:79], v[188:191], a[12:15], v[76:79]
  s_add_u32 m0, s42, 77824
  s_add_u32 s37, s66, 4096
  BL4 v2, s[16:19], s37 offen sc1 lds
  s_waitcnt lgkmcnt(5)
  MF v[44:47], v[192:195], a[8:11], v[44:47]
  ds_read_b128 v[184:187], v3 offset:18432
  MF v[80:83], v[192:195], a[12:15], v[80:83]
  s_add_u32 s36, s44, 8192
  BL4 a[0:3], v6, s[16:19], s36 offen sc1
  s_waitcnt lgkmcnt(5)
  MF v[48:51], v[196:199], a[8:11], v[48:51]
  ds_read_b128 v[188:191], v3 offset:19456
  MF v[84:87], v[196:199], a[12:15], v[84:87]
  BL4 a[4:7], v7, s[16:19], s36 offen sc1
  s_waitcnt lgkmcnt(5)
  MF v[52:55], v[200:203], a[8:11], v[52:55]
  ds_read_b128 v[192:195], v3 offset:20480
  MF v[88:91], v[200:203], a[12:15], v[88:91]
  s_waitcnt lgkmcnt(5)
  MF v[56:59], v[204:207], a[8:11], v[56:59]
  ds_read_b128 v[196:199], v3 offset:21504
  MF v[92:95], v[204:207], a[12:15], v[92:95]
  s_waitcnt lgkmcnt(5)
  MF v[60:63], v[176:179], a[8:11], v[60:63]
  ds_read_b128 v[200:203], v3 offset:22528
  MF v[96:99], v[176:179], a[12:15], v[96:99]
  s_waitcnt lgkmcnt(5)
  MF v[64:67], v[180:183], a[8:11], v[64:67]
  ds_read_b128 v[204:207], v3 offset:23552
  MF v[100:103], v[180:183], a[12:15], v[100:103]
  s_waitcnt vmcnt(28) lgkmcnt(5)
  MF v[32:35], v[184:187], a[16:19], v[32:35]
  ds_read_b128 v[176:179], v3 offset:24576
  s_waitcnt vmcnt(27)
  MF v[68:71], v[184:187], a[20:23], v[68:71]
  BL4 v2, s[16:19], s37 offen offset:1024 sc1 lds
  s_waitcnt lgkmcnt(5)
  MF v[36:39], v[188:191], a[16:19], v[36:39]
  ds_read_b128 v[180:183], v3 offset:25600
  MF v[72:75], v[188:191], a[20:23], v[72:75]
  BL4 v2, s[16:19], s37 offen offset:2048 sc1 lds
  s_waitcnt lgkmcnt(5)
  MF v[40:43], v[192:195], a[16:19], v[40:43]
  ds_read_b128 v[184:187], v3 offset:26624
  MF v[76:79], v[192:195], a[20:23], v[76:79]
  BL4 v2, s[16:19], s37 offen offset:3072 sc1 lds
  s_waitcnt lgkmcnt(5)
  MF v[44:47], v[196:199], a[16:19], v[44:47]
  ds_read_b128 v[188:191], v3 offset:27648
  MF v[80:83], v[196:199], a[20:23], v[80:83]
  s_add_u32 s36, s44, 9216
  BL4 a[8:11], v6, s[16:19], s36 offen sc1
  s_waitcnt lgkmcnt(5)
  MF v[48:51], v[200:203], a[16:19], v[48:51]
  ds_read_b128 v[192:195], v3 offset:28672
  MF v[84:87], v[200:203], a[20:23], v[84:87]
  BL4 a[12:15], v7, s[16:19], s36 offen sc1
  s_waitcnt lgkmcnt(5)
  MF v[52:55], v[204:207], a[16:19], v[52:55]
  ds_read_b128 v[196:199], v3 offset:29696
  MF v[88:91], v[204:207], a[20:23], v[88:91]
  s_waitcnt lgkmcnt(5)
  MF v[56:59], v[176:179], a[16:19], v[56:59]
  ds_read_b128 v[200:203], v3 offset:30720
  MF v[92:95], v[176:179], a[20:23], v[92:95]
  s_waitcnt lgkmcnt(5)
  MF v[60:63], v[180:183], a[16:19], v[60:63]
  ds_read_b128 v[204:207], v3 offset:31744
  MF v[96:99], v[180:183], a[20:23], v[96:99]
  s_waitcnt lgkmcnt(5)
  MF v[64:67], v[184:187], a[16:19], v[64:67]
  ds_read_b128 v[176:179], v3 offset:32768
  MF v[100:103], v[184:187], a[20:23], v[100:103]
  s_waitcnt vmcnt(31) lgkmcnt(5)
  MF v[32:35], v[188:191], a[24:27], v[32:35]
  ds_read_b128 v[180:183], v3 offset:33792
  s_waitcnt vmcnt(30)
  MF v[68:71], v[188:191], a[28:31], v[68:71]
  s_add_u32 m0, s42, 81920
  s_add_u32 s37, s66, 8192
  BL4 v2, s[16:19], s37 offen sc1 lds
  s_waitcnt lgkmcnt(5)
  MF v[36:39], v[192:195], a[24:27], v[36:39]
  ds_read_b128 v[184:187], v3 offset:34816
  MF v[72:75], v[192:195], a[28:31], v[72:75]
  s_add_u32 s36, s44, 10240
  BL4 a[16:19], v6, s[16:19], s36 offen sc1
  s_waitcnt lgkmcnt(5)
  MF v[40:43], v[196:199], a[24:27], v[40:43]
  ds_read_b128 v[188:191], v3 offset:35840
  MF v[76:79], v[196:199], a[28:31], v[76:79]
  BL4 a[20:23], v7, s[16:19], s36 offen sc1
  s_waitcnt lgkmcnt(5)
  MF v[44:47], v[200:203], a[24:27], v[44:47]
  s_waitcnt vmcnt(24)
  s_barrier
  ds_read_b128 v[192:195], v3 offset:36864
  MF v[80:83], v[200:203], a[28:31], v[80:83]
  s_waitcnt lgkmcnt(5)
  MF v[48:51], v[204:207], a[24:27], v[48:51]
  ds_read_b128 v[196:199], v3 offset:37888
  MF v[84:87], v[204:207], a[28:31], v[84:87]
  s_waitcnt lgkmcnt(5)
  MF v[52:55], v[176:179], a[24:27], v[52:55]
  ds_read_b128 v[200:203], v3 offset:38912
  MF v[88:91], v[176:179], a[28:31], v[88:91]
  s_waitcnt lgkmcnt(5)
  MF v[56:59], v[180:183], a[24:27], v[56:59]
  ds_read_b128 v[204:207], v3 offset:39936
  MF v[92:95], v[180:183], a[28:31], v[92:95]
  s_waitcnt lgkmcnt(5)
  MF v[60:63], v[184:187], a[24:27], v[60:63]
  ds_read_b128 v[176:179], v3 offset:40960
  MF v[96:99], v[184:187], a[28:31], v[96:99]
  s_waitcnt lgkmcnt(5)
  MF v[64:67], v[188:191], a[24:27], v[64:67]
  ds_read_b128 v[180:183], v3 offset:41984
  MF v[100:103], v[188:191], a[28:31], v[100:103]
  s_waitcnt vmcnt(23) lgkmcnt(5)
  MF v[32:35], v[192:195], a[32:35], v[32:35]
  ds_read_b128 v[184:187], v3 offset:43008
  s_waitcnt vmcnt(22)
  MF v[68:71], v[192:195], a[36:39], v[68:71]
  s_add_u32 s38, s61, 3
  s_sub_u32 s39, s38, 7
  s_cmp_ge_u32 s38, 7
  s_cselect_b32 s38, s39, s38
  s_lshl_b32 s65, s38, 2
  s_waitcnt lgkmcnt(5)
  MF v[36:39], v[196:199], a[32:35], v[36:39]
  ds_read_b128 v[188:191], v3 offset:44032
  MF v[72:75], v[196:199], a[36:39], v[72:75]
  s_mul_i32 s66, s65, 9216
  s_add_u32 s66, s66, s43
  s_add_u32 s66, s66, s42
  s_add_u32 m0, s42, 110592
  s_add_u32 s37, s66, 0
  BL4 v2, s[16:19], s37 offen sc1 lds
  s_waitcnt lgkmcnt(5)
  MF v[40:43], v[200:203], a[32:35], v[40:43]
  ds_read_b128 v[192:195], v3 offset:45056
  MF v[76:79], v[200:203], a[36:39], v[76:79]
  BL4 v2, s[16:19], s37 offen offset:1024 sc1 lds
  s_waitcnt lgkmcnt(5)
  MF v[44:47], v[204:207], a[32:35], v[44:47]
  ds_read_b128 v[196:199], v3 offset:46080
  MF v[80:83], v[204:207], a[36:39], v[80:83]
  s_add_u32 s36, s44, 11264
  BL4 a[24:27], v6, s[16:19], s36 offen sc1
  s_waitcnt lgkmcnt(5)
  MF v[48:51], v[176:179], a[32:35], v[48:51]
  ds_read_b128 v[200:203], v3 offset:47104
  MF v[84:87], v[176:179], a[36:39], v[84:87]
  BL4 a[28:31], v7, s[16:19], s36 offen sc1
  s_waitcnt lgkmcnt(5)
  MF v[52:55], v[180:183], a[32:35], v[52:55]
  ds_read_b128 v[204:207], v3 offset:48128
  MF v[88:91], v[180:183], a[36:39], v[88:91]
  s_waitcnt lgkmcnt(5)
  MF v[56:59], v[184:187], a[32:35], v[56:59]
  ds_read_b128 v[176:179], v4
  MF v[92:95], v[184:187], a[36:39], v[92:95]
  s_waitcnt lgkmcnt(5)
  MF v[60:63], v[188:191], a[32:35], v[60:63]
  ds_read_b128 v[180:183], v4 offset:1024
  MF v[96:99], v[188:191], a[36:39], v[96:99]
  s_waitcnt lgkmcnt(5)
  MF v[64:67], v[192:195], a[32:35], v[64:67]
  ds_read_b128 v[184:187], v4 offset:2048
  MF v[100:103], v[192:195], a[36:39], v[100:103]
  s_waitcnt vmcnt(25) lgkmcnt(5)
  MF v[32:35], v[196:199], a[40:43], v[32:35]
  ds_read_b128 v[188:191], v4 offset:3072
  s_waitcnt vmcnt(24)
  MF v[68:71], v[196:199], a[44:47], v[68:71]
  BL4 v2, s[16:19], s37 offen offset:2048 sc1 lds
  s_waitcnt lgkmcnt(5)
  MF v[36:39], v[200:203], a[40:43], v[36:39]
  ds_read_b128 v[192:195], v4 offset:4096
  MF v[72:75], v[200:203], a[44:47], v[72:75]
  BL4 v2, s[16:19], s37 offen offset:3072 sc1 lds
  s_waitcnt lgkmcnt(5)
  MF v[40:43], v[204:207], a[40:43], v[40:43]
  ds_read_b128 v[196:199], v4 offset:5120
  MF v[76:79], v[204:207], a[44:47], v[76:79]
  s_add_u32 m0, s42, 114688
  s_add_u32 s37, s66, 4096
  BL4 v2, s[16:19], s37 offen sc1 lds
  s_waitcnt lgkmcnt(5)
  MF v[44:47], v[176:179], a[40:43], v[44:47]
  ds_read_b128 v[200:203], v4 offset:6144
  MF v[80:83], v[176:179], a[44:47], v[80:83]
  s_add_u32 s36, s44, 12288
  BL4 a[32:35], v6, s[16:19], s36 offen sc1
  s_waitcnt lgkmcnt(5)
  MF v[48:51], v[180:183], a[40:43], v[48:51]
  ds_read_b128 v[204:207], v4 offset:7168
  MF v[84:87], v[180:183], a[44:47], v[84:87]
  BL4 a[36:39], v7, s[16:19], s36 offen sc1
  s_waitcnt lgkmcnt(5)
  MF v[52:55], v[184:187], a[40:43], v[52:55]
  ds_read_b128 v[176:179], v4 offset:8192
  MF v[88:91], v[184:187], a[44:47], v[88:91]
  s_waitcnt lgkmcnt(5)
  MF v[56:59], v[188:191], a[40:43], v[56:59]
  ds_read_b128 v[180:183], v4 offset:9216
  MF v[92:95], v[188:191], a[44:47], v[92:95]
  s_waitcnt lgkmcnt(5)
  MF v[60:63], v[192:195], a[40:43], v[60:63]
  ds_read_b128 v[184:187], v4 offset:10240
  MF v[96:99], v[192:195], a[44:47], v[96:99]
  s_waitcnt lgkmcnt(5)
  MF v[64:67], v[196:199], a[40:43], v[64:67]
  ds_read_b128 v[188:191], v4 offset:11264
  MF v[100:103], v[196:199], a[44:47], v[100:103]
  s_waitcnt vmcnt(28) lgkmcnt(5)
  MF v[32:35], v[200:203], a[48:51], v[32:35]
  ds_read_b128 v[192:195], v4 offset:12288
  s_waitcnt vmcnt(27)
  MF v[68:71], v[200:203], a[52:55], v[68:71]
  BL4 v2, s[16:19], s37 offen offset:1024 sc1 lds
  s_waitcnt lgkmcnt(5)
  MF v[36:39], v[204:207], a[48:51], v[36:39]
  ds_read_b128 v[196:199], v4 offset:13312
  MF v[72:75], v[204:207], a[52:55], v[72:75]
  BL4 v2, s[16:19], s37 offen offset:2048 sc1 lds
  s_waitcnt lgkmcnt(5)
  MF v[40:43], v[176:179], a[48:51], v[40:43]
  ds_read_b128 v[200:203], v4 offset:14336
  MF v[76:79], v[176:179], a[52:55], v[76:79]
  BL4 v2, s[16:19], s37 offen offset:3072 sc1 lds
  s_waitcnt lgkmcnt(5)
  MF v[44:47], v[180:183], a[48:51], v[44:47]
  ds_read_b128 v[204:207], v4 offset:15360
  MF v[80:83], v[180:183], a[52:55], v[80:83]
  s_add_u32 s36, s44, 13312
  BL4 a[40:43], v6, s[16:19], s36 offen sc1
  s_waitcnt lgkmcnt(5)
  MF v[48:51], v[184:187], a[48:51], v[48:51]
  ds_read_b128 v[176:179], v4 offset:16384
  MF v[84:87], v[184:187], a[52:55], v[84:87]
  BL4 a[44:47], v7, s[16:19], s36 offen sc1
  s_waitcnt lgkmcnt(5)
  MF v[52:55], v[188:191], a[48:51], v[52:55]
  ds_read_b128 v[180:183], v4 offset:17408
  MF v[88:91], v[188:191], a[52:55], v[88:91]
  s_waitcnt lgkmcnt(5)
  MF v[56:59], v[192:195], a[48:51], v[56:59]
  ds_read_b128 v[184:187], v4 offset:18432
  MF v[92:95], v[192:195], a[52:55], v[92:95]
  s_waitcnt lgkmcnt(5)
  MF v[60:63], v[196:199], a[48:51], v[60:63]
  ds_read_b128 v[188:191], v4 offset:19456
  MF v[96:99], v[196:199], a[52:55], v[96:99]
  s_waitcnt lgkmcnt(5)
  MF v[64:67], v[200:203], a[48:51], v[64:67]
  ds_read_b128 v[192:195], v4 offset:20480
  MF v[100:103], v[200:203], a[52:55], v[100:103]
  s_waitcnt vmcnt(28) lgkmcnt(5)
  MF v[32:35], v[204:207], a[56:59], v[32:35]
  ds_read_b128 v[196:199], v4 offset:21504
  s_waitcnt vmcnt(27)
  MF v[68:71], v[204:207], a[60:63], v[68:71]
  s_add_u32 m0, s42, 118784
  s_add_u32 s37, s66, 8192
  BL4 v2, s[16:19], s37 offen sc1 lds
  s_waitcnt lgkmcnt(5)
  MF v[36:39], v[176:179], a[56:59], v[36:39]
  ds_read_b128 v[200:203], v4 offset:22528
  MF v[72:75], v[176:179], a[60:63], v[72:75]
  s_add_u32 s36, s44, 14336
  BL4 a[48:51], v6, s[16:19], s36 offen sc1
  s_waitcnt lgkmcnt(5)
  MF v[40:43], v[180:183], a[56:59], v[40:43]
  ds_read_b128 v[204:207], v4 offset:23552
  MF v[76:79], v[180:183], a[60:63], v[76:79]
  BL4 a[52:55], v7, s[16:19], s36 offen sc1
  s_waitcnt lgkmcnt(5)
  MF v[44:47], v[184:187], a[56:59], v[44:47]
  s_waitcnt vmcnt(19)
  s_barrier
  ds_read_b128 v[176:179], v4 offset:24576
  MF v[80:83], v[184:187], a[60:63], v[80:83]
  s_waitcnt lgkmcnt(5)
  MF v[48:51], v[188:191], a[56:59], v[48:51]
  ds_read_b128 v[180:183], v4 offset:25600
  MF v[84:87], v[188:191], a[60:63], v[84:87]
  s_waitcnt lgkmcnt(5)
  MF v[52:55], v[192:195], a[56:59], v[52:55]
  ds_read_b128 v[184:187], v4 offset:26624
  MF v[88:91], v[192:195], a[60:63], v[88:91]
  s_waitcnt lgkmcnt(5)
  MF v[56:59], v[196:199], a[56:59], v[56:59]
  ds_read_b128 v[188:191], v4 offset:27648
  MF v[92:95], v[196:199], a[60:63], v[92:95]
  s_waitcnt lgkmcnt(5)
  MF v[60:63], v[200:203], a[56:59], v[60:63]
  ds_read_b128 v[192:195], v4 offset:28672
  MF v[96:99], v[200:203], a[60:63], v[96:99]
  s_waitcnt lgkmcnt(5)
  MF v[64:67], v[204:207], a[56:59], v[64:67]
  ds_read_b128 v[196:199], v4 offset:29696
  MF v[100:103], v[204:207], a[60:63], v[100:103]
  s_waitcnt lgkmcnt(5)
  MF v[32:35], v[176:179], a[0:3], v[32:35]
  ds_read_b128 v[200:203], v4 offset:30720
  MF v[68:71], v[176:179], a[4:7], v[68:71]
  s_add_u32 s38, s61, 4
  s_sub_u32 s39, s38, 7
  s_cmp_ge_u32 s38, 7
  s_cselect_b32 s38, s39, s38
  s_lshl_b32 s62, s38, 2
  s_waitcnt lgkmcnt(5)
  MF v[36:39], v[180:183], a[0:3], v[36:39]
  ds_read_b128 v[204:207], v4 offset:31744
  MF v[72:75], v[180:183], a[4:7], v[72:75]
  s_mul_i32 s66, s62, 9216
  s_add_u32 s66, s66, s43
  s_add_u32 s66, s66, s42
  s_add_u32 m0, s42, 0
  s_add_u32 s37, s66, 0
  BL4 v2, s[16:19], s37 offen sc1 lds
  s_waitcnt lgkmcnt(5)
  MF v[40:43], v[184:187], a[0:3], v[40:43]
  ds_read_b128 v[176:179], v4 offset:32768
  MF v[76:79], v[184:187], a[4:7], v[76:79]
  BL4 v2, s[16:19], s37 offen offset:1024 sc1 lds
  s_waitcnt lgkmcnt(5)
  MF v[44:47], v[188:191], a[0:3], v[44:47]
  ds_read_b128 v[180:183], v4 offset:33792
  v_sub_f32 v10, 1.0, v8
  MF v[80:83], v[188:191], a[4:7], v[80:83]
  v_cvt_pk_bf16_f32 v10, v10, v10
  v_lshlrev_b32 v10, 16, v10
  s_waitcnt lgkmcnt(5)
  MF v[48:51], v[192:195], a[0:3], v[48:51]
  ds_read_b128 v[184:187], v4 offset:34816
  v_sub_f32 v11, 1.0, v9
  MF v[84:87], v[192:195], a[4:7], v[84:87]
  v_cvt_pk_bf16_f32 v11, v11, v11
  v_lshlrev_b32 v11, 16, v11
  s_waitcnt lgkmcnt(5)
  MF v[52:55], v[196:199], a[0:3], v[52:55]
  ds_read_b128 v[188:191], v4 offset:35840
  MF v[88:91], v[196:199], a[4:7], v[88:91]
  s_add_u32 s36, s44, 15360
  BL4 a[56:59], v6, s[16:19], s36 offen sc1
  s_waitcnt lgkmcnt(5)
  MF v[56:59], v[200:203], a[0:3], v[56:59]
  ds_read_b128 v[192:195], v4 offset:36864
  MF v[92:95], v[200:203], a[4:7], v[92:95]
  BL4 a[60:63], v7, s[16:19], s36 offen sc1
  s_waitcnt lgkmcnt(5)
  MF v[60:63], v[204:207], a[0:3], v[60:63]
  ds_read_b128 v[196:199], v4 offset:37888
  MF v[96:99], v[204:207], a[4:7], v[96:99]
  s_waitcnt lgkmcnt(5)
  MF v[64:67], v[176:179], a[0:3], v[64:67]
  ds_read_b128 v[200:203], v4 offset:38912
  MF v[100:103], v[176:179], a[4:7], v[100:103]
  s_waitcnt lgkmcnt(5)
  MF v[32:35], v[180:183], a[8:11], v[32:35]
  ds_read_b128 v[204:207], v4 offset:39936
  MF v[68:71], v[180:183], a[12:15], v[68:71]
  BL4 v2, s[16:19], s37 offen offset:2048 sc1 lds
  s_waitcnt lgkmcnt(5)
  MF v[36:39], v[184:187], a[8:11], v[36:39]
  ds_read_b128 v[176:179], v4 offset:40960
  MF v[72:75], v[184:187], a[12:15], v[72:75]
  BL4 v2, s[16:19], s37 offen offset:3072 sc1 lds
  s_waitcnt lgkmcnt(5)
  MF v[40:43], v[188:191], a[8:11], v[40:43]
  ds_read_b128 v[180:183], v4 offset:41984
  MF v[76:79], v[188:191], a[12:15], v[76:79]
  s_add_u32 m0, s42, 4096
  s_add_u32 s37, s66, 4096
  BL4 v2, s[16:19], s37 offen sc1 lds
  s_waitcnt lgkmcnt(5)
  MF v[44:47], v[192:195], a[8:11], v[44:47]
  ds_read_b128 v[184:187], v4 offset:43008
  MF v[80:83], v[192:195], a[12:15], v[80:83]
  s_add_u32 s36, s44, 16384
  BL4 a[0:3], v6, s[16:19], s36 offen sc1
  s_waitcnt lgkmcnt(5)
  MF v[48:51], v[196:199], a[8:11], v[48:51]
  ds_read_b128 v[188:191], v4 offset:44032
  MF v[84:87], v[196:199], a[12:15], v[84:87]
  BL4 a[4:7], v7, s[16:19], s36 offen sc1
  s_waitcnt lgkmcnt(5)
  MF v[52:55], v[200:203], a[8:11], v[52:55]
  ds_read_b128 v[192:195], v4 offset:45056
  MF v[88:91], v[200:203], a[12:15], v[88:91]
  s_waitcnt lgkmcnt(5)
  MF v[56:59], v[204:207], a[8:11], v[56:59]
  ds_read_b128 v[196:199], v4 offset:46080
  MF v[92:95], v[204:207], a[12:15], v[92:95]
  s_waitcnt lgkmcnt(5)
  MF v[60:63], v[176:179], a[8:11], v[60:63]
  ds_read_b128 v[200:203], v4 offset:47104
  MF v[96:99], v[176:179], a[12:15], v[96:99]
  s_waitcnt lgkmcnt(5)
  MF v[64:67], v[180:183], a[8:11], v[64:67]
  ds_read_b128 v[204:207], v4 offset:48128
  MF v[100:103], v[180:183], a[12:15], v[100:103]
  s_waitcnt vmcnt(27) lgkmcnt(5)
  MF v[32:35], v[184:187], a[16:19], v[32:35]
  ds_read_b128 v[176:179], v5
  s_waitcnt vmcnt(26)
  MF v[68:71], v[184:187], a[20:23], v[68:71]
  BL4 v2, s[16:19], s37 offen offset:1024 sc1 lds
  s_waitcnt lgkmcnt(5)
  MF v[36:39], v[188:191], a[16:19], v[36:39]
  ds_read_b128 v[180:183], v5 offset:1024
  MF v[72:75], v[188:191], a[20:23], v[72:75]
  BL4 v2, s[16:19], s37 offen offset:2048 sc1 lds
  s_waitcnt lgkmcnt(5)
  MF v[40:43], v[192:195], a[16:19], v[40:43]
  ds_read_b128 v[184:187], v5 offset:2048
  MF v[76:79], v[192:195], a[20:23], v[76:79]
  BL4 v2, s[16:19], s37 offen offset:3072 sc1 lds
  s_waitcnt lgkmcnt(5)
  MF v[44:47], v[196:199], a[16:19], v[44:47]
  ds_read_b128 v[188:191], v5 offset:3072
  MF v[80:83], v[196:199], a[20:23], v[80:83]
  s_add_u32 s36, s44, 17408
  BL4 a[8:11], v6, s[16:19], s36 offen sc1
  s_waitcnt lgkmcnt(5)
  MF v[48:51], v[200:203], a[16:19], v[48:51]
  ds_read_b128 v[192:195], v5 offset:4096
  MF v[84:87], v[200:203], a[20:23], v[84:87]
  BL4 a[12:15], v7, s[16:19], s36 offen sc1
  s_waitcnt lgkmcnt(5)
  MF v[52:55], v[204:207], a[16:19], v[52:55]
  ds_read_b128 v[196:199], v5 offset:5120
  MF v[88:91], v[204:207], a[20:23], v[88:91]
  s_waitcnt lgkmcnt(5)
  MF v[56:59], v[176:179], a[16:19], v[56:59]
  ds_read_b128 v[200:203], v5 offset:6144
  MF v[92:95], v[176:179], a[20:23], v[92:95]
  s_waitcnt lgkmcnt(5)
  MF v[60:63], v[180:183], a[16:19], v[60:63]
  ds_read_b128 v[204:207], v5 offset:7168
  MF v[96:99], v[180:183], a[20:23], v[96:99]
  s_waitcnt lgkmcnt(5)
  MF v[64:67], v[184:187], a[16:19], v[64:67]
  ds_read_b128 v[176:179], v5 offset:8192
  MF v[100:103], v[184:187], a[20:23], v[100:103]
  s_waitcnt vmcnt(28) lgkmcnt(5)
  MF v[32:35], v[188:191], a[24:27], v[32:35]
  ds_read_b128 v[180:183], v5 offset:9216
  s_waitcnt vmcnt(27)
  MF v[68:71], v[188:191], a[28:31], v[68:71]
  s_add_u32 m0, s42, 8192
  s_add_u32 s37, s66, 8192
  BL4 v2, s[16:19], s37 offen sc1 lds
  s_waitcnt lgkmcnt(5)
  MF v[36:39], v[192:195], a[24:27], v[36:39]
  ds_read_b128 v[184:187], v5 offset:10240
  MF v[72:75], v[192:195], a[28:31], v[72:75]
  s_add_u32 s36, s44, 18432
  BL4 a[16:19], v6, s[16:19], s36 offen sc1
  s_waitcnt lgkmcnt(5)
  MF v[40:43], v[196:199], a[24:27], v[40:43]
  ds_read_b128 v[188:191], v5 offset:11264
  MF v[76:79], v[196:199], a[28:31], v[76:79]
  BL4 a[20:23], v7, s[16:19], s36 offen sc1
  s_waitcnt lgkmcnt(5)
  MF v[44:47], v[200:203], a[24:27], v[44:47]
  s_waitcnt vmcnt(19)
  s_barrier
  ds_read_b128 v[192:195], v5 offset:12288
  MF v[80:83], v[200:203], a[28:31], v[80:83]
  s_waitcnt lgkmcnt(5)
  MF v[48:51], v[204:207], a[24:27], v[48:51]
  ds_read_b128 v[196:199], v5 offset:13312
  MF v[84:87], v[204:207], a[28:31], v[84:87]
  s_waitcnt lgkmcnt(5)
  MF v[52:55], v[176:179], a[24:27], v[52:55]
  ds_read_b128 v[200:203], v5 offset:14336
  MF v[88:91], v[176:179], a[28:31], v[88:91]
  s_waitcnt lgkmcnt(5)
  MF v[56:59], v[180:183], a[24:27], v[56:59]
  ds_read_b128 v[204:207], v5 offset:15360
  MF v[92:95], v[180:183], a[28:31], v[92:95]
  s_waitcnt lgkmcnt(5)
  MF v[60:63], v[184:187], a[24:27], v[60:63]
  ds_read_b128 v[176:179], v5 offset:16384
  MF v[96:99], v[184:187], a[28:31], v[96:99]
  s_waitcnt lgkmcnt(5)
  MF v[64:67], v[188:191], a[24:27], v[64:67]
  ds_read_b128 v[180:183], v5 offset:17408
  MF v[100:103], v[188:191], a[28:31], v[100:103]
  s_waitcnt lgkmcnt(5)
  MF v[32:35], v[192:195], a[32:35], v[32:35]
  ds_read_b128 v[184:187], v5 offset:18432
  MF v[68:71], v[192:195], a[36:39], v[68:71]
  s_add_u32 s38, s61, 5
  s_sub_u32 s39, s38, 7
  s_cmp_ge_u32 s38, 7
  s_cselect_b32 s38, s39, s38
  s_lshl_b32 s63, s38, 2
  s_waitcnt lgkmcnt(5)
  MF v[36:39], v[196:199], a[32:35], v[36:39]
  ds_read_b128 v[188:191], v5 offset:19456
  MF v[72:75], v[196:199], a[36:39], v[72:75]
  s_mul_i32 s66, s63, 9216
  s_add_u32 s66, s66, s43
  s_add_u32 s66, s66, s42
  s_add_u32 m0, s42, 36864
  s_add_u32 s37, s66, 0
  BL4 v2, s[16:19], s37 offen sc1 lds
  s_waitcnt lgkmcnt(5)
  MF v[40:43], v[200:203], a[32:35], v[40:43]
  ds_read_b128 v[192:195], v5 offset:20480
  MF v[76:79], v[200:203], a[36:39], v[76:79]
  BL4 v2, s[16:19], s37 offen offset:1024 sc1 lds
  s_waitcnt lgkmcnt(5)
  MF v[44:47], v[204:207], a[32:35], v[44:47]
  ds_read_b128 v[196:199], v5 offset:21504
  MF v[80:83], v[204:207], a[36:39], v[80:83]
  buffer_load_dword v17, v13, s[16:19], 0 offen sc1
  s_waitcnt lgkmcnt(5)
  MF v[48:51], v[176:179], a[32:35], v[48:51]
  ds_read_b128 v[200:203], v5 offset:22528
  MF v[84:87], v[176:179], a[36:39], v[84:87]
  s_add_u32 s36, s44, 19456
  BL4 a[24:27], v6, s[16:19], s36 offen sc1
  s_waitcnt lgkmcnt(5)
  MF v[52:55], v[180:183], a[32:35], v[52:55]
  ds_read_b128 v[204:207], v5 offset:23552
  MF v[88:91], v[180:183], a[36:39], v[88:91]
  BL4 a[28:31], v7, s[16:19], s36 offen sc1
  s_waitcnt lgkmcnt(5)
  MF v[56:59], v[184:187], a[32:35], v[56:59]
  ds_read_b128 v[176:179], v5 offset:24576
  MF v[92:95], v[184:187], a[36:39], v[92:95]
  s_waitcnt lgkmcnt(5)
  MF v[60:63], v[188:191], a[32:35], v[60:63]
  ds_read_b128 v[180:183], v5 offset:25600
  MF v[96:99], v[188:191], a[36:39], v[96:99]
  s_waitcnt lgkmcnt(5)
  MF v[64:67], v[192:195], a[32:35], v[64:67]
  ds_read_b128 v[184:187], v5 offset:26624
  MF v[100:103], v[192:195], a[36:39], v[100:103]
  s_waitcnt lgkmcnt(5)
  MF v[32:35], v[196:199], a[40:43], v[32:35]
  ds_read_b128 v[188:191], v5 offset:27648
  MF v[68:71], v[196:199], a[44:47], v[68:71]
  BL4 v2, s[16:19], s37 offen offset:2048 sc1 lds
  s_waitcnt lgkmcnt(5)
  MF v[36:39], v[200:203], a[40:43], v[36:39]
  ds_read_b128 v[192:195], v5 offset:28672
  MF v[72:75], v[200:203], a[44:47], v[72:75]
  BL4 v2, s[16:19], s37 offen offset:3072 sc1 lds
  s_waitcnt lgkmcnt(5)
  MF v[40:43], v[204:207], a[40:43], v[40:43]
  ds_read_b128 v[196:199], v5 offset:29696
  MF v[76:79], v[204:207], a[44:47], v[76:79]
  s_add_u32 m0, s42, 40960
  s_add_u32 s37, s66, 4096
  BL4 v2, s[16:19], s37 offen sc1 lds
  s_waitcnt lgkmcnt(5)
  MF v[44:47], v[176:179], a[40:43], v[44:47]
  ds_read_b128 v[200:203], v5 offset:30720
  MF v[80:83], v[176:179], a[44:47], v[80:83]
  s_add_u32 s36, s44, 20480
  BL4 a[32:35], v6, s[16:19], s36 offen sc1
  s_waitcnt lgkmcnt(5)
  MF v[48:51], v[180:183], a[40:43], v[48:51]
  ds_read_b128 v[204:207], v5 offset:31744
  MF v[84:87], v[180:183], a[44:47], v[84:87]
  BL4 a[36:39], v7, s[16:19], s36 offen sc1
  s_waitcnt lgkmcnt(5)
  MF v[52:55], v[184:187], a[40:43], v[52:55]
  ds_read_b128 v[176:179], v5 offset:32768
  MF v[88:91], v[184:187], a[44:47], v[88:91]
  s_waitcnt lgkmcnt(5)
  MF v[56:59], v[188:191], a[40:43], v[56:59]
  ds_read_b128 v[180:183], v5 offset:33792
  MF v[92:95], v[188:191], a[44:47], v[92:95]
  s_waitcnt lgkmcnt(5)
  MF v[60:63], v[192:195], a[40:43], v[60:63]
  ds_read_b128 v[184:187], v5 offset:34816
  MF v[96:99], v[192:195], a[44:47], v[96:99]
  s_waitcnt lgkmcnt(5)
  MF v[64:67], v[196:199], a[40:43], v[64:67]
  ds_read_b128 v[188:191], v5 offset:35840
  MF v[100:103], v[196:199], a[44:47], v[100:103]
  s_waitcnt vmcnt(28) lgkmcnt(5)
  MF v[32:35], v[200:203], a[48:51], v[32:35]
  ds_read_b128 v[192:195], v5 offset:36864
  s_waitcnt vmcnt(27)
  MF v[68:71], v[200:203], a[52:55], v[68:71]
  BL4 v2, s[16:19], s37 offen offset:1024 sc1 lds
  s_waitcnt lgkmcnt(5)
  MF v[36:39], v[204:207], a[48:51], v[36:39]
  ds_read_b128 v[196:199], v5 offset:37888
  MF v[72:75], v[204:207], a[52:55], v[72:75]
  BL4 v2, s[16:19], s37 offen offset:2048 sc1 lds
  s_waitcnt lgkmcnt(5)
  MF v[40:43], v[176:179], a[48:51], v[40:43]
  ds_read_b128 v[200:203], v5 offset:38912
  MF v[76:79], v[176:179], a[52:55], v[76:79]
  BL4 v2, s[16:19], s37 offen offset:3072 sc1 lds
  s_waitcnt lgkmcnt(5)
  MF v[44:47], v[180:183], a[48:51], v[44:47]
  ds_read_b128 v[204:207], v5 offset:39936
  MF v[80:83], v[180:183], a[52:55], v[80:83]
  s_add_u32 s36, s44, 21504
  BL4 a[40:43], v6, s[16:19], s36 offen sc1
  s_waitcnt lgkmcnt(5)
  MF v[48:51], v[184:187], a[48:51], v[48:51]
  ds_read_b128 v[176:179], v5 offset:40960
  MF v[84:87], v[184:187], a[52:55], v[84:87]
  BL4 a[44:47], v7, s[16:19], s36 offen sc1
  s_waitcnt lgkmcnt(5)
  MF v[52:55], v[188:191], a[48:51], v[52:55]
  ds_read_b128 v[180:183], v5 offset:41984
  MF v[88:91], v[188:191], a[52:55], v[88:91]
  s_waitcnt lgkmcnt(5)
  MF v[56:59], v[192:195], a[48:51], v[56:59]
  ds_read_b128 v[184:187], v5 offset:43008
  MF v[92:95], v[192:195], a[52:55], v[92:95]
  s_waitcnt lgkmcnt(5)
  MF v[60:63], v[196:199], a[48:51], v[60:63]
  ds_read_b128 v[188:191], v5 offset:44032
  MF v[96:99], v[196:199], a[52:55], v[96:99]
  s_waitcnt lgkmcnt(5)
  MF v[64:67], v[200:203], a[48:51], v[64:67]
  ds_read_b128 v[192:195], v5 offset:45056
  MF v[100:103], v[200:203], a[52:55], v[100:103]
  s_waitcnt vmcnt(29) lgkmcnt(5)
  MF v[32:35], v[204:207], a[56:59], v[32:35]
  ds_read_b128 v[196:199], v5 offset:46080
  s_waitcnt vmcnt(28)
  MF v[68:71], v[204:207], a[60:63], v[68:71]
  s_add_u32 m0, s42, 45056
  s_add_u32 s37, s66, 8192
  BL4 v2, s[16:19], s37 offen sc1 lds
  s_waitcnt lgkmcnt(5)
  MF v[36:39], v[176:179], a[56:59], v[36:39]
  ds_read_b128 v[200:203], v5 offset:47104
  MF v[72:75], v[176:179], a[60:63], v[72:75]
  s_add_u32 s36, s44, 22528
  BL4 a[48:51], v6, s[16:19], s36 offen sc1
  s_waitcnt lgkmcnt(5)
  MF v[40:43], v[180:183], a[56:59], v[40:43]
  ds_read_b128 v[204:207], v5 offset:48128
  MF v[76:79], v[180:183], a[60:63], v[76:79]
  BL4 a[52:55], v7, s[16:19], s36 offen sc1
  s_waitcnt lgkmcnt(5)
  MF v[44:47], v[184:187], a[56:59], v[44:47]
  s_waitcnt vmcnt(20)
  s_barrier
  ds_read_b128 v[176:179], v3
  MF v[80:83], v[184:187], a[60:63], v[80:83]
  s_waitcnt lgkmcnt(5)
  MF v[48:51], v[188:191], a[56:59], v[48:51]
  ds_read_b128 v[180:183], v3 offset:1024
  MF v[84:87], v[188:191], a[60:63], v[84:87]
  s_waitcnt lgkmcnt(5)
  MF v[52:55], v[192:195], a[56:59], v[52:55]
  ds_read_b128 v[184:187], v3 offset:2048
  MF v[88:91], v[192:195], a[60:63], v[88:91]
  s_waitcnt lgkmcnt(5)
  MF v[56:59], v[196:199], a[56:59], v[56:59]
  ds_read_b128 v[188:191], v3 offset:3072
  MF v[92:95], v[196:199], a[60:63], v[92:95]
  s_waitcnt lgkmcnt(5)
  MF v[60:63], v[200:203], a[56:59], v[60:63]
  ds_read_b128 v[192:195], v3 offset:4096
  MF v[96:99], v[200:203], a[60:63], v[96:99]
  s_waitcnt lgkmcnt(5)
  MF v[64:67], v[204:207], a[56:59], v[64:67]
  ds_read_b128 v[196:199], v3 offset:5120
  MF v[100:103], v[204:207], a[60:63], v[100:103]
  s_waitcnt lgkmcnt(5)
  MF v[32:35], v[176:179], a[0:3], v[32:35]
  ds_read_b128 v[200:203], v3 offset:6144
  MF v[68:71], v[176:179], a[4:7], v[68:71]
  s_add_u32 s38, s61, 6
  s_sub_u32 s39, s38, 7
  s_cmp_ge_u32 s38, 7
  s_cselect_b32 s38, s39, s38
  s_lshl_b32 s64, s38, 2
  s_waitcnt lgkmcnt(5)
  MF v[36:39], v[180:183], a[0:3], v[36:39]
  ds_read_b128 v[204:207], v3 offset:7168
  MF v[72:75], v[180:183], a[4:7], v[72:75]
  s_mul_i32 s66, s64, 9216
  s_add_u32 s66, s66, s43
  s_add_u32 s66, s66, s42
  s_add_u32 m0, s42, 73728
  s_add_u32 s37, s66, 0
  BL4 v2, s[16:19], s37 offen sc1 lds
  s_waitcnt lgkmcnt(5)
  MF v[40:43], v[184:187], a[0:3], v[40:43]
  ds_read_b128 v[176:179], v3 offset:8192
  MF v[76:79], v[184:187], a[4:7], v[76:79]
  BL4 v2, s[16:19], s37 offen offset:1024 sc1 lds
  s_waitcnt lgkmcnt(5)
  MF v[44:47], v[188:191], a[0:3], v[44:47]
  ds_read_b128 v[180:183], v3 offset:9216
  MF v[80:83], v[188:191], a[4:7], v[80:83]
  s_add_u32 s36, s44, 23552
  BL4 a[56:59], v6, s[16:19], s36 offen sc1
  s_waitcnt lgkmcnt(5)
  MF v[48:51], v[192:195], a[0:3], v[48:51]
  ds_read_b128 v[184:187], v3 offset:10240
  MF v[84:87], v[192:195], a[4:7], v[84:87]
  BL4 a[60:63], v7, s[16:19], s36 offen sc1
  s_waitcnt lgkmcnt(5)
  MF v[52:55], v[196:199], a[0:3], v[52:55]
  ds_read_b128 v[188:191], v3 offset:11264
  MF v[88:91], v[196:199], a[4:7], v[88:91]
  s_waitcnt lgkmcnt(5)
  MF v[56:59], v[200:203], a[0:3], v[56:59]
  ds_read_b128 v[192:195], v3 offset:12288
  MF v[92:95], v[200:203], a[4:7], v[92:95]
  s_waitcnt lgkmcnt(5)
  MF v[60:63], v[204:207], a[0:3], v[60:63]
  ds_read_b128 v[196:199], v3 offset:13312
  MF v[96:99], v[204:207], a[4:7], v[96:99]
  s_waitcnt lgkmcnt(5)
  MF v[64:67], v[176:179], a[0:3], v[64:67]
  ds_read_b128 v[200:203], v3 offset:14336
  MF v[100:103], v[176:179], a[4:7], v[100:103]
  s_waitcnt lgkmcnt(5)
  MF v[32:35], v[180:183], a[8:11], v[32:35]
  ds_read_b128 v[204:207], v3 offset:15360
  MF v[68:71], v[180:183], a[12:15], v[68:71]
  BL4 v2, s[16:19], s37 offen offset:2048 sc1 lds
  s_waitcnt lgkmcnt(5)
  MF v[36:39], v[184:187], a[8:11], v[36:39]
  ds_read_b128 v[176:179], v3 offset:16384
  MF v[72:75], v[184:187], a[12:15], v[72:75]
  BL4 v2, s[16:19], s37 offen offset:3072 sc1 lds
  s_waitcnt lgkmcnt(5)
  MF v[40:43], v[188:191], a[8:11], v[40:43]
  ds_read_b128 v[180:183], v3 offset:17408
  MF v[76:79], v[188:191], a[12:15], v[76:79]
  s_add_u32 m0, s42, 77824
  s_add_u32 s37, s66, 4096
  BL4 v2, s[16:19], s37 offen sc1 lds
  s_waitcnt lgkmcnt(5)
  MF v[44:47], v[192:195], a[8:11], v[44:47]
  ds_read_b128 v[184:187], v3 offset:18432
  MF v[80:83], v[192:195], a[12:15], v[80:83]
  s_add_u32 s36, s44, 24576
  BL4 a[0:3], v6, s[16:19], s36 offen sc1
  s_waitcnt lgkmcnt(5)
  MF v[48:51], v[196:199], a[8:11], v[48:51]
  ds_read_b128 v[188:191], v3 offset:19456
  MF v[84:87], v[196:199], a[12:15], v[84:87]
  BL4 a[4:7], v7, s[16:19], s36 offen sc1
  s_waitcnt lgkmcnt(5)
  MF v[52:55], v[200:203], a[8:11], v[52:55]
  ds_read_b128 v[192:195], v3 offset:20480
  MF v[88:91], v[200:203], a[12:15], v[88:91]
  s_waitcnt lgkmcnt(5)
  MF v[56:59], v[204:207], a[8:11], v[56:59]
  ds_read_b128 v[196:199], v3 offset:21504
  MF v[92:95], v[204:207], a[12:15], v[92:95]
  s_waitcnt lgkmcnt(5)
  MF v[60:63], v[176:179], a[8:11], v[60:63]
  ds_read_b128 v[200:203], v3 offset:22528
  MF v[96:99], v[176:179], a[12:15], v[96:99]
  s_waitcnt lgkmcnt(5)
  MF v[64:67], v[180:183], a[8:11], v[64:67]
  ds_read_b128 v[204:207], v3 offset:23552
  MF v[100:103], v[180:183], a[12:15], v[100:103]
  s_waitcnt vmcnt(28) lgkmcnt(5)
  MF v[32:35], v[184:187], a[16:19], v[32:35]
  ds_read_b128 v[176:179], v3 offset:24576
  s_waitcnt vmcnt(27)
  MF v[68:71], v[184:187], a[20:23], v[68:71]
  BL4 v2, s[16:19], s37 offen offset:1024 sc1 lds
  s_waitcnt lgkmcnt(5)
  MF v[36:39], v[188:191], a[16:19], v[36:39]
  ds_read_b128 v[180:183], v3 offset:25600
  MF v[72:75], v[188:191], a[20:23], v[72:75]
  BL4 v2, s[16:19], s37 offen offset:2048 sc1 lds
  s_waitcnt lgkmcnt(5)
  MF v[40:43], v[192:195], a[16:19], v[40:43]
  ds_read_b128 v[184:187], v3 offset:26624
  MF v[76:79], v[192:195], a[20:23], v[76:79]
  BL4 v2, s[16:19], s37 offen offset:3072 sc1 lds
  s_waitcnt lgkmcnt(5)
  MF v[44:47], v[196:199], a[16:19], v[44:47]
  ds_read_b128 v[188:191], v3 offset:27648
  MF v[80:83], v[196:199], a[20:23], v[80:83]
  s_add_u32 s36, s44, 25600
  BL4 a[8:11], v6, s[16:19], s36 offen sc1
  s_waitcnt lgkmcnt(5)
  MF v[48:51], v[200:203], a[16:19], v[48:51]
  ds_read_b128 v[192:195], v3 offset:28672
  MF v[84:87], v[200:203], a[20:23], v[84:87]
  BL4 a[12:15], v7, s[16:19], s36 offen sc1
  s_waitcnt lgkmcnt(5)
  MF v[52:55], v[204:207], a[16:19], v[52:55]
  ds_read_b128 v[196:199], v3 offset:29696
  MF v[88:91], v[204:207], a[20:23], v[88:91]
  s_waitcnt lgkmcnt(5)
  MF v[56:59], v[176:179], a[16:19], v[56:59]
  ds_read_b128 v[200:203], v3 offset:30720
  MF v[92:95], v[176:179], a[20:23], v[92:95]
  s_waitcnt lgkmcnt(5)
  MF v[60:63], v[180:183], a[16:19], v[60:63]
  ds_read_b128 v[204:207], v3 offset:31744
  MF v[96:99], v[180:183], a[20:23], v[96:99]
  s_waitcnt lgkmcnt(5)
  MF v[64:67], v[184:187], a[16:19], v[64:67]
  ds_read_b128 v[176:179], v3 offset:32768
  MF v[100:103], v[184:187], a[20:23], v[100:103]
  s_cmp_eq_u32 s32, 0
  s_cselect_b32 s41, 255, 0
  s_mov_b32 s40, 262144
POLLB7:
  s_waitcnt vmcnt(29)
  v_cmp_eq_u32 vcc, 1, v17
  s_nop 1
  s_and_b32 s38, vcc_lo, s41
  s_cmp_eq_u32 s38, s41
  s_cbranch_scc1 POLLEDB7
  s_sub_u32 s40, s40, 1
  s_cbranch_scc1 POLLEDB7
  s_sleep 2
  buffer_load_dword v17, v13, s[16:19], 0 offen sc1
  s_waitcnt vmcnt(0)
  s_branch POLLB7
POLLEDB7:
  s_waitcnt vmcnt(28) lgkmcnt(5)
  MF v[32:35], v[188:191], a[24:27], v[32:35]
  ds_read_b128 v[180:183], v3 offset:33792
  s_waitcnt vmcnt(27)
  MF v[68:71], v[188:191], a[28:31], v[68:71]
  s_add_u32 m0, s42, 81920
  s_add_u32 s37, s66, 8192
  BL4 v2, s[16:19], s37 offen sc1 lds
  s_waitcnt lgkmcnt(5)
  MF v[36:39], v[192:195], a[24:27], v[36:39]
  ds_read_b128 v[184:187], v3 offset:34816
  MF v[72:75], v[192:195], a[28:31], v[72:75]
  s_add_u32 s36, s44, 26624
  BL4 a[16:19], v6, s[16:19], s36 offen sc1
  s_waitcnt lgkmcnt(5)
  MF v[40:43], v[196:199], a[24:27], v[40:43]
  ds_read_b128 v[188:191], v3 offset:35840
  MF v[76:79], v[196:199], a[28:31], v[76:79]
  BL4 a[20:23], v7, s[16:19], s36 offen sc1
  s_waitcnt lgkmcnt(5)
  MF v[44:47], v[200:203], a[24:27], v[44:47]
  s_waitcnt vmcnt(19)
  s_barrier
  ds_read_b128 v[192:195], v3 offset:36864
  MF v[80:83], v[200:203], a[28:31], v[80:83]
  s_waitcnt lgkmcnt(5)
  MF v[48:51], v[204:207], a[24:27], v[48:51]
  ds_read_b128 v[196:199], v3 offset:37888
  MF v[84:87], v[204:207], a[28:31], v[84:87]
  s_waitcnt lgkmcnt(5)
  MF v[52:55], v[176:179], a[24:27], v[52:55]
  ds_read_b128 v[200:203], v3 offset:38912
  MF v[88:91], v[176:179], a[28:31], v[88:91]
  s_waitcnt lgkmcnt(5)
  MF v[56:59], v[180:183], a[24:27], v[56:59]
  ds_read_b128 v[204:207], v3 offset:39936
  MF v[92:95], v[180:183], a[28:31], v[92:95]
  s_waitcnt lgkmcnt(5)
  MF v[60:63], v[184:187], a[24:27], v[60:63]
  ds_read_b128 v[176:179], v3 offset:40960
  MF v[96:99], v[184:187], a[28:31], v[96:99]
  s_waitcnt lgkmcnt(5)
  MF v[64:67], v[188:191], a[24:27], v[64:67]
  ds_read_b128 v[180:183], v3 offset:41984
  MF v[100:103], v[188:191], a[28:31], v[100:103]
  s_waitcnt lgkmcnt(5)
  MF v[32:35], v[192:195], a[32:35], v[32:35]
  ds_read_b128 v[184:187], v3 offset:43008
  MF v[68:71], v[192:195], a[36:39], v[68:71]
  s_mov_b32 s65, 28
  s_waitcnt lgkmcnt(5)
  MF v[36:39], v[196:199], a[32:35], v[36:39]
  ds_read_b128 v[188:191], v3 offset:44032
  MF v[72:75], v[196:199], a[36:39], v[72:75]
  s_mul_i32 s66, s65, 9216
  s_add_u32 s66, s66, s43
  s_add_u32 s66, s66, s42
  s_add_u32 m0, s42, 110592
  s_add_u32 s37, s66, 0
  BL4 v2, s[16:19], s37 offen sc1 lds
  s_waitcnt lgkmcnt(5)
  MF v[40:43], v[200:203], a[32:35], v[40:43]
  ds_read_b128 v[192:195], v3 offset:45056
  MF v[76:79], v[200:203], a[36:39], v[76:79]
  BL4 v2, s[16:19], s37 offen offset:1024 sc1 lds
  s_waitcnt lgkmcnt(5)
  MF v[44:47], v[204:207], a[32:35], v[44:47]
  ds_read_b128 v[196:199], v3 offset:46080
  MF v[80:83], v[204:207], a[36:39], v[80:83]
  s_add_u32 s36, s44, 27648
  BL4 a[24:27], v6, s[16:19], s36 offen sc1
  s_waitcnt lgkmcnt(5)
  MF v[48:51], v[176:179], a[32:35], v[48:51]
  ds_read_b128 v[200:203], v3 offset:47104
  MF v[84:87], v[176:179], a[36:39], v[84:87]
  BL4 a[28:31], v7, s[16:19], s36 offen sc1
  s_waitcnt lgkmcnt(5)
  MF v[52:55], v[180:183], a[32:35], v[52:55]
  ds_read_b128 v[204:207], v3 offset:48128
  MF v[88:91], v[180:183], a[36:39], v[88:91]
  s_waitcnt lgkmcnt(5)
  MF v[56:59], v[184:187], a[32:35], v[56:59]
  ds_read_b128 v[176:179], v4
  MF v[92:95], v[184:187], a[36:39], v[92:95]
  s_waitcnt lgkmcnt(5)
  MF v[60:63], v[188:191], a[32:35], v[60:63]
  ds_read_b128 v[180:183], v4 offset:1024
  MF v[96:99], v[188:191], a[36:39], v[96:99]
  s_waitcnt lgkmcnt(5)
  MF v[64:67], v[192:195], a[32:35], v[64:67]
  ds_read_b128 v[184:187], v4 offset:2048
  MF v[100:103], v[192:195], a[36:39], v[100:103]
  s_waitcnt lgkmcnt(5)
  MF v[32:35], v[196:199], a[40:43], v[32:35]
  ds_read_b128 v[188:191], v4 offset:3072
  MF v[68:71], v[196:199], a[44:47], v[68:71]
  BL4 v2, s[16:19], s37 offen offset:2048 sc1 lds
  s_waitcnt lgkmcnt(5)
  MF v[36:39], v[200:203], a[40:43], v[36:39]
  ds_read_b128 v[192:195], v4 offset:4096
  MF v[72:75], v[200:203], a[44:47], v[72:75]
  BL4 v2, s[16:19], s37 offen offset:3072 sc1 lds
  s_waitcnt lgkmcnt(5)
  MF v[40:43], v[204:207], a[40:43], v[40:43]
  ds_read_b128 v[196:199], v4 offset:5120
  MF v[76:79], v[204:207], a[44:47], v[76:79]
  s_add_u32 m0, s42, 114688
  s_add_u32 s37, s66, 4096
  BL4 v2, s[16:19], s37 offen sc1 lds
  s_waitcnt lgkmcnt(5)
  MF v[44:47], v[176:179], a[40:43], v[44:47]
  ds_read_b128 v[200:203], v4 offset:6144
  MF v[80:83], v[176:179], a[44:47], v[80:83]
  s_add_u32 s36, s44, 28672
  BL4 a[32:35], v6, s[16:19], s36 offen sc1
  s_waitcnt lgkmcnt(5)
  MF v[48:51], v[180:183], a[40:43], v[48:51]
  ds_read_b128 v[204:207], v4 offset:7168
  MF v[84:87], v[180:183], a[44:47], v[84:87]
  BL4 a[36:39], v7, s[16:19], s36 offen sc1
  s_waitcnt lgkmcnt(5)
  MF v[52:55], v[184:187], a[40:43], v[52:55]
  ds_read_b128 v[176:179], v4 offset:8192
  MF v[88:91], v[184:187], a[44:47], v[88:91]
  s_waitcnt lgkmcnt(5)
  MF v[56:59], v[188:191], a[40:43], v[56:59]
  ds_read_b128 v[180:183], v4 offset:9216
  MF v[92:95], v[188:191], a[44:47], v[92:95]
  s_waitcnt lgkmcnt(5)
  MF v[60:63], v[192:195], a[40:43], v[60:63]
  ds_read_b128 v[184:187], v4 offset:10240
  MF v[96:99], v[192:195], a[44:47], v[96:99]
  s_waitcnt lgkmcnt(5)
  MF v[64:67], v[196:199], a[40:43], v[64:67]
  ds_read_b128 v[188:191], v4 offset:11264
  MF v[100:103], v[196:199], a[44:47], v[100:103]
  s_waitcnt vmcnt(27) lgkmcnt(5)
  MF v[32:35], v[200:203], a[48:51], v[32:35]
  ds_read_b128 v[192:195], v4 offset:12288
  s_waitcnt vmcnt(26)
  MF v[68:71], v[200:203], a[52:55], v[68:71]
  BL4 v2, s[16:19], s37 offen offset:1024 sc1 lds
  s_waitcnt lgkmcnt(5)
  MF v[36:39], v[204:207], a[48:51], v[36:39]
  ds_read_b128 v[196:199], v4 offset:13312
  MF v[72:75], v[204:207], a[52:55], v[72:75]
  BL4 v2, s[16:19], s37 offen offset:2048 sc1 lds
  s_waitcnt lgkmcnt(5)
  MF v[40:43], v[176:179], a[48:51], v[40:43]
  ds_read_b128 v[200:203], v4 offset:14336
  MF v[76:79], v[176:179], a[52:55], v[76:79]
  BL4 v2, s[16:19], s37 offen offset:3072 sc1 lds
  s_waitcnt lgkmcnt(5)
  MF v[44:47], v[180:183], a[48:51], v[44:47]
  ds_read_b128 v[204:207], v4 offset:15360
  MF v[80:83], v[180:183], a[52:55], v[80:83]
  s_add_u32 s36, s44, 29696
  BL4 a[40:43], v6, s[16:19], s36 offen sc1
  s_waitcnt lgkmcnt(5)
  MF v[48:51], v[184:187], a[48:51], v[48:51]
  ds_read_b128 v[176:179], v4 offset:16384
  MF v[84:87], v[184:187], a[52:55], v[84:87]
  BL4 a[44:47], v7, s[16:19], s36 offen sc1
  s_waitcnt lgkmcnt(5)
  MF v[52:55], v[188:191], a[48:51], v[52:55]
  ds_read_b128 v[180:183], v4 offset:17408
  MF v[88:91], v[188:191], a[52:55], v[88:91]
  s_waitcnt lgkmcnt(5)
  MF v[56:59], v[192:195], a[48:51], v[56:59]
  ds_read_b128 v[184:187], v4 offset:18432
  MF v[92:95], v[192:195], a[52:55], v[92:95]
  s_waitcnt lgkmcnt(5)
  MF v[60:63], v[196:199], a[48:51], v[60:63]
  ds_read_b128 v[188:191], v4 offset:19456
  MF v[96:99], v[196:199], a[52:55], v[96:99]
  s_waitcnt lgkmcnt(5)
  MF v[64:67], v[200:203], a[48:51], v[64:67]
  ds_read_b128 v[192:195], v4 offset:20480
  MF v[100:103], v[200:203], a[52:55], v[100:103]
  s_waitcnt vmcnt(28) lgkmcnt(5)
  MF v[32:35], v[204:207], a[56:59], v[32:35]
  ds_read_b128 v[196:199], v4 offset:21504
  s_waitcnt vmcnt(27)
  MF v[68:71], v[204:207], a[60:63], v[68:71]
  s_add_u32 m0, s42, 118784
  s_add_u32 s37, s66, 8192
  BL4 v2, s[16:19], s37 offen sc1 lds
  s_waitcnt lgkmcnt(5)
  MF v[36:39], v[176:179], a[56:59], v[36:39]
  ds_read_b128 v[200:203], v4 offset:22528
  MF v[72:75], v[176:179], a[60:63], v[72:75]
  s_add_u32 s36, s44, 30720
  BL4 a[48:51], v6, s[16:19], s36 offen sc1
  s_waitcnt lgkmcnt(5)
  MF v[40:43], v[180:183], a[56:59], v[40:43]
  ds_read_b128 v[204:207], v4 offset:23552
  MF v[76:79], v[180:183], a[60:63], v[76:79]
  BL4 a[52:55], v7, s[16:19], s36 offen sc1
  s_waitcnt lgkmcnt(5)
  MF v[44:47], v[184:187], a[56:59], v[44:47]
  s_waitcnt vmcnt(19)
  s_barrier
  ds_read_b128 v[176:179], v4 offset:24576
  MF v[80:83], v[184:187], a[60:63], v[80:83]
  s_waitcnt lgkmcnt(5)
  MF v[48:51], v[188:191], a[56:59], v[48:51]
  ds_read_b128 v[180:183], v4 offset:25600
  MF v[84:87], v[188:191], a[60:63], v[84:87]
  s_waitcnt lgkmcnt(5)
  MF v[52:55], v[192:195], a[56:59], v[52:55]
  ds_read_b128 v[184:187], v4 offset:26624
  MF v[88:91], v[192:195], a[60:63], v[88:91]
  s_waitcnt lgkmcnt(5)
  MF v[56:59], v[196:199], a[56:59], v[56:59]
  ds_read_b128 v[188:191], v4 offset:27648
  MF v[92:95], v[196:199], a[60:63], v[92:95]
  s_waitcnt lgkmcnt(5)
  MF v[60:63], v[200:203], a[56:59], v[60:63]
  ds_read_b128 v[192:195], v4 offset:28672
  MF v[96:99], v[200:203], a[60:63], v[96:99]
  s_waitcnt lgkmcnt(5)
  MF v[64:67], v[204:207], a[56:59], v[64:67]
  ds_read_b128 v[196:199], v4 offset:29696
  MF v[100:103], v[204:207], a[60:63], v[100:103]
  s_waitcnt lgkmcnt(5)
  MF v[32:35], v[176:179], a[0:3], v[32:35]
  ds_read_b128 v[200:203], v4 offset:30720
  MF v[68:71], v[176:179], a[4:7], v[68:71]
  s_mov_b32 s62, 32
  s_waitcnt lgkmcnt(5)
  MF v[36:39], v[180:183], a[0:3], v[36:39]
  ds_read_b128 v[204:207], v4 offset:31744
  MF v[72:75], v[180:183], a[4:7], v[72:75]
  s_mul_i32 s66, s62, 9216
  s_add_u32 s66, s66, s43
  s_add_u32 s66, s66, s42
  s_add_u32 m0, s42, 0
  s_add_u32 s37, s66, 0
  BL4 v2, s[16:19], s37 offen sc1 lds
  s_waitcnt lgkmcnt(5)
  MF v[40:43], v[184:187], a[0:3], v[40:43]
  ds_read_b128 v[176:179], v4 offset:32768
  MF v[76:79], v[184:187], a[4:7], v[76:79]
  BL4 v2, s[16:19], s37 offen offset:1024 sc1 lds
  s_waitcnt lgkmcnt(5)
  MF v[44:47], v[188:191], a[0:3], v[44:47]
  ds_read_b128 v[180:183], v4 offset:33792
  MF v[80:83], v[188:191], a[4:7], v[80:83]
  s_add_u32 s36, s44, 31744
  BL4 a[56:59], v6, s[16:19], s36 offen sc1
  s_waitcnt lgkmcnt(5)
  MF v[48:51], v[192:195], a[0:3], v[48:51]
  ds_read_b128 v[184:187], v4 offset:34816
  MF v[84:87], v[192:195], a[4:7], v[84:87]
  BL4 a[60:63], v7, s[16:19], s36 offen sc1
  s_waitcnt lgkmcnt(5)
  MF v[52:55], v[196:199], a[0:3], v[52:55]
  ds_read_b128 v[188:191], v4 offset:35840
  MF v[88:91], v[196:199], a[4:7], v[88:91]
  s_waitcnt lgkmcnt(5)
  MF v[56:59], v[200:203], a[0:3], v[56:59]
  ds_read_b128 v[192:195], v4 offset:36864
  MF v[92:95], v[200:203], a[4:7], v[92:95]
  s_waitcnt lgkmcnt(5)
  MF v[60:63], v[204:207], a[0:3], v[60:63]
  ds_read_b128 v[196:199], v4 offset:37888
  MF v[96:99], v[204:207], a[4:7], v[96:99]
  s_waitcnt lgkmcnt(5)
  MF v[64:67], v[176:179], a[0:3], v[64:67]
  ds_read_b128 v[200:203], v4 offset:38912
  MF v[100:103], v[176:179], a[4:7], v[100:103]
  s_waitcnt lgkmcnt(5)
  MF v[32:35], v[180:183], a[8:11], v[32:35]
  ds_read_b128 v[204:207], v4 offset:39936
  MF v[68:71], v[180:183], a[12:15], v[68:71]
  BL4 v2, s[16:19], s37 offen offset:2048 sc1 lds
  s_waitcnt lgkmcnt(5)
  MF v[36:39], v[184:187], a[8:11], v[36:39]
  ds_read_b128 v[176:179], v4 offset:40960
  MF v[72:75], v[184:187], a[12:15], v[72:75]
  BL4 v2, s[16:19], s37 offen offset:3072 sc1 lds
  s_waitcnt lgkmcnt(5)
  MF v[40:43], v[188:191], a[8:11], v[40:43]
  ds_read_b128 v[180:183], v4 offset:41984
  MF v[76:79], v[188:191], a[12:15], v[76:79]
  s_add_u32 m0, s42, 4096
  s_add_u32 s37, s66, 4096
  BL4 v2, s[16:19], s37 offen sc1 lds
  s_waitcnt lgkmcnt(5)
  MF v[44:47], v[192:195], a[8:11], v[44:47]
  ds_read_b128 v[184:187], v4 offset:43008
  MF v[80:83], v[192:195], a[12:15], v[80:83]
  s_add_u32 s36, s44, 32768
  BL4 a[0:3], v6, s[16:19], s36 offen sc1
  s_waitcnt lgkmcnt(5)
  MF v[48:51], v[196:199], a[8:11], v[48:51]
  ds_read_b128 v[188:191], v4 offset:44032
  MF v[84:87], v[196:199], a[12:15], v[84:87]
  BL4 a[4:7], v7, s[16:19], s36 offen sc1
  s_waitcnt lgkmcnt(5)
  MF v[52:55], v[200:203], a[8:11], v[52:55]
  ds_read_b128 v[192:195], v4 offset:45056
  MF v[88:91], v[200:203], a[12:15], v[88:91]
  s_waitcnt lgkmcnt(5)
  MF v[56:59], v[204:207], a[8:11], v[56:59]
  ds_read_b128 v[196:199], v4 offset:46080
  MF v[92:95], v[204:207], a[12:15], v[92:95]
  s_waitcnt lgkmcnt(5)
  MF v[60:63], v[176:179], a[8:11], v[60:63]
  ds_read_b128 v[200:203], v4 offset:47104
  MF v[96:99], v[176:179], a[12:15], v[96:99]
  s_waitcnt lgkmcnt(5)
  MF v[64:67], v[180:183], a[8:11], v[64:67]
  ds_read_b128 v[204:207], v4 offset:48128
  MF v[100:103], v[180:183], a[12:15], v[100:103]
  s_waitcnt vmcnt(27) lgkmcnt(5)
  MF v[32:35], v[184:187], a[16:19], v[32:35]
  ds_read_b128 v[176:179], v5
  s_waitcnt vmcnt(26)
  MF v[68:71], v[184:187], a[20:23], v[68:71]
  BL4 v2, s[16:19], s37 offen offset:1024 sc1 lds
  s_waitcnt lgkmcnt(5)
  MF v[36:39], v[188:191], a[16:19], v[36:39]
  ds_read_b128 v[180:183], v5 offset:1024
  MF v[72:75], v[188:191], a[20:23], v[72:75]
  BL4 v2, s[16:19], s37 offen offset:2048 sc1 lds
  s_waitcnt lgkmcnt(5)
  MF v[40:43], v[192:195], a[16:19], v[40:43]
  ds_read_b128 v[184:187], v5 offset:2048
  MF v[76:79], v[192:195], a[20:23], v[76:79]
  BL4 v2, s[16:19], s37 offen offset:3072 sc1 lds
  s_waitcnt lgkmcnt(5)
  MF v[44:47], v[196:199], a[16:19], v[44:47]
  ds_read_b128 v[188:191], v5 offset:3072
  MF v[80:83], v[196:199], a[20:23], v[80:83]
  s_add_u32 s36, s44, 33792
  BL4 a[8:11], v6, s[16:19], s36 offen sc1
  s_waitcnt lgkmcnt(5)
  MF v[48:51], v[200:203], a[16:19], v[48:51]
  ds_read_b128 v[192:195], v5 offset:4096
  MF v[84:87], v[200:203], a[20:23], v[84:87]
  BL4 a[12:15], v7, s[16:19], s36 offen sc1
  s_waitcnt lgkmcnt(5)
  MF v[52:55], v[204:207], a[16:19], v[52:55]
  ds_read_b128 v[196:199], v5 offset:5120
  MF v[88:91], v[204:207], a[20:23], v[88:91]
  s_waitcnt lgkmcnt(5)
  MF v[56:59], v[176:179], a[16:19], v[56:59]
  ds_read_b128 v[200:203], v5 offset:6144
  MF v[92:95], v[176:179], a[20:23], v[92:95]
  s_waitcnt lgkmcnt(5)
  MF v[60:63], v[180:183], a[16:19], v[60:63]
  ds_read_b128 v[204:207], v5 offset:7168
  MF v[96:99], v[180:183], a[20:23], v[96:99]
  s_waitcnt lgkmcnt(5)
  MF v[64:67], v[184:187], a[16:19], v[64:67]
  ds_read_b128 v[176:179], v5 offset:8192
  MF v[100:103], v[184:187], a[20:23], v[100:103]
  s_waitcnt vmcnt(28) lgkmcnt(5)
  MF v[32:35], v[188:191], a[24:27], v[32:35]
  ds_read_b128 v[180:183], v5 offset:9216
  s_waitcnt vmcnt(27)
  MF v[68:71], v[188:191], a[28:31], v[68:71]
  s_add_u32 m0, s42, 8192
  s_add_u32 s37, s66, 8192
  BL4 v2, s[16:19], s37 offen sc1 lds
  s_waitcnt lgkmcnt(5)
  MF v[36:39], v[192:195], a[24:27], v[36:39]
  ds_read_b128 v[184:187], v5 offset:10240
  MF v[72:75], v[192:195], a[28:31], v[72:75]
  s_add_u32 s36, s44, 34816
  BL4 a[16:19], v6, s[16:19], s36 offen sc1
  s_waitcnt lgkmcnt(5)
  MF v[40:43], v[196:199], a[24:27], v[40:43]
  ds_read_b128 v[188:191], v5 offset:11264
  MF v[76:79], v[196:199], a[28:31], v[76:79]
  BL4 a[20:23], v7, s[16:19], s36 offen sc1
  s_waitcnt lgkmcnt(5)
  MF v[44:47], v[200:203], a[24:27], v[44:47]
  s_waitcnt vmcnt(19)
  s_barrier
  ds_read_b128 v[192:195], v5 offset:12288
  MF v[80:83], v[200:203], a[28:31], v[80:83]
  s_waitcnt lgkmcnt(5)
  MF v[48:51], v[204:207], a[24:27], v[48:51]
  ds_read_b128 v[196:199], v5 offset:13312
  MF v[84:87], v[204:207], a[28:31], v[84:87]
  s_waitcnt lgkmcnt(5)
  MF v[52:55], v[176:179], a[24:27], v[52:55]
  ds_read_b128 v[200:203], v5 offset:14336
  MF v[88:91], v[176:179], a[28:31], v[88:91]
  s_waitcnt lgkmcnt(5)
  MF v[56:59], v[180:183], a[24:27], v[56:59]
  ds_read_b128 v[204:207], v5 offset:15360
  MF v[92:95], v[180:183], a[28:31], v[92:95]
  s_waitcnt lgkmcnt(5)
  MF v[60:63], v[184:187], a[24:27], v[60:63]
  ds_read_b128 v[176:179], v5 offset:16384
  MF v[96:99], v[184:187], a[28:31], v[96:99]
  s_waitcnt lgkmcnt(5)
  MF v[64:67], v[188:191], a[24:27], v[64:67]
  ds_read_b128 v[180:183], v5 offset:17408
  MF v[100:103], v[188:191], a[28:31], v[100:103]
  s_waitcnt lgkmcnt(5)
  MF v[104:107], v[192:195], a[32:35], 0
  ds_read_b128 v[184:187], v5 offset:18432
  MF v[140:143], v[192:195], a[36:39], 0
  s_mov_b32 s63, 36
  s_waitcnt lgkmcnt(5)
  MF v[108:111], v[196:199], a[32:35], 0
  ds_read_b128 v[188:191], v5 offset:19456
  MF v[144:147], v[196:199], a[36:39], 0
  s_mul_i32 s66, s63, 9216
  s_add_u32 s66, s66, s43
  s_add_u32 s66, s66, s42
  s_add_u32 m0, s42, 36864
  s_add_u32 s37, s66, 0
  BL4 v2, s[16:19], s37 offen sc1 lds
  s_waitcnt lgkmcnt(5)
  MF v[112:115], v[200:203], a[32:35], 0
  ds_read_b128 v[192:195], v5 offset:20480
  MF v[148:151], v[200:203], a[36:39], 0
  BL4 v2, s[16:19], s37 offen offset:1024 sc1 lds
  s_waitcnt lgkmcnt(5)
  MF v[116:119], v[204:207], a[32:35], 0
  ds_read_b128 v[196:199], v5 offset:21504
  MF v[152:155], v[204:207], a[36:39], 0
  s_add_u32 s36, s44, 35840
  BL4 a[24:27], v6, s[16:19], s36 offen sc1
  s_waitcnt lgkmcnt(5)
  MF v[120:123], v[176:179], a[32:35], 0
  ds_read_b128 v[200:203], v5 offset:22528
  MF v[156:159], v[176:179], a[36:39], 0
  BL4 a[28:31], v7, s[16:19], s36 offen sc1
  s_waitcnt lgkmcnt(5)
  MF v[124:127], v[180:183], a[32:35], 0
  ds_read_b128 v[204:207], v5 offset:23552
  MF v[160:163], v[180:183], a[36:39], 0
  s_waitcnt lgkmcnt(5)
  MF v[128:131], v[184:187], a[32:35], 0
  ds_read_b128 v[176:179], v5 offset:24576
  MF v[164:167], v[184:187], a[36:39], 0
  s_waitcnt lgkmcnt(5)
  MF v[132:135], v[188:191], a[32:35], 0
  ds_read_b128 v[180:183], v5 offset:25600
  MF v[168:171], v[188:191], a[36:39], 0
  s_waitcnt lgkmcnt(5)
  MF v[136:139], v[192:195], a[32:35], 0
  ds_read_b128 v[184:187], v5 offset:26624
  MF v[172:175], v[192:195], a[36:39], 0
  s_waitcnt lgkmcnt(5)
  MF v[104:107], v[196:199], a[40:43], v[104:107]
  ds_read_b128 v[188:191], v5 offset:27648
  MF v[140:143], v[196:199], a[44:47], v[140:143]
  BL4 v2, s[16:19], s37 offen offset:2048 sc1 lds
  s_waitcnt lgkmcnt(5)
  MF v[108:111], v[200:203], a[40:43], v[108:111]
  ds_read_b128 v[192:195], v5 offset:28672
  MF v[144:147], v[200:203], a[44:47], v[144:147]
  BL4 v2, s[16:19], s37 offen offset:3072 sc1 lds
  s_waitcnt lgkmcnt(5)
  MF v[112:115], v[204:207], a[40:43], v[112:115]
  ds_read_b128 v[196:199], v5 offset:29696
  MF v[148:151], v[204:207], a[44:47], v[148:151]
  s_add_u32 m0, s42, 40960
  s_add_u32 s37, s66, 4096
  BL4 v2, s[16:19], s37 offen sc1 lds
  s_waitcnt lgkmcnt(5)
  MF v[116:119], v[176:179], a[40:43], v[116:119]
  ds_read_b128 v[200:203], v5 offset:30720
  MF v[152:155], v[176:179], a[44:47], v[152:155]
  s_add_u32 s36, s44, 36864
  BL4 a[32:35], v6, s[16:19], s36 offen sc1
  s_waitcnt lgkmcnt(5)
  MF v[120:123], v[180:183], a[40:43], v[120:123]
  ds_read_b128 v[204:207], v5 offset:31744
  MF v[156:159], v[180:183], a[44:47], v[156:159]
  BL4 a[36:39], v7, s[16:19], s36 offen sc1
  s_waitcnt lgkmcnt(5)
  MF v[124:127], v[184:187], a[40:43], v[124:127]
  ds_read_b128 v[176:179], v5 offset:32768
  MF v[160:163], v[184:187], a[44:47], v[160:163]
  s_waitcnt lgkmcnt(5)
  MF v[128:131], v[188:191], a[40:43], v[128:131]
  ds_read_b128 v[180:183], v5 offset:33792
  MF v[164:167], v[188:191], a[44:47], v[164:167]
  s_waitcnt lgkmcnt(5)
  MF v[132:135], v[192:195], a[40:43], v[132:135]
  ds_read_b128 v[184:187], v5 offset:34816
  MF v[168:171], v[192:195], a[44:47], v[168:171]
  s_waitcnt lgkmcnt(5)
  MF v[136:139], v[196:199], a[40:43], v[136:139]
  ds_read_b128 v[188:191], v5 offset:35840
  MF v[172:175], v[196:199], a[44:47], v[172:175]
  s_waitcnt vmcnt(27) lgkmcnt(5)
  MF v[104:107], v[200:203], a[48:51], v[104:107]
  ds_read_b128 v[192:195], v5 offset:36864
  s_waitcnt vmcnt(26)
  MF v[140:143], v[200:203], a[52:55], v[140:143]
  BL4 v2, s[16:19], s37 offen offset:1024 sc1 lds
  s_waitcnt lgkmcnt(5)
  MF v[108:111], v[204:207], a[48:51], v[108:111]
  ds_read_b128 v[196:199], v5 offset:37888
  MF v[144:147], v[204:207], a[52:55], v[144:147]
  BL4 v2, s[16:19], s37 offen offset:2048 sc1 lds
  s_waitcnt lgkmcnt(5)
  MF v[112:115], v[176:179], a[48:51], v[112:115]
  ds_read_b128 v[200:203], v5 offset:38912
  MF v[148:151], v[176:179], a[52:55], v[148:151]
  BL4 v2, s[16:19], s37 offen offset:3072 sc1 lds
  s_waitcnt lgkmcnt(5)
  MF v[116:119], v[180:183], a[48:51], v[116:119]
  ds_read_b128 v[204:207], v5 offset:39936
  MF v[152:155], v[180:183], a[52:55], v[152:155]
  s_add_u32 s36, s44, 37888
  BL4 a[40:43], v6, s[16:19], s36 offen sc1
  s_waitcnt lgkmcnt(5)
  MF v[120:123], v[184:187], a[48:51], v[120:123]
  ds_read_b128 v[176:179], v5 offset:40960
  MF v[156:159], v[184:187], a[52:55], v[156:159]
  BL4 a[44:47], v7, s[16:19], s36 offen sc1
  s_waitcnt lgkmcnt(5)
  MF v[124:127], v[188:191], a[48:51], v[124:127]
  ds_read_b128 v[180:183], v5 offset:41984
  MF v[160:163], v[188:191], a[52:55], v[160:163]
  s_waitcnt lgkmcnt(5)
  MF v[128:131], v[192:195], a[48:51], v[128:131]
  ds_read_b128 v[184:187], v5 offset:43008
  MF v[164:167], v[192:195], a[52:55], v[164:167]
  s_waitcnt lgkmcnt(5)
  MF v[132:135], v[196:199], a[48:51], v[132:135]
  ds_read_b128 v[188:191], v5 offset:44032
  MF v[168:171], v[196:199], a[52:55], v[168:171]
  s_waitcnt lgkmcnt(5)
  MF v[136:139], v[200:203], a[48:51], v[136:139]
  ds_read_b128 v[192:195], v5 offset:45056
  MF v[172:175], v[200:203], a[52:55], v[172:175]
  s_waitcnt vmcnt(28) lgkmcnt(5)
  MF v[104:107], v[204:207], a[56:59], v[104:107]
  ds_read_b128 v[196:199], v5 offset:46080
  s_waitcnt vmcnt(27)
  MF v[140:143], v[204:207], a[60:63], v[140:143]
  s_add_u32 m0, s42, 45056
  s_add_u32 s37, s66, 8192
  BL4 v2, s[16:19], s37 offen sc1 lds
  s_waitcnt lgkmcnt(5)
  MF v[108:111], v[176:179], a[56:59], v[108:111]
  ds_read_b128 v[200:203], v5 offset:47104
  MF v[144:147], v[176:179], a[60:63], v[144:147]
  s_add_u32 s36, s44, 38912
  BL4 a[48:51], v6, s[16:19], s36 offen sc1
  s_waitcnt lgkmcnt(5)
  MF v[112:115], v[180:183], a[56:59], v[112:115]
  ds_read_b128 v[204:207], v5 offset:48128
  MF v[148:151], v[180:183], a[60:63], v[148:151]
  BL4 a[52:55], v7, s[16:19], s36 offen sc1
  s_waitcnt lgkmcnt(5)
  MF v[116:119], v[184:187], a[56:59], v[116:119]
  s_waitcnt vmcnt(19)
  s_barrier
  ds_read_b128 v[176:179], v3
  MF v[152:155], v[184:187], a[60:63], v[152:155]
  s_waitcnt lgkmcnt(5)
  MF v[120:123], v[188:191], a[56:59], v[120:123]
  ds_read_b128 v[180:183], v3 offset:1024
  MF v[156:159], v[188:191], a[60:63], v[156:159]
  s_waitcnt lgkmcnt(5)
  MF v[124:127], v[192:195], a[56:59], v[124:127]
  ds_read_b128 v[184:187], v3 offset:2048
  MF v[160:163], v[192:195], a[60:63], v[160:163]
  s_waitcnt lgkmcnt(5)
  MF v[128:131], v[196:199], a[56:59], v[128:131]
  ds_read_b128 v[188:191], v3 offset:3072
  MF v[164:167], v[196:199], a[60:63], v[164:167]
  s_waitcnt lgkmcnt(5)
  MF v[132:135], v[200:203], a[56:59], v[132:135]
  ds_read_b128 v[192:195], v3 offset:4096
  MF v[168:171], v[200:203], a[60:63], v[168:171]
  s_waitcnt lgkmcnt(5)
  MF v[136:139], v[204:207], a[56:59], v[136:139]
  ds_read_b128 v[196:199], v3 offset:5120
  MF v[172:175], v[204:207], a[60:63], v[172:175]
  s_waitcnt lgkmcnt(5)
  MF v[104:107], v[176:179], a[0:3], v[104:107]
  ds_read_b128 v[200:203], v3 offset:6144
  MF v[140:143], v[176:179], a[4:7], v[140:143]
  s_mov_b32 s64, 40
  s_waitcnt lgkmcnt(5)
  MF v[108:111], v[180:183], a[0:3], v[108:111]
  ds_read_b128 v[204:207], v3 offset:7168
  MF v[144:147], v[180:183], a[4:7], v[144:147]
  s_mul_i32 s66, s64, 9216
  s_add_u32 s66, s66, s43
  s_add_u32 s66, s66, s42
  s_add_u32 m0, s42, 73728
  s_add_u32 s37, s66, 0
  BL4 v2, s[16:19], s37 offen sc1 lds
  s_waitcnt lgkmcnt(5)
  MF v[112:115], v[184:187], a[0:3], v[112:115]
  ds_read_b128 v[176:179], v3 offset:8192
  MF v[148:151], v[184:187], a[4:7], v[148:151]
  BL4 v2, s[16:19], s37 offen offset:1024 sc1 lds
  s_waitcnt lgkmcnt(5)
  MF v[116:119], v[188:191], a[0:3], v[116:119]
  ds_read_b128 v[180:183], v3 offset:9216
  MF v[152:155], v[188:191], a[4:7], v[152:155]
  s_add_u32 s36, s44, 39936
  BL4 a[56:59], v6, s[16:19], s36 offen sc1
  s_waitcnt lgkmcnt(5)
  MF v[120:123], v[192:195], a[0:3], v[120:123]
  ds_read_b128 v[184:187], v3 offset:10240
  MF v[156:159], v[192:195], a[4:7], v[156:159]
  BL4 a[60:63], v7, s[16:19], s36 offen sc1
  s_waitcnt lgkmcnt(5)
  MF v[124:127], v[196:199], a[0:3], v[124:127]
  ds_read_b128 v[188:191], v3 offset:11264
  MF v[160:163], v[196:199], a[4:7], v[160:163]
  s_waitcnt lgkmcnt(5)
  MF v[128:131], v[200:203], a[0:3], v[128:131]
  ds_read_b128 v[192:195], v3 offset:12288
  MF v[164:167], v[200:203], a[4:7], v[164:167]
  s_waitcnt lgkmcnt(5)
  MF v[132:135], v[204:207], a[0:3], v[132:135]
  ds_read_b128 v[196:199], v3 offset:13312
  MF v[168:171], v[204:207], a[4:7], v[168:171]
  s_waitcnt lgkmcnt(5)
  MF v[136:139], v[176:179], a[0:3], v[136:139]
  ds_read_b128 v[200:203], v3 offset:14336
  MF v[172:175], v[176:179], a[4:7], v[172:175]
  s_waitcnt lgkmcnt(5)
  MF v[104:107], v[180:183], a[8:11], v[104:107]
  ds_read_b128 v[204:207], v3 offset:15360
  MF v[140:143], v[180:183], a[12:15], v[140:143]
  BL4 v2, s[16:19], s37 offen offset:2048 sc1 lds
  s_waitcnt lgkmcnt(5)
  MF v[108:111], v[184:187], a[8:11], v[108:111]
  ds_read_b128 v[176:179], v3 offset:16384
  MF v[144:147], v[184:187], a[12:15], v[144:147]
  BL4 v2, s[16:19], s37 offen offset:3072 sc1 lds
  s_waitcnt lgkmcnt(5)
  MF v[112:115], v[188:191], a[8:11], v[112:115]
  ds_read_b128 v[180:183], v3 offset:17408
  MF v[148:151], v[188:191], a[12:15], v[148:151]
  s_add_u32 m0, s42, 77824
  s_add_u32 s37, s66, 4096
  BL4 v2, s[16:19], s37 offen sc1 lds
  s_waitcnt lgkmcnt(5)
  MF v[116:119], v[192:195], a[8:11], v[116:119]
  ds_read_b128 v[184:187], v3 offset:18432
  MF v[152:155], v[192:195], a[12:15], v[152:155]
  s_add_u32 s36, s44, 40960
  BL4 a[0:3], v6, s[16:19], s36 offen sc1
  s_waitcnt lgkmcnt(5)
  MF v[120:123], v[196:199], a[8:11], v[120:123]
  ds_read_b128 v[188:191], v3 offset:19456
  MF v[156:159], v[196:199], a[12:15], v[156:159]
  BL4 a[4:7], v7, s[16:19], s36 offen sc1
  s_waitcnt lgkmcnt(5)
  MF v[124:127], v[200:203], a[8:11], v[124:127]
  ds_read_b128 v[192:195], v3 offset:20480
  MF v[160:163], v[200:203], a[12:15], v[160:163]
  s_waitcnt lgkmcnt(5)
  MF v[128:131], v[204:207], a[8:11], v[128:131]
  ds_read_b128 v[196:199], v3 offset:21504
  MF v[164:167], v[204:207], a[12:15], v[164:167]
  s_waitcnt lgkmcnt(5)
  MF v[132:135], v[176:179], a[8:11], v[132:135]
  ds_read_b128 v[200:203], v3 offset:22528
  MF v[168:171], v[176:179], a[12:15], v[168:171]
  s_waitcnt lgkmcnt(5)
  MF v[136:139], v[180:183], a[8:11], v[136:139]
  ds_read_b128 v[204:207], v3 offset:23552
  MF v[172:175], v[180:183], a[12:15], v[172:175]
  s_waitcnt vmcnt(27) lgkmcnt(5)
  MF v[104:107], v[184:187], a[16:19], v[104:107]
  ds_read_b128 v[176:179], v3 offset:24576
  s_waitcnt vmcnt(26)
  MF v[140:143], v[184:187], a[20:23], v[140:143]
  BL4 v2, s[16:19], s37 offen offset:1024 sc1 lds
  s_waitcnt lgkmcnt(5)
  MF v[108:111], v[188:191], a[16:19], v[108:111]
  ds_read_b128 v[180:183], v3 offset:25600
  MF v[144:147], v[188:191], a[20:23], v[144:147]
  BL4 v2, s[16:19], s37 offen offset:2048 sc1 lds
  s_waitcnt lgkmcnt(5)
  MF v[112:115], v[192:195], a[16:19], v[112:115]
  ds_read_b128 v[184:187], v3 offset:26624
  MF v[148:151], v[192:195], a[20:23], v[148:151]
  BL4 v2, s[16:19], s37 offen offset:3072 sc1 lds
  s_waitcnt lgkmcnt(5)
  MF v[116:119], v[196:199], a[16:19], v[116:119]
  ds_read_b128 v[188:191], v3 offset:27648
  MF v[152:155], v[196:199], a[20:23], v[152:155]
  s_add_u32 s36, s44, 41984
  BL4 a[8:11], v6, s[16:19], s36 offen sc1
  s_waitcnt lgkmcnt(5)
  MF v[120:123], v[200:203], a[16:19], v[120:123]
  ds_read_b128 v[192:195], v3 offset:28672
  MF v[156:159], v[200:203], a[20:23], v[156:159]
  BL4 a[12:15], v7, s[16:19], s36 offen sc1
  s_waitcnt lgkmcnt(5)
  MF v[124:127], v[204:207], a[16:19], v[124:127]
  ds_read_b128 v[196:199], v3 offset:29696
  MF v[160:163], v[204:207], a[20:23], v[160:163]
  s_waitcnt lgkmcnt(5)
  MF v[128:131], v[176:179], a[16:19], v[128:131]
  ds_read_b128 v[200:203], v3 offset:30720
  MF v[164:167], v[176:179], a[20:23], v[164:167]
  s_waitcnt lgkmcnt(5)
  MF v[132:135], v[180:183], a[16:19], v[132:135]
  ds_read_b128 v[204:207], v3 offset:31744
  MF v[168:171], v[180:183], a[20:23], v[168:171]
  s_waitcnt lgkmcnt(5)
  MF v[136:139], v[184:187], a[16:19], v[136:139]
  ds_read_b128 v[176:179], v3 offset:32768
  MF v[172:175], v[184:187], a[20:23], v[172:175]
  s_waitcnt vmcnt(28) lgkmcnt(5)
  MF v[104:107], v[188:191], a[24:27], v[104:107]
  ds_read_b128 v[180:183], v3 offset:33792
  s_waitcnt vmcnt(27)
  MF v[140:143], v[188:191], a[28:31], v[140:143]
  s_add_u32 m0, s42, 81920
  s_add_u32 s37, s66, 8192
  BL4 v2, s[16:19], s37 offen sc1 lds
  s_waitcnt lgkmcnt(5)
  MF v[108:111], v[192:195], a[24:27], v[108:111]
  ds_read_b128 v[184:187], v3 offset:34816
  MF v[144:147], v[192:195], a[28:31], v[144:147]
  s_add_u32 s36, s44, 43008
  BL4 a[16:19], v6, s[16:19], s36 offen sc1
  s_waitcnt lgkmcnt(5)
  MF v[112:115], v[196:199], a[24:27], v[112:115]
  ds_read_b128 v[188:191], v3 offset:35840
  MF v[148:151], v[196:199], a[28:31], v[148:151]
  BL4 a[20:23], v7, s[16:19], s36 offen sc1
  s_waitcnt lgkmcnt(5)
  MF v[116:119], v[200:203], a[24:27], v[116:119]
  s_waitcnt vmcnt(19)
  s_barrier
  ds_read_b128 v[192:195], v3 offset:36864
  MF v[152:155], v[200:203], a[28:31], v[152:155]
  s_waitcnt lgkmcnt(5)
  MF v[120:123], v[204:207], a[24:27], v[120:123]
  ds_read_b128 v[196:199], v3 offset:37888
  MF v[156:159], v[204:207], a[28:31], v[156:159]
  s_waitcnt lgkmcnt(5)
  MF v[124:127], v[176:179], a[24:27], v[124:127]
  ds_read_b128 v[200:203], v3 offset:38912
  MF v[160:163], v[176:179], a[28:31], v[160:163]
  s_waitcnt lgkmcnt(5)
  MF v[128:131], v[180:183], a[24:27], v[128:131]
  ds_read_b128 v[204:207], v3 offset:39936
  MF v[164:167], v[180:183], a[28:31], v[164:167]
  s_waitcnt lgkmcnt(5)
  MF v[132:135], v[184:187], a[24:27], v[132:135]
  ds_read_b128 v[176:179], v3 offset:40960
  MF v[168:171], v[184:187], a[28:31], v[168:171]
  s_waitcnt lgkmcnt(5)
  MF v[136:139], v[188:191], a[24:27], v[136:139]
  ds_read_b128 v[180:183], v3 offset:41984
  MF v[172:175], v[188:191], a[28:31], v[172:175]
  s_waitcnt lgkmcnt(5)
  MF v[104:107], v[192:195], a[32:35], v[104:107]
  ds_read_b128 v[184:187], v3 offset:43008
  MF v[140:143], v[192:195], a[36:39], v[140:143]
  s_mov_b32 s65, 44
  s_waitcnt lgkmcnt(5)
  MF v[108:111], v[196:199], a[32:35], v[108:111]
  ds_read_b128 v[188:191], v3 offset:44032
  MF v[144:147], v[196:199], a[36:39], v[144:147]
  s_add_u32 s36, s44, 44032
  BL4 a[24:27], v6, s[16:19], s36 offen sc1
  s_waitcnt lgkmcnt(5)
  MF v[112:115], v[200:203], a[32:35], v[112:115]
  ds_read_b128 v[192:195], v3 offset:45056
  MF v[148:151], v[200:203], a[36:39], v[148:151]
  BL4 a[28:31], v7, s[16:19], s36 offen sc1
  s_waitcnt lgkmcnt(5)
  MF v[116:119], v[204:207], a[32:35], v[116:119]
  ds_read_b128 v[196:199], v3 offset:46080
  MF v[152:155], v[204:207], a[36:39], v[152:155]
  s_waitcnt lgkmcnt(5)
  MF v[120:123], v[176:179], a[32:35], v[120:123]
  ds_read_b128 v[200:203], v3 offset:47104
  MF v[156:159], v[176:179], a[36:39], v[156:159]
  s_waitcnt lgkmcnt(5)
  MF v[124:127], v[180:183], a[32:35], v[124:127]
  ds_read_b128 v[204:207], v3 offset:48128
  MF v[160:163], v[180:183], a[36:39], v[160:163]
  s_waitcnt lgkmcnt(5)
  MF v[128:131], v[184:187], a[32:35], v[128:131]
  ds_read_b128 v[176:179], v4
  MF v[164:167], v[184:187], a[36:39], v[164:167]
  s_waitcnt lgkmcnt(5)
  MF v[132:135], v[188:191], a[32:35], v[132:135]
  ds_read_b128 v[180:183], v4 offset:1024
  MF v[168:171], v[188:191], a[36:39], v[168:171]
  s_waitcnt lgkmcnt(5)
  MF v[136:139], v[192:195], a[32:35], v[136:139]
  ds_read_b128 v[184:187], v4 offset:2048
  MF v[172:175], v[192:195], a[36:39], v[172:175]
  s_waitcnt lgkmcnt(5)
  MF v[32:35], v[196:199], a[40:43], v[32:35]
  ds_read_b128 v[188:191], v4 offset:3072
  MF v[68:71], v[196:199], a[44:47], v[68:71]
  s_lshl_b32 s38, s32, 10
  s_add_u32 m0, s38, 110592
  s_add_u32 s37, s38, 405504
  s_add_u32 s37, s37, s43
  BL4 v2, s[16:19], s37 offen sc1 lds
  s_waitcnt lgkmcnt(5)
  MF v[36:39], v[200:203], a[40:43], v[36:39]
  ds_read_b128 v[192:195], v4 offset:4096
  MF v[72:75], v[200:203], a[44:47], v[72:75]
  s_add_u32 s36, s44, 45056
  BL4 a[32:35], v6, s[16:19], s36 offen sc1
  s_waitcnt lgkmcnt(5)
  MF v[40:43], v[204:207], a[40:43], v[40:43]
  ds_read_b128 v[196:199], v4 offset:5120
  MF v[76:79], v[204:207], a[44:47], v[76:79]
  BL4 a[36:39], v7, s[16:19], s36 offen sc1
  s_waitcnt lgkmcnt(5)
  MF v[44:47], v[176:179], a[40:43], v[44:47]
  ds_read_b128 v[200:203], v4 offset:6144
  MF v[80:83], v[176:179], a[44:47], v[80:83]
  s_waitcnt lgkmcnt(5)
  MF v[48:51], v[180:183], a[40:43], v[48:51]
  ds_read_b128 v[204:207], v4 offset:7168
  MF v[84:87], v[180:183], a[44:47], v[84:87]
  s_waitcnt lgkmcnt(5)
  MF v[52:55], v[184:187], a[40:43], v[52:55]
  ds_read_b128 v[176:179], v4 offset:8192
  MF v[88:91], v[184:187], a[44:47], v[88:91]
  s_waitcnt lgkmcnt(5)
  MF v[56:59], v[188:191], a[40:43], v[56:59]
  ds_read_b128 v[180:183], v4 offset:9216
  MF v[92:95], v[188:191], a[44:47], v[92:95]
  s_waitcnt lgkmcnt(5)
  MF v[60:63], v[192:195], a[40:43], v[60:63]
  ds_read_b128 v[184:187], v4 offset:10240
  MF v[96:99], v[192:195], a[44:47], v[96:99]
  s_waitcnt lgkmcnt(5)
  MF v[64:67], v[196:199], a[40:43], v[64:67]
  ds_read_b128 v[188:191], v4 offset:11264
  MF v[100:103], v[196:199], a[44:47], v[100:103]
  s_waitcnt vmcnt(23) lgkmcnt(5)
  MF v[32:35], v[200:203], a[48:51], v[32:35]
  ds_read_b128 v[192:195], v4 offset:12288
  s_waitcnt vmcnt(22)
  MF v[68:71], v[200:203], a[52:55], v[68:71]
  s_lshl_b32 s38, s32, 10
  s_add_u32 m0, s38, 114688
  s_add_u32 s37, s38, 409600
  s_add_u32 s37, s37, s43
  BL4 v2, s[16:19], s37 offen sc1 lds
  s_waitcnt lgkmcnt(5)
  MF v[36:39], v[204:207], a[48:51], v[36:39]
  ds_read_b128 v[196:199], v4 offset:13312
  v_mul_f32 v104, v8, v104
  MF v[72:75], v[204:207], a[52:55], v[72:75]
  v_mul_f32 v105, v8, v105
  v_mul_f32 v106, v8, v106
  s_waitcnt lgkmcnt(5)
  MF v[40:43], v[176:179], a[48:51], v[40:43]
  ds_read_b128 v[200:203], v4 offset:14336
  v_mul_f32 v107, v8, v107
  MF v[76:79], v[176:179], a[52:55], v[76:79]
  v_mul_f32 v108, v8, v108
  v_mul_f32 v109, v8, v109
  s_waitcnt lgkmcnt(5)
  MF v[44:47], v[180:183], a[48:51], v[44:47]
  ds_read_b128 v[204:207], v4 offset:15360
  v_mul_f32 v110, v8, v110
  MF v[80:83], v[180:183], a[52:55], v[80:83]
  v_mul_f32 v111, v8, v111
  v_mul_f32 v112, v8, v112
  s_waitcnt lgkmcnt(5)
  MF v[48:51], v[184:187], a[48:51], v[48:51]
  ds_read_b128 v[176:179], v4 offset:16384
  v_mul_f32 v113, v8, v113
  MF v[84:87], v[184:187], a[52:55], v[84:87]
  v_mul_f32 v114, v8, v114
  v_mul_f32 v115, v8, v115
  s_waitcnt lgkmcnt(5)
  MF v[52:55], v[188:191], a[48:51], v[52:55]
  ds_read_b128 v[180:183], v4 offset:17408
  v_mul_f32 v116, v8, v116
  MF v[88:91], v[188:191], a[52:55], v[88:91]
  v_mul_f32 v117, v8, v117
  v_mul_f32 v118, v8, v118
  s_waitcnt lgkmcnt(5)
  MF v[56:59], v[192:195], a[48:51], v[56:59]
  ds_read_b128 v[184:187], v4 offset:18432
  v_mul_f32 v119, v8, v119
  MF v[92:95], v[192:195], a[52:55], v[92:95]
  v_mul_f32 v120, v8, v120
  v_mul_f32 v121, v8, v121
  s_waitcnt lgkmcnt(5)
  MF v[60:63], v[196:199], a[48:51], v[60:63]
  ds_read_b128 v[188:191], v4 offset:19456
  v_mul_f32 v122, v8, v122
  MF v[96:99], v[196:199], a[52:55], v[96:99]
  v_mul_f32 v123, v8, v123
  v_mul_f32 v124, v8, v124
  s_waitcnt lgkmcnt(5)
  MF v[64:67], v[200:203], a[48:51], v[64:67]
  ds_read_b128 v[192:195], v4 offset:20480
  v_mul_f32 v125, v8, v125
  MF v[100:103], v[200:203], a[52:55], v[100:103]
  v_mul_f32 v126, v8, v126
  v_mul_f32 v127, v8, v127
  s_waitcnt vmcnt(20) lgkmcnt(5)
  MF v[32:35], v[204:207], a[56:59], v[32:35]
  ds_read_b128 v[196:199], v4 offset:21504
  s_waitcnt vmcnt(19)
  MF v[68:71], v[204:207], a[60:63], v[68:71]
  s_lshl_b32 s38, s32, 10
  s_add_u32 m0, s38, 118784
  s_add_u32 s37, s38, 413696
  s_add_u32 s37, s37, s43
  BL4 v2, s[16:19], s37 offen sc1 lds
  s_waitcnt lgkmcnt(5)
  MF v[36:39], v[176:179], a[56:59], v[36:39]
  ds_read_b128 v[200:203], v4 offset:22528
  v_mul_f32 v128, v8, v128
  MF v[72:75], v[176:179], a[60:63], v[72:75]
  v_mul_f32 v129, v8, v129
  v_mul_f32 v130, v8, v130
  s_waitcnt lgkmcnt(5)
  MF v[40:43], v[180:183], a[56:59], v[40:43]
  ds_read_b128 v[204:207], v4 offset:23552
  v_mul_f32 v131, v8, v131
  MF v[76:79], v[180:183], a[60:63], v[76:79]
  v_mul_f32 v132, v8, v132
  v_mul_f32 v133, v8, v133
  s_waitcnt lgkmcnt(5)
  MF v[44:47], v[184:187], a[56:59], v[44:47]
  s_waitcnt vmcnt(9)
  s_barrier
  ds_read_b128 v[176:179], v4 offset:24576
  v_mul_f32 v134, v8, v134
  MF v[80:83], v[184:187], a[60:63], v[80:83]
  v_mul_f32 v135, v8, v135
  v_mul_f32 v136, v8, v136
  s_waitcnt lgkmcnt(5)
  MF v[48:51], v[188:191], a[56:59], v[48:51]
  ds_read_b128 v[180:183], v4 offset:33792
  v_mul_f32 v137, v8, v137
  MF v[84:87], v[188:191], a[60:63], v[84:87]
  v_mul_f32 v138, v8, v138
  v_mul_f32 v139, v8, v139
  s_waitcnt lgkmcnt(5)
  MF v[52:55], v[192:195], a[56:59], v[52:55]
  ds_read_b128 v[184:187], v4 offset:43008
  v_mul_f32 v140, v9, v140
  MF v[88:91], v[192:195], a[60:63], v[88:91]
  v_mul_f32 v141, v9, v141
  v_mul_f32 v142, v9, v142
  s_waitcnt lgkmcnt(5)
  MF v[56:59], v[196:199], a[56:59], v[56:59]
  ds_read_b128 v[188:191], v5 offset:3072
  v_mul_f32 v143, v9, v143
  MF v[92:95], v[196:199], a[60:63], v[92:95]
  v_mul_f32 v144, v9, v144
  v_mul_f32 v145, v9, v145
  s_waitcnt lgkmcnt(5)
  MF v[60:63], v[200:203], a[56:59], v[60:63]
  s_waitcnt vmcnt(0)
  s_barrier
  ds_read_b128 v[192:195], v5 offset:12288
  v_mul_f32 v146, v9, v146
  MF v[96:99], v[200:203], a[60:63], v[96:99]
  v_mul_f32 v147, v9, v147
  v_mul_f32 v148, v9, v148
  s_waitcnt lgkmcnt(5)
  MF v[64:67], v[204:207], a[56:59], v[64:67]
  ds_read_b128 v[196:199], v4 offset:25600
  v_mul_f32 v149, v9, v149
  MF v[100:103], v[204:207], a[60:63], v[100:103]
  v_mul_f32 v150, v9, v150
  v_mul_f32 v151, v9, v151
  v_mul_f32 v152, v9, v152
  v_mul_f32 v153, v9, v153
  v_mul_f32 v154, v9, v154
  v_mul_f32 v155, v9, v155
  v_mul_f32 v156, v9, v156
  v_mul_f32 v157, v9, v157
  v_mul_f32 v158, v9, v158
  v_mul_f32 v159, v9, v159
  v_mul_f32 v160, v9, v160
  v_mul_f32 v161, v9, v161
  v_mul_f32 v162, v9, v162
  v_mul_f32 v163, v9, v163
  v_mul_f32 v164, v9, v164
  v_mul_f32 v165, v9, v165
  v_mul_f32 v166, v9, v166
  v_mul_f32 v167, v9, v167
  v_mul_f32 v168, v9, v168
  v_mul_f32 v169, v9, v169
  v_mul_f32 v170, v9, v170
  v_mul_f32 v171, v9, v171
  v_mul_f32 v172, v9, v172
  v_mul_f32 v173, v9, v173
  v_mul_f32 v174, v9, v174
  v_mul_f32 v175, v9, v175
  s_cmp_eq_u32 s32, s33
  s_cbranch_scc1 P2_OWNER
  s_waitcnt lgkmcnt(5)
  MF v[32:35], v[176:179], a[0:3], v[32:35]
  ds_read_b128 v[200:203], v4 offset:34816
  MF v[68:71], v[176:179], a[4:7], v[68:71]
  s_waitcnt lgkmcnt(5)
  MF v[32:35], v[180:183], a[8:11], v[32:35]
  ds_read_b128 v[204:207], v4 offset:44032
  MF v[68:71], v[180:183], a[12:15], v[68:71]
  s_waitcnt lgkmcnt(5)
  MF v[32:35], v[184:187], a[16:19], v[32:35]
  ds_read_b128 v[176:179], v5 offset:4096
  MF v[68:71], v[184:187], a[20:23], v[68:71]
  s_waitcnt lgkmcnt(5)
  MF v[32:35], v[188:191], a[24:27], v[32:35]
  ds_read_b128 v[180:183], v5 offset:13312
  MF v[68:71], v[188:191], a[28:31], v[68:71]
  s_waitcnt lgkmcnt(5)
  MF v[32:35], v[192:195], a[32:35], v[32:35]
  ds_read_b128 v[184:187], v4 offset:26624
  MF v[68:71], v[192:195], a[36:39], v[68:71]
  s_waitcnt lgkmcnt(5)
  MF v[36:39], v[196:199], a[0:3], v[36:39]
  ds_read_b128 v[188:191], v4 offset:35840
  MF v[72:75], v[196:199], a[4:7], v[72:75]
  s_waitcnt lgkmcnt(5)
  MF v[36:39], v[200:203], a[8:11], v[36:39]
  ds_read_b128 v[192:195], v4 offset:45056
  MF v[72:75], v[200:203], a[12:15], v[72:75]
  s_waitcnt lgkmcnt(5)
  MF v[36:39], v[204:207], a[16:19], v[36:39]
  ds_read_b128 v[196:199], v5 offset:5120
  v_fma_f32 v32, v10, v32, v104
  MF v[72:75], v[204:207], a[20:23], v[72:75]
  v_fma_f32 v33, v10, v33, v105
  v_fma_f32 v34, v10, v34, v106
  s_waitcnt lgkmcnt(5)
  MF v[36:39], v[176:179], a[24:27], v[36:39]
  ds_read_b128 v[200:203], v5 offset:14336
  v_fma_f32 v35, v10, v35, v107
  MF v[72:75], v[176:179], a[28:31], v[72:75]
  v_cvt_pk_bf16_f32 v104, v32, v33
  v_cvt_pk_bf16_f32 v105, v34, v35
  s_waitcnt lgkmcnt(5)
  MF v[36:39], v[180:183], a[32:35], v[36:39]
  ds_read_b128 v[204:207], v4 offset:27648
  v_fma_f32 v68, v11, v68, v140
  MF v[72:75], v[180:183], a[36:39], v[72:75]
  v_fma_f32 v69, v11, v69, v141
  v_fma_f32 v70, v11, v70, v142
  s_waitcnt lgkmcnt(5)
  MF v[40:43], v[184:187], a[0:3], v[40:43]
  ds_read_b128 v[176:179], v4 offset:36864
  v_fma_f32 v71, v11, v71, v143
  MF v[76:79], v[184:187], a[4:7], v[76:79]
  v_cvt_pk_bf16_f32 v106, v68, v69
  v_cvt_pk_bf16_f32 v107, v70, v71
  s_waitcnt lgkmcnt(5)
  MF v[40:43], v[188:191], a[8:11], v[40:43]
  ds_read_b128 v[180:183], v4 offset:46080
  MF v[76:79], v[188:191], a[12:15], v[76:79]
  s_mov_b32 s38, 0
  buffer_store_dwordx4 v[104:107], v16, s[16:19], s38 offen sc1
  s_waitcnt lgkmcnt(5)
  MF v[40:43], v[192:195], a[16:19], v[40:43]
  ds_read_b128 v[184:187], v5 offset:6144
  v_fma_f32 v36, v10, v36, v108
  MF v[76:79], v[192:195], a[20:23], v[76:79]
  v_fma_f32 v37, v10, v37, v109
  v_fma_f32 v38, v10, v38, v110
  s_waitcnt lgkmcnt(5)
  MF v[40:43], v[196:199], a[24:27], v[40:43]
  ds_read_b128 v[188:191], v5 offset:15360
  v_fma_f32 v39, v10, v39, v111
  MF v[76:79], v[196:199], a[28:31], v[76:79]
  v_cvt_pk_bf16_f32 v108, v36, v37
  v_cvt_pk_bf16_f32 v109, v38, v39
  s_waitcnt lgkmcnt(5)
  MF v[40:43], v[200:203], a[32:35], v[40:43]
  ds_read_b128 v[192:195], v4 offset:28672
  v_fma_f32 v72, v11, v72, v144
  MF v[76:79], v[200:203], a[36:39], v[76:79]
  v_fma_f32 v73, v11, v73, v145
  v_fma_f32 v74, v11, v74, v146
  s_waitcnt lgkmcnt(5)
  MF v[44:47], v[204:207], a[0:3], v[44:47]
  ds_read_b128 v[196:199], v4 offset:37888
  v_fma_f32 v75, v11, v75, v147
  MF v[80:83], v[204:207], a[4:7], v[80:83]
  v_cvt_pk_bf16_f32 v110, v72, v73
  v_cvt_pk_bf16_f32 v111, v74, v75
  s_waitcnt lgkmcnt(5)
  MF v[44:47], v[176:179], a[8:11], v[44:47]
  ds_read_b128 v[200:203], v4 offset:47104
  MF v[80:83], v[176:179], a[12:15], v[80:83]
  s_mov_b32 s38, 0
  buffer_store_dwordx4 v[108:111], v16, s[16:19], s38 offen offset:1024 sc1
  s_waitcnt lgkmcnt(5)
  MF v[44:47], v[180:183], a[16:19], v[44:47]
  ds_read_b128 v[204:207], v5 offset:7168
  v_fma_f32 v40, v10, v40, v112
  MF v[80:83], v[180:183], a[20:23], v[80:83]
  v_fma_f32 v41, v10, v41, v113
  v_fma_f32 v42, v10, v42, v114
  s_waitcnt lgkmcnt(5)
  MF v[44:47], v[184:187], a[24:27], v[44:47]
  ds_read_b128 v[176:179], v5 offset:16384
  v_fma_f32 v43, v10, v43, v115
  MF v[80:83], v[184:187], a[28:31], v[80:83]
  v_cvt_pk_bf16_f32 v112, v40, v41
  v_cvt_pk_bf16_f32 v113, v42, v43
  s_waitcnt lgkmcnt(5)
  MF v[44:47], v[188:191], a[32:35], v[44:47]
  ds_read_b128 v[180:183], v4 offset:29696
  v_fma_f32 v76, v11, v76, v148
  MF v[80:83], v[188:191], a[36:39], v[80:83]
  v_fma_f32 v77, v11, v77, v149
  v_fma_f32 v78, v11, v78, v150
  s_waitcnt lgkmcnt(5)
  MF v[48:51], v[192:195], a[0:3], v[48:51]
  ds_read_b128 v[184:187], v4 offset:38912
  v_fma_f32 v79, v11, v79, v151
  MF v[84:87], v[192:195], a[4:7], v[84:87]
  v_cvt_pk_bf16_f32 v114, v76, v77
  v_cvt_pk_bf16_f32 v115, v78, v79
  s_waitcnt lgkmcnt(5)
  MF v[48:51], v[196:199], a[8:11], v[48:51]
  ds_read_b128 v[188:191], v4 offset:48128
  MF v[84:87], v[196:199], a[12:15], v[84:87]
  s_mov_b32 s38, 0
  buffer_store_dwordx4 v[112:115], v16, s[16:19], s38 offen offset:2048 sc1
  s_waitcnt lgkmcnt(5)
  MF v[48:51], v[200:203], a[16:19], v[48:51]
  ds_read_b128 v[192:195], v5 offset:8192
  v_fma_f32 v44, v10, v44, v116
  MF v[84:87], v[200:203], a[20:23], v[84:87]
  v_fma_f32 v45, v10, v45, v117
  v_fma_f32 v46, v10, v46, v118
  s_waitcnt lgkmcnt(5)
  MF v[48:51], v[204:207], a[24:27], v[48:51]
  ds_read_b128 v[196:199], v5 offset:17408
  v_fma_f32 v47, v10, v47, v119
  MF v[84:87], v[204:207], a[28:31], v[84:87]
  v_cvt_pk_bf16_f32 v116, v44, v45
  v_cvt_pk_bf16_f32 v117, v46, v47
  s_waitcnt lgkmcnt(5)
  MF v[48:51], v[176:179], a[32:35], v[48:51]
  ds_read_b128 v[200:203], v4 offset:30720
  v_fma_f32 v80, v11, v80, v152
  MF v[84:87], v[176:179], a[36:39], v[84:87]
  v_fma_f32 v81, v11, v81, v153
  v_fma_f32 v82, v11, v82, v154
  s_waitcnt lgkmcnt(5)
  MF v[52:55], v[180:183], a[0:3], v[52:55]
  ds_read_b128 v[204:207], v4 offset:39936
  v_fma_f32 v83, v11, v83, v155
  MF v[88:91], v[180:183], a[4:7], v[88:91]
  v_cvt_pk_bf16_f32 v118, v80, v81
  v_cvt_pk_bf16_f32 v119, v82, v83
  s_waitcnt lgkmcnt(5)
  MF v[52:55], v[184:187], a[8:11], v[52:55]
  ds_read_b128 v[176:179], v5
  MF v[88:91], v[184:187], a[12:15], v[88:91]
  s_mov_b32 s38, 0
  buffer_store_dwordx4 v[116:119], v16, s[16:19], s38 offen offset:3072 sc1
  s_waitcnt lgkmcnt(5)
  MF v[52:55], v[188:191], a[16:19], v[52:55]
  ds_read_b128 v[180:183], v5 offset:9216
  v_fma_f32 v48, v10, v48, v120
  MF v[88:91], v[188:191], a[20:23], v[88:91]
  v_fma_f32 v49, v10, v49, v121
  v_fma_f32 v50, v10, v50, v122
  s_waitcnt lgkmcnt(5)
  MF v[52:55], v[192:195], a[24:27], v[52:55]
  ds_read_b128 v[184:187], v5 offset:18432
  v_fma_f32 v51, v10, v51, v123
  MF v[88:91], v[192:195], a[28:31], v[88:91]
  v_cvt_pk_bf16_f32 v120, v48, v49
  v_cvt_pk_bf16_f32 v121, v50, v51
  s_waitcnt lgkmcnt(5)
  MF v[52:55], v[196:199], a[32:35], v[52:55]
  ds_read_b128 v[188:191], v4 offset:31744
  v_fma_f32 v84, v11, v84, v156
  MF v[88:91], v[196:199], a[36:39], v[88:91]
  v_fma_f32 v85, v11, v85, v157
  v_fma_f32 v86, v11, v86, v158
  s_waitcnt lgkmcnt(5)
  MF v[56:59], v[200:203], a[0:3], v[56:59]
  ds_read_b128 v[192:195], v4 offset:40960
  v_fma_f32 v87, v11, v87, v159
  MF v[92:95], v[200:203], a[4:7], v[92:95]
  v_cvt_pk_bf16_f32 v122, v84, v85
  v_cvt_pk_bf16_f32 v123, v86, v87
  s_waitcnt lgkmcnt(5)
  MF v[56:59], v[204:207], a[8:11], v[56:59]
  ds_read_b128 v[196:199], v5 offset:1024
  MF v[92:95], v[204:207], a[12:15], v[92:95]
  s_mov_b32 s38, 4096
  buffer_store_dwordx4 v[120:123], v16, s[16:19], s38 offen sc1
  s_waitcnt lgkmcnt(5)
  MF v[56:59], v[176:179], a[16:19], v[56:59]
  ds_read_b128 v[200:203], v5 offset:10240
  v_fma_f32 v52, v10, v52, v124
  MF v[92:95], v[176:179], a[20:23], v[92:95]
  v_fma_f32 v53, v10, v53, v125
  v_fma_f32 v54, v10, v54, v126
  s_waitcnt lgkmcnt(5)
  MF v[56:59], v[180:183], a[24:27], v[56:59]
  ds_read_b128 v[204:207], v5 offset:19456
  v_fma_f32 v55, v10, v55, v127
  MF v[92:95], v[180:183], a[28:31], v[92:95]
  v_cvt_pk_bf16_f32 v124, v52, v53
  v_cvt_pk_bf16_f32 v125, v54, v55
  s_waitcnt lgkmcnt(5)
  MF v[56:59], v[184:187], a[32:35], v[56:59]
  ds_read_b128 v[176:179], v4 offset:32768
  v_fma_f32 v88, v11, v88, v160
  MF v[92:95], v[184:187], a[36:39], v[92:95]
  v_fma_f32 v89, v11, v89, v161
  v_fma_f32 v90, v11, v90, v162
  s_waitcnt lgkmcnt(5)
  MF v[60:63], v[188:191], a[0:3], v[60:63]
  ds_read_b128 v[180:183], v4 offset:41984
  v_fma_f32 v91, v11, v91, v163
  MF v[96:99], v[188:191], a[4:7], v[96:99]
  v_cvt_pk_bf16_f32 v126, v88, v89
  v_cvt_pk_bf16_f32 v127, v90, v91
  s_waitcnt lgkmcnt(5)
  MF v[60:63], v[192:195], a[8:11], v[60:63]
  ds_read_b128 v[184:187], v5 offset:2048
  MF v[96:99], v[192:195], a[12:15], v[96:99]
  s_mov_b32 s38, 4096
  buffer_store_dwordx4 v[124:127], v16, s[16:19], s38 offen offset:1024 sc1
  s_waitcnt lgkmcnt(5)
  MF v[60:63], v[196:199], a[16:19], v[60:63]
  ds_read_b128 v[188:191], v5 offset:11264
  v_fma_f32 v56, v10, v56, v128
  MF v[96:99], v[196:199], a[20:23], v[96:99]
  v_fma_f32 v57, v10, v57, v129
  v_fma_f32 v58, v10, v58, v130
  s_waitcnt lgkmcnt(5)
  MF v[60:63], v[200:203], a[24:27], v[60:63]
  ds_read_b128 v[192:195], v5 offset:20480
  v_fma_f32 v59, v10, v59, v131
  MF v[96:99], v[200:203], a[28:31], v[96:99]
  v_cvt_pk_bf16_f32 v128, v56, v57
  v_cvt_pk_bf16_f32 v129, v58, v59
  s_waitcnt lgkmcnt(5)
  MF v[60:63], v[204:207], a[32:35], v[60:63]
  v_fma_f32 v92, v11, v92, v164
  MF v[96:99], v[204:207], a[36:39], v[96:99]
  v_fma_f32 v93, v11, v93, v165
  v_fma_f32 v94, v11, v94, v166
  s_waitcnt lgkmcnt(4)
  MF v[64:67], v[176:179], a[0:3], v[64:67]
  v_fma_f32 v95, v11, v95, v167
  MF v[100:103], v[176:179], a[4:7], v[100:103]
  v_cvt_pk_bf16_f32 v130, v92, v93
  v_cvt_pk_bf16_f32 v131, v94, v95
  s_waitcnt lgkmcnt(3)
  MF v[64:67], v[180:183], a[8:11], v[64:67]
  MF v[100:103], v[180:183], a[12:15], v[100:103]
  s_mov_b32 s38, 4096
  buffer_store_dwordx4 v[128:131], v16, s[16:19], s38 offen offset:2048 sc1
  s_waitcnt lgkmcnt(2)
  MF v[64:67], v[184:187], a[16:19], v[64:67]
  v_fma_f32 v60, v10, v60, v132
  MF v[100:103], v[184:187], a[20:23], v[100:103]
  v_fma_f32 v61, v10, v61, v133
  v_fma_f32 v62, v10, v62, v134
  s_waitcnt lgkmcnt(1)
  MF v[64:67], v[188:191], a[24:27], v[64:67]
  v_fma_f32 v63, v10, v63, v135
  MF v[100:103], v[188:191], a[28:31], v[100:103]
  v_cvt_pk_bf16_f32 v132, v60, v61
  v_cvt_pk_bf16_f32 v133, v62, v63
  s_waitcnt lgkmcnt(0)
  MF v[64:67], v[192:195], a[32:35], v[64:67]
  v_fma_f32 v96, v11, v96, v168
  MF v[100:103], v[192:195], a[36:39], v[100:103]
  v_fma_f32 v97, v11, v97, v169
  v_fma_f32 v98, v11, v98, v170
  v_fma_f32 v99, v11, v99, v171
  v_cvt_pk_bf16_f32 v134, v96, v97
  v_cvt_pk_bf16_f32 v135, v98, v99
  s_mov_b32 s38, 4096
  buffer_store_dwordx4 v[132:135], v16, s[16:19], s38 offen offset:3072 sc1
  v_fma_f32 v64, v10, v64, v136
  v_fma_f32 v65, v10, v65, v137
  v_fma_f32 v66, v10, v66, v138
  v_fma_f32 v67, v10, v67, v139
  v_cvt_pk_bf16_f32 v136, v64, v65
  v_cvt_pk_bf16_f32 v137, v66, v67
  v_fma_f32 v100, v11, v100, v172
  v_fma_f32 v101, v11, v101, v173
  v_fma_f32 v102, v11, v102, v174
  v_fma_f32 v103, v11, v103, v175
  v_cvt_pk_bf16_f32 v138, v100, v101
  v_cvt_pk_bf16_f32 v139, v102, v103
  s_mov_b32 s38, 8192
  buffer_store_dwordx4 v[136:139], v16, s[16:19], s38 offen sc1
  s_add_u32 s38, s33, 1
  s_and_b32 s38, s38, 3
  s_mul_i32 s53, s38, 18432
  s_add_u32 s38, s33, 2
  s_and_b32 s38, s38, 3
  s_mul_i32 s54, s38, 18432
  s_add_u32 s38, s33, 3
  s_and_b32 s38, s38, 3
  s_mul_i32 s55, s38, 18432
  s_sub_u32 s67, s32, s33
  s_sub_u32 s67, s67, 1
  s_and_b32 s67, s67, 3
  s_add_u32 s47, s67, 3
  s_lshl_b32 s50, s34, 3
  s_lshl_b32 s38, s33, 1
  s_add_u32 s50, s50, s38
  s_add_u32 s50, s50, 0
  s_lshr_b32 s51, s50, 2
  s_lshl_b32 s51, s51, 6
  s_and_b32 s38, s50, 3
  s_lshl_b32 s38, s38, 2
  s_add_u32 s51, s51, s38
  s_mul_i32 s52, s35, 144
  s_lshl_b32 s38, s47, 4
  s_add_u32 s52, s52, s38
  v_add_u32 v56, s51, v20
  v_lshrrev_b32 v57, 4, v1
  v_lshlrev_b32 v57, 2, v57
  v_add_u32 v57, s52, v57
  v_lshlrev_b32 v58, 2, v56
  v_add_u32 v58, 32505856, v58
  buffer_load_dword v59, v58, s[16:19], 0 offen sc1
  v_mul_u32_u24 v58, 576, v56
  v_add_u32 v58, v58, v57
  v_lshlrev_b32 v56, 1, v58
  buffer_load_dwordx2 v[52:53], v56, s[4:7], 0 offen
  v_lshlrev_b32 v57, 1, v57
  buffer_load_dwordx2 v[54:55], v57, s[24:27], 0 offen
  v_lshlrev_b32 v58, 2, v58
  s_lshl_b32 s50, s34, 3
  s_lshl_b32 s38, s33, 1
  s_add_u32 s50, s50, s38
  s_add_u32 s50, s50, 1
  s_lshr_b32 s51, s50, 2
  s_lshl_b32 s51, s51, 6
  s_and_b32 s38, s50, 3
  s_lshl_b32 s38, s38, 2
  s_add_u32 s51, s51, s38
  s_mul_i32 s52, s35, 144
  s_lshl_b32 s38, s47, 4
  s_add_u32 s52, s52, s38
  v_add_u32 v64, s51, v20
  v_lshrrev_b32 v65, 4, v1
  v_lshlrev_b32 v65, 2, v65
  v_add_u32 v65, s52, v65
  v_lshlrev_b32 v66, 2, v64
  v_add_u32 v66, 32505856, v66
  buffer_load_dword v67, v66, s[16:19], 0 offen sc1
  v_mul_u32_u24 v66, 576, v64
  v_add_u32 v66, v66, v65
  v_lshlrev_b32 v64, 1, v66
  buffer_load_dwordx2 v[60:61], v64, s[4:7], 0 offen
  v_lshlrev_b32 v65, 1, v65
  buffer_load_dwordx2 v[62:63], v65, s[24:27], 0 offen
  v_lshlrev_b32 v66, 2, v66
  s_lshl_b32 s56, s47, 10
  s_add_u32 s47, s67, 6
  s_lshl_b32 s50, s34, 3
  s_lshl_b32 s38, s33, 1
  s_add_u32 s50, s50, s38
  s_add_u32 s50, s50, 0
  s_lshr_b32 s51, s50, 2
  s_lshl_b32 s51, s51, 6
  s_and_b32 s38, s50, 3
  s_lshl_b32 s38, s38, 2
  s_add_u32 s51, s51, s38
  s_mul_i32 s52, s35, 144
  s_lshl_b32 s38, s47, 4
  s_add_u32 s52, s52, s38
  v_add_u32 v104, s51, v20
  v_lshrrev_b32 v105, 4, v1
  v_lshlrev_b32 v105, 2, v105
  v_add_u32 v105, s52, v105
  v_lshlrev_b32 v106, 2, v104
  v_add_u32 v106, 32505856, v106
  buffer_load_dword v107, v106, s[16:19], 0 offen sc1
  v_mul_u32_u24 v106, 576, v104
  v_add_u32 v106, v106, v105
  v_lshlrev_b32 v104, 1, v106
  buffer_load_dwordx2 v[100:101], v104, s[4:7], 0 offen
  v_lshlrev_b32 v105, 1, v105
  buffer_load_dwordx2 v[102:103], v105, s[24:27], 0 offen
  v_lshlrev_b32 v106, 2, v106
  s_lshl_b32 s50, s34, 3
  s_lshl_b32 s38, s33, 1
  s_add_u32 s50, s50, s38
  s_add_u32 s50, s50, 1
  s_lshr_b32 s51, s50, 2
  s_lshl_b32 s51, s51, 6
  s_and_b32 s38, s50, 3
  s_lshl_b32 s38, s38, 2
  s_add_u32 s51, s51, s38
  s_mul_i32 s52, s35, 144
  s_lshl_b32 s38, s47, 4
  s_add_u32 s52, s52, s38
  v_add_u32 v112, s51, v20
  v_lshrrev_b32 v113, 4, v1
  v_lshlrev_b32 v113, 2, v113
  v_add_u32 v113, s52, v113
  v_lshlrev_b32 v114, 2, v112
  v_add_u32 v114, 32505856, v114
  buffer_load_dword v115, v114, s[16:19], 0 offen sc1
  v_mul_u32_u24 v114, 576, v112
  v_add_u32 v114, v114, v113
  v_lshlrev_b32 v112, 1, v114
  buffer_load_dwordx2 v[108:109], v112, s[4:7], 0 offen
  v_lshlrev_b32 v113, 1, v113
  buffer_load_dwordx2 v[110:111], v113, s[24:27], 0 offen
  v_lshlrev_b32 v114, 2, v114
  s_lshl_b32 s57, s47, 10
  v_mov_b32 v18, 1
  s_waitcnt vmcnt(18)
  buffer_store_dword v18, v14, s[16:19], 0 offen sc1
  s_waitcnt vmcnt(13)
  buffer_store_dword v18, v14, s[16:19], 0 offen offset:16 sc1
  v_add_u32 v15, 16, v15
  s_barrier
  s_lshl_b32 s38, s56, 1
  v_add_u32 v22, s38, v2
  ds_read_b128 v[44:47], v22
  ds_read_b128 v[48:51], v22 offset:1024
  s_lshl_b32 s38, s57, 1
  v_add_u32 v22, s38, v2
  ds_read_b128 v[92:95], v22
  ds_read_b128 v[96:99], v22 offset:1024
  s_waitcnt vmcnt(12)
  v_lshlrev_b32 v18, 16, v52
  v_and_b32 v19, 0xffff0000, v52
  s_waitcnt vmcnt(11)
  v_lshlrev_b32 v23, 16, v54
  v_and_b32 v22, 0xffff0000, v54
  v_mul_f32 v18, v18, v23
  v_mul_f32 v19, v19, v22
  v_cvt_pk_bf16_f32 v18, v18, v19
  v_lshlrev_b32 v23, 16, v18
  v_and_b32 v22, 0xffff0000, v18
  s_waitcnt lgkmcnt(3)
  v_fma_f32 v44, v59, v23, v44
  v_fma_f32 v45, v59, v22, v45
  v_lshlrev_b32 v18, 16, v53
  v_and_b32 v19, 0xffff0000, v53
  v_lshlrev_b32 v23, 16, v55
  v_and_b32 v22, 0xffff0000, v55
  v_mul_f32 v18, v18, v23
  v_mul_f32 v19, v19, v22
  v_cvt_pk_bf16_f32 v18, v18, v19
  v_lshlrev_b32 v23, 16, v18
  v_and_b32 v22, 0xffff0000, v18
  v_fma_f32 v46, v59, v23, v46
  v_fma_f32 v47, v59, v22, v47
  s_waitcnt vmcnt(9)
  v_lshlrev_b32 v18, 16, v60
  v_and_b32 v19, 0xffff0000, v60
  s_waitcnt vmcnt(8)
  v_lshlrev_b32 v23, 16, v62
  v_and_b32 v22, 0xffff0000, v62
  v_mul_f32 v18, v18, v23
  v_mul_f32 v19, v19, v22
  v_cvt_pk_bf16_f32 v18, v18, v19
  v_lshlrev_b32 v23, 16, v18
  v_and_b32 v22, 0xffff0000, v18
  s_waitcnt lgkmcnt(2)
  v_fma_f32 v48, v67, v23, v48
  v_fma_f32 v49, v67, v22, v49
  v_lshlrev_b32 v18, 16, v61
  v_and_b32 v19, 0xffff0000, v61
  v_lshlrev_b32 v23, 16, v63
  v_and_b32 v22, 0xffff0000, v63
  v_mul_f32 v18, v18, v23
  v_mul_f32 v19, v19, v22
  v_cvt_pk_bf16_f32 v18, v18, v19
  v_lshlrev_b32 v23, 16, v18
  v_and_b32 v22, 0xffff0000, v18
  v_fma_f32 v50, v67, v23, v50
  v_fma_f32 v51, v67, v22, v51
  s_waitcnt vmcnt(6)
  v_lshlrev_b32 v18, 16, v100
  v_and_b32 v19, 0xffff0000, v100
  s_waitcnt vmcnt(5)
  v_lshlrev_b32 v23, 16, v102
  v_and_b32 v22, 0xffff0000, v102
  v_mul_f32 v18, v18, v23
  v_mul_f32 v19, v19, v22
  v_cvt_pk_bf16_f32 v18, v18, v19
  v_lshlrev_b32 v23, 16, v18
  v_and_b32 v22, 0xffff0000, v18
  s_waitcnt lgkmcnt(1)
  v_fma_f32 v92, v107, v23, v92
  v_fma_f32 v93, v107, v22, v93
  v_lshlrev_b32 v18, 16, v101
  v_and_b32 v19, 0xffff0000, v101
  v_lshlrev_b32 v23, 16, v103
  v_and_b32 v22, 0xffff0000, v103
  v_mul_f32 v18, v18, v23
  v_mul_f32 v19, v19, v22
  v_cvt_pk_bf16_f32 v18, v18, v19
  v_lshlrev_b32 v23, 16, v18
  v_and_b32 v22, 0xffff0000, v18
  v_fma_f32 v94, v107, v23, v94
  v_fma_f32 v95, v107, v22, v95
  s_waitcnt vmcnt(3)
  v_lshlrev_b32 v18, 16, v108
  v_and_b32 v19, 0xffff0000, v108
  s_waitcnt vmcnt(2)
  v_lshlrev_b32 v23, 16, v110
  v_and_b32 v22, 0xffff0000, v110
  v_mul_f32 v18, v18, v23
  v_mul_f32 v19, v19, v22
  v_cvt_pk_bf16_f32 v18, v18, v19
  v_lshlrev_b32 v23, 16, v18
  v_and_b32 v22, 0xffff0000, v18
  s_waitcnt lgkmcnt(0)
  v_fma_f32 v96, v115, v23, v96
  v_fma_f32 v97, v115, v22, v97
  v_lshlrev_b32 v18, 16, v109
  v_and_b32 v19, 0xffff0000, v109
  v_lshlrev_b32 v23, 16, v111
  v_and_b32 v22, 0xffff0000, v111
  v_mul_f32 v18, v18, v23
  v_mul_f32 v19, v19, v22
  v_cvt_pk_bf16_f32 v18, v18, v19
  v_lshlrev_b32 v23, 16, v18
  v_and_b32 v22, 0xffff0000, v18
  v_fma_f32 v98, v115, v23, v98
  v_fma_f32 v99, v115, v22, v99
  s_mov_b32 s41, s46
  s_mov_b32 s40, 262144
  buffer_load_dword v24, v15, s[16:19], 0 offen sc1
  s_sleep 3
  buffer_load_dword v25, v15, s[16:19], 0 offen sc1
  s_sleep 3
  buffer_load_dword v26, v15, s[16:19], 0 offen sc1
  s_sleep 3
PPY8:
  buffer_load_dword v27, v15, s[16:19], 0 offen sc1
  s_waitcnt vmcnt(3)
  v_cmp_eq_u32 vcc, 1, v24
  s_nop 1
  s_and_b32 s38, vcc_lo, s41
  s_cmp_eq_u32 s38, s41
  s_cbranch_scc1 PPDY8
  buffer_load_dword v24, v15, s[16:19], 0 offen sc1
  s_waitcnt vmcnt(3)
  v_cmp_eq_u32 vcc, 1, v25
  s_nop 1
  s_and_b32 s38, vcc_lo, s41
  s_cmp_eq_u32 s38, s41
  s_cbranch_scc1 PPDY8
  buffer_load_dword v25, v15, s[16:19], 0 offen sc1
  s_waitcnt vmcnt(3)
  v_cmp_eq_u32 vcc, 1, v26
  s_nop 1
  s_and_b32 s38, vcc_lo, s41
  s_cmp_eq_u32 s38, s41
  s_cbranch_scc1 PPDY8
  buffer_load_dword v26, v15, s[16:19], 0 offen sc1
  s_waitcnt vmcnt(3)
  v_cmp_eq_u32 vcc, 1, v27
  s_nop 1
  s_and_b32 s38, vcc_lo, s41
  s_cmp_eq_u32 s38, s41
  s_cbranch_scc1 PPDY8
  s_sub_u32 s40, s40, 1
  s_cbranch_scc0 PPY8
PPDY8:
  s_add_u32 s38, s53, s56
  BL4 v[32:35], v21, s[16:19], s38 offen sc1
  s_add_u32 s38, s54, s56
  BL4 v[36:39], v21, s[16:19], s38 offen sc1
  s_add_u32 s38, s55, s56
  BL4 v[40:43], v21, s[16:19], s38 offen sc1
  s_add_u32 s38, s53, s57
  BL4 v[80:83], v21, s[16:19], s38 offen sc1
  s_add_u32 s38, s54, s57
  BL4 v[84:87], v21, s[16:19], s38 offen sc1
  s_add_u32 s38, s55, s57
  BL4 v[88:91], v21, s[16:19], s38 offen sc1
  s_waitcnt vmcnt(5)
  v_lshlrev_b32 v22, 16, v32
  v_and_b32 v23, 0xffff0000, v32
  v_lshlrev_b32 v18, 16, v33
  v_and_b32 v19, 0xffff0000, v33
  v_add_f32 v44, v44, v22
  v_add_f32 v45, v45, v23
  v_add_f32 v46, v46, v18
  v_add_f32 v47, v47, v19
  s_waitcnt vmcnt(4)
  v_lshlrev_b32 v22, 16, v36
  v_and_b32 v23, 0xffff0000, v36
  v_lshlrev_b32 v18, 16, v37
  v_and_b32 v19, 0xffff0000, v37
  v_add_f32 v44, v44, v22
  v_add_f32 v45, v45, v23
  v_add_f32 v46, v46, v18
  v_add_f32 v47, v47, v19
  s_waitcnt vmcnt(3)
  v_lshlrev_b32 v22, 16, v40
  v_and_b32 v23, 0xffff0000, v40
  v_lshlrev_b32 v18, 16, v41
  v_and_b32 v19, 0xffff0000, v41
  v_add_f32 v44, v44, v22
  v_add_f32 v45, v45, v23
  v_add_f32 v46, v46, v18
  v_add_f32 v47, v47, v19
  buffer_store_dwordx4 v[44:47], v58, s[28:31], 0 offen sc1
  v_lshlrev_b32 v22, 16, v34
  v_and_b32 v23, 0xffff0000, v34
  v_lshlrev_b32 v18, 16, v35
  v_and_b32 v19, 0xffff0000, v35
  v_add_f32 v48, v48, v22
  v_add_f32 v49, v49, v23
  v_add_f32 v50, v50, v18
  v_add_f32 v51, v51, v19
  v_lshlrev_b32 v22, 16, v38
  v_and_b32 v23, 0xffff0000, v38
  v_lshlrev_b32 v18, 16, v39
  v_and_b32 v19, 0xffff0000, v39
  v_add_f32 v48, v48, v22
  v_add_f32 v49, v49, v23
  v_add_f32 v50, v50, v18
  v_add_f32 v51, v51, v19
  v_lshlrev_b32 v22, 16, v42
  v_and_b32 v23, 0xffff0000, v42
  v_lshlrev_b32 v18, 16, v43
  v_and_b32 v19, 0xffff0000, v43
  v_add_f32 v48, v48, v22
  v_add_f32 v49, v49, v23
  v_add_f32 v50, v50, v18
  v_add_f32 v51, v51, v19
  buffer_store_dwordx4 v[48:51], v66, s[28:31], 0 offen sc1
  s_waitcnt vmcnt(4)
  v_lshlrev_b32 v22, 16, v80
  v_and_b32 v23, 0xffff0000, v80
  v_lshlrev_b32 v18, 16, v81
  v_and_b32 v19, 0xffff0000, v81
  v_add_f32 v92, v92, v22
  v_add_f32 v93, v93, v23
  v_add_f32 v94, v94, v18
  v_add_f32 v95, v95, v19
  s_waitcnt vmcnt(3)
  v_lshlrev_b32 v22, 16, v84
  v_and_b32 v23, 0xffff0000, v84
  v_lshlrev_b32 v18, 16, v85
  v_and_b32 v19, 0xffff0000, v85
  v_add_f32 v92, v92, v22
  v_add_f32 v93, v93, v23
  v_add_f32 v94, v94, v18
  v_add_f32 v95, v95, v19
  s_waitcnt vmcnt(2)
  v_lshlrev_b32 v22, 16, v88
  v_and_b32 v23, 0xffff0000, v88
  v_lshlrev_b32 v18, 16, v89
  v_and_b32 v19, 0xffff0000, v89
  v_add_f32 v92, v92, v22
  v_add_f32 v93, v93, v23
  v_add_f32 v94, v94, v18
  v_add_f32 v95, v95, v19
  buffer_store_dwordx4 v[92:95], v106, s[28:31], 0 offen sc1
  v_lshlrev_b32 v22, 16, v82
  v_and_b32 v23, 0xffff0000, v82
  v_lshlrev_b32 v18, 16, v83
  v_and_b32 v19, 0xffff0000, v83
  v_add_f32 v96, v96, v22
  v_add_f32 v97, v97, v23
  v_add_f32 v98, v98, v18
  v_add_f32 v99, v99, v19
  v_lshlrev_b32 v22, 16, v86
  v_and_b32 v23, 0xffff0000, v86
  v_lshlrev_b32 v18, 16, v87
  v_and_b32 v19, 0xffff0000, v87
  v_add_f32 v96, v96, v22
  v_add_f32 v97, v97, v23
  v_add_f32 v98, v98, v18
  v_add_f32 v99, v99, v19
  v_lshlrev_b32 v22, 16, v90
  v_and_b32 v23, 0xffff0000, v90
  v_lshlrev_b32 v18, 16, v91
  v_and_b32 v19, 0xffff0000, v91
  v_add_f32 v96, v96, v22
  v_add_f32 v97, v97, v23
  v_add_f32 v98, v98, v18
  v_add_f32 v99, v99, v19
  buffer_store_dwordx4 v[96:99], v114, s[28:31], 0 offen sc1
  s_endpgm
P2_OWNER:
  s_waitcnt lgkmcnt(5)
  MF v[32:35], v[176:179], a[0:3], v[32:35]
  ds_read_b128 v[200:203], v4 offset:34816
  MF v[68:71], v[176:179], a[4:7], v[68:71]
  s_waitcnt lgkmcnt(5)
  MF v[32:35], v[180:183], a[8:11], v[32:35]
  ds_read_b128 v[204:207], v4 offset:44032
  MF v[68:71], v[180:183], a[12:15], v[68:71]
  s_waitcnt lgkmcnt(5)
  MF v[32:35], v[184:187], a[16:19], v[32:35]
  ds_read_b128 v[176:179], v5 offset:4096
  MF v[68:71], v[184:187], a[20:23], v[68:71]
  s_waitcnt lgkmcnt(5)
  MF v[32:35], v[188:191], a[24:27], v[32:35]
  ds_read_b128 v[180:183], v5 offset:13312
  MF v[68:71], v[188:191], a[28:31], v[68:71]
  s_waitcnt lgkmcnt(5)
  MF v[32:35], v[192:195], a[32:35], v[32:35]
  ds_read_b128 v[184:187], v4 offset:26624
  MF v[68:71], v[192:195], a[36:39], v[68:71]
  s_waitcnt lgkmcnt(5)
  MF v[36:39], v[196:199], a[0:3], v[36:39]
  ds_read_b128 v[188:191], v4 offset:35840
  MF v[72:75], v[196:199], a[4:7], v[72:75]
  s_waitcnt lgkmcnt(5)
  MF v[36:39], v[200:203], a[8:11], v[36:39]
  ds_read_b128 v[192:195], v4 offset:45056
  MF v[72:75], v[200:203], a[12:15], v[72:75]
  s_waitcnt lgkmcnt(5)
  MF v[36:39], v[204:207], a[16:19], v[36:39]
  ds_read_b128 v[196:199], v5 offset:5120
  v_fma_f32 v32, v10, v32, v104
  MF v[72:75], v[204:207], a[20:23], v[72:75]
  v_fma_f32 v33, v10, v33, v105
  v_fma_f32 v34, v10, v34, v106
  s_waitcnt lgkmcnt(5)
  MF v[36:39], v[176:179], a[24:27], v[36:39]
  ds_read_b128 v[200:203], v5 offset:14336
  v_fma_f32 v35, v10, v35, v107
  MF v[72:75], v[176:179], a[28:31], v[72:75]
  v_fma_f32 v68, v11, v68, v140
  v_fma_f32 v69, v11, v69, v141
  s_waitcnt lgkmcnt(5)
  MF v[36:39], v[180:183], a[32:35], v[36:39]
  ds_read_b128 v[204:207], v4 offset:27648
  v_fma_f32 v70, v11, v70, v142
  MF v[72:75], v[180:183], a[36:39], v[72:75]
  v_fma_f32 v71, v11, v71, v143
  s_waitcnt lgkmcnt(5)
  MF v[40:43], v[184:187], a[0:3], v[40:43]
  ds_read_b128 v[176:179], v4 offset:36864
  MF v[76:79], v[184:187], a[4:7], v[76:79]
  s_waitcnt lgkmcnt(5)
  MF v[40:43], v[188:191], a[8:11], v[40:43]
  ds_read_b128 v[180:183], v4 offset:46080
  MF v[76:79], v[188:191], a[12:15], v[76:79]
  s_waitcnt lgkmcnt(5)
  MF v[40:43], v[192:195], a[16:19], v[40:43]
  ds_read_b128 v[184:187], v5 offset:6144
  v_fma_f32 v36, v10, v36, v108
  MF v[76:79], v[192:195], a[20:23], v[76:79]
  v_fma_f32 v37, v10, v37, v109
  v_fma_f32 v38, v10, v38, v110
  s_waitcnt lgkmcnt(5)
  MF v[40:43], v[196:199], a[24:27], v[40:43]
  ds_read_b128 v[188:191], v5 offset:15360
  v_fma_f32 v39, v10, v39, v111
  MF v[76:79], v[196:199], a[28:31], v[76:79]
  v_fma_f32 v72, v11, v72, v144
  v_fma_f32 v73, v11, v73, v145
  s_waitcnt lgkmcnt(5)
  MF v[40:43], v[200:203], a[32:35], v[40:43]
  ds_read_b128 v[192:195], v4 offset:28672
  v_fma_f32 v74, v11, v74, v146
  MF v[76:79], v[200:203], a[36:39], v[76:79]
  v_fma_f32 v75, v11, v75, v147
  s_waitcnt lgkmcnt(5)
  MF v[44:47], v[204:207], a[0:3], v[44:47]
  ds_read_b128 v[196:199], v4 offset:37888
  MF v[80:83], v[204:207], a[4:7], v[80:83]
  s_waitcnt lgkmcnt(5)
  MF v[44:47], v[176:179], a[8:11], v[44:47]
  ds_read_b128 v[200:203], v4 offset:47104
  MF v[80:83], v[176:179], a[12:15], v[80:83]
  s_waitcnt lgkmcnt(5)
  MF v[44:47], v[180:183], a[16:19], v[44:47]
  ds_read_b128 v[204:207], v5 offset:7168
  v_fma_f32 v40, v10, v40, v112
  MF v[80:83], v[180:183], a[20:23], v[80:83]
  v_fma_f32 v41, v10, v41, v113
  v_fma_f32 v42, v10, v42, v114
  s_waitcnt lgkmcnt(5)
  MF v[44:47], v[184:187], a[24:27], v[44:47]
  ds_read_b128 v[176:179], v5 offset:16384
  v_fma_f32 v43, v10, v43, v115
  MF v[80:83], v[184:187], a[28:31], v[80:83]
  v_fma_f32 v76, v11, v76, v148
  v_fma_f32 v77, v11, v77, v149
  s_waitcnt lgkmcnt(5)
  MF v[44:47], v[188:191], a[32:35], v[44:47]
  ds_read_b128 v[180:183], v4 offset:29696
  v_fma_f32 v78, v11, v78, v150
  MF v[80:83], v[188:191], a[36:39], v[80:83]
  v_fma_f32 v79, v11, v79, v151
  s_waitcnt lgkmcnt(5)
  MF v[48:51], v[192:195], a[0:3], v[48:51]
  ds_read_b128 v[184:187], v4 offset:38912
  MF v[84:87], v[192:195], a[4:7], v[84:87]
  s_waitcnt lgkmcnt(5)
  MF v[48:51], v[196:199], a[8:11], v[48:51]
  ds_read_b128 v[188:191], v4 offset:48128
  MF v[84:87], v[196:199], a[12:15], v[84:87]
  s_waitcnt lgkmcnt(5)
  MF v[48:51], v[200:203], a[16:19], v[48:51]
  ds_read_b128 v[192:195], v5 offset:8192
  v_fma_f32 v44, v10, v44, v116
  MF v[84:87], v[200:203], a[20:23], v[84:87]
  v_fma_f32 v45, v10, v45, v117
  v_fma_f32 v46, v10, v46, v118
  s_waitcnt lgkmcnt(5)
  MF v[48:51], v[204:207], a[24:27], v[48:51]
  ds_read_b128 v[196:199], v5 offset:17408
  v_fma_f32 v47, v10, v47, v119
  MF v[84:87], v[204:207], a[28:31], v[84:87]
  ds_write_b128 v2, v[44:47] offset:6144
  s_waitcnt lgkmcnt(6)
  MF v[48:51], v[176:179], a[32:35], v[48:51]
  ds_read_b128 v[200:203], v4 offset:30720
  v_fma_f32 v80, v11, v80, v152
  MF v[84:87], v[176:179], a[36:39], v[84:87]
  v_fma_f32 v81, v11, v81, v153
  v_fma_f32 v82, v11, v82, v154
  s_waitcnt lgkmcnt(6)
  MF v[52:55], v[180:183], a[0:3], v[52:55]
  ds_read_b128 v[204:207], v4 offset:39936
  v_fma_f32 v83, v11, v83, v155
  MF v[88:91], v[180:183], a[4:7], v[88:91]
  ds_write_b128 v2, v[80:83] offset:7168
  s_waitcnt lgkmcnt(7)
  MF v[52:55], v[184:187], a[8:11], v[52:55]
  ds_read_b128 v[176:179], v5
  MF v[88:91], v[184:187], a[12:15], v[88:91]
  s_waitcnt lgkmcnt(7)
  MF v[52:55], v[188:191], a[16:19], v[52:55]
  ds_read_b128 v[180:183], v5 offset:9216
  v_fma_f32 v48, v10, v48, v120
  MF v[88:91], v[188:191], a[20:23], v[88:91]
  v_fma_f32 v49, v10, v49, v121
  v_fma_f32 v50, v10, v50, v122
  s_waitcnt lgkmcnt(7)
  MF v[52:55], v[192:195], a[24:27], v[52:55]
  ds_read_b128 v[184:187], v5 offset:18432
  v_fma_f32 v51, v10, v51, v123
  MF v[88:91], v[192:195], a[28:31], v[88:91]
  ds_write_b128 v2, v[48:51] offset:8192
  s_waitcnt lgkmcnt(8)
  MF v[52:55], v[196:199], a[32:35], v[52:55]
  ds_read_b128 v[188:191], v4 offset:31744
  v_fma_f32 v84, v11, v84, v156
  MF v[88:91], v[196:199], a[36:39], v[88:91]
  v_fma_f32 v85, v11, v85, v157
  v_fma_f32 v86, v11, v86, v158
  s_waitcnt lgkmcnt(7)
  MF v[56:59], v[200:203], a[0:3], v[56:59]
  ds_read_b128 v[192:195], v4 offset:40960
  v_fma_f32 v87, v11, v87, v159
  MF v[92:95], v[200:203], a[4:7], v[92:95]
  ds_write_b128 v2, v[84:87] offset:9216
  s_waitcnt lgkmcnt(8)
  MF v[56:59], v[204:207], a[8:11], v[56:59]
  ds_read_b128 v[196:199], v5 offset:1024
  MF v[92:95], v[204:207], a[12:15], v[92:95]
  s_waitcnt lgkmcnt(7)
  MF v[56:59], v[176:179], a[16:19], v[56:59]
  ds_read_b128 v[200:203], v5 offset:10240
  v_fma_f32 v52, v10, v52, v124
  MF v[92:95], v[176:179], a[20:23], v[92:95]
  v_fma_f32 v53, v10, v53, v125
  v_fma_f32 v54, v10, v54, v126
  s_waitcnt lgkmcnt(7)
  MF v[56:59], v[180:183], a[24:27], v[56:59]
  ds_read_b128 v[204:207], v5 offset:19456
  v_fma_f32 v55, v10, v55, v127
  MF v[92:95], v[180:183], a[28:31], v[92:95]
  ds_write_b128 v2, v[52:55] offset:10240
  s_waitcnt lgkmcnt(8)
  MF v[56:59], v[184:187], a[32:35], v[56:59]
  ds_read_b128 v[176:179], v4 offset:32768
  v_fma_f32 v88, v11, v88, v160
  MF v[92:95], v[184:187], a[36:39], v[92:95]
  v_fma_f32 v89, v11, v89, v161
  v_fma_f32 v90, v11, v90, v162
  s_waitcnt lgkmcnt(7)
  MF v[60:63], v[188:191], a[0:3], v[60:63]
  ds_read_b128 v[180:183], v4 offset:41984
  v_fma_f32 v91, v11, v91, v163
  MF v[96:99], v[188:191], a[4:7], v[96:99]
  ds_write_b128 v2, v[88:91] offset:11264
  s_waitcnt lgkmcnt(8)
  MF v[60:63], v[192:195], a[8:11], v[60:63]
  ds_read_b128 v[184:187], v5 offset:2048
  MF v[96:99], v[192:195], a[12:15], v[96:99]
  s_waitcnt lgkmcnt(7)
  MF v[60:63], v[196:199], a[16:19], v[60:63]
  ds_read_b128 v[188:191], v5 offset:11264
  v_fma_f32 v56, v10, v56, v128
  MF v[96:99], v[196:199], a[20:23], v[96:99]
  v_fma_f32 v57, v10, v57, v129
  v_fma_f32 v58, v10, v58, v130
  s_waitcnt lgkmcnt(7)
  MF v[60:63], v[200:203], a[24:27], v[60:63]
  ds_read_b128 v[192:195], v5 offset:20480
  v_fma_f32 v59, v10, v59, v131
  MF v[96:99], v[200:203], a[28:31], v[96:99]
  ds_write_b128 v2, v[56:59] offset:12288
  s_waitcnt lgkmcnt(8)
  MF v[60:63], v[204:207], a[32:35], v[60:63]
  v_fma_f32 v92, v11, v92, v164
  MF v[96:99], v[204:207], a[36:39], v[96:99]
  v_fma_f32 v93, v11, v93, v165
  v_fma_f32 v94, v11, v94, v166
  s_waitcnt lgkmcnt(6)
  MF v[64:67], v[176:179], a[0:3], v[64:67]
  v_fma_f32 v95, v11, v95, v167
  MF v[100:103], v[176:179], a[4:7], v[100:103]
  ds_write_b128 v2, v[92:95] offset:13312
  s_waitcnt lgkmcnt(6)
  MF v[64:67], v[180:183], a[8:11], v[64:67]
  MF v[100:103], v[180:183], a[12:15], v[100:103]
  s_waitcnt lgkmcnt(4)
  MF v[64:67], v[184:187], a[16:19], v[64:67]
  v_fma_f32 v60, v10, v60, v132
  MF v[100:103], v[184:187], a[20:23], v[100:103]
  v_fma_f32 v61, v10, v61, v133
  v_fma_f32 v62, v10, v62, v134
  s_waitcnt lgkmcnt(3)
  MF v[64:67], v[188:191], a[24:27], v[64:67]
  v_fma_f32 v63, v10, v63, v135
  MF v[100:103], v[188:191], a[28:31], v[100:103]
  ds_write_b128 v2, v[60:63] offset:14336
  s_waitcnt lgkmcnt(3)
  MF v[64:67], v[192:195], a[32:35], v[64:67]
  v_fma_f32 v96, v11, v96, v168
  MF v[100:103], v[192:195], a[36:39], v[100:103]
  v_fma_f32 v97, v11, v97, v169
  v_fma_f32 v98, v11, v98, v170
  v_fma_f32 v99, v11, v99, v171
  ds_write_b128 v2, v[96:99] offset:15360
  s_nop 1
  v_fma_f32 v64, v10, v64, v136
  v_fma_f32 v65, v10, v65, v137
  v_fma_f32 v66, v10, v66, v138
  v_fma_f32 v67, v10, v67, v139
  ds_write_b128 v2, v[64:67] offset:16384
  v_fma_f32 v100, v11, v100, v172
  v_fma_f32 v101, v11, v101, v173
  v_fma_f32 v102, v11, v102, v174
  v_fma_f32 v103, v11, v103, v175
  ds_write_b128 v2, v[100:103] offset:17408
  s_add_u32 s38, s33, 1
  s_and_b32 s38, s38, 3
  s_mul_i32 s53, s38, 18432
  s_add_u32 s38, s33, 2
  s_and_b32 s38, s38, 3
  s_mul_i32 s54, s38, 18432
  s_add_u32 s38, s33, 3
  s_and_b32 s38, s38, 3
  s_mul_i32 s55, s38, 18432
  s_mov_b32 s47, 0
  s_lshl_b32 s50, s34, 3
  s_lshl_b32 s38, s33, 1
  s_add_u32 s50, s50, s38
  s_add_u32 s50, s50, 0
  s_lshr_b32 s51, s50, 2
  s_lshl_b32 s51, s51, 6
  s_and_b32 s38, s50, 3
  s_lshl_b32 s38, s38, 2
  s_add_u32 s51, s51, s38
  s_mul_i32 s52, s35, 144
  s_lshl_b32 s38, s47, 4
  s_add_u32 s52, s52, s38
  v_add_u32 v128, s51, v20
  v_lshrrev_b32 v129, 4, v1
  v_lshlrev_b32 v129, 2, v129
  v_add_u32 v129, s52, v129
  v_mul_u32_u24 v130, 576, v128
  v_add_u32 v130, v130, v129
  v_lshlrev_b32 v128, 1, v130
  buffer_load_dwordx2 v[124:125], v128, s[4:7], 0 offen
  v_lshlrev_b32 v129, 1, v129
  buffer_load_dwordx2 v[126:127], v129, s[24:27], 0 offen
  v_lshlrev_b32 v130, 2, v130
  s_lshl_b32 s50, s34, 3
  s_lshl_b32 s38, s33, 1
  s_add_u32 s50, s50, s38
  s_add_u32 s50, s50, 1
  s_lshr_b32 s51, s50, 2
  s_lshl_b32 s51, s51, 6
  s_and_b32 s38, s50, 3
  s_lshl_b32 s38, s38, 2
  s_add_u32 s51, s51, s38
  s_mul_i32 s52, s35, 144
  s_lshl_b32 s38, s47, 4
  s_add_u32 s52, s52, s38
  v_add_u32 v136, s51, v20
  v_lshrrev_b32 v137, 4, v1
  v_lshlrev_b32 v137, 2, v137
  v_add_u32 v137, s52, v137
  v_mul_u32_u24 v138, 576, v136
  v_add_u32 v138, v138, v137
  v_lshlrev_b32 v136, 1, v138
  buffer_load_dwordx2 v[132:133], v136, s[4:7], 0 offen
  v_lshlrev_b32 v137, 1, v137
  buffer_load_dwordx2 v[134:135], v137, s[24:27], 0 offen
  v_lshlrev_b32 v138, 2, v138
  s_lshl_b32 s56, s47, 10
  s_mov_b32 s47, 1
  s_lshl_b32 s50, s34, 3
  s_lshl_b32 s38, s33, 1
  s_add_u32 s50, s50, s38
  s_add_u32 s50, s50, 0
  s_lshr_b32 s51, s50, 2
  s_lshl_b32 s51, s51, 6
  s_and_b32 s38, s50, 3
  s_lshl_b32 s38, s38, 2
  s_add_u32 s51, s51, s38
  s_mul_i32 s52, s35, 144
  s_lshl_b32 s38, s47, 4
  s_add_u32 s52, s52, s38
  v_add_u32 v168, s51, v20
  v_lshrrev_b32 v169, 4, v1
  v_lshlrev_b32 v169, 2, v169
  v_add_u32 v169, s52, v169
  v_mul_u32_u24 v170, 576, v168
  v_add_u32 v170, v170, v169
  v_lshlrev_b32 v168, 1, v170
  buffer_load_dwordx2 v[164:165], v168, s[4:7], 0 offen
  v_lshlrev_b32 v169, 1, v169
  buffer_load_dwordx2 v[166:167], v169, s[24:27], 0 offen
  v_lshlrev_b32 v170, 2, v170
  s_lshl_b32 s50, s34, 3
  s_lshl_b32 s38, s33, 1
  s_add_u32 s50, s50, s38
  s_add_u32 s50, s50, 1
  s_lshr_b32 s51, s50, 2
  s_lshl_b32 s51, s51, 6
  s_and_b32 s38, s50, 3
  s_lshl_b32 s38, s38, 2
  s_add_u32 s51, s51, s38
  s_mul_i32 s52, s35, 144
  s_lshl_b32 s38, s47, 4
  s_add_u32 s52, s52, s38
  v_add_u32 v176, s51, v20
  v_lshrrev_b32 v177, 4, v1
  v_lshlrev_b32 v177, 2, v177
  v_add_u32 v177, s52, v177
  v_mul_u32_u24 v178, 576, v176
  v_add_u32 v178, v178, v177
  v_lshlrev_b32 v176, 1, v178
  buffer_load_dwordx2 v[172:173], v176, s[4:7], 0 offen
  v_lshlrev_b32 v177, 1, v177
  buffer_load_dwordx2 v[174:175], v177, s[24:27], 0 offen
  v_lshlrev_b32 v178, 2, v178
  s_lshl_b32 s57, s47, 10
  s_mov_b32 s47, 2
  s_lshl_b32 s50, s34, 3
  s_lshl_b32 s38, s33, 1
  s_add_u32 s50, s50, s38
  s_add_u32 s50, s50, 0
  s_lshr_b32 s51, s50, 2
  s_lshl_b32 s51, s51, 6
  s_and_b32 s38, s50, 3
  s_lshl_b32 s38, s38, 2
  s_add_u32 s51, s51, s38
  s_mul_i32 s52, s35, 144
  s_lshl_b32 s38, s47, 4
  s_add_u32 s52, s52, s38
  v_add_u32 v208, s51, v20
  v_lshrrev_b32 v209, 4, v1
  v_lshlrev_b32 v209, 2, v209
  v_add_u32 v209, s52, v209
  v_mul_u32_u24 v210, 576, v208
  v_add_u32 v210, v210, v209
  v_lshlrev_b32 v208, 1, v210
  buffer_load_dwordx2 v[204:205], v208, s[4:7], 0 offen
  v_lshlrev_b32 v209, 1, v209
  buffer_load_dwordx2 v[206:207], v209, s[24:27], 0 offen
  v_lshlrev_b32 v210, 2, v210
  s_lshl_b32 s50, s34, 3
  s_lshl_b32 s38, s33, 1
  s_add_u32 s50, s50, s38
  s_add_u32 s50, s50, 1
  s_lshr_b32 s51, s50, 2
  s_lshl_b32 s51, s51, 6
  s_and_b32 s38, s50, 3
  s_lshl_b32 s38, s38, 2
  s_add_u32 s51, s51, s38
  s_mul_i32 s52, s35, 144
  s_lshl_b32 s38, s47, 4
  s_add_u32 s52, s52, s38
  v_add_u32 v216, s51, v20
  v_lshrrev_b32 v217, 4, v1
  v_lshlrev_b32 v217, 2, v217
  v_add_u32 v217, s52, v217
  v_mul_u32_u24 v218, 576, v216
  v_add_u32 v218, v218, v217
  v_lshlrev_b32 v216, 1, v218
  buffer_load_dwordx2 v[212:213], v216, s[4:7], 0 offen
  v_lshlrev_b32 v217, 1, v217
  buffer_load_dwordx2 v[214:215], v217, s[24:27], 0 offen
  v_lshlrev_b32 v218, 2, v218
  s_lshl_b32 s58, s47, 10
  s_waitcnt lgkmcnt(0)
  s_barrier
  s_waitcnt vmcnt(11)
  v_lshlrev_b32 v18, 16, v124
  v_and_b32 v19, 0xffff0000, v124
  s_waitcnt vmcnt(10)
  v_lshlrev_b32 v23, 16, v126
  v_and_b32 v22, 0xffff0000, v126
  v_mul_f32 v18, v18, v23
  v_mul_f32 v19, v19, v22
  v_cvt_pk_bf16_f32 v18, v18, v19
  v_lshlrev_b32 v23, 16, v18
  v_and_b32 v22, 0xffff0000, v18
  v_fma_f32 v32, v8, v23, v32
  v_fma_f32 v33, v8, v22, v33
  v_lshlrev_b32 v18, 16, v125
  v_and_b32 v19, 0xffff0000, v125
  v_lshlrev_b32 v23, 16, v127
  v_and_b32 v22, 0xffff0000, v127
  v_mul_f32 v18, v18, v23
  v_mul_f32 v19, v19, v22
  v_cvt_pk_bf16_f32 v18, v18, v19
  v_lshlrev_b32 v23, 16, v18
  v_and_b32 v22, 0xffff0000, v18
  v_fma_f32 v34, v8, v23, v34
  v_fma_f32 v35, v8, v22, v35
  s_waitcnt vmcnt(9)
  v_lshlrev_b32 v18, 16, v132
  v_and_b32 v19, 0xffff0000, v132
  s_waitcnt vmcnt(8)
  v_lshlrev_b32 v23, 16, v134
  v_and_b32 v22, 0xffff0000, v134
  v_mul_f32 v18, v18, v23
  v_mul_f32 v19, v19, v22
  v_cvt_pk_bf16_f32 v18, v18, v19
  v_lshlrev_b32 v23, 16, v18
  v_and_b32 v22, 0xffff0000, v18
  v_fma_f32 v68, v9, v23, v68
  v_fma_f32 v69, v9, v22, v69
  v_lshlrev_b32 v18, 16, v133
  v_and_b32 v19, 0xffff0000, v133
  v_lshlrev_b32 v23, 16, v135
  v_and_b32 v22, 0xffff0000, v135
  v_mul_f32 v18, v18, v23
  v_mul_f32 v19, v19, v22
  v_cvt_pk_bf16_f32 v18, v18, v19
  v_lshlrev_b32 v23, 16, v18
  v_and_b32 v22, 0xffff0000, v18
  v_fma_f32 v70, v9, v23, v70
  v_fma_f32 v71, v9, v22, v71
  s_waitcnt vmcnt(7)
  v_lshlrev_b32 v18, 16, v164
  v_and_b32 v19, 0xffff0000, v164
  s_waitcnt vmcnt(6)
  v_lshlrev_b32 v23, 16, v166
  v_and_b32 v22, 0xffff0000, v166
  v_mul_f32 v18, v18, v23
  v_mul_f32 v19, v19, v22
  v_cvt_pk_bf16_f32 v18, v18, v19
  v_lshlrev_b32 v23, 16, v18
  v_and_b32 v22, 0xffff0000, v18
  v_fma_f32 v36, v8, v23, v36
  v_fma_f32 v37, v8, v22, v37
  v_lshlrev_b32 v18, 16, v165
  v_and_b32 v19, 0xffff0000, v165
  v_lshlrev_b32 v23, 16, v167
  v_and_b32 v22, 0xffff0000, v167
  v_mul_f32 v18, v18, v23
  v_mul_f32 v19, v19, v22
  v_cvt_pk_bf16_f32 v18, v18, v19
  v_lshlrev_b32 v23, 16, v18
  v_and_b32 v22, 0xffff0000, v18
  v_fma_f32 v38, v8, v23, v38
  v_fma_f32 v39, v8, v22, v39
  s_waitcnt vmcnt(5)
  v_lshlrev_b32 v18, 16, v172
  v_and_b32 v19, 0xffff0000, v172
  s_waitcnt vmcnt(4)
  v_lshlrev_b32 v23, 16, v174
  v_and_b32 v22, 0xffff0000, v174
  v_mul_f32 v18, v18, v23
  v_mul_f32 v19, v19, v22
  v_cvt_pk_bf16_f32 v18, v18, v19
  v_lshlrev_b32 v23, 16, v18
  v_and_b32 v22, 0xffff0000, v18
  v_fma_f32 v72, v9, v23, v72
  v_fma_f32 v73, v9, v22, v73
  v_lshlrev_b32 v18, 16, v173
  v_and_b32 v19, 0xffff0000, v173
  v_lshlrev_b32 v23, 16, v175
  v_and_b32 v22, 0xffff0000, v175
  v_mul_f32 v18, v18, v23
  v_mul_f32 v19, v19, v22
  v_cvt_pk_bf16_f32 v18, v18, v19
  v_lshlrev_b32 v23, 16, v18
  v_and_b32 v22, 0xffff0000, v18
  v_fma_f32 v74, v9, v23, v74
  v_fma_f32 v75, v9, v22, v75
  s_waitcnt vmcnt(3)
  v_lshlrev_b32 v18, 16, v204
  v_and_b32 v19, 0xffff0000, v204
  s_waitcnt vmcnt(2)
  v_lshlrev_b32 v23, 16, v206
  v_and_b32 v22, 0xffff0000, v206
  v_mul_f32 v18, v18, v23
  v_mul_f32 v19, v19, v22
  v_cvt_pk_bf16_f32 v18, v18, v19
  v_lshlrev_b32 v23, 16, v18
  v_and_b32 v22, 0xffff0000, v18
  v_fma_f32 v40, v8, v23, v40
  v_fma_f32 v41, v8, v22, v41
  v_lshlrev_b32 v18, 16, v205
  v_and_b32 v19, 0xffff0000, v205
  v_lshlrev_b32 v23, 16, v207
  v_and_b32 v22, 0xffff0000, v207
  v_mul_f32 v18, v18, v23
  v_mul_f32 v19, v19, v22
  v_cvt_pk_bf16_f32 v18, v18, v19
  v_lshlrev_b32 v23, 16, v18
  v_and_b32 v22, 0xffff0000, v18
  v_fma_f32 v42, v8, v23, v42
  v_fma_f32 v43, v8, v22, v43
  s_waitcnt vmcnt(1)
  v_lshlrev_b32 v18, 16, v212
  v_and_b32 v19, 0xffff0000, v212
  s_waitcnt vmcnt(0)
  v_lshlrev_b32 v23, 16, v214
  v_and_b32 v22, 0xffff0000, v214
  v_mul_f32 v18, v18, v23
  v_mul_f32 v19, v19, v22
  v_cvt_pk_bf16_f32 v18, v18, v19
  v_lshlrev_b32 v23, 16, v18
  v_and_b32 v22, 0xffff0000, v18
  v_fma_f32 v76, v9, v23, v76
  v_fma_f32 v77, v9, v22, v77
  v_lshlrev_b32 v18, 16, v213
  v_and_b32 v19, 0xffff0000, v213
  v_lshlrev_b32 v23, 16, v215
  v_and_b32 v22, 0xffff0000, v215
  v_mul_f32 v18, v18, v23
  v_mul_f32 v19, v19, v22
  v_cvt_pk_bf16_f32 v18, v18, v19
  v_lshlrev_b32 v23, 16, v18
  v_and_b32 v22, 0xffff0000, v18
  v_fma_f32 v78, v9, v23, v78
  v_fma_f32 v79, v9, v22, v79
  s_mov_b32 s41, s46
  s_mov_b32 s40, 262144
  buffer_load_dword v24, v15, s[16:19], 0 offen sc1
  s_sleep 3
  buffer_load_dword v25, v15, s[16:19], 0 offen sc1
  s_sleep 3
  buffer_load_dword v26, v15, s[16:19], 0 offen sc1
  s_sleep 3
PPX9:
  buffer_load_dword v27, v15, s[16:19], 0 offen sc1
  s_waitcnt vmcnt(3)
  v_cmp_eq_u32 vcc, 1, v24
  s_nop 1
  s_and_b32 s38, vcc_lo, s41
  s_cmp_eq_u32 s38, s41
  s_cbranch_scc1 PPDX9
  buffer_load_dword v24, v15, s[16:19], 0 offen sc1
  s_waitcnt vmcnt(3)
  v_cmp_eq_u32 vcc, 1, v25
  s_nop 1
  s_and_b32 s38, vcc_lo, s41
  s_cmp_eq_u32 s38, s41
  s_cbranch_scc1 PPDX9
  buffer_load_dword v25, v15, s[16:19], 0 offen sc1
  s_waitcnt vmcnt(3)
  v_cmp_eq_u32 vcc, 1, v26
  s_nop 1
  s_and_b32 s38, vcc_lo, s41
  s_cmp_eq_u32 s38, s41
  s_cbranch_scc1 PPDX9
  buffer_load_dword v26, v15, s[16:19], 0 offen sc1
  s_waitcnt vmcnt(3)
  v_cmp_eq_u32 vcc, 1, v27
  s_nop 1
  s_and_b32 s38, vcc_lo, s41
  s_cmp_eq_u32 s38, s41
  s_cbranch_scc1 PPDX9
  s_sub_u32 s40, s40, 1
  s_cbranch_scc0 PPX9
PPDX9:
  s_add_u32 s38, s53, s56
  BL4 v[104:107], v21, s[16:19], s38 offen sc1
  s_add_u32 s38, s54, s56
  BL4 v[108:111], v21, s[16:19], s38 offen sc1
  s_add_u32 s38, s55, s56
  BL4 v[112:115], v21, s[16:19], s38 offen sc1
  s_add_u32 s38, s53, s57
  BL4 v[144:147], v21, s[16:19], s38 offen sc1
  s_add_u32 s38, s54, s57
  BL4 v[148:151], v21, s[16:19], s38 offen sc1
  s_add_u32 s38, s55, s57
  BL4 v[152:155], v21, s[16:19], s38 offen sc1
  s_add_u32 s38, s53, s58
  BL4 v[184:187], v21, s[16:19], s38 offen sc1
  s_add_u32 s38, s54, s58
  BL4 v[188:191], v21, s[16:19], s38 offen sc1
  s_add_u32 s38, s55, s58
  BL4 v[192:195], v21, s[16:19], s38 offen sc1
  s_waitcnt vmcnt(8)
  v_lshlrev_b32 v22, 16, v104
  v_and_b32 v23, 0xffff0000, v104
  v_lshlrev_b32 v18, 16, v105
  v_and_b32 v19, 0xffff0000, v105
  v_add_f32 v32, v32, v22
  v_add_f32 v33, v33, v23
  v_add_f32 v34, v34, v18
  v_add_f32 v35, v35, v19
  s_waitcnt vmcnt(7)
  v_lshlrev_b32 v22, 16, v108
  v_and_b32 v23, 0xffff0000, v108
  v_lshlrev_b32 v18, 16, v109
  v_and_b32 v19, 0xffff0000, v109
  v_add_f32 v32, v32, v22
  v_add_f32 v33, v33, v23
  v_add_f32 v34, v34, v18
  v_add_f32 v35, v35, v19
  s_waitcnt vmcnt(6)
  v_lshlrev_b32 v22, 16, v112
  v_and_b32 v23, 0xffff0000, v112
  v_lshlrev_b32 v18, 16, v113
  v_and_b32 v19, 0xffff0000, v113
  v_add_f32 v32, v32, v22
  v_add_f32 v33, v33, v23
  v_add_f32 v34, v34, v18
  v_add_f32 v35, v35, v19
  buffer_store_dwordx4 v[32:35], v130, s[28:31], 0 offen sc1
  v_lshlrev_b32 v22, 16, v106
  v_and_b32 v23, 0xffff0000, v106
  v_lshlrev_b32 v18, 16, v107
  v_and_b32 v19, 0xffff0000, v107
  v_add_f32 v68, v68, v22
  v_add_f32 v69, v69, v23
  v_add_f32 v70, v70, v18
  v_add_f32 v71, v71, v19
  v_lshlrev_b32 v22, 16, v110
  v_and_b32 v23, 0xffff0000, v110
  v_lshlrev_b32 v18, 16, v111
  v_and_b32 v19, 0xffff0000, v111
  v_add_f32 v68, v68, v22
  v_add_f32 v69, v69, v23
  v_add_f32 v70, v70, v18
  v_add_f32 v71, v71, v19
  v_lshlrev_b32 v22, 16, v114
  v_and_b32 v23, 0xffff0000, v114
  v_lshlrev_b32 v18, 16, v115
  v_and_b32 v19, 0xffff0000, v115
  v_add_f32 v68, v68, v22
  v_add_f32 v69, v69, v23
  v_add_f32 v70, v70, v18
  v_add_f32 v71, v71, v19
  buffer_store_dwordx4 v[68:71], v138, s[28:31], 0 offen sc1
  s_waitcnt vmcnt(7)
  v_lshlrev_b32 v22, 16, v144
  v_and_b32 v23, 0xffff0000, v144
  v_lshlrev_b32 v18, 16, v145
  v_and_b32 v19, 0xffff0000, v145
  v_add_f32 v36, v36, v22
  v_add_f32 v37, v37, v23
  v_add_f32 v38, v38, v18
  v_add_f32 v39, v39, v19
  s_waitcnt vmcnt(6)
  v_lshlrev_b32 v22, 16, v148
  v_and_b32 v23, 0xffff0000, v148
  v_lshlrev_b32 v18, 16, v149
  v_and_b32 v19, 0xffff0000, v149
  v_add_f32 v36, v36, v22
  v_add_f32 v37, v37, v23
  v_add_f32 v38, v38, v18
  v_add_f32 v39, v39, v19
  s_waitcnt vmcnt(5)
  v_lshlrev_b32 v22, 16, v152
  v_and_b32 v23, 0xffff0000, v152
  v_lshlrev_b32 v18, 16, v153
  v_and_b32 v19, 0xffff0000, v153
  v_add_f32 v36, v36, v22
  v_add_f32 v37, v37, v23
  v_add_f32 v38, v38, v18
  v_add_f32 v39, v39, v19
  buffer_store_dwordx4 v[36:39], v170, s[28:31], 0 offen sc1
  v_lshlrev_b32 v22, 16, v146
  v_and_b32 v23, 0xffff0000, v146
  v_lshlrev_b32 v18, 16, v147
  v_and_b32 v19, 0xffff0000, v147
  v_add_f32 v72, v72, v22
  v_add_f32 v73, v73, v23
  v_add_f32 v74, v74, v18
  v_add_f32 v75, v75, v19
  v_lshlrev_b32 v22, 16, v150
  v_and_b32 v23, 0xffff0000, v150
  v_lshlrev_b32 v18, 16, v151
  v_and_b32 v19, 0xffff0000, v151
  v_add_f32 v72, v72, v22
  v_add_f32 v73, v73, v23
  v_add_f32 v74, v74, v18
  v_add_f32 v75, v75, v19
  v_lshlrev_b32 v22, 16, v154
  v_and_b32 v23, 0xffff0000, v154
  v_lshlrev_b32 v18, 16, v155
  v_and_b32 v19, 0xffff0000, v155
  v_add_f32 v72, v72, v22
  v_add_f32 v73, v73, v23
  v_add_f32 v74, v74, v18
  v_add_f32 v75, v75, v19
  buffer_store_dwordx4 v[72:75], v178, s[28:31], 0 offen sc1
  s_waitcnt vmcnt(6)
  v_lshlrev_b32 v22, 16, v184
  v_and_b32 v23, 0xffff0000, v184
  v_lshlrev_b32 v18, 16, v185
  v_and_b32 v19, 0xffff0000, v185
  v_add_f32 v40, v40, v22
  v_add_f32 v41, v41, v23
  v_add_f32 v42, v42, v18
  v_add_f32 v43, v43, v19
  s_waitcnt vmcnt(5)
  v_lshlrev_b32 v22, 16, v188
  v_and_b32 v23, 0xffff0000, v188
  v_lshlrev_b32 v18, 16, v189
  v_and_b32 v19, 0xffff0000, v189
  v_add_f32 v40, v40, v22
  v_add_f32 v41, v41, v23
  v_add_f32 v42, v42, v18
  v_add_f32 v43, v43, v19
  s_waitcnt vmcnt(4)
  v_lshlrev_b32 v22, 16, v192
  v_and_b32 v23, 0xffff0000, v192
  v_lshlrev_b32 v18, 16, v193
  v_and_b32 v19, 0xffff0000, v193
  v_add_f32 v40, v40, v22
  v_add_f32 v41, v41, v23
  v_add_f32 v42, v42, v18
  v_add_f32 v43, v43, v19
  buffer_store_dwordx4 v[40:43], v210, s[28:31], 0 offen sc1
  v_lshlrev_b32 v22, 16, v186
  v_and_b32 v23, 0xffff0000, v186
  v_lshlrev_b32 v18, 16, v187
  v_and_b32 v19, 0xffff0000, v187
  v_add_f32 v76, v76, v22
  v_add_f32 v77, v77, v23
  v_add_f32 v78, v78, v18
  v_add_f32 v79, v79, v19
  v_lshlrev_b32 v22, 16, v190
  v_and_b32 v23, 0xffff0000, v190
  v_lshlrev_b32 v18, 16, v191
  v_and_b32 v19, 0xffff0000, v191
  v_add_f32 v76, v76, v22
  v_add_f32 v77, v77, v23
  v_add_f32 v78, v78, v18
  v_add_f32 v79, v79, v19
  v_lshlrev_b32 v22, 16, v194
  v_and_b32 v23, 0xffff0000, v194
  v_lshlrev_b32 v18, 16, v195
  v_and_b32 v19, 0xffff0000, v195
  v_add_f32 v76, v76, v22
  v_add_f32 v77, v77, v23
  v_add_f32 v78, v78, v18
  v_add_f32 v79, v79, v19
  buffer_store_dwordx4 v[76:79], v218, s[28:31], 0 offen sc1
  s_endpgm
KERNEL_END:
.section .rodata,"a"
.p2align 6
.amdhsa_kernel gated_mix__ssm_conv_s5__glu_gated_reglu__prompt_kernel
  .amdhsa_next_free_vgpr 512
  .amdhsa_next_free_sgpr 102
  .amdhsa_accum_offset 256
  .amdhsa_group_segment_fixed_size 0
  .amdhsa_kernarg_size 136
  .amdhsa_user_sgpr_count 2
  .amdhsa_user_sgpr_kernarg_segment_ptr 1
  .amdhsa_system_sgpr_workgroup_id_x 1
.end_amdhsa_kernel
```
